```python
import torch

def _softmax(x, axis=-1):
    return torch.softmax(x, dim=axis)
def _gelu(x):
    return torch.nn.functional.gelu(x, approximate="tanh")
def _silu(x):
    return torch.nn.functional.silu(x)
def _sigmoid(x):
    return torch.sigmoid(x)
def _layernorm(x, axis=-1, eps=1e-5):
    m = x.mean(dim=axis, keepdim=True)
    v = x.var(dim=axis, keepdim=True, unbiased=False)
    return (x - m) / torch.sqrt(v + eps)
def _scatter_add(tgt, idx, src, axis=0):
    return tgt.clone().index_add_(axis, idx, src)
def _segment_sum(src, seg, n):
    out = torch.zeros((n,) + src.shape[1:], dtype=src.dtype)
    return out.index_add_(0, seg, src)
def _pad(x, pw):
    flat = tuple(v for pair in reversed(pw) for v in pair)
    return torch.nn.functional.pad(x, flat)

kernel_name = 'gated_mix__compressed_kv_cla__moe_arch_mod__prompt'

def setup_inputs():

    _w = (lambda a: (lambda t: t.to(torch.bfloat16) if t.is_floating_point() else t)(torch.as_tensor(a)))
    def _A_setup():
        B, H, Sq, Sk, D, M = 1, 32, 2048, 2048, 128, 576
        Dc = 4 * D
        return {
            "x": _w((lambda *s: torch.randn(*s, dtype=torch.bfloat16) * 0.05)(B, Sq, M)),
            "c_kv": _w((lambda *s: torch.randn(*s, dtype=torch.bfloat16) * 0.8)(B, Sk, Dc)),
            "w_q": _w((lambda *s: torch.randn(*s, dtype=torch.bfloat16) * 6.4)(M, H, D) * (M ** -0.5)),
            "w_uk": _w((lambda *s: torch.randn(*s, dtype=torch.bfloat16) * 6.4)(Dc, H, D) * (Dc ** -0.5)),
            "w_uv": _w((lambda *s: torch.randn(*s, dtype=torch.bfloat16) * 0.8)(Dc, H, D) * (Dc ** -0.5)),
            "w_o": _w((lambda *s: torch.randn(*s, dtype=torch.bfloat16) * 0.8)(H, D, M) * ((H * D) ** -0.5)),
        }
    _A_in = _A_setup()

    def _B_setup():
        B, S, D, F, C = 1, 2048, 576, 4608, 1
        return {
            "x": _w((lambda *s: torch.randn(*s, dtype=torch.bfloat16) * 0.05)(B, S, D)),
            "w_r": _w((lambda *s: torch.randn(*s, dtype=torch.bfloat16) * 3.2)(D)),
            "w_gate": _w((lambda *s: torch.randn(*s, dtype=torch.bfloat16) * 0.2)(D, F)),
            "w_up": _w((lambda *s: torch.randn(*s, dtype=torch.bfloat16) * 0.2)(D, F)),
            "w_down": _w((lambda *s: torch.randn(*s, dtype=torch.bfloat16) * 0.2)(F, D)),
        }
    _B_in = _B_setup()

    return {
        "A_x": _A_in["x"],
        "A_c_kv": _A_in["c_kv"],
        "A_w_q": _A_in["w_q"],
        "A_w_uk": _A_in["w_uk"],
        "A_w_uv": _A_in["w_uv"],
        "A_w_o": _A_in["w_o"],
        "B_x": _B_in["x"],
        "B_w_r": _B_in["w_r"],
        "B_w_gate": _B_in["w_gate"],
        "B_w_up": _B_in["w_up"],
        "B_w_down": _B_in["w_down"],
        "gate_w": _w((lambda *s: torch.randn(*s, dtype=torch.bfloat16) * 0.05)(576) * 16.0),
    }

def reference(A_x, A_c_kv, A_w_q, A_w_uk, A_w_uv, A_w_o, B_x, B_w_r, B_w_gate, B_w_up, B_w_down, gate_w):
    def _A_ref(x, c_kv, w_q, w_uk, w_uv, w_o):
        B, Sq, M = x.shape[0], x.shape[1], x.shape[2]
        Sk = c_kv.shape[1]
        H, D = w_q.shape[1], w_q.shape[2]
        q = torch.einsum("bqm,mhd->bhqd", x, w_q)
        k = torch.einsum("bkc,chd->bhkd", c_kv, w_uk)
        v = torch.einsum("bkc,chd->bhkd", c_kv, w_uv)
        scores = torch.einsum("bhqd,bhkd->bhqk", q, k) * (D ** -0.5)
        off = Sk - Sq
        qi = torch.arange(Sq)[:, None]
        kj = torch.arange(Sk)[None, :]
        cmask = kj <= (qi + off)
        scores = torch.where(cmask[None, None], scores, -1e9)
        p = _softmax(scores, axis=-1)
        ctx = torch.einsum("bhqk,bhkd->bhqd", p, v)
        return torch.einsum("bhqd,hdm->bqm", ctx, w_o)

    def _B_ref(x, w_r, w_gate, w_up, w_down):
        B, S, D = x.shape
        C = 1
        r = x @ w_r
        idx = torch.argsort(-r, axis=-1)[:, :C]
        idx_e = (lambda x, n, axis: torch.repeat_interleave(x, n, dim=axis))(idx.reshape(B, C, 1), D, axis=2)
        x_sel = (lambda x, i, axis: torch.take_along_dim(x, i, dim=axis))(x, idx_e, axis=1)
        g = _silu(x_sel @ w_gate)
        u = x_sel @ w_up
        y = (g * u) @ w_down
        r_sel = _sigmoid((lambda x, i, axis: torch.take_along_dim(x, i, dim=axis))(r, idx, axis=1))
        y = y * r_sel.reshape(B, C, 1)
        b_off = (torch.arange(B) * S).reshape(B, 1)
        flat_idx = (idx + b_off).reshape(B * C)
        zero = (x * 0.0).reshape(B * S, D)
        upd = _scatter_add(zero, flat_idx, y.reshape(B * C, D), axis=0)
        return x + upd.reshape(B, S, D)

    x = A_x
    g = _sigmoid((x * gate_w).sum(-1, keepdims=True))
    a = _A_ref(x, A_c_kv, A_w_q, A_w_uk, A_w_uv, A_w_o)
    b = _B_ref(x, B_w_r, B_w_gate, B_w_up, B_w_down)
    return g * a + (1 - g) * b
```

```asm
; @launch grid=(256,1,1) block=(256,1,1) lds=163840
.amdgcn_target "amdgcn-amd-amdhsa--gfx950"
.text
.globl gated_mix__compressed_kv_cla__moe_arch_mod__prompt_kernel
.p2align 8
.type gated_mix__compressed_kv_cla__moe_arch_mod__prompt_kernel,@function
gated_mix__compressed_kv_cla__moe_arch_mod__prompt_kernel:
  s_cmp_ge_u32 s2, 256
  s_cbranch_scc1 L_end
  s_load_dwordx16 s[40:55], s[0:1], 0
  s_load_dwordx8 s[56:63], s[0:1], 64
  s_load_dwordx4 s[64:67], s[0:1], 96
  s_load_dwordx2 s[68:69], s[0:1], 112
  v_lshrrev_b32 v21, 6, v0
  v_and_b32 v1, 63, v0
  v_readfirstlane_b32 s34, v21
  v_lshlrev_b32 v2, 4, v1
  s_getpc_b64 s[92:93]
L_pc:
  v_min_u32 v21, 6, v1
  s_lshr_b32 s73, s2, 3
  s_lshl_b32 s73, s73, 2
  s_add_u32 s73, s73, s34
  s_mul_i32 s73, s73, 7
  v_add_u32 v21, s73, v21
  v_lshlrev_b32 v21, 7, v21
  v_add_u32 v21, L_pc-L_pc, v21
  v_min_u32 v21, L_code_end-L_pc-4, v21
  v_and_b32 v21, -4, v21
  global_load_dword v30, v21, s[92:93]
  s_and_b32 s35, s2, 7
  s_lshl_b32 s35, s35, 2
  s_lshr_b32 s70, s2, 3
  s_and_b32 s70, s70, 3
  s_add_u32 s35, s35, s70
  s_lshr_b32 s36, s2, 5
  s_lshl_b32 s39, s36, 2
  s_add_u32 s37, s39, s34
  s_sub_u32 s38, 63, s37
  v_lshrrev_b32 v21, 3, v1
  v_lshrrev_b32 v22, 4, v1
  v_and_b32 v23, 7, v1
  v_xor_b32 v23, v23, v22
  v_lshlrev_b32 v23, 4, v23
  v_lshl_add_u32 v3, v21, 10, v23
  v_xor_b32 v4, 64, v3
  v_and_b32 v21, 15, v1
  v_lshrrev_b32 v23, 1, v21
  v_xor_b32 v23, v23, v22
  v_lshlrev_b32 v23, 5, v23
  v_and_b32 v24, 1, v1
  v_lshl_add_u32 v23, v24, 4, v23
  v_lshl_add_u32 v7, v22, 13, v23
  v_xor_b32 v8, 0x80, v7
  s_and_b32 s70, s34, 1
  s_lshl_b32 s70, s70, 2
  s_lshr_b32 s71, s34, 1
  s_add_u32 s70, s70, s71
  s_lshl_b32 s70, s70, 3
  s_add_u32 s70, s70, s36
  s_lshl_b32 s74, s70, 15
  s_add_u32 s75, s74, 524288
  s_lshl_b32 s70, s35, 8
  s_and_b32 s71, s34, 1
  s_lshl_b32 s71, s71, 17
  s_add_u32 s78, s70, s71
  s_lshl_b32 s71, s34, 17
  s_add_u32 s79, s70, s71
  s_lshl_b32 s80, s34, 13
  s_lshl_b32 s81, s34, 12
  s_add_u32 s81, s81, 98304
  s_mov_b32 s6, 2097152
  s_mov_b32 s7, 0x20000
  s_mov_b32 s10, 4194304
  s_mov_b32 s11, 0x20000
  s_cmp_lt_u32 s34, 2
  s_waitcnt lgkmcnt(0)
  s_mov_b32 s4, s42
  s_mov_b32 s5, s43
  s_cselect_b32 s8, s46, s48
  s_cselect_b32 s9, s47, s49
  s_mov_b32 s20, s68
  s_mov_b32 s21, s69
  s_mov_b32 s22, 83886080
  s_mov_b32 s23, 0x20000
  s_cmp_lt_u32 s2, 7
  s_cbranch_scc0 L_1
  s_lshl_b32 s70, s2, 12
  s_lshl_b32 s71, s34, 10
  s_add_u32 s70, s70, s71
  s_add_u32 s70, s70, 58195968
  s_lshl_b32 s71, s34, 13
  s_add_u32 s71, s71, 58228736
  s_cmp_eq_u32 s2, 6
  s_cselect_b32 s70, s71, s70
  s_cselect_b32 s71, 7, 4
  v_lshlrev_b32 v36, s71, v1
  v_mov_b32 v32, 0
  v_mov_b32 v33, 0
  v_mov_b32 v34, 0
  v_mov_b32 v35, 0
  buffer_store_dwordx4 v[32:35], v36, s[20:23], s70 offen sc1
L_1:
  s_add_u32 s70, s74, 0
  s_add_u32 m0, s80, 0
  s_nop 0
  buffer_load_dwordx4 v3, s[4:7], s70 offen  lds
  s_add_u32 s70, s74, 8192
  s_add_u32 m0, s80, 1024
  s_nop 0
  buffer_load_dwordx4 v4, s[4:7], s70 offen  lds
  s_add_u32 s70, s74, 16384
  s_add_u32 m0, s80, 2048
  s_nop 0
  buffer_load_dwordx4 v3, s[4:7], s70 offen  lds
  s_add_u32 s70, s74, 24576
  s_add_u32 m0, s80, 3072
  s_nop 0
  buffer_load_dwordx4 v4, s[4:7], s70 offen  lds
  s_add_u32 s70, s75, 0
  s_add_u32 m0, s80, 4096
  s_nop 0
  buffer_load_dwordx4 v3, s[4:7], s70 offen  lds
  s_add_u32 s70, s75, 8192
  s_add_u32 m0, s80, 5120
  s_nop 0
  buffer_load_dwordx4 v4, s[4:7], s70 offen  lds
  s_add_u32 s70, s75, 16384
  s_add_u32 m0, s80, 6144
  s_nop 0
  buffer_load_dwordx4 v3, s[4:7], s70 offen  lds
  s_add_u32 s70, s75, 24576
  s_add_u32 m0, s80, 7168
  s_nop 0
  buffer_load_dwordx4 v4, s[4:7], s70 offen  lds
  s_add_u32 s70, s78, 0
  s_add_u32 m0, s81, 0
  s_nop 0
  buffer_load_dwordx4 v7, s[8:11], s70 offen  lds
  s_add_u32 s70, s78, 32768
  s_add_u32 m0, s81, 1024
  s_nop 0
  buffer_load_dwordx4 v7, s[8:11], s70 offen  lds
  s_add_u32 s70, s78, 65536
  s_add_u32 m0, s81, 2048
  s_nop 0
  buffer_load_dwordx4 v8, s[8:11], s70 offen  lds
  s_add_u32 s70, s78, 98304
  s_add_u32 m0, s81, 3072
  s_nop 0
  buffer_load_dwordx4 v8, s[8:11], s70 offen  lds
  s_add_u32 s70, s78, 262144
  s_add_u32 m0, s81, 16384
  s_nop 0
  buffer_load_dwordx4 v7, s[8:11], s70 offen  lds
  s_add_u32 s70, s78, 294912
  s_add_u32 m0, s81, 17408
  s_nop 0
  buffer_load_dwordx4 v7, s[8:11], s70 offen  lds
  s_add_u32 s70, s78, 327680
  s_add_u32 m0, s81, 18432
  s_nop 0
  buffer_load_dwordx4 v8, s[8:11], s70 offen  lds
  s_add_u32 s70, s78, 360448
  s_add_u32 m0, s81, 19456
  s_nop 0
  buffer_load_dwordx4 v8, s[8:11], s70 offen  lds
  s_add_u32 s70, s74, 128
  s_add_u32 m0, s80, 32768
  s_nop 0
  buffer_load_dwordx4 v3, s[4:7], s70 offen  lds
  s_add_u32 s70, s74, 8320
  s_add_u32 m0, s80, 33792
  s_nop 0
  buffer_load_dwordx4 v4, s[4:7], s70 offen  lds
  s_add_u32 s70, s74, 16512
  s_add_u32 m0, s80, 34816
  s_nop 0
  buffer_load_dwordx4 v3, s[4:7], s70 offen  lds
  s_add_u32 s70, s74, 24704
  s_add_u32 m0, s80, 35840
  s_nop 0
  buffer_load_dwordx4 v4, s[4:7], s70 offen  lds
  s_add_u32 s70, s75, 128
  s_add_u32 m0, s80, 36864
  s_nop 0
  buffer_load_dwordx4 v3, s[4:7], s70 offen  lds
  s_add_u32 s70, s75, 8320
  s_add_u32 m0, s80, 37888
  s_nop 0
  buffer_load_dwordx4 v4, s[4:7], s70 offen  lds
  s_add_u32 s70, s75, 16512
  s_add_u32 m0, s80, 38912
  s_nop 0
  buffer_load_dwordx4 v3, s[4:7], s70 offen  lds
  s_add_u32 s70, s75, 24704
  s_add_u32 m0, s80, 39936
  s_nop 0
  buffer_load_dwordx4 v4, s[4:7], s70 offen  lds
  s_add_u32 s70, s78, 524288
  s_add_u32 m0, s81, 32768
  s_nop 0
  buffer_load_dwordx4 v7, s[8:11], s70 offen  lds
  s_add_u32 s70, s78, 557056
  s_add_u32 m0, s81, 33792
  s_nop 0
  buffer_load_dwordx4 v7, s[8:11], s70 offen  lds
  s_add_u32 s70, s78, 589824
  s_add_u32 m0, s81, 34816
  s_nop 0
  buffer_load_dwordx4 v8, s[8:11], s70 offen  lds
  s_add_u32 s70, s78, 622592
  s_add_u32 m0, s81, 35840
  s_nop 0
  buffer_load_dwordx4 v8, s[8:11], s70 offen  lds
  v_lshrrev_b32 v23, 1, v21
  v_xor_b32 v23, v23, v22
  v_lshlrev_b32 v23, 4, v23
  v_lshl_add_u32 v23, v21, 7, v23
  s_and_b32 s70, s34, 1
  s_lshl_b32 s70, s70, 14
  v_add_u32 v9, s70, v23
  v_xor_b32 v10, 64, v9
  v_add_u32 v11, 0x10000, v9
  v_add_u32 v12, 0x10000, v10
  v_lshrrev_b32 v23, 2, v21
  v_lshl_add_u32 v24, v22, 3, v23
  v_lshlrev_b32 v24, 8, v24
  v_and_b32 v25, 1, v22
  v_lshl_add_u32 v23, v25, 2, v23
  v_lshl_add_u32 v24, v23, 5, v24
  v_and_b32 v23, 3, v21
  v_lshl_add_u32 v24, v23, 3, v24
  v_add_u32 v13, 98304, v24
  v_xor_b32 v14, 32, v13
  v_xor_b32 v15, 64, v13
  v_xor_b32 v16, 96, v13
  v_xor_b32 v17, 128, v13
  v_xor_b32 v18, 160, v13
  v_xor_b32 v19, 192, v13
  v_xor_b32 v20, 224, v13
  s_mov_b32 s12, s40
  s_mov_b32 s13, s41
  s_mov_b32 s14, 2359296
  s_mov_b32 s15, 0x20000
  s_mov_b32 s16, s44
  s_mov_b32 s17, s45
  s_mov_b32 s18, 4718592
  s_mov_b32 s19, 0x20000
  s_mov_b32 s24, s54
  s_mov_b32 s25, s55
  s_mov_b32 s26, 1152
  s_mov_b32 s27, 0x20000
  s_mov_b32 s28, s62
  s_mov_b32 s29, s63
  s_mov_b32 s30, 1152
  s_mov_b32 s31, 0x20000
  s_mul_i32 s76, s37, 36864
  s_mul_i32 s77, s38, 36864
  s_lshl_b32 s82, s35, 20
  s_lshl_b32 s70, s36, 14
  s_add_u32 s82, s82, s70
  s_and_b32 s70, s34, 1
  s_lshl_b32 s70, s70, 17
  s_add_u32 s82, s82, s70
  s_lshr_b32 s70, s34, 1
  s_lshl_b32 s70, s70, 13
  s_add_u32 s82, s82, s70
  s_add_u32 s82, s82, 65536
  s_lshl_b32 s89, s2, 4
  s_lshl_b32 s70, s34, 2
  s_add_u32 s89, s89, s70
  s_add_u32 s89, s89, 58195968
  s_and_b32 s100, s2, 31
  s_lshl_b32 s100, s100, 7
  s_lshl_b32 s71, s36, 4
  s_add_u32 s100, s100, s71
  s_add_u32 s100, s100, s70
  s_add_u32 s100, s100, 58195968
  s_getreg_b32 s101, hwreg(HW_REG_XCC_ID, 0, 4)
  s_add_u32 s101, s101, 1
  s_cmp_lt_u32 s34, 2
  s_cbranch_scc0 L_phaseA_V
  s_waitcnt vmcnt(16)
  s_barrier
  ds_read_b128 a[64:67], v9 offset:0
  ds_read_b64_tr_b16 a[32:33], v13 offset:0
  ds_read_b64_tr_b16 a[34:35], v13 offset:1024
  ds_read_b128 a[68:71], v9 offset:2048
  ds_read_b64_tr_b16 a[36:37], v14 offset:0
  ds_read_b64_tr_b16 a[38:39], v14 offset:1024
  ds_read_b128 a[72:75], v9 offset:4096
  ds_read_b64_tr_b16 a[40:41], v15 offset:0
  ds_read_b64_tr_b16 a[42:43], v15 offset:1024
  ds_read_b128 a[76:79], v9 offset:6144
  ds_read_b64_tr_b16 a[44:45], v16 offset:0
  ds_read_b64_tr_b16 a[46:47], v16 offset:1024
  ds_read_b128 a[80:83], v9 offset:8192
  ds_read_b64_tr_b16 a[48:49], v17 offset:0
  ds_read_b64_tr_b16 a[50:51], v17 offset:1024
  ds_read_b128 a[84:87], v9 offset:10240
  ds_read_b64_tr_b16 a[52:53], v18 offset:0
  ds_read_b64_tr_b16 a[54:55], v18 offset:1024
  ds_read_b128 a[88:91], v9 offset:12288
  ds_read_b64_tr_b16 a[56:57], v19 offset:0
  ds_read_b64_tr_b16 a[58:59], v19 offset:1024
  ds_read_b128 a[92:95], v9 offset:14336
  ds_read_b64_tr_b16 a[60:61], v20 offset:0
  ds_read_b64_tr_b16 a[62:63], v20 offset:1024
  s_cmp_lt_u32 s2, 7
  s_cbranch_scc0 L_2
  s_lshl_b32 s70, s2, 4
  s_lshl_b32 s71, s34, 2
  s_add_u32 s70, s70, s71
  v_mov_b32 v21, 1
  v_mov_b32 v22, s70
  s_mov_b64 exec, 1
  global_store_dword v22, v21, s[66:67] sc1
  s_mov_b64 exec, -1
L_2:
  s_waitcnt vmcnt(12) lgkmcnt(0)
  s_barrier
  v_mfma_f32_16x16x32_bf16 v[96:99], a[32:35], a[64:67], 0
  s_add_u32 s70, s78, 786432
  ds_read_b128 a[128:131], v10 offset:0
  v_mfma_f32_16x16x32_bf16 v[128:131], a[32:35], a[68:71], 0
  s_add_u32 m0, s81, 49152
  ds_read_b64_tr_b16 a[96:97], v13 offset:16384
  v_mfma_f32_16x16x32_bf16 v[160:163], a[32:35], a[72:75], 0
  buffer_load_dwordx4 v7, s[8:11], s70 offen  lds
  v_mfma_f32_16x16x32_bf16 v[192:195], a[32:35], a[76:79], 0
  v_mfma_f32_16x16x32_bf16 v[224:227], a[32:35], a[80:83], 0
  s_add_u32 s70, s78, 819200
  ds_read_b64_tr_b16 a[98:99], v13 offset:17408
  v_mfma_f32_16x16x32_bf16 v[88:91], a[32:35], a[84:87], 0
  s_add_u32 m0, s81, 50176
  v_mfma_f32_16x16x32_bf16 v[56:59], a[32:35], a[88:91], 0
  buffer_load_dwordx4 v7, s[8:11], s70 offen  lds
  v_mfma_f32_16x16x32_bf16 a[0:3], a[32:35], a[92:95], 0
  ds_read_b128 a[132:135], v10 offset:2048
  v_mfma_f32_16x16x32_bf16 a[4:7], a[36:39], a[92:95], 0
  s_add_u32 s70, s78, 851968
  v_mfma_f32_16x16x32_bf16 v[60:63], a[36:39], a[88:91], 0
  s_add_u32 m0, s81, 51200
  ds_read_b64_tr_b16 a[100:101], v14 offset:16384
  v_mfma_f32_16x16x32_bf16 v[92:95], a[36:39], a[84:87], 0
  buffer_load_dwordx4 v8, s[8:11], s70 offen  lds
  v_mfma_f32_16x16x32_bf16 v[228:231], a[36:39], a[80:83], 0
  ds_read_b64_tr_b16 a[102:103], v14 offset:17408
  v_mfma_f32_16x16x32_bf16 v[196:199], a[36:39], a[76:79], 0
  s_add_u32 s70, s78, 884736
  v_mfma_f32_16x16x32_bf16 v[164:167], a[36:39], a[72:75], 0
  s_add_u32 m0, s81, 52224
  ds_read_b128 a[136:139], v10 offset:4096
  v_mfma_f32_16x16x32_bf16 v[132:135], a[36:39], a[68:71], 0
  buffer_load_dwordx4 v8, s[8:11], s70 offen  lds
  v_mfma_f32_16x16x32_bf16 v[100:103], a[36:39], a[64:67], 0
  v_mfma_f32_16x16x32_bf16 v[104:107], a[40:43], a[64:67], 0
  s_add_u32 s70, s74, 256
  ds_read_b64_tr_b16 a[104:105], v15 offset:16384
  v_mfma_f32_16x16x32_bf16 v[136:139], a[40:43], a[68:71], 0
  s_add_u32 m0, s80, 65536
  v_mfma_f32_16x16x32_bf16 v[168:171], a[40:43], a[72:75], 0
  buffer_load_dwordx4 v3, s[4:7], s70 offen  lds
  v_mfma_f32_16x16x32_bf16 v[200:203], a[40:43], a[76:79], 0
  ds_read_b64_tr_b16 a[106:107], v15 offset:17408
  v_mfma_f32_16x16x32_bf16 v[232:235], a[40:43], a[80:83], 0
  s_add_u32 s70, s74, 8448
  ds_read_b128 a[140:143], v10 offset:6144
  v_mfma_f32_16x16x32_bf16 v[80:83], a[40:43], a[84:87], 0
  s_add_u32 m0, s80, 66560
  v_mfma_f32_16x16x32_bf16 v[48:51], a[40:43], a[88:91], 0
  buffer_load_dwordx4 v4, s[4:7], s70 offen  lds
  v_mfma_f32_16x16x32_bf16 a[8:11], a[40:43], a[92:95], 0
  ds_read_b64_tr_b16 a[108:109], v16 offset:16384
  v_mfma_f32_16x16x32_bf16 a[12:15], a[44:47], a[92:95], 0
  s_add_u32 s70, s74, 16640
  v_mfma_f32_16x16x32_bf16 v[52:55], a[44:47], a[88:91], 0
  s_add_u32 m0, s80, 67584
  ds_read_b64_tr_b16 a[110:111], v16 offset:17408
  v_mfma_f32_16x16x32_bf16 v[84:87], a[44:47], a[84:87], 0
  buffer_load_dwordx4 v3, s[4:7], s70 offen  lds
  v_mfma_f32_16x16x32_bf16 v[236:239], a[44:47], a[80:83], 0
  v_mfma_f32_16x16x32_bf16 v[204:207], a[44:47], a[76:79], 0
  s_add_u32 s70, s74, 24832
  ds_read_b128 a[144:147], v10 offset:8192
  v_mfma_f32_16x16x32_bf16 v[172:175], a[44:47], a[72:75], 0
  s_add_u32 m0, s80, 68608
  ds_read_b64_tr_b16 a[112:113], v17 offset:16384
  v_mfma_f32_16x16x32_bf16 v[140:143], a[44:47], a[68:71], 0
  buffer_load_dwordx4 v4, s[4:7], s70 offen  lds
  v_mfma_f32_16x16x32_bf16 v[108:111], a[44:47], a[64:67], 0
  v_mfma_f32_16x16x32_bf16 v[112:115], a[48:51], a[64:67], 0
  s_add_u32 s70, s75, 256
  ds_read_b64_tr_b16 a[114:115], v17 offset:17408
  v_mfma_f32_16x16x32_bf16 v[144:147], a[48:51], a[68:71], 0
  s_add_u32 m0, s80, 69632
  v_mfma_f32_16x16x32_bf16 v[176:179], a[48:51], a[72:75], 0
  buffer_load_dwordx4 v3, s[4:7], s70 offen  lds
  v_mfma_f32_16x16x32_bf16 v[208:211], a[48:51], a[76:79], 0
  ds_read_b128 a[148:151], v10 offset:10240
  v_mfma_f32_16x16x32_bf16 v[240:243], a[48:51], a[80:83], 0
  s_add_u32 s70, s78, 1048576
  v_mfma_f32_16x16x32_bf16 v[72:75], a[48:51], a[84:87], 0
  s_add_u32 m0, s81, 0
  ds_read_b64_tr_b16 a[116:117], v18 offset:16384
  v_mfma_f32_16x16x32_bf16 v[40:43], a[48:51], a[88:91], 0
  buffer_load_dwordx4 v7, s[8:11], s70 offen  lds
  v_mfma_f32_16x16x32_bf16 a[16:19], a[48:51], a[92:95], 0
  ds_read_b64_tr_b16 a[118:119], v18 offset:17408
  v_mfma_f32_16x16x32_bf16 a[20:23], a[52:55], a[92:95], 0
  s_add_u32 s70, s75, 8448
  v_mfma_f32_16x16x32_bf16 v[44:47], a[52:55], a[88:91], 0
  s_add_u32 m0, s80, 70656
  ds_read_b128 a[152:155], v10 offset:12288
  v_mfma_f32_16x16x32_bf16 v[76:79], a[52:55], a[84:87], 0
  buffer_load_dwordx4 v4, s[4:7], s70 offen  lds
  v_mfma_f32_16x16x32_bf16 v[244:247], a[52:55], a[80:83], 0
  v_mfma_f32_16x16x32_bf16 v[212:215], a[52:55], a[76:79], 0
  s_add_u32 s70, s78, 1081344
  ds_read_b64_tr_b16 a[120:121], v19 offset:16384
  v_mfma_f32_16x16x32_bf16 v[180:183], a[52:55], a[72:75], 0
  s_add_u32 m0, s81, 1024
  v_mfma_f32_16x16x32_bf16 v[148:151], a[52:55], a[68:71], 0
  buffer_load_dwordx4 v7, s[8:11], s70 offen  lds
  v_mfma_f32_16x16x32_bf16 v[116:119], a[52:55], a[64:67], 0
  ds_read_b64_tr_b16 a[122:123], v19 offset:17408
  v_mfma_f32_16x16x32_bf16 v[120:123], a[56:59], a[64:67], 0
  s_add_u32 s70, s75, 16640
  ds_read_b128 a[156:159], v10 offset:14336
  v_mfma_f32_16x16x32_bf16 v[152:155], a[56:59], a[68:71], 0
  s_add_u32 m0, s80, 71680
  v_mfma_f32_16x16x32_bf16 v[184:187], a[56:59], a[72:75], 0
  buffer_load_dwordx4 v3, s[4:7], s70 offen  lds
  v_mfma_f32_16x16x32_bf16 v[216:219], a[56:59], a[76:79], 0
  ds_read_b64_tr_b16 a[124:125], v20 offset:16384
  v_mfma_f32_16x16x32_bf16 v[248:251], a[56:59], a[80:83], 0
  s_add_u32 s70, s78, 1114112
  v_mfma_f32_16x16x32_bf16 v[64:67], a[56:59], a[84:87], 0
  s_add_u32 m0, s81, 2048
  ds_read_b64_tr_b16 a[126:127], v20 offset:17408
  v_mfma_f32_16x16x32_bf16 v[32:35], a[56:59], a[88:91], 0
  buffer_load_dwordx4 v8, s[8:11], s70 offen  lds
  v_mfma_f32_16x16x32_bf16 a[24:27], a[56:59], a[92:95], 0
  v_mfma_f32_16x16x32_bf16 a[28:31], a[60:63], a[92:95], 0
  s_add_u32 s70, s75, 24832
  v_mfma_f32_16x16x32_bf16 v[36:39], a[60:63], a[88:91], 0
  s_add_u32 m0, s80, 72704
  v_mfma_f32_16x16x32_bf16 v[68:71], a[60:63], a[84:87], 0
  buffer_load_dwordx4 v4, s[4:7], s70 offen  lds
  v_mfma_f32_16x16x32_bf16 v[252:255], a[60:63], a[80:83], 0
  v_mfma_f32_16x16x32_bf16 v[220:223], a[60:63], a[76:79], 0
  s_add_u32 s70, s78, 1146880
  v_mfma_f32_16x16x32_bf16 v[188:191], a[60:63], a[72:75], 0
  s_add_u32 m0, s81, 3072
  v_mfma_f32_16x16x32_bf16 v[156:159], a[60:63], a[68:71], 0
  buffer_load_dwordx4 v8, s[8:11], s70 offen  lds
  s_waitcnt vmcnt(16) lgkmcnt(0)
  v_mfma_f32_16x16x32_bf16 v[124:127], a[60:63], a[64:67], 0
  s_barrier
  v_mfma_f32_16x16x32_bf16 v[96:99], a[96:99], a[128:131], v[96:99]
  s_bfe_u32 s71, s2, 0x10001
  s_lshl_b32 s71, s71, 3
  ds_read_b128 a[64:67], v9 offset:32768
  v_mfma_f32_16x16x32_bf16 v[128:131], a[96:99], a[132:135], v[128:131]
  v_and_b32 v21, 15, v1
  v_mfma_f32_16x16x32_bf16 v[160:163], a[96:99], a[136:139], v[160:163]
  ds_read_b64_tr_b16 a[32:33], v13 offset:32768
  v_lshrrev_b32 v22, 4, v1
  v_mfma_f32_16x16x32_bf16 v[192:195], a[96:99], a[140:143], v[192:195]
  s_add_u32 s70, s74, 384
  v_lshlrev_b32 v22, 3, v22
  v_mfma_f32_16x16x32_bf16 v[224:227], a[96:99], a[144:147], v[224:227]
  s_add_u32 m0, s80, 0
  ds_read_b64_tr_b16 a[34:35], v13 offset:33792
  v_sub_u32 v21, v21, v22
  v_mfma_f32_16x16x32_bf16 v[88:91], a[96:99], a[148:151], v[88:91]
  buffer_load_dwordx4 v3, s[4:7], s70 offen  lds
  v_mfma_f32_16x16x32_bf16 v[56:59], a[96:99], a[152:155], v[56:59]
  v_and_b32 v22, 1, v21
  v_mfma_f32_16x16x32_bf16 a[0:3], a[96:99], a[156:159], a[0:3]
  ds_read_b128 a[68:71], v9 offset:34816
  v_lshlrev_b32 v22, 4, v22
  v_mfma_f32_16x16x32_bf16 a[4:7], a[100:103], a[156:159], a[4:7]
  v_mov_b32 v23, 0x3f80
  v_mfma_f32_16x16x32_bf16 v[60:63], a[100:103], a[152:155], v[60:63]
  ds_read_b64_tr_b16 a[36:37], v14 offset:32768
  v_lshlrev_b32 v22, v22, v23
  v_mfma_f32_16x16x32_bf16 v[92:95], a[100:103], a[148:151], v[92:95]
  s_add_u32 s70, s78, 1310720
  v_ashrrev_i32 v21, 1, v21
  v_mfma_f32_16x16x32_bf16 v[228:231], a[100:103], a[144:147], v[228:231]
  s_add_u32 m0, s81, 16384
  ds_read_b64_tr_b16 a[38:39], v14 offset:33792
  v_cmp_eq_u32 vcc, 0, v21
  v_mfma_f32_16x16x32_bf16 v[196:199], a[100:103], a[140:143], v[196:199]
  s_nop 0
  buffer_load_dwordx4 v7, s[8:11], s70 offen  lds
  v_mfma_f32_16x16x32_bf16 v[164:167], a[100:103], a[136:139], v[164:167]
  v_cndmask_b32 v23, 0, v22, vcc
  v_mfma_f32_16x16x32_bf16 v[132:135], a[100:103], a[132:135], v[132:135]
  ds_read_b128 a[72:75], v9 offset:36864
  v_accvgpr_write_b32 a220, v23
  v_mfma_f32_16x16x32_bf16 v[100:103], a[100:103], a[128:131], v[100:103]
  v_cmp_eq_u32 vcc, 1, v21
  v_mfma_f32_16x16x32_bf16 v[104:107], a[104:107], a[128:131], v[104:107]
  s_nop 0
  ds_read_b64_tr_b16 a[40:41], v15 offset:32768
  v_cndmask_b32 v23, 0, v22, vcc
  v_mfma_f32_16x16x32_bf16 v[136:139], a[104:107], a[132:135], v[136:139]
  s_add_u32 s70, s74, 8576
  v_accvgpr_write_b32 a221, v23
  v_mfma_f32_16x16x32_bf16 v[168:171], a[104:107], a[136:139], v[168:171]
  s_add_u32 m0, s80, 1024
  ds_read_b64_tr_b16 a[42:43], v15 offset:33792
  v_cmp_eq_u32 vcc, 2, v21
  v_mfma_f32_16x16x32_bf16 v[200:203], a[104:107], a[140:143], v[200:203]
  s_nop 0
  buffer_load_dwordx4 v4, s[4:7], s70 offen  lds
  v_mfma_f32_16x16x32_bf16 v[232:235], a[104:107], a[144:147], v[232:235]
  v_cndmask_b32 v23, 0, v22, vcc
  v_mfma_f32_16x16x32_bf16 v[80:83], a[104:107], a[148:151], v[80:83]
  ds_read_b128 a[76:79], v9 offset:38912
  v_accvgpr_write_b32 a222, v23
  v_mfma_f32_16x16x32_bf16 v[48:51], a[104:107], a[152:155], v[48:51]
  v_cmp_eq_u32 vcc, 3, v21
  v_mfma_f32_16x16x32_bf16 a[8:11], a[104:107], a[156:159], a[8:11]
  s_nop 0
  ds_read_b64_tr_b16 a[44:45], v16 offset:32768
  v_cndmask_b32 v23, 0, v22, vcc
  v_mfma_f32_16x16x32_bf16 a[12:15], a[108:111], a[156:159], a[12:15]
  s_add_u32 s70, s78, 1343488
  v_accvgpr_write_b32 a223, v23
  v_mfma_f32_16x16x32_bf16 v[52:55], a[108:111], a[152:155], v[52:55]
  s_add_u32 m0, s81, 17408
  ds_read_b64_tr_b16 a[46:47], v16 offset:33792
  v_and_b32 v21, 15, v1
  v_mfma_f32_16x16x32_bf16 v[84:87], a[108:111], a[148:151], v[84:87]
  buffer_load_dwordx4 v7, s[8:11], s70 offen  lds
  v_mfma_f32_16x16x32_bf16 v[236:239], a[108:111], a[144:147], v[236:239]
  v_lshrrev_b32 v22, 4, v1
  v_mfma_f32_16x16x32_bf16 v[204:207], a[108:111], a[140:143], v[204:207]
  ds_read_b128 a[80:83], v9 offset:40960
  v_lshlrev_b32 v22, 3, v22
  v_mfma_f32_16x16x32_bf16 v[172:175], a[108:111], a[136:139], v[172:175]
  v_sub_u32 v21, v21, v22
  v_mfma_f32_16x16x32_bf16 v[140:143], a[108:111], a[132:135], v[140:143]
  ds_read_b64_tr_b16 a[48:49], v17 offset:32768
  v_add_u32 v21, 16, v21
  v_mfma_f32_16x16x32_bf16 v[108:111], a[108:111], a[128:131], v[108:111]
  s_add_u32 s70, s74, 16768
  v_and_b32 v22, 1, v21
  v_mfma_f32_16x16x32_bf16 v[112:115], a[112:115], a[128:131], v[112:115]
  s_add_u32 m0, s80, 2048
  ds_read_b64_tr_b16 a[50:51], v17 offset:33792
  v_lshlrev_b32 v22, 4, v22
  v_mfma_f32_16x16x32_bf16 v[144:147], a[112:115], a[132:135], v[144:147]
  buffer_load_dwordx4 v3, s[4:7], s70 offen  lds
  v_mfma_f32_16x16x32_bf16 v[176:179], a[112:115], a[136:139], v[176:179]
  v_mov_b32 v23, 0x3f80
  v_mfma_f32_16x16x32_bf16 v[208:211], a[112:115], a[140:143], v[208:211]
  ds_read_b128 a[84:87], v9 offset:43008
  v_lshlrev_b32 v22, v22, v23
  v_mfma_f32_16x16x32_bf16 v[240:243], a[112:115], a[144:147], v[240:243]
  v_ashrrev_i32 v21, 1, v21
  v_mfma_f32_16x16x32_bf16 v[72:75], a[112:115], a[148:151], v[72:75]
  ds_read_b64_tr_b16 a[52:53], v18 offset:32768
  v_cmp_eq_u32 vcc, 0, v21
  v_mfma_f32_16x16x32_bf16 v[40:43], a[112:115], a[152:155], v[40:43]
  s_add_u32 s70, s78, 1376256
  s_nop 0
  v_cndmask_b32 v23, 0, v22, vcc
  v_mfma_f32_16x16x32_bf16 a[16:19], a[112:115], a[156:159], a[16:19]
  s_add_u32 m0, s81, 18432
  ds_read_b64_tr_b16 a[54:55], v18 offset:33792
  v_accvgpr_write_b32 a224, v23
  v_mfma_f32_16x16x32_bf16 a[20:23], a[116:119], a[156:159], a[20:23]
  buffer_load_dwordx4 v8, s[8:11], s70 offen  lds
  v_mfma_f32_16x16x32_bf16 v[44:47], a[116:119], a[152:155], v[44:47]
  v_cmp_eq_u32 vcc, 1, v21
  v_mfma_f32_16x16x32_bf16 v[76:79], a[116:119], a[148:151], v[76:79]
  s_nop 0
  ds_read_b128 a[88:91], v9 offset:45056
  v_cndmask_b32 v23, 0, v22, vcc
  v_mfma_f32_16x16x32_bf16 v[244:247], a[116:119], a[144:147], v[244:247]
  v_accvgpr_write_b32 a225, v23
  v_mfma_f32_16x16x32_bf16 v[212:215], a[116:119], a[140:143], v[212:215]
  ds_read_b64_tr_b16 a[56:57], v19 offset:32768
  v_cmp_eq_u32 vcc, 2, v21
  v_mfma_f32_16x16x32_bf16 v[180:183], a[116:119], a[136:139], v[180:183]
  s_add_u32 s70, s74, 24960
  s_nop 0
  v_cndmask_b32 v23, 0, v22, vcc
  v_mfma_f32_16x16x32_bf16 v[148:151], a[116:119], a[132:135], v[148:151]
  s_add_u32 m0, s80, 3072
  ds_read_b64_tr_b16 a[58:59], v19 offset:33792
  v_accvgpr_write_b32 a226, v23
  v_mfma_f32_16x16x32_bf16 v[116:119], a[116:119], a[128:131], v[116:119]
  buffer_load_dwordx4 v4, s[4:7], s70 offen  lds
  v_mfma_f32_16x16x32_bf16 v[120:123], a[120:123], a[128:131], v[120:123]
  v_cmp_eq_u32 vcc, 3, v21
  v_mfma_f32_16x16x32_bf16 v[152:155], a[120:123], a[132:135], v[152:155]
  s_nop 0
  ds_read_b128 a[92:95], v9 offset:47104
  v_cndmask_b32 v23, 0, v22, vcc
  v_mfma_f32_16x16x32_bf16 v[184:187], a[120:123], a[136:139], v[184:187]
  v_accvgpr_write_b32 a227, v23
  v_mfma_f32_16x16x32_bf16 v[216:219], a[120:123], a[140:143], v[216:219]
  ds_read_b64_tr_b16 a[60:61], v20 offset:32768
  v_and_b32 v21, 15, v1
  v_mfma_f32_16x16x32_bf16 v[248:251], a[120:123], a[144:147], v[248:251]
  s_add_u32 s70, s78, 1409024
  v_lshrrev_b32 v22, 4, v1
  v_mfma_f32_16x16x32_bf16 v[64:67], a[120:123], a[148:151], v[64:67]
  s_add_u32 m0, s81, 19456
  ds_read_b64_tr_b16 a[62:63], v20 offset:33792
  v_lshlrev_b32 v22, 3, v22
  v_mfma_f32_16x16x32_bf16 v[32:35], a[120:123], a[152:155], v[32:35]
  buffer_load_dwordx4 v8, s[8:11], s70 offen  lds
  v_mfma_f32_16x16x32_bf16 a[24:27], a[120:123], a[156:159], a[24:27]
  v_sub_u32 v21, v21, v22
  v_mfma_f32_16x16x32_bf16 a[28:31], a[124:127], a[156:159], a[28:31]
  v_subrev_u32 v21, s71, v21
  v_mfma_f32_16x16x32_bf16 v[36:39], a[124:127], a[152:155], v[36:39]
  v_and_b32 v22, 1, v21
  v_mfma_f32_16x16x32_bf16 v[68:71], a[124:127], a[148:151], v[68:71]
  v_lshlrev_b32 v22, 4, v22
  v_mfma_f32_16x16x32_bf16 v[252:255], a[124:127], a[144:147], v[252:255]
  v_mov_b32 v23, 0x3f80
  v_mfma_f32_16x16x32_bf16 v[220:223], a[124:127], a[140:143], v[220:223]
  v_lshlrev_b32 v22, v22, v23
  v_mfma_f32_16x16x32_bf16 v[188:191], a[124:127], a[136:139], v[188:191]
  v_mfma_f32_16x16x32_bf16 v[156:159], a[124:127], a[132:135], v[156:159]
  s_waitcnt vmcnt(20) lgkmcnt(0)
  v_mfma_f32_16x16x32_bf16 v[124:127], a[124:127], a[128:131], v[124:127]
  s_barrier
  v_mfma_f32_16x16x32_bf16 v[96:99], a[32:35], a[64:67], v[96:99]
  ds_read_b128 a[128:131], v10 offset:32768
  v_ashrrev_i32 v21, 1, v21
  v_mfma_f32_16x16x32_bf16 v[128:131], a[32:35], a[68:71], v[128:131]
  v_cmp_eq_u32 vcc, 0, v21
  v_mfma_f32_16x16x32_bf16 v[160:163], a[32:35], a[72:75], v[160:163]
  s_nop 0
  ds_read_b64_tr_b16 a[96:97], v13 offset:49152
  v_cndmask_b32 v23, 0, v22, vcc
  v_mfma_f32_16x16x32_bf16 v[192:195], a[32:35], a[76:79], v[192:195]
  s_add_u32 s70, s75, 384
  v_accvgpr_write_b32 a228, v23
  v_mfma_f32_16x16x32_bf16 v[224:227], a[32:35], a[80:83], v[224:227]
  s_add_u32 m0, s80, 4096
  ds_read_b64_tr_b16 a[98:99], v13 offset:50176
  v_cmp_eq_u32 vcc, 1, v21
  v_mfma_f32_16x16x32_bf16 v[88:91], a[32:35], a[84:87], v[88:91]
  s_nop 0
  buffer_load_dwordx4 v3, s[4:7], s70 offen  lds
  v_mfma_f32_16x16x32_bf16 v[56:59], a[32:35], a[88:91], v[56:59]
  v_cndmask_b32 v23, 0, v22, vcc
  v_mfma_f32_16x16x32_bf16 a[0:3], a[32:35], a[92:95], a[0:3]
  ds_read_b128 a[132:135], v10 offset:34816
  v_accvgpr_write_b32 a229, v23
  v_mfma_f32_16x16x32_bf16 a[4:7], a[36:39], a[92:95], a[4:7]
  v_cmp_eq_u32 vcc, 2, v21
  v_mfma_f32_16x16x32_bf16 v[60:63], a[36:39], a[88:91], v[60:63]
  s_nop 0
  ds_read_b64_tr_b16 a[100:101], v14 offset:49152
  v_cndmask_b32 v23, 0, v22, vcc
  v_mfma_f32_16x16x32_bf16 v[92:95], a[36:39], a[84:87], v[92:95]
  s_add_u32 s70, s78, 1572864
  v_accvgpr_write_b32 a230, v23
  v_mfma_f32_16x16x32_bf16 v[228:231], a[36:39], a[80:83], v[228:231]
  s_add_u32 m0, s81, 32768
  ds_read_b64_tr_b16 a[102:103], v14 offset:50176
  v_cmp_eq_u32 vcc, 3, v21
  v_mfma_f32_16x16x32_bf16 v[196:199], a[36:39], a[76:79], v[196:199]
  s_nop 0
  buffer_load_dwordx4 v7, s[8:11], s70 offen  lds
  v_mfma_f32_16x16x32_bf16 v[164:167], a[36:39], a[72:75], v[164:167]
  v_cndmask_b32 v23, 0, v22, vcc
  v_mfma_f32_16x16x32_bf16 v[132:135], a[36:39], a[68:71], v[132:135]
  ds_read_b128 a[136:139], v10 offset:36864
  v_accvgpr_write_b32 a231, v23
  v_mfma_f32_16x16x32_bf16 v[100:103], a[36:39], a[64:67], v[100:103]
  v_mfma_f32_16x16x32_bf16 v[104:107], a[40:43], a[64:67], v[104:107]
  ds_read_b64_tr_b16 a[104:105], v15 offset:49152
  v_mfma_f32_16x16x32_bf16 v[136:139], a[40:43], a[68:71], v[136:139]
  s_add_u32 s70, s75, 8576
  v_mfma_f32_16x16x32_bf16 v[168:171], a[40:43], a[72:75], v[168:171]
  s_add_u32 m0, s80, 5120
  ds_read_b64_tr_b16 a[106:107], v15 offset:50176
  v_mfma_f32_16x16x32_bf16 v[200:203], a[40:43], a[76:79], v[200:203]
  buffer_load_dwordx4 v4, s[4:7], s70 offen  lds
  v_mfma_f32_16x16x32_bf16 v[232:235], a[40:43], a[80:83], v[232:235]
  v_mfma_f32_16x16x32_bf16 v[80:83], a[40:43], a[84:87], v[80:83]
  ds_read_b128 a[140:143], v10 offset:38912
  v_mfma_f32_16x16x32_bf16 v[48:51], a[40:43], a[88:91], v[48:51]
  v_mfma_f32_16x16x32_bf16 a[8:11], a[40:43], a[92:95], a[8:11]
  ds_read_b64_tr_b16 a[108:109], v16 offset:49152
  v_mfma_f32_16x16x32_bf16 a[12:15], a[44:47], a[92:95], a[12:15]
  s_add_u32 s70, s78, 1605632
  v_mfma_f32_16x16x32_bf16 v[52:55], a[44:47], a[88:91], v[52:55]
  s_add_u32 m0, s81, 33792
  ds_read_b64_tr_b16 a[110:111], v16 offset:50176
  v_mfma_f32_16x16x32_bf16 v[84:87], a[44:47], a[84:87], v[84:87]
  buffer_load_dwordx4 v7, s[8:11], s70 offen  lds
  v_mfma_f32_16x16x32_bf16 v[236:239], a[44:47], a[80:83], v[236:239]
  v_mfma_f32_16x16x32_bf16 v[204:207], a[44:47], a[76:79], v[204:207]
  ds_read_b128 a[144:147], v10 offset:40960
  v_mfma_f32_16x16x32_bf16 v[172:175], a[44:47], a[72:75], v[172:175]
  v_mfma_f32_16x16x32_bf16 v[140:143], a[44:47], a[68:71], v[140:143]
  ds_read_b64_tr_b16 a[112:113], v17 offset:49152
  v_mfma_f32_16x16x32_bf16 v[108:111], a[44:47], a[64:67], v[108:111]
  s_add_u32 s70, s75, 16768
  v_mfma_f32_16x16x32_bf16 v[112:115], a[48:51], a[64:67], v[112:115]
  s_add_u32 m0, s80, 6144
  ds_read_b64_tr_b16 a[114:115], v17 offset:50176
  v_mfma_f32_16x16x32_bf16 v[144:147], a[48:51], a[68:71], v[144:147]
  buffer_load_dwordx4 v3, s[4:7], s70 offen  lds
  v_mfma_f32_16x16x32_bf16 v[176:179], a[48:51], a[72:75], v[176:179]
  v_mfma_f32_16x16x32_bf16 v[208:211], a[48:51], a[76:79], v[208:211]
  ds_read_b128 a[148:151], v10 offset:43008
  v_mfma_f32_16x16x32_bf16 v[240:243], a[48:51], a[80:83], v[240:243]
  v_mfma_f32_16x16x32_bf16 v[72:75], a[48:51], a[84:87], v[72:75]
  ds_read_b64_tr_b16 a[116:117], v18 offset:49152
  v_mfma_f32_16x16x32_bf16 v[40:43], a[48:51], a[88:91], v[40:43]
  s_add_u32 s70, s78, 1638400
  v_mfma_f32_16x16x32_bf16 a[16:19], a[48:51], a[92:95], a[16:19]
  s_add_u32 m0, s81, 34816
  ds_read_b64_tr_b16 a[118:119], v18 offset:50176
  v_mfma_f32_16x16x32_bf16 a[20:23], a[52:55], a[92:95], a[20:23]
  buffer_load_dwordx4 v8, s[8:11], s70 offen  lds
  v_mfma_f32_16x16x32_bf16 v[44:47], a[52:55], a[88:91], v[44:47]
  v_mfma_f32_16x16x32_bf16 v[76:79], a[52:55], a[84:87], v[76:79]
  ds_read_b128 a[152:155], v10 offset:45056
  v_mfma_f32_16x16x32_bf16 v[244:247], a[52:55], a[80:83], v[244:247]
  v_mfma_f32_16x16x32_bf16 v[212:215], a[52:55], a[76:79], v[212:215]
  ds_read_b64_tr_b16 a[120:121], v19 offset:49152
  v_mfma_f32_16x16x32_bf16 v[180:183], a[52:55], a[72:75], v[180:183]
  s_add_u32 s70, s75, 24960
  v_mfma_f32_16x16x32_bf16 v[148:151], a[52:55], a[68:71], v[148:151]
  s_add_u32 m0, s80, 7168
  ds_read_b64_tr_b16 a[122:123], v19 offset:50176
  v_mfma_f32_16x16x32_bf16 v[116:119], a[52:55], a[64:67], v[116:119]
  buffer_load_dwordx4 v4, s[4:7], s70 offen  lds
  v_mfma_f32_16x16x32_bf16 v[120:123], a[56:59], a[64:67], v[120:123]
  v_mfma_f32_16x16x32_bf16 v[152:155], a[56:59], a[68:71], v[152:155]
  ds_read_b128 a[156:159], v10 offset:47104
  v_mfma_f32_16x16x32_bf16 v[184:187], a[56:59], a[72:75], v[184:187]
  v_mfma_f32_16x16x32_bf16 v[216:219], a[56:59], a[76:79], v[216:219]
  ds_read_b64_tr_b16 a[124:125], v20 offset:49152
  v_mfma_f32_16x16x32_bf16 v[248:251], a[56:59], a[80:83], v[248:251]
  s_add_u32 s70, s78, 1671168
  v_mfma_f32_16x16x32_bf16 v[64:67], a[56:59], a[84:87], v[64:67]
  s_add_u32 m0, s81, 35840
  ds_read_b64_tr_b16 a[126:127], v20 offset:50176
  v_mfma_f32_16x16x32_bf16 v[32:35], a[56:59], a[88:91], v[32:35]
  buffer_load_dwordx4 v8, s[8:11], s70 offen  lds
  v_mfma_f32_16x16x32_bf16 a[24:27], a[56:59], a[92:95], a[24:27]
  v_mfma_f32_16x16x32_bf16 a[28:31], a[60:63], a[92:95], a[28:31]
  v_mfma_f32_16x16x32_bf16 v[36:39], a[60:63], a[88:91], v[36:39]
  v_mfma_f32_16x16x32_bf16 v[68:71], a[60:63], a[84:87], v[68:71]
  v_mfma_f32_16x16x32_bf16 v[252:255], a[60:63], a[80:83], v[252:255]
  v_mfma_f32_16x16x32_bf16 v[220:223], a[60:63], a[76:79], v[220:223]
  v_mfma_f32_16x16x32_bf16 v[188:191], a[60:63], a[72:75], v[188:191]
  v_mfma_f32_16x16x32_bf16 v[156:159], a[60:63], a[68:71], v[156:159]
  s_waitcnt vmcnt(16) lgkmcnt(0)
  v_mfma_f32_16x16x32_bf16 v[124:127], a[60:63], a[64:67], v[124:127]
  s_barrier
  v_mfma_f32_16x16x32_bf16 v[96:99], a[96:99], a[128:131], v[96:99]
  ds_read_b128 a[64:67], v11 offset:0
  v_lshrrev_b32 v21, 4, v1
  v_mfma_f32_16x16x32_bf16 v[128:131], a[96:99], a[132:135], v[128:131]
  v_and_b32 v22, 7, v1
  v_mfma_f32_16x16x32_bf16 v[160:163], a[96:99], a[136:139], v[160:163]
  ds_read_b64_tr_b16 a[32:33], v13 offset:0
  v_lshl_add_u32 v22, v21, 3, v22
  v_mfma_f32_16x16x32_bf16 v[192:195], a[96:99], a[140:143], v[192:195]
  s_add_u32 s70, s74, 512
  v_lshlrev_b32 v22, 4, v22
  v_mfma_f32_16x16x32_bf16 v[224:227], a[96:99], a[144:147], v[224:227]
  s_add_u32 m0, s80, 32768
  ds_read_b64_tr_b16 a[34:35], v13 offset:1024
  v_add_u32 v21, 1, v21
  v_mfma_f32_16x16x32_bf16 v[88:91], a[96:99], a[148:151], v[88:91]
  buffer_load_dwordx4 v3, s[4:7], s70 offen  lds
  v_mfma_f32_16x16x32_bf16 v[56:59], a[96:99], a[152:155], v[56:59]
  v_lshrrev_b32 v21, 2, v21
  v_mfma_f32_16x16x32_bf16 a[0:3], a[96:99], a[156:159], a[0:3]
  ds_read_b128 a[68:71], v11 offset:2048
  v_lshl_add_u32 v22, v21, 28, v22
  v_mfma_f32_16x16x32_bf16 a[4:7], a[100:103], a[156:159], a[4:7]
  v_bfe_u32 v21, v1, 3, 1
  v_mfma_f32_16x16x32_bf16 v[60:63], a[100:103], a[152:155], v[60:63]
  ds_read_b64_tr_b16 a[36:37], v14 offset:0
  v_mul_u32_u24 v21, 1152, v21
  v_mfma_f32_16x16x32_bf16 v[92:95], a[100:103], a[148:151], v[92:95]
  s_add_u32 s70, s78, 1835008
  v_add_u32 v21, v21, v22
  v_mfma_f32_16x16x32_bf16 v[228:231], a[100:103], a[144:147], v[228:231]
  s_add_u32 m0, s81, 49152
  s_lshl_b32 s71, s2, 3
  ds_read_b64_tr_b16 a[38:39], v14 offset:1024
  v_mfma_f32_16x16x32_bf16 v[196:199], a[100:103], a[140:143], v[196:199]
  s_lshl_b32 s72, s34, 1
  buffer_load_dwordx4 v7, s[8:11], s70 offen  lds
  v_mfma_f32_16x16x32_bf16 v[164:167], a[100:103], a[136:139], v[164:167]
  s_add_u32 s71, s71, s72
  s_mul_i32 s71, s71, 1152
  v_mfma_f32_16x16x32_bf16 v[132:135], a[100:103], a[132:135], v[132:135]
  ds_read_b128 a[72:75], v11 offset:4096
  v_mfma_f32_16x16x32_bf16 v[100:103], a[100:103], a[128:131], v[100:103]
  buffer_load_dwordx4 a[160:163], v21, s[12:15], s71 offen offset:0
  v_mfma_f32_16x16x32_bf16 v[104:107], a[104:107], a[128:131], v[104:107]
  ds_read_b64_tr_b16 a[40:41], v15 offset:0
  v_mfma_f32_16x16x32_bf16 v[136:139], a[104:107], a[132:135], v[136:139]
  s_add_u32 s70, s74, 8704
  buffer_load_dwordx4 a[172:175], v22, s[24:27], 0 offen offset:0
  v_mfma_f32_16x16x32_bf16 v[168:171], a[104:107], a[136:139], v[168:171]
  s_add_u32 m0, s80, 33792
  ds_read_b64_tr_b16 a[42:43], v15 offset:1024
  v_mfma_f32_16x16x32_bf16 v[200:203], a[104:107], a[140:143], v[200:203]
  buffer_load_dwordx4 v4, s[4:7], s70 offen  lds
  v_mfma_f32_16x16x32_bf16 v[232:235], a[104:107], a[144:147], v[232:235]
  buffer_load_dwordx4 a[184:187], v22, s[28:31], 0 offen offset:0
  v_mfma_f32_16x16x32_bf16 v[80:83], a[104:107], a[148:151], v[80:83]
  ds_read_b128 a[76:79], v11 offset:6144
  v_mfma_f32_16x16x32_bf16 v[48:51], a[104:107], a[152:155], v[48:51]
  buffer_load_dwordx4 a[164:167], v21, s[12:15], s71 offen offset:384
  v_mfma_f32_16x16x32_bf16 a[8:11], a[104:107], a[156:159], a[8:11]
  ds_read_b64_tr_b16 a[44:45], v16 offset:0
  v_mfma_f32_16x16x32_bf16 a[12:15], a[108:111], a[156:159], a[12:15]
  s_add_u32 s70, s78, 1867776
  buffer_load_dwordx4 a[176:179], v22, s[24:27], 0 offen offset:384
  v_mfma_f32_16x16x32_bf16 v[52:55], a[108:111], a[152:155], v[52:55]
  s_add_u32 m0, s81, 50176
  ds_read_b64_tr_b16 a[46:47], v16 offset:1024
  v_mfma_f32_16x16x32_bf16 v[84:87], a[108:111], a[148:151], v[84:87]
  buffer_load_dwordx4 v7, s[8:11], s70 offen  lds
  v_mfma_f32_16x16x32_bf16 v[236:239], a[108:111], a[144:147], v[236:239]
  buffer_load_dwordx4 a[188:191], v22, s[28:31], 0 offen offset:384
  v_mfma_f32_16x16x32_bf16 v[204:207], a[108:111], a[140:143], v[204:207]
  ds_read_b128 a[80:83], v11 offset:8192
  v_mfma_f32_16x16x32_bf16 v[172:175], a[108:111], a[136:139], v[172:175]
  buffer_load_dwordx4 a[168:171], v21, s[12:15], s71 offen offset:768
  v_mfma_f32_16x16x32_bf16 v[140:143], a[108:111], a[132:135], v[140:143]
  ds_read_b64_tr_b16 a[48:49], v17 offset:0
  v_mfma_f32_16x16x32_bf16 v[108:111], a[108:111], a[128:131], v[108:111]
  s_add_u32 s70, s74, 16896
  buffer_load_dwordx4 a[180:183], v22, s[24:27], 0 offen offset:768
  v_mfma_f32_16x16x32_bf16 v[112:115], a[112:115], a[128:131], v[112:115]
  s_add_u32 m0, s80, 34816
  ds_read_b64_tr_b16 a[50:51], v17 offset:1024
  v_mfma_f32_16x16x32_bf16 v[144:147], a[112:115], a[132:135], v[144:147]
  buffer_load_dwordx4 v3, s[4:7], s70 offen  lds
  v_mfma_f32_16x16x32_bf16 v[176:179], a[112:115], a[136:139], v[176:179]
  buffer_load_dwordx4 a[192:195], v22, s[28:31], 0 offen offset:768
  v_mfma_f32_16x16x32_bf16 v[208:211], a[112:115], a[140:143], v[208:211]
  ds_read_b128 a[84:87], v11 offset:10240
  v_mfma_f32_16x16x32_bf16 v[240:243], a[112:115], a[144:147], v[240:243]
  v_mfma_f32_16x16x32_bf16 v[72:75], a[112:115], a[148:151], v[72:75]
  ds_read_b64_tr_b16 a[52:53], v18 offset:0
  v_mfma_f32_16x16x32_bf16 v[40:43], a[112:115], a[152:155], v[40:43]
  s_add_u32 s70, s78, 1900544
  v_mfma_f32_16x16x32_bf16 a[16:19], a[112:115], a[156:159], a[16:19]
  s_add_u32 m0, s81, 51200
  ds_read_b64_tr_b16 a[54:55], v18 offset:1024
  v_mfma_f32_16x16x32_bf16 a[20:23], a[116:119], a[156:159], a[20:23]
  buffer_load_dwordx4 v8, s[8:11], s70 offen  lds
  v_mfma_f32_16x16x32_bf16 v[44:47], a[116:119], a[152:155], v[44:47]
  v_mfma_f32_16x16x32_bf16 v[76:79], a[116:119], a[148:151], v[76:79]
  ds_read_b128 a[88:91], v11 offset:12288
  v_mfma_f32_16x16x32_bf16 v[244:247], a[116:119], a[144:147], v[244:247]
  v_mfma_f32_16x16x32_bf16 v[212:215], a[116:119], a[140:143], v[212:215]
  ds_read_b64_tr_b16 a[56:57], v19 offset:0
  v_mfma_f32_16x16x32_bf16 v[180:183], a[116:119], a[136:139], v[180:183]
  s_add_u32 s70, s74, 25088
  v_mfma_f32_16x16x32_bf16 v[148:151], a[116:119], a[132:135], v[148:151]
  s_add_u32 m0, s80, 35840
  ds_read_b64_tr_b16 a[58:59], v19 offset:1024
  v_mfma_f32_16x16x32_bf16 v[116:119], a[116:119], a[128:131], v[116:119]
  buffer_load_dwordx4 v4, s[4:7], s70 offen  lds
  v_mfma_f32_16x16x32_bf16 v[120:123], a[120:123], a[128:131], v[120:123]
  v_mfma_f32_16x16x32_bf16 v[152:155], a[120:123], a[132:135], v[152:155]
  ds_read_b128 a[92:95], v11 offset:14336
  v_mfma_f32_16x16x32_bf16 v[184:187], a[120:123], a[136:139], v[184:187]
  v_mfma_f32_16x16x32_bf16 v[216:219], a[120:123], a[140:143], v[216:219]
  ds_read_b64_tr_b16 a[60:61], v20 offset:0
  v_mfma_f32_16x16x32_bf16 v[248:251], a[120:123], a[144:147], v[248:251]
  s_add_u32 s70, s78, 1933312
  v_mfma_f32_16x16x32_bf16 v[64:67], a[120:123], a[148:151], v[64:67]
  s_add_u32 m0, s81, 52224
  ds_read_b64_tr_b16 a[62:63], v20 offset:1024
  v_mfma_f32_16x16x32_bf16 v[32:35], a[120:123], a[152:155], v[32:35]
  buffer_load_dwordx4 v8, s[8:11], s70 offen  lds
  v_mfma_f32_16x16x32_bf16 a[24:27], a[120:123], a[156:159], a[24:27]
  v_mfma_f32_16x16x32_bf16 a[28:31], a[124:127], a[156:159], a[28:31]
  v_mfma_f32_16x16x32_bf16 v[36:39], a[124:127], a[152:155], v[36:39]
  v_mfma_f32_16x16x32_bf16 v[68:71], a[124:127], a[148:151], v[68:71]
  v_mfma_f32_16x16x32_bf16 v[252:255], a[124:127], a[144:147], v[252:255]
  v_mfma_f32_16x16x32_bf16 v[220:223], a[124:127], a[140:143], v[220:223]
  v_mfma_f32_16x16x32_bf16 v[188:191], a[124:127], a[136:139], v[188:191]
  v_mfma_f32_16x16x32_bf16 v[156:159], a[124:127], a[132:135], v[156:159]
  s_waitcnt vmcnt(25) lgkmcnt(0)
  v_mfma_f32_16x16x32_bf16 v[124:127], a[124:127], a[128:131], v[124:127]
  s_barrier
  v_mfma_f32_16x16x32_bf16 v[96:99], a[32:35], a[64:67], v[96:99]
  ds_read_b128 a[128:131], v12 offset:0
  v_min_u32 v29, 27, v1
  v_mfma_f32_16x16x32_bf16 v[128:131], a[32:35], a[68:71], v[128:131]
  v_lshlrev_b32 v29, 2, v29
  v_mfma_f32_16x16x32_bf16 v[160:163], a[32:35], a[72:75], v[160:163]
  ds_read_b64_tr_b16 a[96:97], v13 offset:16384
  v_mfma_f32_16x16x32_bf16 v[192:195], a[32:35], a[76:79], v[192:195]
  s_add_u32 s70, s75, 512
  global_load_dword v29, v29, s[66:67] sc1
  v_mfma_f32_16x16x32_bf16 v[224:227], a[32:35], a[80:83], v[224:227]
  s_add_u32 m0, s80, 36864
  s_lshr_b32 s97, s2, 1
  ds_read_b64_tr_b16 a[98:99], v13 offset:17408
  v_mfma_f32_16x16x32_bf16 v[88:91], a[32:35], a[84:87], v[88:91]
  s_mul_i32 s97, s97, 36864
  buffer_load_dwordx4 v3, s[4:7], s70 offen  lds
  v_mfma_f32_16x16x32_bf16 v[56:59], a[32:35], a[88:91], v[56:59]
  s_and_b32 s73, s2, 1
  s_lshl_b32 s73, s73, 2
  s_add_u32 s73, s73, s34
  v_mfma_f32_16x16x32_bf16 a[0:3], a[32:35], a[92:95], a[0:3]
  s_mul_i32 s73, s73, 144
  s_add_u32 s97, s97, s73
  ds_read_b128 a[132:135], v12 offset:2048
  v_mfma_f32_16x16x32_bf16 a[4:7], a[36:39], a[92:95], a[4:7]
  s_add_u32 s32, s97, 18432
  s_mov_b32 s24, s50
  s_mov_b32 s25, s51
  v_mfma_f32_16x16x32_bf16 v[60:63], a[36:39], a[88:91], v[60:63]
  s_mov_b32 s26, 4718592
  ds_read_b64_tr_b16 a[100:101], v14 offset:16384
  v_and_b32 v5, 15, v1
  v_mfma_f32_16x16x32_bf16 v[92:95], a[36:39], a[84:87], v[92:95]
  s_add_u32 s70, s78, 2097152
  v_mul_u32_u24 v5, 1152, v5
  v_mfma_f32_16x16x32_bf16 v[228:231], a[36:39], a[80:83], v[228:231]
  s_add_u32 m0, s81, 0
  ds_read_b64_tr_b16 a[102:103], v14 offset:17408
  v_lshrrev_b32 v6, 4, v1
  v_mfma_f32_16x16x32_bf16 v[196:199], a[36:39], a[76:79], v[196:199]
  buffer_load_dwordx4 v7, s[8:11], s70 offen  lds
  v_mfma_f32_16x16x32_bf16 v[164:167], a[36:39], a[72:75], v[164:167]
  v_lshl_add_u32 v5, v6, 4, v5
  v_mfma_f32_16x16x32_bf16 v[132:135], a[36:39], a[68:71], v[132:135]
  ds_read_b128 a[136:139], v12 offset:4096
  v_lshl_add_u32 v6, v6, 28, v5
  v_mfma_f32_16x16x32_bf16 v[100:103], a[36:39], a[64:67], v[100:103]
  v_mfma_f32_16x16x32_bf16 v[104:107], a[40:43], a[64:67], v[104:107]
  ds_read_b64_tr_b16 a[104:105], v15 offset:16384
  v_mfma_f32_16x16x32_bf16 v[136:139], a[40:43], a[68:71], v[136:139]
  s_add_u32 s70, s75, 8704
  v_mfma_f32_16x16x32_bf16 v[168:171], a[40:43], a[72:75], v[168:171]
  s_add_u32 m0, s80, 37888
  ds_read_b64_tr_b16 a[106:107], v15 offset:17408
  v_mfma_f32_16x16x32_bf16 v[200:203], a[40:43], a[76:79], v[200:203]
  buffer_load_dwordx4 v4, s[4:7], s70 offen  lds
  v_mfma_f32_16x16x32_bf16 v[232:235], a[40:43], a[80:83], v[232:235]
  v_mfma_f32_16x16x32_bf16 v[80:83], a[40:43], a[84:87], v[80:83]
  ds_read_b128 a[140:143], v12 offset:6144
  v_mfma_f32_16x16x32_bf16 v[48:51], a[40:43], a[88:91], v[48:51]
  v_mfma_f32_16x16x32_bf16 a[8:11], a[40:43], a[92:95], a[8:11]
  ds_read_b64_tr_b16 a[108:109], v16 offset:16384
  v_mfma_f32_16x16x32_bf16 a[12:15], a[44:47], a[92:95], a[12:15]
  s_add_u32 s70, s78, 2129920
  v_mfma_f32_16x16x32_bf16 v[52:55], a[44:47], a[88:91], v[52:55]
  s_add_u32 m0, s81, 1024
  ds_read_b64_tr_b16 a[110:111], v16 offset:17408
  v_mfma_f32_16x16x32_bf16 v[84:87], a[44:47], a[84:87], v[84:87]
  buffer_load_dwordx4 v7, s[8:11], s70 offen  lds
  v_mfma_f32_16x16x32_bf16 v[236:239], a[44:47], a[80:83], v[236:239]
  v_mfma_f32_16x16x32_bf16 v[204:207], a[44:47], a[76:79], v[204:207]
  ds_read_b128 a[144:147], v12 offset:8192
  v_mfma_f32_16x16x32_bf16 v[172:175], a[44:47], a[72:75], v[172:175]
  v_mfma_f32_16x16x32_bf16 v[140:143], a[44:47], a[68:71], v[140:143]
  ds_read_b64_tr_b16 a[112:113], v17 offset:16384
  v_mfma_f32_16x16x32_bf16 v[108:111], a[44:47], a[64:67], v[108:111]
  s_add_u32 s70, s75, 16896
  v_mfma_f32_16x16x32_bf16 v[112:115], a[48:51], a[64:67], v[112:115]
  s_add_u32 m0, s80, 38912
  ds_read_b64_tr_b16 a[114:115], v17 offset:17408
  v_mfma_f32_16x16x32_bf16 v[144:147], a[48:51], a[68:71], v[144:147]
  buffer_load_dwordx4 v3, s[4:7], s70 offen  lds
  v_mfma_f32_16x16x32_bf16 v[176:179], a[48:51], a[72:75], v[176:179]
  v_mfma_f32_16x16x32_bf16 v[208:211], a[48:51], a[76:79], v[208:211]
  ds_read_b128 a[148:151], v12 offset:10240
  v_mfma_f32_16x16x32_bf16 v[240:243], a[48:51], a[80:83], v[240:243]
  v_mfma_f32_16x16x32_bf16 v[72:75], a[48:51], a[84:87], v[72:75]
  ds_read_b64_tr_b16 a[116:117], v18 offset:16384
  v_mfma_f32_16x16x32_bf16 v[40:43], a[48:51], a[88:91], v[40:43]
  s_add_u32 s70, s78, 2162688
  v_mfma_f32_16x16x32_bf16 a[16:19], a[48:51], a[92:95], a[16:19]
  s_add_u32 m0, s81, 2048
  ds_read_b64_tr_b16 a[118:119], v18 offset:17408
  v_mfma_f32_16x16x32_bf16 a[20:23], a[52:55], a[92:95], a[20:23]
  buffer_load_dwordx4 v8, s[8:11], s70 offen  lds
  v_mfma_f32_16x16x32_bf16 v[44:47], a[52:55], a[88:91], v[44:47]
  v_mfma_f32_16x16x32_bf16 v[76:79], a[52:55], a[84:87], v[76:79]
  ds_read_b128 a[152:155], v12 offset:12288
  v_mfma_f32_16x16x32_bf16 v[244:247], a[52:55], a[80:83], v[244:247]
  v_mfma_f32_16x16x32_bf16 v[212:215], a[52:55], a[76:79], v[212:215]
  ds_read_b64_tr_b16 a[120:121], v19 offset:16384
  v_mfma_f32_16x16x32_bf16 v[180:183], a[52:55], a[72:75], v[180:183]
  s_add_u32 s70, s75, 25088
  v_mfma_f32_16x16x32_bf16 v[148:151], a[52:55], a[68:71], v[148:151]
  s_add_u32 m0, s80, 39936
  ds_read_b64_tr_b16 a[122:123], v19 offset:17408
  v_mfma_f32_16x16x32_bf16 v[116:119], a[52:55], a[64:67], v[116:119]
  buffer_load_dwordx4 v4, s[4:7], s70 offen  lds
  v_mfma_f32_16x16x32_bf16 v[120:123], a[56:59], a[64:67], v[120:123]
  v_mfma_f32_16x16x32_bf16 v[152:155], a[56:59], a[68:71], v[152:155]
  ds_read_b128 a[156:159], v12 offset:14336
  v_mfma_f32_16x16x32_bf16 v[184:187], a[56:59], a[72:75], v[184:187]
  v_mfma_f32_16x16x32_bf16 v[216:219], a[56:59], a[76:79], v[216:219]
  ds_read_b64_tr_b16 a[124:125], v20 offset:16384
  v_mfma_f32_16x16x32_bf16 v[248:251], a[56:59], a[80:83], v[248:251]
  s_add_u32 s70, s78, 2195456
  v_mfma_f32_16x16x32_bf16 v[64:67], a[56:59], a[84:87], v[64:67]
  s_add_u32 m0, s81, 3072
  ds_read_b64_tr_b16 a[126:127], v20 offset:17408
  v_mfma_f32_16x16x32_bf16 v[32:35], a[56:59], a[88:91], v[32:35]
  buffer_load_dwordx4 v8, s[8:11], s70 offen  lds
  v_mfma_f32_16x16x32_bf16 a[24:27], a[56:59], a[92:95], a[24:27]
  v_mfma_f32_16x16x32_bf16 a[28:31], a[60:63], a[92:95], a[28:31]
  v_mfma_f32_16x16x32_bf16 v[36:39], a[60:63], a[88:91], v[36:39]
  v_mfma_f32_16x16x32_bf16 v[68:71], a[60:63], a[84:87], v[68:71]
  v_mfma_f32_16x16x32_bf16 v[252:255], a[60:63], a[80:83], v[252:255]
  v_mfma_f32_16x16x32_bf16 v[220:223], a[60:63], a[76:79], v[220:223]
  v_mfma_f32_16x16x32_bf16 v[188:191], a[60:63], a[72:75], v[188:191]
  v_mfma_f32_16x16x32_bf16 v[156:159], a[60:63], a[68:71], v[156:159]
  s_waitcnt vmcnt(26) lgkmcnt(0)
  v_mfma_f32_16x16x32_bf16 v[124:127], a[60:63], a[64:67], v[124:127]
  s_barrier
  v_mfma_f32_16x16x32_bf16 v[96:99], a[96:99], a[128:131], v[96:99]
  ds_read_b128 a[64:67], v9 offset:0
  v_mfma_f32_16x16x32_bf16 v[128:131], a[96:99], a[132:135], v[128:131]
  buffer_load_dwordx4 a[196:199], v5, s[24:27], s97 offen offset:0 nt
  v_mfma_f32_16x16x32_bf16 v[160:163], a[96:99], a[136:139], v[160:163]
  ds_read_b64_tr_b16 a[32:33], v13 offset:32768
  v_mfma_f32_16x16x32_bf16 v[192:195], a[96:99], a[140:143], v[192:195]
  s_add_u32 s70, s74, 640
  buffer_load_dwordx4 a[200:203], v5, s[24:27], s97 offen offset:64 nt
  v_mfma_f32_16x16x32_bf16 v[224:227], a[96:99], a[144:147], v[224:227]
  s_add_u32 m0, s80, 65536
  ds_read_b64_tr_b16 a[34:35], v13 offset:33792
  v_mfma_f32_16x16x32_bf16 v[88:91], a[96:99], a[148:151], v[88:91]
  buffer_load_dwordx4 v3, s[4:7], s70 offen  lds
  v_mfma_f32_16x16x32_bf16 v[56:59], a[96:99], a[152:155], v[56:59]
  v_mfma_f32_16x16x32_bf16 a[0:3], a[96:99], a[156:159], a[0:3]
  ds_read_b128 a[68:71], v9 offset:2048
  v_mfma_f32_16x16x32_bf16 a[4:7], a[100:103], a[156:159], a[4:7]
  v_mfma_f32_16x16x32_bf16 v[60:63], a[100:103], a[152:155], v[60:63]
  ds_read_b64_tr_b16 a[36:37], v14 offset:32768
  v_mfma_f32_16x16x32_bf16 v[92:95], a[100:103], a[148:151], v[92:95]
  s_add_u32 s70, s78, 2359296
  v_mfma_f32_16x16x32_bf16 v[228:231], a[100:103], a[144:147], v[228:231]
  s_add_u32 m0, s81, 16384
  ds_read_b64_tr_b16 a[38:39], v14 offset:33792
  v_mfma_f32_16x16x32_bf16 v[196:199], a[100:103], a[140:143], v[196:199]
  buffer_load_dwordx4 v7, s[8:11], s70 offen  lds
  v_mfma_f32_16x16x32_bf16 v[164:167], a[100:103], a[136:139], v[164:167]
  v_mfma_f32_16x16x32_bf16 v[132:135], a[100:103], a[132:135], v[132:135]
  ds_read_b128 a[72:75], v9 offset:4096
  v_mfma_f32_16x16x32_bf16 v[100:103], a[100:103], a[128:131], v[100:103]
  v_mfma_f32_16x16x32_bf16 v[104:107], a[104:107], a[128:131], v[104:107]
  ds_read_b64_tr_b16 a[40:41], v15 offset:32768
  v_mfma_f32_16x16x32_bf16 v[136:139], a[104:107], a[132:135], v[136:139]
  s_add_u32 s70, s74, 8832
  v_mfma_f32_16x16x32_bf16 v[168:171], a[104:107], a[136:139], v[168:171]
  s_add_u32 m0, s80, 66560
  ds_read_b64_tr_b16 a[42:43], v15 offset:33792
  v_mfma_f32_16x16x32_bf16 v[200:203], a[104:107], a[140:143], v[200:203]
  buffer_load_dwordx4 v4, s[4:7], s70 offen  lds
  v_mfma_f32_16x16x32_bf16 v[232:235], a[104:107], a[144:147], v[232:235]
  v_mfma_f32_16x16x32_bf16 v[80:83], a[104:107], a[148:151], v[80:83]
  ds_read_b128 a[76:79], v9 offset:6144
  v_mfma_f32_16x16x32_bf16 v[48:51], a[104:107], a[152:155], v[48:51]
  v_mfma_f32_16x16x32_bf16 a[8:11], a[104:107], a[156:159], a[8:11]
  ds_read_b64_tr_b16 a[44:45], v16 offset:32768
  v_mfma_f32_16x16x32_bf16 a[12:15], a[108:111], a[156:159], a[12:15]
  s_add_u32 s70, s78, 2392064
  v_mfma_f32_16x16x32_bf16 v[52:55], a[108:111], a[152:155], v[52:55]
  s_add_u32 m0, s81, 17408
  ds_read_b64_tr_b16 a[46:47], v16 offset:33792
  v_mfma_f32_16x16x32_bf16 v[84:87], a[108:111], a[148:151], v[84:87]
  buffer_load_dwordx4 v7, s[8:11], s70 offen  lds
  v_mfma_f32_16x16x32_bf16 v[236:239], a[108:111], a[144:147], v[236:239]
  v_mfma_f32_16x16x32_bf16 v[204:207], a[108:111], a[140:143], v[204:207]
  ds_read_b128 a[80:83], v9 offset:8192
  v_mfma_f32_16x16x32_bf16 v[172:175], a[108:111], a[136:139], v[172:175]
  v_mfma_f32_16x16x32_bf16 v[140:143], a[108:111], a[132:135], v[140:143]
  ds_read_b64_tr_b16 a[48:49], v17 offset:32768
  v_mfma_f32_16x16x32_bf16 v[108:111], a[108:111], a[128:131], v[108:111]
  s_add_u32 s70, s74, 17024
  v_mfma_f32_16x16x32_bf16 v[112:115], a[112:115], a[128:131], v[112:115]
  s_add_u32 m0, s80, 67584
  ds_read_b64_tr_b16 a[50:51], v17 offset:33792
  v_mfma_f32_16x16x32_bf16 v[144:147], a[112:115], a[132:135], v[144:147]
  buffer_load_dwordx4 v3, s[4:7], s70 offen  lds
  v_mfma_f32_16x16x32_bf16 v[176:179], a[112:115], a[136:139], v[176:179]
  v_mfma_f32_16x16x32_bf16 v[208:211], a[112:115], a[140:143], v[208:211]
  ds_read_b128 a[84:87], v9 offset:10240
  v_mfma_f32_16x16x32_bf16 v[240:243], a[112:115], a[144:147], v[240:243]
  v_mfma_f32_16x16x32_bf16 v[72:75], a[112:115], a[148:151], v[72:75]
  ds_read_b64_tr_b16 a[52:53], v18 offset:32768
  v_mfma_f32_16x16x32_bf16 v[40:43], a[112:115], a[152:155], v[40:43]
  s_add_u32 s70, s78, 2424832
  v_mfma_f32_16x16x32_bf16 a[16:19], a[112:115], a[156:159], a[16:19]
  s_add_u32 m0, s81, 18432
  ds_read_b64_tr_b16 a[54:55], v18 offset:33792
  v_mfma_f32_16x16x32_bf16 a[20:23], a[116:119], a[156:159], a[20:23]
  buffer_load_dwordx4 v8, s[8:11], s70 offen  lds
  v_mfma_f32_16x16x32_bf16 v[44:47], a[116:119], a[152:155], v[44:47]
  v_mfma_f32_16x16x32_bf16 v[76:79], a[116:119], a[148:151], v[76:79]
  ds_read_b128 a[88:91], v9 offset:12288
  v_mfma_f32_16x16x32_bf16 v[244:247], a[116:119], a[144:147], v[244:247]
  v_mfma_f32_16x16x32_bf16 v[212:215], a[116:119], a[140:143], v[212:215]
  ds_read_b64_tr_b16 a[56:57], v19 offset:32768
  v_mfma_f32_16x16x32_bf16 v[180:183], a[116:119], a[136:139], v[180:183]
  s_add_u32 s70, s74, 25216
  v_mfma_f32_16x16x32_bf16 v[148:151], a[116:119], a[132:135], v[148:151]
  s_add_u32 m0, s80, 68608
  ds_read_b64_tr_b16 a[58:59], v19 offset:33792
  v_mfma_f32_16x16x32_bf16 v[116:119], a[116:119], a[128:131], v[116:119]
  buffer_load_dwordx4 v4, s[4:7], s70 offen  lds
  v_mfma_f32_16x16x32_bf16 v[120:123], a[120:123], a[128:131], v[120:123]
  v_mfma_f32_16x16x32_bf16 v[152:155], a[120:123], a[132:135], v[152:155]
  ds_read_b128 a[92:95], v9 offset:14336
  v_mfma_f32_16x16x32_bf16 v[184:187], a[120:123], a[136:139], v[184:187]
  v_mfma_f32_16x16x32_bf16 v[216:219], a[120:123], a[140:143], v[216:219]
  ds_read_b64_tr_b16 a[60:61], v20 offset:32768
  v_mfma_f32_16x16x32_bf16 v[248:251], a[120:123], a[144:147], v[248:251]
  s_add_u32 s70, s78, 2457600
  v_mfma_f32_16x16x32_bf16 v[64:67], a[120:123], a[148:151], v[64:67]
  s_add_u32 m0, s81, 19456
  ds_read_b64_tr_b16 a[62:63], v20 offset:33792
  v_mfma_f32_16x16x32_bf16 v[32:35], a[120:123], a[152:155], v[32:35]
  buffer_load_dwordx4 v8, s[8:11], s70 offen  lds
  v_mfma_f32_16x16x32_bf16 a[24:27], a[120:123], a[156:159], a[24:27]
  v_mfma_f32_16x16x32_bf16 a[28:31], a[124:127], a[156:159], a[28:31]
  v_mfma_f32_16x16x32_bf16 v[36:39], a[124:127], a[152:155], v[36:39]
  v_mfma_f32_16x16x32_bf16 v[68:71], a[124:127], a[148:151], v[68:71]
  v_mfma_f32_16x16x32_bf16 v[252:255], a[124:127], a[144:147], v[252:255]
  v_mfma_f32_16x16x32_bf16 v[220:223], a[124:127], a[140:143], v[220:223]
  v_mfma_f32_16x16x32_bf16 v[188:191], a[124:127], a[136:139], v[188:191]
  v_mfma_f32_16x16x32_bf16 v[156:159], a[124:127], a[132:135], v[156:159]
  s_waitcnt vmcnt(19) lgkmcnt(0)
  v_mfma_f32_16x16x32_bf16 v[124:127], a[124:127], a[128:131], v[124:127]
  s_barrier
  v_mfma_f32_16x16x32_bf16 v[96:99], a[32:35], a[64:67], v[96:99]
  ds_read_b128 a[128:131], v10 offset:0
  v_mfma_f32_16x16x32_bf16 v[128:131], a[32:35], a[68:71], v[128:131]
  buffer_load_dwordx4 a[204:207], v6, s[24:27], s97 offen offset:128 nt
  v_mfma_f32_16x16x32_bf16 v[160:163], a[32:35], a[72:75], v[160:163]
  ds_read_b64_tr_b16 a[96:97], v13 offset:49152
  v_mfma_f32_16x16x32_bf16 v[192:195], a[32:35], a[76:79], v[192:195]
  s_add_u32 s70, s75, 640
  buffer_load_dwordx4 a[208:211], v5, s[24:27], s32 offen offset:0 nt
  v_mfma_f32_16x16x32_bf16 v[224:227], a[32:35], a[80:83], v[224:227]
  s_add_u32 m0, s80, 69632
  ds_read_b64_tr_b16 a[98:99], v13 offset:50176
  v_mfma_f32_16x16x32_bf16 v[88:91], a[32:35], a[84:87], v[88:91]
  buffer_load_dwordx4 v3, s[4:7], s70 offen  lds
  v_mfma_f32_16x16x32_bf16 v[56:59], a[32:35], a[88:91], v[56:59]
  v_mfma_f32_16x16x32_bf16 a[0:3], a[32:35], a[92:95], a[0:3]
  ds_read_b128 a[132:135], v10 offset:2048
  v_mfma_f32_16x16x32_bf16 a[4:7], a[36:39], a[92:95], a[4:7]
  v_mfma_f32_16x16x32_bf16 v[60:63], a[36:39], a[88:91], v[60:63]
  ds_read_b64_tr_b16 a[100:101], v14 offset:49152
  v_mfma_f32_16x16x32_bf16 v[92:95], a[36:39], a[84:87], v[92:95]
  s_add_u32 s70, s78, 2621440
  v_mfma_f32_16x16x32_bf16 v[228:231], a[36:39], a[80:83], v[228:231]
  s_add_u32 m0, s81, 32768
  ds_read_b64_tr_b16 a[102:103], v14 offset:50176
  v_mfma_f32_16x16x32_bf16 v[196:199], a[36:39], a[76:79], v[196:199]
  buffer_load_dwordx4 v7, s[8:11], s70 offen  lds
  v_mfma_f32_16x16x32_bf16 v[164:167], a[36:39], a[72:75], v[164:167]
  v_mfma_f32_16x16x32_bf16 v[132:135], a[36:39], a[68:71], v[132:135]
  ds_read_b128 a[136:139], v10 offset:4096
  v_mfma_f32_16x16x32_bf16 v[100:103], a[36:39], a[64:67], v[100:103]
  v_mfma_f32_16x16x32_bf16 v[104:107], a[40:43], a[64:67], v[104:107]
  ds_read_b64_tr_b16 a[104:105], v15 offset:49152
  v_mfma_f32_16x16x32_bf16 v[136:139], a[40:43], a[68:71], v[136:139]
  s_add_u32 s70, s75, 8832
  v_mfma_f32_16x16x32_bf16 v[168:171], a[40:43], a[72:75], v[168:171]
  s_add_u32 m0, s80, 70656
  ds_read_b64_tr_b16 a[106:107], v15 offset:50176
  v_mfma_f32_16x16x32_bf16 v[200:203], a[40:43], a[76:79], v[200:203]
  buffer_load_dwordx4 v4, s[4:7], s70 offen  lds
  v_mfma_f32_16x16x32_bf16 v[232:235], a[40:43], a[80:83], v[232:235]
  v_mfma_f32_16x16x32_bf16 v[80:83], a[40:43], a[84:87], v[80:83]
  ds_read_b128 a[140:143], v10 offset:6144
  v_mfma_f32_16x16x32_bf16 v[48:51], a[40:43], a[88:91], v[48:51]
  v_mfma_f32_16x16x32_bf16 a[8:11], a[40:43], a[92:95], a[8:11]
  ds_read_b64_tr_b16 a[108:109], v16 offset:49152
  v_mfma_f32_16x16x32_bf16 a[12:15], a[44:47], a[92:95], a[12:15]
  s_add_u32 s70, s78, 2654208
  v_mfma_f32_16x16x32_bf16 v[52:55], a[44:47], a[88:91], v[52:55]
  s_add_u32 m0, s81, 33792
  ds_read_b64_tr_b16 a[110:111], v16 offset:50176
  v_mfma_f32_16x16x32_bf16 v[84:87], a[44:47], a[84:87], v[84:87]
  buffer_load_dwordx4 v7, s[8:11], s70 offen  lds
  v_mfma_f32_16x16x32_bf16 v[236:239], a[44:47], a[80:83], v[236:239]
  v_mfma_f32_16x16x32_bf16 v[204:207], a[44:47], a[76:79], v[204:207]
  ds_read_b128 a[144:147], v10 offset:8192
  v_mfma_f32_16x16x32_bf16 v[172:175], a[44:47], a[72:75], v[172:175]
  v_mfma_f32_16x16x32_bf16 v[140:143], a[44:47], a[68:71], v[140:143]
  ds_read_b64_tr_b16 a[112:113], v17 offset:49152
  v_mfma_f32_16x16x32_bf16 v[108:111], a[44:47], a[64:67], v[108:111]
  s_add_u32 s70, s75, 17024
  v_mfma_f32_16x16x32_bf16 v[112:115], a[48:51], a[64:67], v[112:115]
  s_add_u32 m0, s80, 71680
  ds_read_b64_tr_b16 a[114:115], v17 offset:50176
  v_mfma_f32_16x16x32_bf16 v[144:147], a[48:51], a[68:71], v[144:147]
  buffer_load_dwordx4 v3, s[4:7], s70 offen  lds
  v_mfma_f32_16x16x32_bf16 v[176:179], a[48:51], a[72:75], v[176:179]
  v_mfma_f32_16x16x32_bf16 v[208:211], a[48:51], a[76:79], v[208:211]
  ds_read_b128 a[148:151], v10 offset:10240
  v_mfma_f32_16x16x32_bf16 v[240:243], a[48:51], a[80:83], v[240:243]
  v_mfma_f32_16x16x32_bf16 v[72:75], a[48:51], a[84:87], v[72:75]
  ds_read_b64_tr_b16 a[116:117], v18 offset:49152
  v_mfma_f32_16x16x32_bf16 v[40:43], a[48:51], a[88:91], v[40:43]
  s_add_u32 s70, s78, 2686976
  v_mfma_f32_16x16x32_bf16 a[16:19], a[48:51], a[92:95], a[16:19]
  s_add_u32 m0, s81, 34816
  ds_read_b64_tr_b16 a[118:119], v18 offset:50176
  v_mfma_f32_16x16x32_bf16 a[20:23], a[52:55], a[92:95], a[20:23]
  buffer_load_dwordx4 v8, s[8:11], s70 offen  lds
  v_mfma_f32_16x16x32_bf16 v[44:47], a[52:55], a[88:91], v[44:47]
  v_mfma_f32_16x16x32_bf16 v[76:79], a[52:55], a[84:87], v[76:79]
  ds_read_b128 a[152:155], v10 offset:12288
  v_mfma_f32_16x16x32_bf16 v[244:247], a[52:55], a[80:83], v[244:247]
  v_mfma_f32_16x16x32_bf16 v[212:215], a[52:55], a[76:79], v[212:215]
  ds_read_b64_tr_b16 a[120:121], v19 offset:49152
  v_mfma_f32_16x16x32_bf16 v[180:183], a[52:55], a[72:75], v[180:183]
  s_add_u32 s70, s75, 25216
  v_mfma_f32_16x16x32_bf16 v[148:151], a[52:55], a[68:71], v[148:151]
  s_add_u32 m0, s80, 72704
  ds_read_b64_tr_b16 a[122:123], v19 offset:50176
  v_mfma_f32_16x16x32_bf16 v[116:119], a[52:55], a[64:67], v[116:119]
  buffer_load_dwordx4 v4, s[4:7], s70 offen  lds
  v_mfma_f32_16x16x32_bf16 v[120:123], a[56:59], a[64:67], v[120:123]
  v_mfma_f32_16x16x32_bf16 v[152:155], a[56:59], a[68:71], v[152:155]
  ds_read_b128 a[156:159], v10 offset:14336
  v_mfma_f32_16x16x32_bf16 v[184:187], a[56:59], a[72:75], v[184:187]
  v_mfma_f32_16x16x32_bf16 v[216:219], a[56:59], a[76:79], v[216:219]
  ds_read_b64_tr_b16 a[124:125], v20 offset:49152
  v_mfma_f32_16x16x32_bf16 v[248:251], a[56:59], a[80:83], v[248:251]
  s_add_u32 s70, s78, 2719744
  v_mfma_f32_16x16x32_bf16 v[64:67], a[56:59], a[84:87], v[64:67]
  s_add_u32 m0, s81, 35840
  ds_read_b64_tr_b16 a[126:127], v20 offset:50176
  v_mfma_f32_16x16x32_bf16 v[32:35], a[56:59], a[88:91], v[32:35]
  buffer_load_dwordx4 v8, s[8:11], s70 offen  lds
  v_mfma_f32_16x16x32_bf16 a[24:27], a[56:59], a[92:95], a[24:27]
  v_mfma_f32_16x16x32_bf16 a[28:31], a[60:63], a[92:95], a[28:31]
  v_mfma_f32_16x16x32_bf16 v[36:39], a[60:63], a[88:91], v[36:39]
  v_mfma_f32_16x16x32_bf16 v[68:71], a[60:63], a[84:87], v[68:71]
  v_mfma_f32_16x16x32_bf16 v[252:255], a[60:63], a[80:83], v[252:255]
  v_mfma_f32_16x16x32_bf16 v[220:223], a[60:63], a[76:79], v[220:223]
  v_mfma_f32_16x16x32_bf16 v[188:191], a[60:63], a[72:75], v[188:191]
  v_mfma_f32_16x16x32_bf16 v[156:159], a[60:63], a[68:71], v[156:159]
  s_waitcnt vmcnt(20) lgkmcnt(0)
  v_mfma_f32_16x16x32_bf16 v[124:127], a[60:63], a[64:67], v[124:127]
  s_barrier
  v_mfma_f32_16x16x32_bf16 v[96:99], a[96:99], a[128:131], v[96:99]
  ds_read_b128 a[64:67], v9 offset:32768
  v_mfma_f32_16x16x32_bf16 v[128:131], a[96:99], a[132:135], v[128:131]
  buffer_load_dwordx4 a[212:215], v5, s[24:27], s32 offen offset:64 nt
  v_mfma_f32_16x16x32_bf16 v[160:163], a[96:99], a[136:139], v[160:163]
  ds_read_b64_tr_b16 a[32:33], v13 offset:0
  v_mfma_f32_16x16x32_bf16 v[192:195], a[96:99], a[140:143], v[192:195]
  s_add_u32 s70, s74, 768
  buffer_load_dwordx4 a[216:219], v6, s[24:27], s32 offen offset:128 nt
  v_mfma_f32_16x16x32_bf16 v[224:227], a[96:99], a[144:147], v[224:227]
  s_add_u32 m0, s80, 0
  ds_read_b64_tr_b16 a[34:35], v13 offset:1024
  v_cmp_ne_u32 vcc, 1, v29
  s_cbranch_vccnz L_spin_3
L_back_4:
  v_mfma_f32_16x16x32_bf16 v[88:91], a[96:99], a[148:151], v[88:91]
  buffer_load_dwordx4 v3, s[4:7], s70 offen  lds
  v_mfma_f32_16x16x32_bf16 v[22:25], a[160:163], a[172:175], 0
  v_mfma_f32_16x16x32_bf16 v[56:59], a[96:99], a[152:155], v[56:59]
  v_mfma_f32_16x16x32_bf16 v[26:29], a[160:163], a[184:187], 0
  v_mfma_f32_16x16x32_bf16 a[0:3], a[96:99], a[156:159], a[0:3]
  ds_read_b128 a[68:71], v9 offset:34816
  v_mfma_f32_16x16x32_bf16 v[22:25], a[164:167], a[176:179], v[22:25]
  v_mfma_f32_16x16x32_bf16 a[4:7], a[100:103], a[156:159], a[4:7]
  v_mfma_f32_16x16x32_bf16 v[26:29], a[164:167], a[188:191], v[26:29]
  v_mfma_f32_16x16x32_bf16 v[60:63], a[100:103], a[152:155], v[60:63]
  ds_read_b64_tr_b16 a[36:37], v14 offset:0
  v_mfma_f32_16x16x32_bf16 v[22:25], a[168:171], a[180:183], v[22:25]
  v_mfma_f32_16x16x32_bf16 v[92:95], a[100:103], a[148:151], v[92:95]
  s_add_u32 s70, s78, 2883584
  v_mfma_f32_16x16x32_bf16 v[26:29], a[168:171], a[192:195], v[26:29]
  v_mfma_f32_16x16x32_bf16 v[228:231], a[100:103], a[144:147], v[228:231]
  s_add_u32 m0, s81, 49152
  ds_read_b64_tr_b16 a[38:39], v14 offset:1024
  v_and_b32 v21, 3, v1
  v_mfma_f32_16x16x32_bf16 v[196:199], a[100:103], a[140:143], v[196:199]
  s_nop 0
  buffer_load_dwordx4 v7, s[8:11], s70 offen  lds
  v_mfma_f32_16x16x32_bf16 v[164:167], a[100:103], a[136:139], v[164:167]
  s_nop 0
  v_cmp_eq_u32 vcc, 1, v21
  v_mfma_f32_16x16x32_bf16 v[132:135], a[100:103], a[132:135], v[132:135]
  s_nop 0
  ds_read_b128 a[72:75], v9 offset:36864
  v_cndmask_b32 v22, v22, v23, vcc
  v_mfma_f32_16x16x32_bf16 v[100:103], a[100:103], a[128:131], v[100:103]
  v_cndmask_b32 v26, v26, v27, vcc
  v_mfma_f32_16x16x32_bf16 v[104:107], a[104:107], a[128:131], v[104:107]
  ds_read_b64_tr_b16 a[40:41], v15 offset:0
  v_cmp_eq_u32 vcc, 2, v21
  v_mfma_f32_16x16x32_bf16 v[136:139], a[104:107], a[132:135], v[136:139]
  s_add_u32 s70, s74, 8960
  s_nop 0
  v_cndmask_b32 v22, v22, v24, vcc
  v_mfma_f32_16x16x32_bf16 v[168:171], a[104:107], a[136:139], v[168:171]
  s_add_u32 m0, s80, 1024
  ds_read_b64_tr_b16 a[42:43], v15 offset:1024
  v_cndmask_b32 v26, v26, v28, vcc
  v_mfma_f32_16x16x32_bf16 v[200:203], a[104:107], a[140:143], v[200:203]
  buffer_load_dwordx4 v4, s[4:7], s70 offen  lds
  v_mfma_f32_16x16x32_bf16 v[232:235], a[104:107], a[144:147], v[232:235]
  v_cmp_eq_u32 vcc, 3, v21
  v_mfma_f32_16x16x32_bf16 v[80:83], a[104:107], a[148:151], v[80:83]
  s_nop 0
  ds_read_b128 a[76:79], v9 offset:38912
  v_cndmask_b32 v22, v22, v25, vcc
  v_mfma_f32_16x16x32_bf16 v[48:51], a[104:107], a[152:155], v[48:51]
  v_cndmask_b32 v26, v26, v29, vcc
  v_mfma_f32_16x16x32_bf16 a[8:11], a[104:107], a[156:159], a[8:11]
  ds_read_b64_tr_b16 a[44:45], v16 offset:0
  v_lshrrev_b32 v21, 4, v1
  v_mfma_f32_16x16x32_bf16 a[12:15], a[108:111], a[156:159], a[12:15]
  s_add_u32 s70, s78, 2916352
  v_bfe_u32 v23, v1, 2, 2
  v_mfma_f32_16x16x32_bf16 v[52:55], a[108:111], a[152:155], v[52:55]
  s_add_u32 m0, s81, 50176
  ds_read_b64_tr_b16 a[46:47], v16 offset:1024
  v_cmp_eq_u32 vcc, v21, v23
  v_mfma_f32_16x16x32_bf16 v[84:87], a[108:111], a[148:151], v[84:87]
  s_nop 0
  buffer_load_dwordx4 v7, s[8:11], s70 offen  lds
  v_mfma_f32_16x16x32_bf16 v[236:239], a[108:111], a[144:147], v[236:239]
  v_cndmask_b32 v22, 0, v22, vcc
  v_mfma_f32_16x16x32_bf16 v[204:207], a[108:111], a[140:143], v[204:207]
  ds_read_b128 a[80:83], v9 offset:40960
  v_cndmask_b32 v26, 0, v26, vcc
  v_mfma_f32_16x16x32_bf16 v[172:175], a[108:111], a[136:139], v[172:175]
  v_add_f32_dpp v22, v22, v22 row_ror:8 row_mask:0xf bank_mask:0xf
  v_mfma_f32_16x16x32_bf16 v[140:143], a[108:111], a[132:135], v[140:143]
  ds_read_b64_tr_b16 a[48:49], v17 offset:0
  v_add_f32_dpp v26, v26, v26 row_ror:8 row_mask:0xf bank_mask:0xf
  v_mfma_f32_16x16x32_bf16 v[108:111], a[108:111], a[128:131], v[108:111]
  s_add_u32 s70, s74, 17152
  v_add_f32_dpp v22, v22, v22 row_ror:4 row_mask:0xf bank_mask:0xf
  v_mfma_f32_16x16x32_bf16 v[112:115], a[112:115], a[128:131], v[112:115]
  s_add_u32 m0, s80, 2048
  ds_read_b64_tr_b16 a[50:51], v17 offset:1024
  v_add_f32_dpp v26, v26, v26 row_ror:4 row_mask:0xf bank_mask:0xf
  v_mfma_f32_16x16x32_bf16 v[144:147], a[112:115], a[132:135], v[144:147]
  buffer_load_dwordx4 v3, s[4:7], s70 offen  lds
  v_mfma_f32_16x16x32_bf16 v[176:179], a[112:115], a[136:139], v[176:179]
  v_add_f32_dpp v22, v22, v22 row_ror:2 row_mask:0xf bank_mask:0xf
  v_mfma_f32_16x16x32_bf16 v[208:211], a[112:115], a[140:143], v[208:211]
  ds_read_b128 a[84:87], v9 offset:43008
  v_add_f32_dpp v26, v26, v26 row_ror:2 row_mask:0xf bank_mask:0xf
  v_mfma_f32_16x16x32_bf16 v[240:243], a[112:115], a[144:147], v[240:243]
  v_add_f32_dpp v22, v22, v22 row_ror:1 row_mask:0xf bank_mask:0xf
  v_mfma_f32_16x16x32_bf16 v[72:75], a[112:115], a[148:151], v[72:75]
  ds_read_b64_tr_b16 a[52:53], v18 offset:0
  v_add_f32_dpp v26, v26, v26 row_ror:1 row_mask:0xf bank_mask:0xf
  v_mfma_f32_16x16x32_bf16 v[40:43], a[112:115], a[152:155], v[40:43]
  s_add_u32 s70, s78, 2949120
  v_mov_b32 v23, v22
  v_mfma_f32_16x16x32_bf16 a[16:19], a[112:115], a[156:159], a[16:19]
  s_add_u32 m0, s81, 51200
  ds_read_b64_tr_b16 a[54:55], v18 offset:1024
  v_mov_b32 v24, v26
  v_mfma_f32_16x16x32_bf16 a[20:23], a[116:119], a[156:159], a[20:23]
  buffer_load_dwordx4 v8, s[8:11], s70 offen  lds
  v_mfma_f32_16x16x32_bf16 v[44:47], a[116:119], a[152:155], v[44:47]
  v_permlane16_swap_b32 v22, v23
  v_mfma_f32_16x16x32_bf16 v[76:79], a[116:119], a[148:151], v[76:79]
  ds_read_b128 a[88:91], v9 offset:45056
  v_mfma_f32_16x16x32_bf16 v[244:247], a[116:119], a[144:147], v[244:247]
  v_permlane16_swap_b32 v26, v24
  v_mfma_f32_16x16x32_bf16 v[212:215], a[116:119], a[140:143], v[212:215]
  ds_read_b64_tr_b16 a[56:57], v19 offset:0
  v_add_f32 v22, v22, v23
  v_mfma_f32_16x16x32_bf16 v[180:183], a[116:119], a[136:139], v[180:183]
  s_add_u32 s70, s74, 25344
  v_add_f32 v26, v26, v24
  v_mfma_f32_16x16x32_bf16 v[148:151], a[116:119], a[132:135], v[148:151]
  s_add_u32 m0, s80, 3072
  ds_read_b64_tr_b16 a[58:59], v19 offset:1024
  v_lshrrev_b32 v21, 5, v1
  v_mfma_f32_16x16x32_bf16 v[116:119], a[116:119], a[128:131], v[116:119]
  s_lshl_b32 s71, s2, 3
  buffer_load_dwordx4 v4, s[4:7], s70 offen  lds
  v_mfma_f32_16x16x32_bf16 v[120:123], a[120:123], a[128:131], v[120:123]
  s_lshl_b32 s72, s34, 1
  s_add_u32 s71, s71, s72
  v_add_u32 v21, s71, v21
  v_mfma_f32_16x16x32_bf16 v[152:155], a[120:123], a[132:135], v[152:155]
  ds_read_b128 a[92:95], v9 offset:47104
  v_cvt_pk_bf16_f32 v23, v22, v22
  v_mfma_f32_16x16x32_bf16 v[184:187], a[120:123], a[136:139], v[184:187]
  v_cvt_pk_bf16_f32 v24, v26, v26
  v_mfma_f32_16x16x32_bf16 v[216:219], a[120:123], a[140:143], v[216:219]
  ds_read_b64_tr_b16 a[60:61], v20 offset:0
  v_ashrrev_i32 v25, 31, v23
  v_mfma_f32_16x16x32_bf16 v[248:251], a[120:123], a[144:147], v[248:251]
  s_add_u32 s70, s78, 2981888
  v_or_b32 v25, 0x80000000, v25
  v_mfma_f32_16x16x32_bf16 v[64:67], a[120:123], a[148:151], v[64:67]
  s_add_u32 m0, s81, 52224
  ds_read_b64_tr_b16 a[62:63], v20 offset:1024
  v_xor_b32 v23, v23, v25
  v_mfma_f32_16x16x32_bf16 v[32:35], a[120:123], a[152:155], v[32:35]
  buffer_load_dwordx4 v8, s[8:11], s70 offen  lds
  v_mfma_f32_16x16x32_bf16 a[24:27], a[120:123], a[156:159], a[24:27]
  v_and_b32 v23, 0xffff0000, v23
  v_mfma_f32_16x16x32_bf16 a[28:31], a[124:127], a[156:159], a[28:31]
  v_sub_u32 v25, 0x87ff, v21
  v_mfma_f32_16x16x32_bf16 v[36:39], a[124:127], a[152:155], v[36:39]
  v_or_b32 v23, v23, v25
  v_mfma_f32_16x16x32_bf16 v[68:71], a[124:127], a[148:151], v[68:71]
  v_mov_b32 v25, v23
  v_mfma_f32_16x16x32_bf16 v[252:255], a[124:127], a[144:147], v[252:255]
  s_nop 0
  v_permlane32_swap_b32 v23, v25
  v_mfma_f32_16x16x32_bf16 v[220:223], a[124:127], a[140:143], v[220:223]
  v_max_u32 v23, v23, v25
  v_mfma_f32_16x16x32_bf16 v[188:191], a[124:127], a[136:139], v[188:191]
  v_mfma_f32_16x16x32_bf16 v[156:159], a[124:127], a[132:135], v[156:159]
  s_waitcnt vmcnt(20) lgkmcnt(0)
  v_mfma_f32_16x16x32_bf16 v[124:127], a[124:127], a[128:131], v[124:127]
  s_barrier
  v_mfma_f32_16x16x32_bf16 v[96:99], a[32:35], a[64:67], v[96:99]
  ds_read_b128 a[128:131], v10 offset:32768
  v_and_b32 v24, 0xffff0000, v24
  v_mfma_f32_16x16x32_bf16 v[128:131], a[32:35], a[68:71], v[128:131]
  v_mul_f32 v24, 0xbfb8aa3b, v24
  v_mfma_f32_16x16x32_bf16 v[160:163], a[32:35], a[72:75], v[160:163]
  ds_read_b64_tr_b16 a[96:97], v13 offset:16384
  v_mfma_f32_16x16x32_bf16 v[192:195], a[32:35], a[76:79], v[192:195]
  s_add_u32 s70, s75, 768
  v_exp_f32 v24, v24
  v_mfma_f32_16x16x32_bf16 v[224:227], a[32:35], a[80:83], v[224:227]
  s_add_u32 m0, s80, 4096
  ds_read_b64_tr_b16 a[98:99], v13 offset:17408
  v_add_f32 v24, 1.0, v24
  v_mfma_f32_16x16x32_bf16 v[88:91], a[32:35], a[84:87], v[88:91]
  buffer_load_dwordx4 v3, s[4:7], s70 offen  lds
  v_mfma_f32_16x16x32_bf16 v[56:59], a[32:35], a[88:91], v[56:59]
  v_rcp_f32 v24, v24
  v_mfma_f32_16x16x32_bf16 a[0:3], a[32:35], a[92:95], a[0:3]
  ds_read_b128 a[132:135], v10 offset:34816
  v_cvt_pk_bf16_f32 v24, v24, v24
  v_mfma_f32_16x16x32_bf16 a[4:7], a[36:39], a[92:95], a[4:7]
  v_and_b32 v24, 0xffff0000, v24
  v_mfma_f32_16x16x32_bf16 v[60:63], a[36:39], a[88:91], v[60:63]
  ds_read_b64_tr_b16 a[100:101], v14 offset:16384
  v_lshlrev_b32 v25, 2, v21
  v_mfma_f32_16x16x32_bf16 v[92:95], a[36:39], a[84:87], v[92:95]
  s_add_u32 s70, s78, 3145728
  v_mov_b32 v26, s101
  v_mfma_f32_16x16x32_bf16 v[228:231], a[36:39], a[80:83], v[228:231]
  s_add_u32 m0, s81, 0
  s_add_u32 s72, s89, 12288
  ds_read_b64_tr_b16 a[102:103], v14 offset:17408
  v_mfma_f32_16x16x32_bf16 v[196:199], a[36:39], a[76:79], v[196:199]
  s_mov_b32 s73, 57671680
  buffer_load_dwordx4 v7, s[8:11], s70 offen  lds
  v_mfma_f32_16x16x32_bf16 v[164:167], a[36:39], a[72:75], v[164:167]
  s_add_u32 s71, s100, 16384
  s_mov_b64 exec, 1
  buffer_store_dword v23, off, s[20:23], s72 sc1
  buffer_store_dword v26, off, s[20:23], s71 sc1
  s_mov_b32 exec_hi, 1
  buffer_store_dword v24, v25, s[20:23], s73 offen sc1
  s_mov_b64 exec, -1
  v_mfma_f32_16x16x32_bf16 v[132:135], a[36:39], a[68:71], v[132:135]
  ds_read_b128 a[136:139], v10 offset:36864
  v_mfma_f32_16x16x32_bf16 v[100:103], a[36:39], a[64:67], v[100:103]
  v_mfma_f32_16x16x32_bf16 v[104:107], a[40:43], a[64:67], v[104:107]
  ds_read_b64_tr_b16 a[104:105], v15 offset:16384
  v_mfma_f32_16x16x32_bf16 v[136:139], a[40:43], a[68:71], v[136:139]
  s_add_u32 s70, s75, 8960
  v_mfma_f32_16x16x32_bf16 v[168:171], a[40:43], a[72:75], v[168:171]
  s_add_u32 m0, s80, 5120
  ds_read_b64_tr_b16 a[106:107], v15 offset:17408
  v_mfma_f32_16x16x32_bf16 v[200:203], a[40:43], a[76:79], v[200:203]
  buffer_load_dwordx4 v4, s[4:7], s70 offen  lds
  v_mfma_f32_16x16x32_bf16 v[232:235], a[40:43], a[80:83], v[232:235]
  v_mfma_f32_16x16x32_bf16 v[80:83], a[40:43], a[84:87], v[80:83]
  ds_read_b128 a[140:143], v10 offset:38912
  v_mfma_f32_16x16x32_bf16 v[48:51], a[40:43], a[88:91], v[48:51]
  v_mfma_f32_16x16x32_bf16 a[8:11], a[40:43], a[92:95], a[8:11]
  ds_read_b64_tr_b16 a[108:109], v16 offset:16384
  v_mfma_f32_16x16x32_bf16 a[12:15], a[44:47], a[92:95], a[12:15]
  s_add_u32 s70, s78, 3178496
  v_mfma_f32_16x16x32_bf16 v[52:55], a[44:47], a[88:91], v[52:55]
  s_add_u32 m0, s81, 1024
  ds_read_b64_tr_b16 a[110:111], v16 offset:17408
  v_mfma_f32_16x16x32_bf16 v[84:87], a[44:47], a[84:87], v[84:87]
  buffer_load_dwordx4 v7, s[8:11], s70 offen  lds
  v_mfma_f32_16x16x32_bf16 v[236:239], a[44:47], a[80:83], v[236:239]
  v_mfma_f32_16x16x32_bf16 v[204:207], a[44:47], a[76:79], v[204:207]
  ds_read_b128 a[144:147], v10 offset:40960
  v_mfma_f32_16x16x32_bf16 v[172:175], a[44:47], a[72:75], v[172:175]
  v_mfma_f32_16x16x32_bf16 v[140:143], a[44:47], a[68:71], v[140:143]
  ds_read_b64_tr_b16 a[112:113], v17 offset:16384
  v_mfma_f32_16x16x32_bf16 v[108:111], a[44:47], a[64:67], v[108:111]
  s_add_u32 s70, s75, 17152
  v_mfma_f32_16x16x32_bf16 v[112:115], a[48:51], a[64:67], v[112:115]
  s_add_u32 m0, s80, 6144
  ds_read_b64_tr_b16 a[114:115], v17 offset:17408
  v_mfma_f32_16x16x32_bf16 v[144:147], a[48:51], a[68:71], v[144:147]
  buffer_load_dwordx4 v3, s[4:7], s70 offen  lds
  v_mfma_f32_16x16x32_bf16 v[176:179], a[48:51], a[72:75], v[176:179]
  v_mfma_f32_16x16x32_bf16 v[208:211], a[48:51], a[76:79], v[208:211]
  ds_read_b128 a[148:151], v10 offset:43008
  v_mfma_f32_16x16x32_bf16 v[240:243], a[48:51], a[80:83], v[240:243]
  v_mfma_f32_16x16x32_bf16 v[72:75], a[48:51], a[84:87], v[72:75]
  ds_read_b64_tr_b16 a[116:117], v18 offset:16384
  v_mfma_f32_16x16x32_bf16 v[40:43], a[48:51], a[88:91], v[40:43]
  s_add_u32 s70, s78, 3211264
  v_mfma_f32_16x16x32_bf16 a[16:19], a[48:51], a[92:95], a[16:19]
  s_add_u32 m0, s81, 2048
  ds_read_b64_tr_b16 a[118:119], v18 offset:17408
  v_mfma_f32_16x16x32_bf16 a[20:23], a[52:55], a[92:95], a[20:23]
  buffer_load_dwordx4 v8, s[8:11], s70 offen  lds
  v_mfma_f32_16x16x32_bf16 v[44:47], a[52:55], a[88:91], v[44:47]
  v_mfma_f32_16x16x32_bf16 v[76:79], a[52:55], a[84:87], v[76:79]
  ds_read_b128 a[152:155], v10 offset:45056
  v_mfma_f32_16x16x32_bf16 v[244:247], a[52:55], a[80:83], v[244:247]
  v_mfma_f32_16x16x32_bf16 v[212:215], a[52:55], a[76:79], v[212:215]
  ds_read_b64_tr_b16 a[120:121], v19 offset:16384
  v_mfma_f32_16x16x32_bf16 v[180:183], a[52:55], a[72:75], v[180:183]
  s_add_u32 s70, s75, 25344
  v_mfma_f32_16x16x32_bf16 v[148:151], a[52:55], a[68:71], v[148:151]
  s_add_u32 m0, s80, 7168
  ds_read_b64_tr_b16 a[122:123], v19 offset:17408
  v_mfma_f32_16x16x32_bf16 v[116:119], a[52:55], a[64:67], v[116:119]
  buffer_load_dwordx4 v4, s[4:7], s70 offen  lds
  v_mfma_f32_16x16x32_bf16 v[120:123], a[56:59], a[64:67], v[120:123]
  v_mfma_f32_16x16x32_bf16 v[152:155], a[56:59], a[68:71], v[152:155]
  ds_read_b128 a[156:159], v10 offset:47104
  v_mfma_f32_16x16x32_bf16 v[184:187], a[56:59], a[72:75], v[184:187]
  v_mfma_f32_16x16x32_bf16 v[216:219], a[56:59], a[76:79], v[216:219]
  ds_read_b64_tr_b16 a[124:125], v20 offset:16384
  v_mfma_f32_16x16x32_bf16 v[248:251], a[56:59], a[80:83], v[248:251]
  s_add_u32 s70, s78, 3244032
  v_mfma_f32_16x16x32_bf16 v[64:67], a[56:59], a[84:87], v[64:67]
  s_add_u32 m0, s81, 3072
  ds_read_b64_tr_b16 a[126:127], v20 offset:17408
  v_mfma_f32_16x16x32_bf16 v[32:35], a[56:59], a[88:91], v[32:35]
  buffer_load_dwordx4 v8, s[8:11], s70 offen  lds
  v_mfma_f32_16x16x32_bf16 a[24:27], a[56:59], a[92:95], a[24:27]
  v_mfma_f32_16x16x32_bf16 a[28:31], a[60:63], a[92:95], a[28:31]
  v_mfma_f32_16x16x32_bf16 v[36:39], a[60:63], a[88:91], v[36:39]
  v_mfma_f32_16x16x32_bf16 v[68:71], a[60:63], a[84:87], v[68:71]
  v_mfma_f32_16x16x32_bf16 v[252:255], a[60:63], a[80:83], v[252:255]
  v_mfma_f32_16x16x32_bf16 v[220:223], a[60:63], a[76:79], v[220:223]
  v_mfma_f32_16x16x32_bf16 v[188:191], a[60:63], a[72:75], v[188:191]
  v_mfma_f32_16x16x32_bf16 v[156:159], a[60:63], a[68:71], v[156:159]
  s_waitcnt vmcnt(21) lgkmcnt(0)
  v_mfma_f32_16x16x32_bf16 v[124:127], a[60:63], a[64:67], v[124:127]
  s_barrier
  v_mfma_f32_16x16x32_bf16 v[96:99], a[96:99], a[128:131], v[96:99]
  ds_read_b128 a[64:67], v11 offset:0
  v_lshrrev_b32 v6, 3, v1
  v_mfma_f32_16x16x32_bf16 v[128:131], a[96:99], a[132:135], v[128:131]
  v_lshl_add_u32 v5, v6, 7, v3
  v_mfma_f32_16x16x32_bf16 v[160:163], a[96:99], a[136:139], v[160:163]
  ds_read_b64_tr_b16 a[32:33], v13 offset:32768
  v_lshl_add_u32 v6, v6, 7, v4
  v_mfma_f32_16x16x32_bf16 v[192:195], a[96:99], a[140:143], v[192:195]
  s_add_u32 s70, s74, 896
  v_mfma_f32_16x16x32_bf16 v[224:227], a[96:99], a[144:147], v[224:227]
  s_add_u32 m0, s80, 32768
  ds_read_b64_tr_b16 a[34:35], v13 offset:33792
  v_mfma_f32_16x16x32_bf16 v[88:91], a[96:99], a[148:151], v[88:91]
  buffer_load_dwordx4 v3, s[4:7], s70 offen  lds
  v_mfma_f32_16x16x32_bf16 v[56:59], a[96:99], a[152:155], v[56:59]
  v_mfma_f32_16x16x32_bf16 a[0:3], a[96:99], a[156:159], a[0:3]
  ds_read_b128 a[68:71], v11 offset:2048
  v_mfma_f32_16x16x32_bf16 a[4:7], a[100:103], a[156:159], a[4:7]
  v_mfma_f32_16x16x32_bf16 v[60:63], a[100:103], a[152:155], v[60:63]
  ds_read_b64_tr_b16 a[36:37], v14 offset:32768
  v_mfma_f32_16x16x32_bf16 v[92:95], a[100:103], a[148:151], v[92:95]
  s_add_u32 s70, s78, 3407872
  v_mfma_f32_16x16x32_bf16 v[228:231], a[100:103], a[144:147], v[228:231]
  s_add_u32 m0, s81, 16384
  ds_read_b64_tr_b16 a[38:39], v14 offset:33792
  v_mfma_f32_16x16x32_bf16 v[196:199], a[100:103], a[140:143], v[196:199]
  buffer_load_dwordx4 v7, s[8:11], s70 offen  lds
  v_mfma_f32_16x16x32_bf16 v[164:167], a[100:103], a[136:139], v[164:167]
  v_mfma_f32_16x16x32_bf16 v[132:135], a[100:103], a[132:135], v[132:135]
  ds_read_b128 a[72:75], v11 offset:4096
  v_mfma_f32_16x16x32_bf16 v[100:103], a[100:103], a[128:131], v[100:103]
  v_mfma_f32_16x16x32_bf16 v[104:107], a[104:107], a[128:131], v[104:107]
  ds_read_b64_tr_b16 a[40:41], v15 offset:32768
  v_mfma_f32_16x16x32_bf16 v[136:139], a[104:107], a[132:135], v[136:139]
  s_add_u32 s70, s74, 9088
  v_mfma_f32_16x16x32_bf16 v[168:171], a[104:107], a[136:139], v[168:171]
  s_add_u32 m0, s80, 33792
  ds_read_b64_tr_b16 a[42:43], v15 offset:33792
  v_mfma_f32_16x16x32_bf16 v[200:203], a[104:107], a[140:143], v[200:203]
  buffer_load_dwordx4 v4, s[4:7], s70 offen  lds
  v_mfma_f32_16x16x32_bf16 v[232:235], a[104:107], a[144:147], v[232:235]
  v_mfma_f32_16x16x32_bf16 v[80:83], a[104:107], a[148:151], v[80:83]
  ds_read_b128 a[76:79], v11 offset:6144
  v_mfma_f32_16x16x32_bf16 v[48:51], a[104:107], a[152:155], v[48:51]
  v_mfma_f32_16x16x32_bf16 a[8:11], a[104:107], a[156:159], a[8:11]
  ds_read_b64_tr_b16 a[44:45], v16 offset:32768
  v_mfma_f32_16x16x32_bf16 a[12:15], a[108:111], a[156:159], a[12:15]
  s_add_u32 s70, s78, 3440640
  v_mfma_f32_16x16x32_bf16 v[52:55], a[108:111], a[152:155], v[52:55]
  s_add_u32 m0, s81, 17408
  ds_read_b64_tr_b16 a[46:47], v16 offset:33792
  v_mfma_f32_16x16x32_bf16 v[84:87], a[108:111], a[148:151], v[84:87]
  buffer_load_dwordx4 v7, s[8:11], s70 offen  lds
  v_mfma_f32_16x16x32_bf16 v[236:239], a[108:111], a[144:147], v[236:239]
  v_mfma_f32_16x16x32_bf16 v[204:207], a[108:111], a[140:143], v[204:207]
  ds_read_b128 a[80:83], v11 offset:8192
  v_mfma_f32_16x16x32_bf16 v[172:175], a[108:111], a[136:139], v[172:175]
  v_mfma_f32_16x16x32_bf16 v[140:143], a[108:111], a[132:135], v[140:143]
  ds_read_b64_tr_b16 a[48:49], v17 offset:32768
  v_mfma_f32_16x16x32_bf16 v[108:111], a[108:111], a[128:131], v[108:111]
  s_add_u32 s70, s74, 17280
  v_mfma_f32_16x16x32_bf16 v[112:115], a[112:115], a[128:131], v[112:115]
  s_add_u32 m0, s80, 34816
  ds_read_b64_tr_b16 a[50:51], v17 offset:33792
  v_mfma_f32_16x16x32_bf16 v[144:147], a[112:115], a[132:135], v[144:147]
  buffer_load_dwordx4 v3, s[4:7], s70 offen  lds
  v_mfma_f32_16x16x32_bf16 v[176:179], a[112:115], a[136:139], v[176:179]
  v_mfma_f32_16x16x32_bf16 v[208:211], a[112:115], a[140:143], v[208:211]
  ds_read_b128 a[84:87], v11 offset:10240
  v_mfma_f32_16x16x32_bf16 v[240:243], a[112:115], a[144:147], v[240:243]
  v_mfma_f32_16x16x32_bf16 v[72:75], a[112:115], a[148:151], v[72:75]
  ds_read_b64_tr_b16 a[52:53], v18 offset:32768
  v_mfma_f32_16x16x32_bf16 v[40:43], a[112:115], a[152:155], v[40:43]
  s_add_u32 s70, s78, 3473408
  v_mfma_f32_16x16x32_bf16 a[16:19], a[112:115], a[156:159], a[16:19]
  s_add_u32 m0, s81, 18432
  ds_read_b64_tr_b16 a[54:55], v18 offset:33792
  v_mfma_f32_16x16x32_bf16 a[20:23], a[116:119], a[156:159], a[20:23]
  buffer_load_dwordx4 v8, s[8:11], s70 offen  lds
  v_mfma_f32_16x16x32_bf16 v[44:47], a[116:119], a[152:155], v[44:47]
  v_mfma_f32_16x16x32_bf16 v[76:79], a[116:119], a[148:151], v[76:79]
  ds_read_b128 a[88:91], v11 offset:12288
  v_mfma_f32_16x16x32_bf16 v[244:247], a[116:119], a[144:147], v[244:247]
  v_mfma_f32_16x16x32_bf16 v[212:215], a[116:119], a[140:143], v[212:215]
  ds_read_b64_tr_b16 a[56:57], v19 offset:32768
  v_mfma_f32_16x16x32_bf16 v[180:183], a[116:119], a[136:139], v[180:183]
  s_add_u32 s70, s74, 25472
  v_mfma_f32_16x16x32_bf16 v[148:151], a[116:119], a[132:135], v[148:151]
  s_add_u32 m0, s80, 35840
  ds_read_b64_tr_b16 a[58:59], v19 offset:33792
  v_mfma_f32_16x16x32_bf16 v[116:119], a[116:119], a[128:131], v[116:119]
  buffer_load_dwordx4 v4, s[4:7], s70 offen  lds
  v_mfma_f32_16x16x32_bf16 v[120:123], a[120:123], a[128:131], v[120:123]
  v_mfma_f32_16x16x32_bf16 v[152:155], a[120:123], a[132:135], v[152:155]
  ds_read_b128 a[92:95], v11 offset:14336
  v_mfma_f32_16x16x32_bf16 v[184:187], a[120:123], a[136:139], v[184:187]
  v_mfma_f32_16x16x32_bf16 v[216:219], a[120:123], a[140:143], v[216:219]
  ds_read_b64_tr_b16 a[60:61], v20 offset:32768
  v_mfma_f32_16x16x32_bf16 v[248:251], a[120:123], a[144:147], v[248:251]
  s_add_u32 s70, s78, 3506176
  v_mfma_f32_16x16x32_bf16 v[64:67], a[120:123], a[148:151], v[64:67]
  s_add_u32 m0, s81, 19456
  ds_read_b64_tr_b16 a[62:63], v20 offset:33792
  v_mfma_f32_16x16x32_bf16 v[32:35], a[120:123], a[152:155], v[32:35]
  buffer_load_dwordx4 v8, s[8:11], s70 offen  lds
  v_mfma_f32_16x16x32_bf16 a[24:27], a[120:123], a[156:159], a[24:27]
  v_mfma_f32_16x16x32_bf16 a[28:31], a[124:127], a[156:159], a[28:31]
  v_mfma_f32_16x16x32_bf16 v[36:39], a[124:127], a[152:155], v[36:39]
  v_mfma_f32_16x16x32_bf16 v[68:71], a[124:127], a[148:151], v[68:71]
  v_mfma_f32_16x16x32_bf16 v[252:255], a[124:127], a[144:147], v[252:255]
  v_mfma_f32_16x16x32_bf16 v[220:223], a[124:127], a[140:143], v[220:223]
  v_mfma_f32_16x16x32_bf16 v[188:191], a[124:127], a[136:139], v[188:191]
  v_mfma_f32_16x16x32_bf16 v[156:159], a[124:127], a[132:135], v[156:159]
  s_waitcnt vmcnt(19) lgkmcnt(0)
  v_mfma_f32_16x16x32_bf16 v[124:127], a[124:127], a[128:131], v[124:127]
  s_barrier
  v_mfma_f32_16x16x32_bf16 v[96:99], a[32:35], a[64:67], v[96:99]
  ds_read_b128 a[128:131], v12 offset:0
  v_min_u32 v21, 35, v1
  v_mfma_f32_16x16x32_bf16 v[128:131], a[32:35], a[68:71], v[128:131]
  s_lshr_b32 s71, s2, 3
  s_lshl_b32 s71, s71, 2
  s_add_u32 s71, s71, s34
  v_mfma_f32_16x16x32_bf16 v[160:163], a[32:35], a[72:75], v[160:163]
  s_mul_i32 s71, s71, 36
  ds_read_b64_tr_b16 a[96:97], v13 offset:49152
  v_add_u32 v21, s71, v21
  v_mfma_f32_16x16x32_bf16 v[192:195], a[32:35], a[76:79], v[192:195]
  s_add_u32 s70, s75, 896
  v_lshrrev_b32 v22, 3, v21
  v_mfma_f32_16x16x32_bf16 v[224:227], a[32:35], a[80:83], v[224:227]
  s_add_u32 m0, s80, 36864
  ds_read_b64_tr_b16 a[98:99], v13 offset:50176
  v_lshlrev_b32 v22, 13, v22
  v_mfma_f32_16x16x32_bf16 v[88:91], a[32:35], a[84:87], v[88:91]
  buffer_load_dwordx4 v3, s[4:7], s70 offen  lds
  v_mfma_f32_16x16x32_bf16 v[56:59], a[32:35], a[88:91], v[56:59]
  v_and_b32 v21, 7, v21
  v_mfma_f32_16x16x32_bf16 a[0:3], a[32:35], a[92:95], a[0:3]
  ds_read_b128 a[132:135], v12 offset:2048
  v_lshl_add_u32 v21, v21, 7, v22
  v_mfma_f32_16x16x32_bf16 a[4:7], a[36:39], a[92:95], a[4:7]
  s_and_b32 s71, s2, 7
  s_lshl_b32 s71, s71, 10
  v_mfma_f32_16x16x32_bf16 v[60:63], a[36:39], a[88:91], v[60:63]
  ds_read_b64_tr_b16 a[100:101], v14 offset:49152
  v_mfma_f32_16x16x32_bf16 v[92:95], a[36:39], a[84:87], v[92:95]
  s_add_u32 s70, s78, 3670016
  buffer_load_dword v30, v21, s[16:19], s71 offen
  v_mfma_f32_16x16x32_bf16 v[228:231], a[36:39], a[80:83], v[228:231]
  s_add_u32 m0, s81, 32768
  ds_read_b64_tr_b16 a[102:103], v14 offset:50176
  v_mfma_f32_16x16x32_bf16 v[196:199], a[36:39], a[76:79], v[196:199]
  buffer_load_dwordx4 v7, s[8:11], s70 offen  lds
  v_mfma_f32_16x16x32_bf16 v[164:167], a[36:39], a[72:75], v[164:167]
  v_mfma_f32_16x16x32_bf16 v[132:135], a[36:39], a[68:71], v[132:135]
  ds_read_b128 a[136:139], v12 offset:4096
  v_mfma_f32_16x16x32_bf16 v[100:103], a[36:39], a[64:67], v[100:103]
  v_mfma_f32_16x16x32_bf16 v[104:107], a[40:43], a[64:67], v[104:107]
  ds_read_b64_tr_b16 a[104:105], v15 offset:49152
  v_mfma_f32_16x16x32_bf16 v[136:139], a[40:43], a[68:71], v[136:139]
  s_add_u32 s70, s75, 9088
  v_mfma_f32_16x16x32_bf16 v[168:171], a[40:43], a[72:75], v[168:171]
  s_add_u32 m0, s80, 37888
  ds_read_b64_tr_b16 a[106:107], v15 offset:50176
  v_mfma_f32_16x16x32_bf16 v[200:203], a[40:43], a[76:79], v[200:203]
  buffer_load_dwordx4 v4, s[4:7], s70 offen  lds
  v_mfma_f32_16x16x32_bf16 v[232:235], a[40:43], a[80:83], v[232:235]
  v_mfma_f32_16x16x32_bf16 v[80:83], a[40:43], a[84:87], v[80:83]
  ds_read_b128 a[140:143], v12 offset:6144
  v_mfma_f32_16x16x32_bf16 v[48:51], a[40:43], a[88:91], v[48:51]
  v_mfma_f32_16x16x32_bf16 a[8:11], a[40:43], a[92:95], a[8:11]
  ds_read_b64_tr_b16 a[108:109], v16 offset:49152
  v_mfma_f32_16x16x32_bf16 a[12:15], a[44:47], a[92:95], a[12:15]
  s_add_u32 s70, s78, 3702784
  v_mfma_f32_16x16x32_bf16 v[52:55], a[44:47], a[88:91], v[52:55]
  s_add_u32 m0, s81, 33792
  ds_read_b64_tr_b16 a[110:111], v16 offset:50176
  v_mfma_f32_16x16x32_bf16 v[84:87], a[44:47], a[84:87], v[84:87]
  buffer_load_dwordx4 v7, s[8:11], s70 offen  lds
  v_mfma_f32_16x16x32_bf16 v[236:239], a[44:47], a[80:83], v[236:239]
  v_mfma_f32_16x16x32_bf16 v[204:207], a[44:47], a[76:79], v[204:207]
  ds_read_b128 a[144:147], v12 offset:8192
  v_mfma_f32_16x16x32_bf16 v[172:175], a[44:47], a[72:75], v[172:175]
  v_mfma_f32_16x16x32_bf16 v[140:143], a[44:47], a[68:71], v[140:143]
  ds_read_b64_tr_b16 a[112:113], v17 offset:49152
  v_mfma_f32_16x16x32_bf16 v[108:111], a[44:47], a[64:67], v[108:111]
  s_add_u32 s70, s75, 17280
  v_mfma_f32_16x16x32_bf16 v[112:115], a[48:51], a[64:67], v[112:115]
  s_add_u32 m0, s80, 38912
  ds_read_b64_tr_b16 a[114:115], v17 offset:50176
  v_mfma_f32_16x16x32_bf16 v[144:147], a[48:51], a[68:71], v[144:147]
  buffer_load_dwordx4 v3, s[4:7], s70 offen  lds
  v_mfma_f32_16x16x32_bf16 v[176:179], a[48:51], a[72:75], v[176:179]
  v_mfma_f32_16x16x32_bf16 v[208:211], a[48:51], a[76:79], v[208:211]
  ds_read_b128 a[148:151], v12 offset:10240
  v_mfma_f32_16x16x32_bf16 v[240:243], a[48:51], a[80:83], v[240:243]
  v_mfma_f32_16x16x32_bf16 v[72:75], a[48:51], a[84:87], v[72:75]
  ds_read_b64_tr_b16 a[116:117], v18 offset:49152
  v_mfma_f32_16x16x32_bf16 v[40:43], a[48:51], a[88:91], v[40:43]
  s_add_u32 s70, s78, 3735552
  v_mfma_f32_16x16x32_bf16 a[16:19], a[48:51], a[92:95], a[16:19]
  s_add_u32 m0, s81, 34816
  ds_read_b64_tr_b16 a[118:119], v18 offset:50176
  v_mfma_f32_16x16x32_bf16 a[20:23], a[52:55], a[92:95], a[20:23]
  buffer_load_dwordx4 v8, s[8:11], s70 offen  lds
  v_mfma_f32_16x16x32_bf16 v[44:47], a[52:55], a[88:91], v[44:47]
  v_mfma_f32_16x16x32_bf16 v[76:79], a[52:55], a[84:87], v[76:79]
  ds_read_b128 a[152:155], v12 offset:12288
  v_mfma_f32_16x16x32_bf16 v[244:247], a[52:55], a[80:83], v[244:247]
  v_mfma_f32_16x16x32_bf16 v[212:215], a[52:55], a[76:79], v[212:215]
  ds_read_b64_tr_b16 a[120:121], v19 offset:49152
  v_mfma_f32_16x16x32_bf16 v[180:183], a[52:55], a[72:75], v[180:183]
  s_add_u32 s70, s75, 25472
  v_mfma_f32_16x16x32_bf16 v[148:151], a[52:55], a[68:71], v[148:151]
  s_add_u32 m0, s80, 39936
  ds_read_b64_tr_b16 a[122:123], v19 offset:50176
  v_mfma_f32_16x16x32_bf16 v[116:119], a[52:55], a[64:67], v[116:119]
  buffer_load_dwordx4 v4, s[4:7], s70 offen  lds
  v_mfma_f32_16x16x32_bf16 v[120:123], a[56:59], a[64:67], v[120:123]
  v_mfma_f32_16x16x32_bf16 v[152:155], a[56:59], a[68:71], v[152:155]
  ds_read_b128 a[156:159], v12 offset:14336
  v_mfma_f32_16x16x32_bf16 v[184:187], a[56:59], a[72:75], v[184:187]
  v_mfma_f32_16x16x32_bf16 v[216:219], a[56:59], a[76:79], v[216:219]
  ds_read_b64_tr_b16 a[124:125], v20 offset:49152
  v_mfma_f32_16x16x32_bf16 v[248:251], a[56:59], a[80:83], v[248:251]
  s_add_u32 s70, s78, 3768320
  v_mfma_f32_16x16x32_bf16 v[64:67], a[56:59], a[84:87], v[64:67]
  s_add_u32 m0, s81, 35840
  ds_read_b64_tr_b16 a[126:127], v20 offset:50176
  v_mfma_f32_16x16x32_bf16 v[32:35], a[56:59], a[88:91], v[32:35]
  buffer_load_dwordx4 v8, s[8:11], s70 offen  lds
  v_mfma_f32_16x16x32_bf16 a[24:27], a[56:59], a[92:95], a[24:27]
  v_mfma_f32_16x16x32_bf16 a[28:31], a[60:63], a[92:95], a[28:31]
  v_mfma_f32_16x16x32_bf16 v[36:39], a[60:63], a[88:91], v[36:39]
  v_mfma_f32_16x16x32_bf16 v[68:71], a[60:63], a[84:87], v[68:71]
  v_mfma_f32_16x16x32_bf16 v[252:255], a[60:63], a[80:83], v[252:255]
  v_mfma_f32_16x16x32_bf16 v[220:223], a[60:63], a[76:79], v[220:223]
  v_mfma_f32_16x16x32_bf16 v[188:191], a[60:63], a[72:75], v[188:191]
  v_mfma_f32_16x16x32_bf16 v[156:159], a[60:63], a[68:71], v[156:159]
  s_waitcnt vmcnt(17) lgkmcnt(0)
  v_mfma_f32_16x16x32_bf16 v[124:127], a[60:63], a[64:67], v[124:127]
  s_barrier
  v_mfma_f32_16x16x32_bf16 v[96:99], a[96:99], a[128:131], v[96:99]
  s_and_b32 s72, s2, 1
  s_lshl_b32 s72, s72, 2
  ds_read_b128 a[64:67], v9 offset:0
  v_mfma_f32_16x16x32_bf16 v[128:131], a[96:99], a[132:135], v[128:131]
  s_add_u32 s72, s72, s34
  s_lshl_b32 s72, s72, 6
  s_lshr_b32 s71, s2, 2
  v_mfma_f32_16x16x32_bf16 v[160:163], a[96:99], a[136:139], v[160:163]
  s_add_u32 s72, s72, s71
  s_mul_i32 s72, s72, 9216
  ds_read_b64_tr_b16 a[32:33], v13 offset:0
  v_mfma_f32_16x16x32_bf16 v[192:195], a[96:99], a[140:143], v[192:195]
  s_add_u32 s70, s76, 0
  s_add_u32 s72, s72, 52428800
  s_bfe_u32 s71, s2, 0x10001
  v_mfma_f32_16x16x32_bf16 v[224:227], a[96:99], a[144:147], v[224:227]
  s_add_u32 m0, s80, 65536
  s_lshl_b32 s97, s71, 12
  ds_read_b64_tr_b16 a[34:35], v13 offset:1024
  v_mfma_f32_16x16x32_bf16 v[88:91], a[96:99], a[148:151], v[88:91]
  s_add_u32 s97, s97, s72
  buffer_load_dwordx4 v5, s[12:15], s70 offen  lds
  v_mfma_f32_16x16x32_bf16 v[56:59], a[96:99], a[152:155], v[56:59]
  s_add_u32 s32, s72, 8192
  s_lshl_b32 s71, s71, 3
  s_lshl_b32 s73, 0x00ff00ff, s71
  v_mfma_f32_16x16x32_bf16 v[22:25], a[196:199], a[220:223], 0
  v_mfma_f32_16x16x32_bf16 a[0:3], a[96:99], a[156:159], a[0:3]
  ds_read_b128 a[68:71], v9 offset:2048
  v_mfma_f32_16x16x32_bf16 v[26:29], a[208:211], a[220:223], 0
  v_mfma_f32_16x16x32_bf16 a[4:7], a[100:103], a[156:159], a[4:7]
  s_nop 1
  v_mfma_f32_16x16x32_bf16 v[60:63], a[100:103], a[152:155], v[60:63]
  s_nop 1
  ds_read_b64_tr_b16 a[36:37], v14 offset:0
  v_mfma_f32_16x16x32_bf16 v[92:95], a[100:103], a[148:151], v[92:95]
  s_add_u32 s70, s78, 3932160
  s_nop 1
  v_mfma_f32_16x16x32_bf16 v[228:231], a[100:103], a[144:147], v[228:231]
  s_add_u32 m0, s81, 49152
  ds_read_b64_tr_b16 a[38:39], v14 offset:1024
  v_cvt_pk_bf16_f32 v22, v22, v23
  v_mfma_f32_16x16x32_bf16 v[196:199], a[100:103], a[140:143], v[196:199]
  buffer_load_dwordx4 v7, s[8:11], s70 offen  lds
  v_mfma_f32_16x16x32_bf16 v[164:167], a[100:103], a[136:139], v[164:167]
  v_cvt_pk_bf16_f32 v23, v24, v25
  v_mfma_f32_16x16x32_bf16 v[132:135], a[100:103], a[132:135], v[132:135]
  ds_read_b128 a[72:75], v9 offset:4096
  v_cvt_pk_bf16_f32 v24, v26, v27
  v_mfma_f32_16x16x32_bf16 v[100:103], a[100:103], a[128:131], v[100:103]
  v_cvt_pk_bf16_f32 v25, v28, v29
  v_mfma_f32_16x16x32_bf16 v[104:107], a[104:107], a[128:131], v[104:107]
  ds_read_b64_tr_b16 a[40:41], v15 offset:0
  v_mfma_f32_16x16x32_bf16 v[136:139], a[104:107], a[132:135], v[136:139]
  s_add_u32 s70, s76, 9216
  buffer_store_dwordx4 v[22:25], v2, s[20:23], s97 offen offset:0 sc1
  v_mfma_f32_16x16x32_bf16 v[168:171], a[104:107], a[136:139], v[168:171]
  s_add_u32 m0, s80, 66560
  ds_read_b64_tr_b16 a[42:43], v15 offset:1024
  v_mfma_f32_16x16x32_bf16 v[200:203], a[104:107], a[140:143], v[200:203]
  buffer_load_dwordx4 v6, s[12:15], s70 offen  lds
  v_mfma_f32_16x16x32_bf16 v[232:235], a[104:107], a[144:147], v[232:235]
  s_nop 1
  v_mfma_f32_16x16x32_bf16 v[22:25], a[196:199], a[224:227], 0
  v_mfma_f32_16x16x32_bf16 v[80:83], a[104:107], a[148:151], v[80:83]
  ds_read_b128 a[76:79], v9 offset:6144
  v_mfma_f32_16x16x32_bf16 v[26:29], a[208:211], a[224:227], 0
  v_mfma_f32_16x16x32_bf16 v[48:51], a[104:107], a[152:155], v[48:51]
  s_nop 1
  v_mfma_f32_16x16x32_bf16 a[8:11], a[104:107], a[156:159], a[8:11]
  s_nop 1
  ds_read_b64_tr_b16 a[44:45], v16 offset:0
  v_mfma_f32_16x16x32_bf16 a[12:15], a[108:111], a[156:159], a[12:15]
  s_add_u32 s70, s78, 3964928
  s_nop 1
  v_mfma_f32_16x16x32_bf16 v[52:55], a[108:111], a[152:155], v[52:55]
  s_add_u32 m0, s81, 50176
  ds_read_b64_tr_b16 a[46:47], v16 offset:1024
  v_cvt_pk_bf16_f32 v22, v22, v23
  v_mfma_f32_16x16x32_bf16 v[84:87], a[108:111], a[148:151], v[84:87]
  buffer_load_dwordx4 v7, s[8:11], s70 offen  lds
  v_mfma_f32_16x16x32_bf16 v[236:239], a[108:111], a[144:147], v[236:239]
  v_cvt_pk_bf16_f32 v23, v24, v25
  v_mfma_f32_16x16x32_bf16 v[204:207], a[108:111], a[140:143], v[204:207]
  ds_read_b128 a[80:83], v9 offset:8192
  v_cvt_pk_bf16_f32 v24, v26, v27
  v_mfma_f32_16x16x32_bf16 v[172:175], a[108:111], a[136:139], v[172:175]
  v_cvt_pk_bf16_f32 v25, v28, v29
  v_mfma_f32_16x16x32_bf16 v[140:143], a[108:111], a[132:135], v[140:143]
  ds_read_b64_tr_b16 a[48:49], v17 offset:0
  v_mfma_f32_16x16x32_bf16 v[108:111], a[108:111], a[128:131], v[108:111]
  s_add_u32 s70, s76, 18432
  buffer_store_dwordx4 v[22:25], v2, s[20:23], s97 offen offset:1024 sc1
  v_mfma_f32_16x16x32_bf16 v[112:115], a[112:115], a[128:131], v[112:115]
  s_add_u32 m0, s80, 67584
  ds_read_b64_tr_b16 a[50:51], v17 offset:1024
  v_mfma_f32_16x16x32_bf16 v[144:147], a[112:115], a[132:135], v[144:147]
  buffer_load_dwordx4 v5, s[12:15], s70 offen  lds
  v_mfma_f32_16x16x32_bf16 v[176:179], a[112:115], a[136:139], v[176:179]
  s_nop 1
  v_mfma_f32_16x16x32_bf16 v[22:25], a[200:203], a[220:223], 0
  v_mfma_f32_16x16x32_bf16 v[208:211], a[112:115], a[140:143], v[208:211]
  ds_read_b128 a[84:87], v9 offset:10240
  v_mfma_f32_16x16x32_bf16 v[26:29], a[212:215], a[220:223], 0
  v_mfma_f32_16x16x32_bf16 v[240:243], a[112:115], a[144:147], v[240:243]
  s_nop 1
  v_mfma_f32_16x16x32_bf16 v[72:75], a[112:115], a[148:151], v[72:75]
  s_nop 1
  ds_read_b64_tr_b16 a[52:53], v18 offset:0
  v_mfma_f32_16x16x32_bf16 v[40:43], a[112:115], a[152:155], v[40:43]
  s_add_u32 s70, s78, 3997696
  s_nop 1
  v_mfma_f32_16x16x32_bf16 a[16:19], a[112:115], a[156:159], a[16:19]
  s_add_u32 m0, s81, 51200
  ds_read_b64_tr_b16 a[54:55], v18 offset:1024
  v_cvt_pk_bf16_f32 v22, v22, v23
  v_mfma_f32_16x16x32_bf16 a[20:23], a[116:119], a[156:159], a[20:23]
  buffer_load_dwordx4 v8, s[8:11], s70 offen  lds
  v_mfma_f32_16x16x32_bf16 v[44:47], a[116:119], a[152:155], v[44:47]
  v_cvt_pk_bf16_f32 v23, v24, v25
  v_mfma_f32_16x16x32_bf16 v[76:79], a[116:119], a[148:151], v[76:79]
  ds_read_b128 a[88:91], v9 offset:12288
  v_cvt_pk_bf16_f32 v24, v26, v27
  v_mfma_f32_16x16x32_bf16 v[244:247], a[116:119], a[144:147], v[244:247]
  v_cvt_pk_bf16_f32 v25, v28, v29
  v_mfma_f32_16x16x32_bf16 v[212:215], a[116:119], a[140:143], v[212:215]
  ds_read_b64_tr_b16 a[56:57], v19 offset:0
  v_mfma_f32_16x16x32_bf16 v[180:183], a[116:119], a[136:139], v[180:183]
  s_add_u32 s70, s76, 27648
  buffer_store_dwordx4 v[22:25], v2, s[20:23], s97 offen offset:2048 sc1
  v_mfma_f32_16x16x32_bf16 v[148:151], a[116:119], a[132:135], v[148:151]
  s_add_u32 m0, s80, 68608
  ds_read_b64_tr_b16 a[58:59], v19 offset:1024
  v_mfma_f32_16x16x32_bf16 v[116:119], a[116:119], a[128:131], v[116:119]
  buffer_load_dwordx4 v6, s[12:15], s70 offen  lds
  v_mfma_f32_16x16x32_bf16 v[120:123], a[120:123], a[128:131], v[120:123]
  s_nop 1
  v_mfma_f32_16x16x32_bf16 v[22:25], a[200:203], a[224:227], 0
  v_mfma_f32_16x16x32_bf16 v[152:155], a[120:123], a[132:135], v[152:155]
  ds_read_b128 a[92:95], v9 offset:14336
  v_mfma_f32_16x16x32_bf16 v[26:29], a[212:215], a[224:227], 0
  v_mfma_f32_16x16x32_bf16 v[184:187], a[120:123], a[136:139], v[184:187]
  s_nop 1
  v_mfma_f32_16x16x32_bf16 v[216:219], a[120:123], a[140:143], v[216:219]
  s_nop 1
  ds_read_b64_tr_b16 a[60:61], v20 offset:0
  v_mfma_f32_16x16x32_bf16 v[248:251], a[120:123], a[144:147], v[248:251]
  s_add_u32 s70, s78, 4030464
  s_nop 1
  v_mfma_f32_16x16x32_bf16 v[64:67], a[120:123], a[148:151], v[64:67]
  s_add_u32 m0, s81, 52224
  ds_read_b64_tr_b16 a[62:63], v20 offset:1024
  v_cvt_pk_bf16_f32 v22, v22, v23
  v_mfma_f32_16x16x32_bf16 v[32:35], a[120:123], a[152:155], v[32:35]
  buffer_load_dwordx4 v8, s[8:11], s70 offen  lds
  v_mfma_f32_16x16x32_bf16 a[24:27], a[120:123], a[156:159], a[24:27]
  v_cvt_pk_bf16_f32 v23, v24, v25
  v_mfma_f32_16x16x32_bf16 a[28:31], a[124:127], a[156:159], a[28:31]
  v_cvt_pk_bf16_f32 v24, v26, v27
  v_mfma_f32_16x16x32_bf16 v[36:39], a[124:127], a[152:155], v[36:39]
  v_cvt_pk_bf16_f32 v25, v28, v29
  v_mfma_f32_16x16x32_bf16 v[68:71], a[124:127], a[148:151], v[68:71]
  buffer_store_dwordx4 v[22:25], v2, s[20:23], s97 offen offset:3072 sc1
  v_mfma_f32_16x16x32_bf16 v[252:255], a[124:127], a[144:147], v[252:255]
  s_nop 1
  v_mfma_f32_16x16x32_bf16 v[22:25], a[204:207], a[228:231], 0
  v_mfma_f32_16x16x32_bf16 v[220:223], a[124:127], a[140:143], v[220:223]
  v_mfma_f32_16x16x32_bf16 v[26:29], a[216:219], a[228:231], 0
  v_mfma_f32_16x16x32_bf16 v[188:191], a[124:127], a[136:139], v[188:191]
  v_mfma_f32_16x16x32_bf16 v[156:159], a[124:127], a[132:135], v[156:159]
  s_waitcnt vmcnt(21) lgkmcnt(0)
  v_mfma_f32_16x16x32_bf16 v[124:127], a[124:127], a[128:131], v[124:127]
  s_barrier
  v_mfma_f32_16x16x32_bf16 v[96:99], a[32:35], a[64:67], v[96:99]
  s_nop 1
  ds_read_b128 a[128:131], v10 offset:0
  v_mfma_f32_16x16x32_bf16 v[128:131], a[32:35], a[68:71], v[128:131]
  s_nop 1
  v_mfma_f32_16x16x32_bf16 v[160:163], a[32:35], a[72:75], v[160:163]
  s_nop 1
  ds_read_b64_tr_b16 a[96:97], v13 offset:16384
  v_mfma_f32_16x16x32_bf16 v[192:195], a[32:35], a[76:79], v[192:195]
  s_add_u32 s70, s77, 0
  v_cvt_pk_bf16_f32 v22, v22, v23
  v_mfma_f32_16x16x32_bf16 v[224:227], a[32:35], a[80:83], v[224:227]
  s_add_u32 m0, s80, 69632
  ds_read_b64_tr_b16 a[98:99], v13 offset:17408
  v_cvt_pk_bf16_f32 v23, v24, v25
  v_mfma_f32_16x16x32_bf16 v[88:91], a[32:35], a[84:87], v[88:91]
  buffer_load_dwordx4 v5, s[12:15], s70 offen  lds
  v_mfma_f32_16x16x32_bf16 v[56:59], a[32:35], a[88:91], v[56:59]
  v_cvt_pk_bf16_f32 v24, v26, v27
  v_mfma_f32_16x16x32_bf16 a[0:3], a[32:35], a[92:95], a[0:3]
  ds_read_b128 a[132:135], v10 offset:2048
  v_cvt_pk_bf16_f32 v25, v28, v29
  v_mfma_f32_16x16x32_bf16 a[4:7], a[36:39], a[92:95], a[4:7]
  s_mov_b32 exec_lo, s73
  s_mov_b32 exec_hi, s73
  buffer_store_dwordx4 v[22:25], v2, s[20:23], s32 offen sc1
  s_mov_b64 exec, -1
  v_mfma_f32_16x16x32_bf16 v[60:63], a[36:39], a[88:91], v[60:63]
  s_nop 1
  ds_read_b64_tr_b16 a[100:101], v14 offset:16384
  v_mfma_f32_16x16x32_bf16 v[92:95], a[36:39], a[84:87], v[92:95]
  s_add_u32 s70, s79, 0
  v_mfma_f32_16x16x32_bf16 v[228:231], a[36:39], a[80:83], v[228:231]
  s_add_u32 m0, s81, 0
  ds_read_b64_tr_b16 a[102:103], v14 offset:17408
  v_mfma_f32_16x16x32_bf16 v[196:199], a[36:39], a[76:79], v[196:199]
  buffer_load_dwordx4 v7, s[16:19], s70 offen  lds
  v_mfma_f32_16x16x32_bf16 v[164:167], a[36:39], a[72:75], v[164:167]
  v_mfma_f32_16x16x32_bf16 v[132:135], a[36:39], a[68:71], v[132:135]
  ds_read_b128 a[136:139], v10 offset:4096
  v_mfma_f32_16x16x32_bf16 v[100:103], a[36:39], a[64:67], v[100:103]
  v_mfma_f32_16x16x32_bf16 v[104:107], a[40:43], a[64:67], v[104:107]
  ds_read_b64_tr_b16 a[104:105], v15 offset:16384
  v_mfma_f32_16x16x32_bf16 v[136:139], a[40:43], a[68:71], v[136:139]
  s_add_u32 s70, s77, 9216
  v_mfma_f32_16x16x32_bf16 v[168:171], a[40:43], a[72:75], v[168:171]
  s_add_u32 m0, s80, 70656
  ds_read_b64_tr_b16 a[106:107], v15 offset:17408
  v_mfma_f32_16x16x32_bf16 v[200:203], a[40:43], a[76:79], v[200:203]
  buffer_load_dwordx4 v6, s[12:15], s70 offen  lds
  v_mfma_f32_16x16x32_bf16 v[232:235], a[40:43], a[80:83], v[232:235]
  v_mfma_f32_16x16x32_bf16 v[80:83], a[40:43], a[84:87], v[80:83]
  ds_read_b128 a[140:143], v10 offset:6144
  v_mfma_f32_16x16x32_bf16 v[48:51], a[40:43], a[88:91], v[48:51]
  v_mfma_f32_16x16x32_bf16 a[8:11], a[40:43], a[92:95], a[8:11]
  ds_read_b64_tr_b16 a[108:109], v16 offset:16384
  v_mfma_f32_16x16x32_bf16 a[12:15], a[44:47], a[92:95], a[12:15]
  s_add_u32 s70, s79, 32768
  v_mfma_f32_16x16x32_bf16 v[52:55], a[44:47], a[88:91], v[52:55]
  s_add_u32 m0, s81, 1024
  ds_read_b64_tr_b16 a[110:111], v16 offset:17408
  v_mfma_f32_16x16x32_bf16 v[84:87], a[44:47], a[84:87], v[84:87]
  buffer_load_dwordx4 v7, s[16:19], s70 offen  lds
  v_mfma_f32_16x16x32_bf16 v[236:239], a[44:47], a[80:83], v[236:239]
  v_mfma_f32_16x16x32_bf16 v[204:207], a[44:47], a[76:79], v[204:207]
  ds_read_b128 a[144:147], v10 offset:8192
  v_mfma_f32_16x16x32_bf16 v[172:175], a[44:47], a[72:75], v[172:175]
  v_mfma_f32_16x16x32_bf16 v[140:143], a[44:47], a[68:71], v[140:143]
  ds_read_b64_tr_b16 a[112:113], v17 offset:16384
  v_mfma_f32_16x16x32_bf16 v[108:111], a[44:47], a[64:67], v[108:111]
  s_add_u32 s70, s77, 18432
  v_mfma_f32_16x16x32_bf16 v[112:115], a[48:51], a[64:67], v[112:115]
  s_add_u32 m0, s80, 71680
  ds_read_b64_tr_b16 a[114:115], v17 offset:17408
  v_mfma_f32_16x16x32_bf16 v[144:147], a[48:51], a[68:71], v[144:147]
  buffer_load_dwordx4 v5, s[12:15], s70 offen  lds
  v_mfma_f32_16x16x32_bf16 v[176:179], a[48:51], a[72:75], v[176:179]
  v_mfma_f32_16x16x32_bf16 v[208:211], a[48:51], a[76:79], v[208:211]
  ds_read_b128 a[148:151], v10 offset:10240
  v_mfma_f32_16x16x32_bf16 v[240:243], a[48:51], a[80:83], v[240:243]
  v_mfma_f32_16x16x32_bf16 v[72:75], a[48:51], a[84:87], v[72:75]
  ds_read_b64_tr_b16 a[116:117], v18 offset:16384
  v_mfma_f32_16x16x32_bf16 v[40:43], a[48:51], a[88:91], v[40:43]
  s_add_u32 s70, s79, 65536
  v_mfma_f32_16x16x32_bf16 a[16:19], a[48:51], a[92:95], a[16:19]
  s_add_u32 m0, s81, 2048
  ds_read_b64_tr_b16 a[118:119], v18 offset:17408
  v_mfma_f32_16x16x32_bf16 a[20:23], a[52:55], a[92:95], a[20:23]
  buffer_load_dwordx4 v8, s[16:19], s70 offen  lds
  v_mfma_f32_16x16x32_bf16 v[44:47], a[52:55], a[88:91], v[44:47]
  v_mfma_f32_16x16x32_bf16 v[76:79], a[52:55], a[84:87], v[76:79]
  ds_read_b128 a[152:155], v10 offset:12288
  v_mfma_f32_16x16x32_bf16 v[244:247], a[52:55], a[80:83], v[244:247]
  v_mfma_f32_16x16x32_bf16 v[212:215], a[52:55], a[76:79], v[212:215]
  ds_read_b64_tr_b16 a[120:121], v19 offset:16384
  v_mfma_f32_16x16x32_bf16 v[180:183], a[52:55], a[72:75], v[180:183]
  s_add_u32 s70, s77, 27648
  v_mfma_f32_16x16x32_bf16 v[148:151], a[52:55], a[68:71], v[148:151]
  s_add_u32 m0, s80, 72704
  ds_read_b64_tr_b16 a[122:123], v19 offset:17408
  v_mfma_f32_16x16x32_bf16 v[116:119], a[52:55], a[64:67], v[116:119]
  buffer_load_dwordx4 v6, s[12:15], s70 offen  lds
  v_mfma_f32_16x16x32_bf16 v[120:123], a[56:59], a[64:67], v[120:123]
  v_mfma_f32_16x16x32_bf16 v[152:155], a[56:59], a[68:71], v[152:155]
  ds_read_b128 a[156:159], v10 offset:14336
  v_mfma_f32_16x16x32_bf16 v[184:187], a[56:59], a[72:75], v[184:187]
  v_mfma_f32_16x16x32_bf16 v[216:219], a[56:59], a[76:79], v[216:219]
  ds_read_b64_tr_b16 a[124:125], v20 offset:16384
  v_mfma_f32_16x16x32_bf16 v[248:251], a[56:59], a[80:83], v[248:251]
  s_add_u32 s70, s79, 98304
  v_mfma_f32_16x16x32_bf16 v[64:67], a[56:59], a[84:87], v[64:67]
  s_add_u32 m0, s81, 3072
  ds_read_b64_tr_b16 a[126:127], v20 offset:17408
  v_mfma_f32_16x16x32_bf16 v[32:35], a[56:59], a[88:91], v[32:35]
  buffer_load_dwordx4 v8, s[16:19], s70 offen  lds
  v_mfma_f32_16x16x32_bf16 a[24:27], a[56:59], a[92:95], a[24:27]
  v_mfma_f32_16x16x32_bf16 a[28:31], a[60:63], a[92:95], a[28:31]
  v_mfma_f32_16x16x32_bf16 v[36:39], a[60:63], a[88:91], v[36:39]
  v_mfma_f32_16x16x32_bf16 v[68:71], a[60:63], a[84:87], v[68:71]
  v_mfma_f32_16x16x32_bf16 v[252:255], a[60:63], a[80:83], v[252:255]
  v_mfma_f32_16x16x32_bf16 v[220:223], a[60:63], a[76:79], v[220:223]
  v_mfma_f32_16x16x32_bf16 v[188:191], a[60:63], a[72:75], v[188:191]
  v_mfma_f32_16x16x32_bf16 v[156:159], a[60:63], a[68:71], v[156:159]
  s_waitcnt vmcnt(21) lgkmcnt(0)
  v_mfma_f32_16x16x32_bf16 v[124:127], a[60:63], a[64:67], v[124:127]
  s_barrier
  v_mfma_f32_16x16x32_bf16 v[96:99], a[96:99], a[128:131], v[96:99]
  ds_read_b128 a[64:67], v9 offset:32768
  v_and_b32 v23, 31, v1
  v_mfma_f32_16x16x32_bf16 v[128:131], a[96:99], a[132:135], v[128:131]
  v_lshlrev_b32 v23, 2, v23
  v_mfma_f32_16x16x32_bf16 v[160:163], a[96:99], a[136:139], v[160:163]
  s_and_b32 s72, s100, 0xffffff80
  s_add_u32 s72, s72, 16384
  ds_read_b64_tr_b16 a[32:33], v13 offset:32768
  v_mfma_f32_16x16x32_bf16 v[192:195], a[96:99], a[140:143], v[192:195]
  s_add_u32 s70, s76, 128
  buffer_load_dword v23, v23, s[20:23], s72 offen sc1
  v_mfma_f32_16x16x32_bf16 v[224:227], a[96:99], a[144:147], v[224:227]
  s_add_u32 m0, s80, 0
  ds_read_b64_tr_b16 a[34:35], v13 offset:33792
  v_mfma_f32_16x16x32_bf16 v[88:91], a[96:99], a[148:151], v[88:91]
  buffer_load_dwordx4 v5, s[12:15], s70 offen  lds
  v_mfma_f32_16x16x32_bf16 v[56:59], a[96:99], a[152:155], v[56:59]
  v_mfma_f32_16x16x32_bf16 a[0:3], a[96:99], a[156:159], a[0:3]
  ds_read_b128 a[68:71], v9 offset:34816
  v_mfma_f32_16x16x32_bf16 a[4:7], a[100:103], a[156:159], a[4:7]
  v_mfma_f32_16x16x32_bf16 v[60:63], a[100:103], a[152:155], v[60:63]
  ds_read_b64_tr_b16 a[36:37], v14 offset:32768
  v_mfma_f32_16x16x32_bf16 v[92:95], a[100:103], a[148:151], v[92:95]
  s_add_u32 s70, s79, 524288
  v_mfma_f32_16x16x32_bf16 v[228:231], a[100:103], a[144:147], v[228:231]
  s_add_u32 m0, s81, 16384
  ds_read_b64_tr_b16 a[38:39], v14 offset:33792
  v_mfma_f32_16x16x32_bf16 v[196:199], a[100:103], a[140:143], v[196:199]
  buffer_load_dwordx4 v7, s[16:19], s70 offen  lds
  v_mfma_f32_16x16x32_bf16 v[164:167], a[100:103], a[136:139], v[164:167]
  v_mfma_f32_16x16x32_bf16 v[132:135], a[100:103], a[132:135], v[132:135]
  ds_read_b128 a[72:75], v9 offset:36864
  v_mfma_f32_16x16x32_bf16 v[100:103], a[100:103], a[128:131], v[100:103]
  v_mfma_f32_16x16x32_bf16 v[104:107], a[104:107], a[128:131], v[104:107]
  ds_read_b64_tr_b16 a[40:41], v15 offset:32768
  v_mfma_f32_16x16x32_bf16 v[136:139], a[104:107], a[132:135], v[136:139]
  s_add_u32 s70, s76, 9344
  v_mfma_f32_16x16x32_bf16 v[168:171], a[104:107], a[136:139], v[168:171]
  s_add_u32 m0, s80, 1024
  ds_read_b64_tr_b16 a[42:43], v15 offset:33792
  v_mfma_f32_16x16x32_bf16 v[200:203], a[104:107], a[140:143], v[200:203]
  buffer_load_dwordx4 v6, s[12:15], s70 offen  lds
  v_mfma_f32_16x16x32_bf16 v[232:235], a[104:107], a[144:147], v[232:235]
  v_mfma_f32_16x16x32_bf16 v[80:83], a[104:107], a[148:151], v[80:83]
  ds_read_b128 a[76:79], v9 offset:38912
  v_mfma_f32_16x16x32_bf16 v[48:51], a[104:107], a[152:155], v[48:51]
  v_mfma_f32_16x16x32_bf16 a[8:11], a[104:107], a[156:159], a[8:11]
  ds_read_b64_tr_b16 a[44:45], v16 offset:32768
  v_mfma_f32_16x16x32_bf16 a[12:15], a[108:111], a[156:159], a[12:15]
  s_add_u32 s70, s79, 557056
  v_mfma_f32_16x16x32_bf16 v[52:55], a[108:111], a[152:155], v[52:55]
  s_add_u32 m0, s81, 17408
  ds_read_b64_tr_b16 a[46:47], v16 offset:33792
  v_mfma_f32_16x16x32_bf16 v[84:87], a[108:111], a[148:151], v[84:87]
  buffer_load_dwordx4 v7, s[16:19], s70 offen  lds
  v_mfma_f32_16x16x32_bf16 v[236:239], a[108:111], a[144:147], v[236:239]
  v_mfma_f32_16x16x32_bf16 v[204:207], a[108:111], a[140:143], v[204:207]
  ds_read_b128 a[80:83], v9 offset:40960
  v_mfma_f32_16x16x32_bf16 v[172:175], a[108:111], a[136:139], v[172:175]
  v_mfma_f32_16x16x32_bf16 v[140:143], a[108:111], a[132:135], v[140:143]
  ds_read_b64_tr_b16 a[48:49], v17 offset:32768
  v_mfma_f32_16x16x32_bf16 v[108:111], a[108:111], a[128:131], v[108:111]
  s_add_u32 s70, s76, 18560
  v_mfma_f32_16x16x32_bf16 v[112:115], a[112:115], a[128:131], v[112:115]
  s_add_u32 m0, s80, 2048
  ds_read_b64_tr_b16 a[50:51], v17 offset:33792
  v_mfma_f32_16x16x32_bf16 v[144:147], a[112:115], a[132:135], v[144:147]
  buffer_load_dwordx4 v5, s[12:15], s70 offen  lds
  v_mfma_f32_16x16x32_bf16 v[176:179], a[112:115], a[136:139], v[176:179]
  v_mfma_f32_16x16x32_bf16 v[208:211], a[112:115], a[140:143], v[208:211]
  ds_read_b128 a[84:87], v9 offset:43008
  v_mfma_f32_16x16x32_bf16 v[240:243], a[112:115], a[144:147], v[240:243]
  v_mfma_f32_16x16x32_bf16 v[72:75], a[112:115], a[148:151], v[72:75]
  ds_read_b64_tr_b16 a[52:53], v18 offset:32768
  v_mfma_f32_16x16x32_bf16 v[40:43], a[112:115], a[152:155], v[40:43]
  s_add_u32 s70, s79, 589824
  v_mfma_f32_16x16x32_bf16 a[16:19], a[112:115], a[156:159], a[16:19]
  s_add_u32 m0, s81, 18432
  ds_read_b64_tr_b16 a[54:55], v18 offset:33792
  v_mfma_f32_16x16x32_bf16 a[20:23], a[116:119], a[156:159], a[20:23]
  buffer_load_dwordx4 v8, s[16:19], s70 offen  lds
  v_mfma_f32_16x16x32_bf16 v[44:47], a[116:119], a[152:155], v[44:47]
  v_mfma_f32_16x16x32_bf16 v[76:79], a[116:119], a[148:151], v[76:79]
  ds_read_b128 a[88:91], v9 offset:45056
  v_mfma_f32_16x16x32_bf16 v[244:247], a[116:119], a[144:147], v[244:247]
  v_mfma_f32_16x16x32_bf16 v[212:215], a[116:119], a[140:143], v[212:215]
  ds_read_b64_tr_b16 a[56:57], v19 offset:32768
  v_mfma_f32_16x16x32_bf16 v[180:183], a[116:119], a[136:139], v[180:183]
  s_add_u32 s70, s76, 27776
  v_mfma_f32_16x16x32_bf16 v[148:151], a[116:119], a[132:135], v[148:151]
  s_add_u32 m0, s80, 3072
  ds_read_b64_tr_b16 a[58:59], v19 offset:33792
  v_mfma_f32_16x16x32_bf16 v[116:119], a[116:119], a[128:131], v[116:119]
  buffer_load_dwordx4 v6, s[12:15], s70 offen  lds
  v_mfma_f32_16x16x32_bf16 v[120:123], a[120:123], a[128:131], v[120:123]
  v_mfma_f32_16x16x32_bf16 v[152:155], a[120:123], a[132:135], v[152:155]
  ds_read_b128 a[92:95], v9 offset:47104
  v_mfma_f32_16x16x32_bf16 v[184:187], a[120:123], a[136:139], v[184:187]
  v_mfma_f32_16x16x32_bf16 v[216:219], a[120:123], a[140:143], v[216:219]
  ds_read_b64_tr_b16 a[60:61], v20 offset:32768
  v_mfma_f32_16x16x32_bf16 v[248:251], a[120:123], a[144:147], v[248:251]
  s_add_u32 s70, s79, 622592
  v_mfma_f32_16x16x32_bf16 v[64:67], a[120:123], a[148:151], v[64:67]
  s_add_u32 m0, s81, 19456
  ds_read_b64_tr_b16 a[62:63], v20 offset:33792
  v_mfma_f32_16x16x32_bf16 v[32:35], a[120:123], a[152:155], v[32:35]
  buffer_load_dwordx4 v8, s[16:19], s70 offen  lds
  v_mfma_f32_16x16x32_bf16 a[24:27], a[120:123], a[156:159], a[24:27]
  v_mfma_f32_16x16x32_bf16 a[28:31], a[124:127], a[156:159], a[28:31]
  v_mfma_f32_16x16x32_bf16 v[36:39], a[124:127], a[152:155], v[36:39]
  v_mfma_f32_16x16x32_bf16 v[68:71], a[124:127], a[148:151], v[68:71]
  v_mfma_f32_16x16x32_bf16 v[252:255], a[124:127], a[144:147], v[252:255]
  v_mfma_f32_16x16x32_bf16 v[220:223], a[124:127], a[140:143], v[220:223]
  v_mfma_f32_16x16x32_bf16 v[188:191], a[124:127], a[136:139], v[188:191]
  v_mfma_f32_16x16x32_bf16 v[156:159], a[124:127], a[132:135], v[156:159]
  s_waitcnt vmcnt(19) lgkmcnt(0)
  v_mfma_f32_16x16x32_bf16 v[124:127], a[124:127], a[128:131], v[124:127]
  s_barrier
  v_mfma_f32_16x16x32_bf16 v[96:99], a[32:35], a[64:67], v[96:99]
  ds_read_b128 a[128:131], v10 offset:32768
  v_mfma_f32_16x16x32_bf16 v[128:131], a[32:35], a[68:71], v[128:131]
  v_mfma_f32_16x16x32_bf16 v[160:163], a[32:35], a[72:75], v[160:163]
  ds_read_b64_tr_b16 a[96:97], v13 offset:49152
  v_mfma_f32_16x16x32_bf16 v[192:195], a[32:35], a[76:79], v[192:195]
  s_add_u32 s70, s77, 128
  v_mfma_f32_16x16x32_bf16 v[224:227], a[32:35], a[80:83], v[224:227]
  s_add_u32 m0, s80, 4096
  ds_read_b64_tr_b16 a[98:99], v13 offset:50176
  v_mfma_f32_16x16x32_bf16 v[88:91], a[32:35], a[84:87], v[88:91]
  buffer_load_dwordx4 v5, s[12:15], s70 offen  lds
  v_mfma_f32_16x16x32_bf16 v[56:59], a[32:35], a[88:91], v[56:59]
  v_mfma_f32_16x16x32_bf16 a[0:3], a[32:35], a[92:95], a[0:3]
  ds_read_b128 a[132:135], v10 offset:34816
  v_mfma_f32_16x16x32_bf16 a[4:7], a[36:39], a[92:95], a[4:7]
  v_mfma_f32_16x16x32_bf16 v[60:63], a[36:39], a[88:91], v[60:63]
  ds_read_b64_tr_b16 a[100:101], v14 offset:49152
  v_mfma_f32_16x16x32_bf16 v[92:95], a[36:39], a[84:87], v[92:95]
  s_add_u32 s70, s79, 1048576
  v_mfma_f32_16x16x32_bf16 v[228:231], a[36:39], a[80:83], v[228:231]
  s_add_u32 m0, s81, 32768
  ds_read_b64_tr_b16 a[102:103], v14 offset:50176
  v_mfma_f32_16x16x32_bf16 v[196:199], a[36:39], a[76:79], v[196:199]
  buffer_load_dwordx4 v7, s[16:19], s70 offen  lds
  v_mfma_f32_16x16x32_bf16 v[164:167], a[36:39], a[72:75], v[164:167]
  v_mfma_f32_16x16x32_bf16 v[132:135], a[36:39], a[68:71], v[132:135]
  ds_read_b128 a[136:139], v10 offset:36864
  v_mfma_f32_16x16x32_bf16 v[100:103], a[36:39], a[64:67], v[100:103]
  v_mfma_f32_16x16x32_bf16 v[104:107], a[40:43], a[64:67], v[104:107]
  ds_read_b64_tr_b16 a[104:105], v15 offset:49152
  v_mfma_f32_16x16x32_bf16 v[136:139], a[40:43], a[68:71], v[136:139]
  s_add_u32 s70, s77, 9344
  v_mfma_f32_16x16x32_bf16 v[168:171], a[40:43], a[72:75], v[168:171]
  s_add_u32 m0, s80, 5120
  ds_read_b64_tr_b16 a[106:107], v15 offset:50176
  v_mfma_f32_16x16x32_bf16 v[200:203], a[40:43], a[76:79], v[200:203]
  buffer_load_dwordx4 v6, s[12:15], s70 offen  lds
  v_mfma_f32_16x16x32_bf16 v[232:235], a[40:43], a[80:83], v[232:235]
  v_mfma_f32_16x16x32_bf16 v[80:83], a[40:43], a[84:87], v[80:83]
  ds_read_b128 a[140:143], v10 offset:38912
  v_mfma_f32_16x16x32_bf16 v[48:51], a[40:43], a[88:91], v[48:51]
  v_mfma_f32_16x16x32_bf16 a[8:11], a[40:43], a[92:95], a[8:11]
  ds_read_b64_tr_b16 a[108:109], v16 offset:49152
  v_mfma_f32_16x16x32_bf16 a[12:15], a[44:47], a[92:95], a[12:15]
  s_add_u32 s70, s79, 1081344
  v_mfma_f32_16x16x32_bf16 v[52:55], a[44:47], a[88:91], v[52:55]
  s_add_u32 m0, s81, 33792
  ds_read_b64_tr_b16 a[110:111], v16 offset:50176
  v_mfma_f32_16x16x32_bf16 v[84:87], a[44:47], a[84:87], v[84:87]
  buffer_load_dwordx4 v7, s[16:19], s70 offen  lds
  v_mfma_f32_16x16x32_bf16 v[236:239], a[44:47], a[80:83], v[236:239]
  v_mfma_f32_16x16x32_bf16 v[204:207], a[44:47], a[76:79], v[204:207]
  ds_read_b128 a[144:147], v10 offset:40960
  v_mfma_f32_16x16x32_bf16 v[172:175], a[44:47], a[72:75], v[172:175]
  v_mfma_f32_16x16x32_bf16 v[140:143], a[44:47], a[68:71], v[140:143]
  ds_read_b64_tr_b16 a[112:113], v17 offset:49152
  v_mfma_f32_16x16x32_bf16 v[108:111], a[44:47], a[64:67], v[108:111]
  s_add_u32 s70, s77, 18560
  v_mfma_f32_16x16x32_bf16 v[112:115], a[48:51], a[64:67], v[112:115]
  s_add_u32 m0, s80, 6144
  ds_read_b64_tr_b16 a[114:115], v17 offset:50176
  v_mfma_f32_16x16x32_bf16 v[144:147], a[48:51], a[68:71], v[144:147]
  buffer_load_dwordx4 v5, s[12:15], s70 offen  lds
  v_mfma_f32_16x16x32_bf16 v[176:179], a[48:51], a[72:75], v[176:179]
  v_mfma_f32_16x16x32_bf16 v[208:211], a[48:51], a[76:79], v[208:211]
  ds_read_b128 a[148:151], v10 offset:43008
  v_mfma_f32_16x16x32_bf16 v[240:243], a[48:51], a[80:83], v[240:243]
  v_mfma_f32_16x16x32_bf16 v[72:75], a[48:51], a[84:87], v[72:75]
  ds_read_b64_tr_b16 a[116:117], v18 offset:49152
  v_mfma_f32_16x16x32_bf16 v[40:43], a[48:51], a[88:91], v[40:43]
  s_add_u32 s70, s79, 1114112
  v_mfma_f32_16x16x32_bf16 a[16:19], a[48:51], a[92:95], a[16:19]
  s_add_u32 m0, s81, 34816
  ds_read_b64_tr_b16 a[118:119], v18 offset:50176
  v_mfma_f32_16x16x32_bf16 a[20:23], a[52:55], a[92:95], a[20:23]
  buffer_load_dwordx4 v8, s[16:19], s70 offen  lds
  v_mfma_f32_16x16x32_bf16 v[44:47], a[52:55], a[88:91], v[44:47]
  v_mfma_f32_16x16x32_bf16 v[76:79], a[52:55], a[84:87], v[76:79]
  ds_read_b128 a[152:155], v10 offset:45056
  v_mfma_f32_16x16x32_bf16 v[244:247], a[52:55], a[80:83], v[244:247]
  v_mfma_f32_16x16x32_bf16 v[212:215], a[52:55], a[76:79], v[212:215]
  ds_read_b64_tr_b16 a[120:121], v19 offset:49152
  v_mfma_f32_16x16x32_bf16 v[180:183], a[52:55], a[72:75], v[180:183]
  s_add_u32 s70, s77, 27776
  v_mfma_f32_16x16x32_bf16 v[148:151], a[52:55], a[68:71], v[148:151]
  s_add_u32 m0, s80, 7168
  ds_read_b64_tr_b16 a[122:123], v19 offset:50176
  v_mfma_f32_16x16x32_bf16 v[116:119], a[52:55], a[64:67], v[116:119]
  buffer_load_dwordx4 v6, s[12:15], s70 offen  lds
  v_mfma_f32_16x16x32_bf16 v[120:123], a[56:59], a[64:67], v[120:123]
  v_mfma_f32_16x16x32_bf16 v[152:155], a[56:59], a[68:71], v[152:155]
  ds_read_b128 a[156:159], v10 offset:47104
  v_mfma_f32_16x16x32_bf16 v[184:187], a[56:59], a[72:75], v[184:187]
  v_mfma_f32_16x16x32_bf16 v[216:219], a[56:59], a[76:79], v[216:219]
  ds_read_b64_tr_b16 a[124:125], v20 offset:49152
  v_mfma_f32_16x16x32_bf16 v[248:251], a[56:59], a[80:83], v[248:251]
  s_add_u32 s70, s79, 1146880
  v_mfma_f32_16x16x32_bf16 v[64:67], a[56:59], a[84:87], v[64:67]
  s_add_u32 m0, s81, 35840
  ds_read_b64_tr_b16 a[126:127], v20 offset:50176
  v_mfma_f32_16x16x32_bf16 v[32:35], a[56:59], a[88:91], v[32:35]
  buffer_load_dwordx4 v8, s[16:19], s70 offen  lds
  v_mfma_f32_16x16x32_bf16 a[24:27], a[56:59], a[92:95], a[24:27]
  v_mfma_f32_16x16x32_bf16 a[28:31], a[60:63], a[92:95], a[28:31]
  v_mfma_f32_16x16x32_bf16 v[36:39], a[60:63], a[88:91], v[36:39]
  v_mfma_f32_16x16x32_bf16 v[68:71], a[60:63], a[84:87], v[68:71]
  v_mfma_f32_16x16x32_bf16 v[252:255], a[60:63], a[80:83], v[252:255]
  v_mfma_f32_16x16x32_bf16 v[220:223], a[60:63], a[76:79], v[220:223]
  v_mfma_f32_16x16x32_bf16 v[188:191], a[60:63], a[72:75], v[188:191]
  v_mfma_f32_16x16x32_bf16 v[156:159], a[60:63], a[68:71], v[156:159]
  s_waitcnt vmcnt(17) lgkmcnt(0)
  v_mfma_f32_16x16x32_bf16 v[124:127], a[60:63], a[64:67], v[124:127]
  s_barrier
  v_mfma_f32_16x16x32_bf16 v[96:99], a[96:99], a[128:131], v[96:99]
  s_lshl_b32 s71, s34, 13
  v_mfma_f32_16x16x32_bf16 v[128:131], a[96:99], a[132:135], v[128:131]
  s_and_b32 s72, s34, 1
  v_mfma_f32_16x16x32_bf16 v[160:163], a[96:99], a[136:139], v[160:163]
  s_lshl_b32 s72, s72, 14
  v_mfma_f32_16x16x32_bf16 v[192:195], a[96:99], a[140:143], v[192:195]
  s_add_u32 s70, s76, 256
  v_mfma_f32_16x16x32_bf16 v[224:227], a[96:99], a[144:147], v[224:227]
  s_add_u32 m0, s80, 32768
  v_mfma_f32_16x16x32_bf16 v[88:91], a[96:99], a[148:151], v[88:91]
  buffer_load_dwordx4 v5, s[12:15], s70 offen  lds
  v_mfma_f32_16x16x32_bf16 v[56:59], a[96:99], a[152:155], v[56:59]
  s_sub_u32 s71, s71, s72
  v_mfma_f32_16x16x32_bf16 a[0:3], a[96:99], a[156:159], a[0:3]
  v_add_u32 v9, s71, v9
  v_add_u32 v10, s71, v10
  v_mfma_f32_16x16x32_bf16 a[4:7], a[100:103], a[156:159], a[4:7]
  v_add_u32 v11, s71, v11
  v_add_u32 v12, s71, v12
  v_mfma_f32_16x16x32_bf16 v[60:63], a[100:103], a[152:155], v[60:63]
  ds_read_b64_tr_b16 a[32:33], v13 offset:0
  v_mfma_f32_16x16x32_bf16 v[92:95], a[100:103], a[148:151], v[92:95]
  s_add_u32 s70, s79, 1572864
  v_mfma_f32_16x16x32_bf16 v[228:231], a[100:103], a[144:147], v[228:231]
  s_add_u32 m0, s81, 49152
  ds_read_b64_tr_b16 a[34:35], v13 offset:1024
  v_mfma_f32_16x16x32_bf16 v[196:199], a[100:103], a[140:143], v[196:199]
  buffer_load_dwordx4 v7, s[16:19], s70 offen  lds
  v_mfma_f32_16x16x32_bf16 v[164:167], a[100:103], a[136:139], v[164:167]
  v_mfma_f32_16x16x32_bf16 v[132:135], a[100:103], a[132:135], v[132:135]
  ds_read_b128 a[64:67], v11 offset:0
  v_mfma_f32_16x16x32_bf16 v[100:103], a[100:103], a[128:131], v[100:103]
  v_mfma_f32_16x16x32_bf16 v[104:107], a[104:107], a[128:131], v[104:107]
  ds_read_b64_tr_b16 a[36:37], v14 offset:0
  v_mfma_f32_16x16x32_bf16 v[136:139], a[104:107], a[132:135], v[136:139]
  s_add_u32 s70, s76, 9472
  v_mfma_f32_16x16x32_bf16 v[168:171], a[104:107], a[136:139], v[168:171]
  s_add_u32 m0, s80, 33792
  ds_read_b64_tr_b16 a[38:39], v14 offset:1024
  v_mfma_f32_16x16x32_bf16 v[200:203], a[104:107], a[140:143], v[200:203]
  buffer_load_dwordx4 v6, s[12:15], s70 offen  lds
  v_mfma_f32_16x16x32_bf16 v[232:235], a[104:107], a[144:147], v[232:235]
  v_mfma_f32_16x16x32_bf16 v[80:83], a[104:107], a[148:151], v[80:83]
  ds_read_b128 a[68:71], v11 offset:2048
  v_mfma_f32_16x16x32_bf16 v[48:51], a[104:107], a[152:155], v[48:51]
  v_mfma_f32_16x16x32_bf16 a[8:11], a[104:107], a[156:159], a[8:11]
  ds_read_b64_tr_b16 a[40:41], v15 offset:0
  v_mfma_f32_16x16x32_bf16 a[12:15], a[108:111], a[156:159], a[12:15]
  s_add_u32 s70, s79, 1605632
  v_mfma_f32_16x16x32_bf16 v[52:55], a[108:111], a[152:155], v[52:55]
  s_add_u32 m0, s81, 50176
  ds_read_b64_tr_b16 a[42:43], v15 offset:1024
  v_mfma_f32_16x16x32_bf16 v[84:87], a[108:111], a[148:151], v[84:87]
  buffer_load_dwordx4 v7, s[16:19], s70 offen  lds
  v_mfma_f32_16x16x32_bf16 v[236:239], a[108:111], a[144:147], v[236:239]
  v_mfma_f32_16x16x32_bf16 v[204:207], a[108:111], a[140:143], v[204:207]
  ds_read_b128 a[72:75], v11 offset:4096
  v_mfma_f32_16x16x32_bf16 v[172:175], a[108:111], a[136:139], v[172:175]
  v_mfma_f32_16x16x32_bf16 v[140:143], a[108:111], a[132:135], v[140:143]
  ds_read_b64_tr_b16 a[44:45], v16 offset:0
  v_mfma_f32_16x16x32_bf16 v[108:111], a[108:111], a[128:131], v[108:111]
  s_add_u32 s70, s76, 18688
  v_mfma_f32_16x16x32_bf16 v[112:115], a[112:115], a[128:131], v[112:115]
  s_add_u32 m0, s80, 34816
  ds_read_b64_tr_b16 a[46:47], v16 offset:1024
  v_mfma_f32_16x16x32_bf16 v[144:147], a[112:115], a[132:135], v[144:147]
  buffer_load_dwordx4 v5, s[12:15], s70 offen  lds
  v_mfma_f32_16x16x32_bf16 v[176:179], a[112:115], a[136:139], v[176:179]
  v_mfma_f32_16x16x32_bf16 v[208:211], a[112:115], a[140:143], v[208:211]
  ds_read_b128 a[76:79], v11 offset:6144
  v_mfma_f32_16x16x32_bf16 v[240:243], a[112:115], a[144:147], v[240:243]
  v_mfma_f32_16x16x32_bf16 v[72:75], a[112:115], a[148:151], v[72:75]
  ds_read_b64_tr_b16 a[48:49], v17 offset:0
  v_mfma_f32_16x16x32_bf16 v[40:43], a[112:115], a[152:155], v[40:43]
  s_add_u32 s70, s79, 1638400
  v_mfma_f32_16x16x32_bf16 a[16:19], a[112:115], a[156:159], a[16:19]
  s_add_u32 m0, s81, 51200
  ds_read_b64_tr_b16 a[50:51], v17 offset:1024
  v_mfma_f32_16x16x32_bf16 a[20:23], a[116:119], a[156:159], a[20:23]
  buffer_load_dwordx4 v8, s[16:19], s70 offen  lds
  v_mfma_f32_16x16x32_bf16 v[44:47], a[116:119], a[152:155], v[44:47]
  v_mfma_f32_16x16x32_bf16 v[76:79], a[116:119], a[148:151], v[76:79]
  ds_read_b64_tr_b16 a[52:53], v18 offset:0
  v_mfma_f32_16x16x32_bf16 v[244:247], a[116:119], a[144:147], v[244:247]
  v_mfma_f32_16x16x32_bf16 v[212:215], a[116:119], a[140:143], v[212:215]
  ds_read_b64_tr_b16 a[54:55], v18 offset:1024
  v_mfma_f32_16x16x32_bf16 v[180:183], a[116:119], a[136:139], v[180:183]
  s_add_u32 s70, s76, 27904
  v_mfma_f32_16x16x32_bf16 v[148:151], a[116:119], a[132:135], v[148:151]
  s_add_u32 m0, s80, 35840
  ds_read_b64_tr_b16 a[56:57], v19 offset:0
  v_mfma_f32_16x16x32_bf16 v[116:119], a[116:119], a[128:131], v[116:119]
  buffer_load_dwordx4 v6, s[12:15], s70 offen  lds
  v_mfma_f32_16x16x32_bf16 v[120:123], a[120:123], a[128:131], v[120:123]
  v_mfma_f32_16x16x32_bf16 v[152:155], a[120:123], a[132:135], v[152:155]
  ds_read_b64_tr_b16 a[58:59], v19 offset:1024
  v_mfma_f32_16x16x32_bf16 v[184:187], a[120:123], a[136:139], v[184:187]
  v_mfma_f32_16x16x32_bf16 v[216:219], a[120:123], a[140:143], v[216:219]
  ds_read_b64_tr_b16 a[60:61], v20 offset:0
  v_mfma_f32_16x16x32_bf16 v[248:251], a[120:123], a[144:147], v[248:251]
  s_add_u32 s70, s79, 1671168
  v_mfma_f32_16x16x32_bf16 v[64:67], a[120:123], a[148:151], v[64:67]
  s_add_u32 m0, s81, 52224
  ds_read_b64_tr_b16 a[62:63], v20 offset:1024
  v_mfma_f32_16x16x32_bf16 v[32:35], a[120:123], a[152:155], v[32:35]
  buffer_load_dwordx4 v8, s[16:19], s70 offen  lds
  v_mfma_f32_16x16x32_bf16 a[24:27], a[120:123], a[156:159], a[24:27]
  v_mfma_f32_16x16x32_bf16 a[28:31], a[124:127], a[156:159], a[28:31]
  v_mfma_f32_16x16x32_bf16 v[36:39], a[124:127], a[152:155], v[36:39]
  v_mfma_f32_16x16x32_bf16 v[68:71], a[124:127], a[148:151], v[68:71]
  v_mfma_f32_16x16x32_bf16 v[252:255], a[124:127], a[144:147], v[252:255]
  v_mfma_f32_16x16x32_bf16 v[220:223], a[124:127], a[140:143], v[220:223]
  v_mfma_f32_16x16x32_bf16 v[188:191], a[124:127], a[136:139], v[188:191]
  v_mfma_f32_16x16x32_bf16 v[156:159], a[124:127], a[132:135], v[156:159]
  s_waitcnt lgkmcnt(0)
  v_mfma_f32_16x16x32_bf16 v[124:127], a[124:127], a[128:131], v[124:127]
  s_branch L_phaseB
L_phaseA_V:
  s_waitcnt vmcnt(16)
  s_barrier
  ds_read_b128 a[32:35], v9 offset:0
  ds_read_b64_tr_b16 a[64:65], v13 offset:8192
  ds_read_b64_tr_b16 a[66:67], v13 offset:9216
  ds_read_b128 a[36:39], v9 offset:2048
  ds_read_b64_tr_b16 a[68:69], v14 offset:8192
  ds_read_b64_tr_b16 a[70:71], v14 offset:9216
  ds_read_b128 a[40:43], v9 offset:4096
  ds_read_b64_tr_b16 a[72:73], v15 offset:8192
  ds_read_b64_tr_b16 a[74:75], v15 offset:9216
  ds_read_b128 a[44:47], v9 offset:6144
  ds_read_b64_tr_b16 a[76:77], v16 offset:8192
  ds_read_b64_tr_b16 a[78:79], v16 offset:9216
  ds_read_b128 a[48:51], v9 offset:8192
  ds_read_b64_tr_b16 a[80:81], v17 offset:8192
  ds_read_b64_tr_b16 a[82:83], v17 offset:9216
  ds_read_b128 a[52:55], v9 offset:10240
  ds_read_b64_tr_b16 a[84:85], v18 offset:8192
  ds_read_b64_tr_b16 a[86:87], v18 offset:9216
  ds_read_b128 a[56:59], v9 offset:12288
  ds_read_b64_tr_b16 a[88:89], v19 offset:8192
  ds_read_b64_tr_b16 a[90:91], v19 offset:9216
  ds_read_b128 a[60:63], v9 offset:14336
  ds_read_b64_tr_b16 a[92:93], v20 offset:8192
  ds_read_b64_tr_b16 a[94:95], v20 offset:9216
  s_cmp_lt_u32 s2, 7
  s_cbranch_scc0 L_5
  s_lshl_b32 s70, s2, 4
  s_lshl_b32 s71, s34, 2
  s_add_u32 s70, s70, s71
  v_mov_b32 v21, 1
  v_mov_b32 v22, s70
  s_mov_b64 exec, 1
  global_store_dword v22, v21, s[66:67] sc1
  s_mov_b64 exec, -1
L_5:
  s_waitcnt vmcnt(12) lgkmcnt(0)
  s_barrier
  v_mfma_f32_16x16x32_bf16 v[96:99], a[32:35], a[64:67], 0
  s_add_u32 s70, s78, 786432
  ds_read_b128 a[96:99], v10 offset:0
  v_mfma_f32_16x16x32_bf16 v[104:107], a[32:35], a[68:71], 0
  s_add_u32 m0, s81, 49152
  ds_read_b64_tr_b16 a[128:129], v13 offset:24576
  v_mfma_f32_16x16x32_bf16 v[112:115], a[32:35], a[72:75], 0
  buffer_load_dwordx4 v7, s[8:11], s70 offen  lds
  v_mfma_f32_16x16x32_bf16 v[120:123], a[32:35], a[76:79], 0
  v_mfma_f32_16x16x32_bf16 v[128:131], a[32:35], a[80:83], 0
  s_add_u32 s70, s78, 819200
  ds_read_b64_tr_b16 a[130:131], v13 offset:25600
  v_mfma_f32_16x16x32_bf16 v[136:139], a[32:35], a[84:87], 0
  s_add_u32 m0, s81, 50176
  v_mfma_f32_16x16x32_bf16 v[144:147], a[32:35], a[88:91], 0
  buffer_load_dwordx4 v7, s[8:11], s70 offen  lds
  v_mfma_f32_16x16x32_bf16 v[152:155], a[32:35], a[92:95], 0
  ds_read_b128 a[100:103], v10 offset:2048
  v_mfma_f32_16x16x32_bf16 v[156:159], a[36:39], a[92:95], 0
  s_add_u32 s70, s78, 851968
  v_mfma_f32_16x16x32_bf16 v[148:151], a[36:39], a[88:91], 0
  s_add_u32 m0, s81, 51200
  ds_read_b64_tr_b16 a[132:133], v14 offset:24576
  v_mfma_f32_16x16x32_bf16 v[140:143], a[36:39], a[84:87], 0
  buffer_load_dwordx4 v8, s[8:11], s70 offen  lds
  v_mfma_f32_16x16x32_bf16 v[132:135], a[36:39], a[80:83], 0
  ds_read_b64_tr_b16 a[134:135], v14 offset:25600
  v_mfma_f32_16x16x32_bf16 v[124:127], a[36:39], a[76:79], 0
  s_add_u32 s70, s78, 884736
  v_mfma_f32_16x16x32_bf16 v[116:119], a[36:39], a[72:75], 0
  s_add_u32 m0, s81, 52224
  ds_read_b128 a[104:107], v10 offset:4096
  v_mfma_f32_16x16x32_bf16 v[108:111], a[36:39], a[68:71], 0
  buffer_load_dwordx4 v8, s[8:11], s70 offen  lds
  v_mfma_f32_16x16x32_bf16 v[100:103], a[36:39], a[64:67], 0
  v_mfma_f32_16x16x32_bf16 v[160:163], a[40:43], a[64:67], 0
  s_add_u32 s70, s74, 256
  ds_read_b64_tr_b16 a[136:137], v15 offset:24576
  v_mfma_f32_16x16x32_bf16 v[168:171], a[40:43], a[68:71], 0
  s_add_u32 m0, s80, 65536
  v_mfma_f32_16x16x32_bf16 v[176:179], a[40:43], a[72:75], 0
  buffer_load_dwordx4 v3, s[4:7], s70 offen  lds
  v_mfma_f32_16x16x32_bf16 v[184:187], a[40:43], a[76:79], 0
  ds_read_b64_tr_b16 a[138:139], v15 offset:25600
  v_mfma_f32_16x16x32_bf16 v[192:195], a[40:43], a[80:83], 0
  s_add_u32 s70, s74, 8448
  ds_read_b128 a[108:111], v10 offset:6144
  v_mfma_f32_16x16x32_bf16 v[200:203], a[40:43], a[84:87], 0
  s_add_u32 m0, s80, 66560
  v_mfma_f32_16x16x32_bf16 v[208:211], a[40:43], a[88:91], 0
  buffer_load_dwordx4 v4, s[4:7], s70 offen  lds
  v_mfma_f32_16x16x32_bf16 v[216:219], a[40:43], a[92:95], 0
  ds_read_b64_tr_b16 a[140:141], v16 offset:24576
  v_mfma_f32_16x16x32_bf16 v[220:223], a[44:47], a[92:95], 0
  s_add_u32 s70, s74, 16640
  v_mfma_f32_16x16x32_bf16 v[212:215], a[44:47], a[88:91], 0
  s_add_u32 m0, s80, 67584
  ds_read_b64_tr_b16 a[142:143], v16 offset:25600
  v_mfma_f32_16x16x32_bf16 v[204:207], a[44:47], a[84:87], 0
  buffer_load_dwordx4 v3, s[4:7], s70 offen  lds
  v_mfma_f32_16x16x32_bf16 v[196:199], a[44:47], a[80:83], 0
  v_mfma_f32_16x16x32_bf16 v[188:191], a[44:47], a[76:79], 0
  s_add_u32 s70, s74, 24832
  ds_read_b128 a[112:115], v10 offset:8192
  v_mfma_f32_16x16x32_bf16 v[180:183], a[44:47], a[72:75], 0
  s_add_u32 m0, s80, 68608
  ds_read_b64_tr_b16 a[144:145], v17 offset:24576
  v_mfma_f32_16x16x32_bf16 v[172:175], a[44:47], a[68:71], 0
  buffer_load_dwordx4 v4, s[4:7], s70 offen  lds
  v_mfma_f32_16x16x32_bf16 v[164:167], a[44:47], a[64:67], 0
  v_mfma_f32_16x16x32_bf16 v[224:227], a[48:51], a[64:67], 0
  s_add_u32 s70, s75, 256
  ds_read_b64_tr_b16 a[146:147], v17 offset:25600
  v_mfma_f32_16x16x32_bf16 v[232:235], a[48:51], a[68:71], 0
  s_add_u32 m0, s80, 69632
  v_mfma_f32_16x16x32_bf16 v[240:243], a[48:51], a[72:75], 0
  buffer_load_dwordx4 v3, s[4:7], s70 offen  lds
  v_mfma_f32_16x16x32_bf16 v[248:251], a[48:51], a[76:79], 0
  ds_read_b128 a[116:119], v10 offset:10240
  v_mfma_f32_16x16x32_bf16 v[88:91], a[48:51], a[80:83], 0
  s_add_u32 s70, s78, 1048576
  v_mfma_f32_16x16x32_bf16 v[80:83], a[48:51], a[84:87], 0
  s_add_u32 m0, s81, 0
  ds_read_b64_tr_b16 a[148:149], v18 offset:24576
  v_mfma_f32_16x16x32_bf16 v[72:75], a[48:51], a[88:91], 0
  buffer_load_dwordx4 v7, s[8:11], s70 offen  lds
  v_mfma_f32_16x16x32_bf16 v[64:67], a[48:51], a[92:95], 0
  ds_read_b64_tr_b16 a[150:151], v18 offset:25600
  v_mfma_f32_16x16x32_bf16 v[68:71], a[52:55], a[92:95], 0
  s_add_u32 s70, s75, 8448
  v_mfma_f32_16x16x32_bf16 v[76:79], a[52:55], a[88:91], 0
  s_add_u32 m0, s80, 70656
  ds_read_b128 a[120:123], v10 offset:12288
  v_mfma_f32_16x16x32_bf16 v[84:87], a[52:55], a[84:87], 0
  buffer_load_dwordx4 v4, s[4:7], s70 offen  lds
  v_mfma_f32_16x16x32_bf16 v[92:95], a[52:55], a[80:83], 0
  v_mfma_f32_16x16x32_bf16 v[252:255], a[52:55], a[76:79], 0
  s_add_u32 s70, s78, 1081344
  ds_read_b64_tr_b16 a[152:153], v19 offset:24576
  v_mfma_f32_16x16x32_bf16 v[244:247], a[52:55], a[72:75], 0
  s_add_u32 m0, s81, 1024
  v_mfma_f32_16x16x32_bf16 v[236:239], a[52:55], a[68:71], 0
  buffer_load_dwordx4 v7, s[8:11], s70 offen  lds
  v_mfma_f32_16x16x32_bf16 v[228:231], a[52:55], a[64:67], 0
  ds_read_b64_tr_b16 a[154:155], v19 offset:25600
  v_mfma_f32_16x16x32_bf16 v[56:59], a[56:59], a[64:67], 0
  s_add_u32 s70, s75, 16640
  ds_read_b128 a[124:127], v10 offset:14336
  v_mfma_f32_16x16x32_bf16 v[48:51], a[56:59], a[68:71], 0
  s_add_u32 m0, s80, 71680
  v_mfma_f32_16x16x32_bf16 v[40:43], a[56:59], a[72:75], 0
  buffer_load_dwordx4 v3, s[4:7], s70 offen  lds
  v_mfma_f32_16x16x32_bf16 v[32:35], a[56:59], a[76:79], 0
  ds_read_b64_tr_b16 a[156:157], v20 offset:24576
  v_mfma_f32_16x16x32_bf16 a[0:3], a[56:59], a[80:83], 0
  s_add_u32 s70, s78, 1114112
  v_mfma_f32_16x16x32_bf16 a[8:11], a[56:59], a[84:87], 0
  s_add_u32 m0, s81, 2048
  ds_read_b64_tr_b16 a[158:159], v20 offset:25600
  v_mfma_f32_16x16x32_bf16 a[16:19], a[56:59], a[88:91], 0
  buffer_load_dwordx4 v8, s[8:11], s70 offen  lds
  v_mfma_f32_16x16x32_bf16 a[24:27], a[56:59], a[92:95], 0
  v_mfma_f32_16x16x32_bf16 a[28:31], a[60:63], a[92:95], 0
  s_add_u32 s70, s75, 24832
  v_mfma_f32_16x16x32_bf16 a[20:23], a[60:63], a[88:91], 0
  s_add_u32 m0, s80, 72704
  v_mfma_f32_16x16x32_bf16 a[12:15], a[60:63], a[84:87], 0
  buffer_load_dwordx4 v4, s[4:7], s70 offen  lds
  v_mfma_f32_16x16x32_bf16 a[4:7], a[60:63], a[80:83], 0
  v_mfma_f32_16x16x32_bf16 v[36:39], a[60:63], a[76:79], 0
  s_add_u32 s70, s78, 1146880
  v_mfma_f32_16x16x32_bf16 v[44:47], a[60:63], a[72:75], 0
  s_add_u32 m0, s81, 3072
  v_mfma_f32_16x16x32_bf16 v[52:55], a[60:63], a[68:71], 0
  buffer_load_dwordx4 v8, s[8:11], s70 offen  lds
  s_waitcnt vmcnt(16) lgkmcnt(0)
  v_mfma_f32_16x16x32_bf16 v[60:63], a[60:63], a[64:67], 0
  s_barrier
  v_mfma_f32_16x16x32_bf16 v[96:99], a[96:99], a[128:131], v[96:99]
  s_bfe_u32 s71, s2, 0x10001
  s_lshl_b32 s71, s71, 3
  ds_read_b128 a[32:35], v9 offset:32768
  v_mfma_f32_16x16x32_bf16 v[104:107], a[96:99], a[132:135], v[104:107]
  v_and_b32 v21, 15, v1
  v_mfma_f32_16x16x32_bf16 v[112:115], a[96:99], a[136:139], v[112:115]
  ds_read_b64_tr_b16 a[64:65], v13 offset:40960
  v_lshrrev_b32 v22, 4, v1
  v_mfma_f32_16x16x32_bf16 v[120:123], a[96:99], a[140:143], v[120:123]
  s_add_u32 s70, s74, 384
  v_lshlrev_b32 v22, 3, v22
  v_mfma_f32_16x16x32_bf16 v[128:131], a[96:99], a[144:147], v[128:131]
  s_add_u32 m0, s80, 0
  ds_read_b64_tr_b16 a[66:67], v13 offset:41984
  v_sub_u32 v21, v21, v22
  v_mfma_f32_16x16x32_bf16 v[136:139], a[96:99], a[148:151], v[136:139]
  buffer_load_dwordx4 v3, s[4:7], s70 offen  lds
  v_mfma_f32_16x16x32_bf16 v[144:147], a[96:99], a[152:155], v[144:147]
  v_and_b32 v22, 1, v21
  v_mfma_f32_16x16x32_bf16 v[152:155], a[96:99], a[156:159], v[152:155]
  ds_read_b128 a[36:39], v9 offset:34816
  v_lshlrev_b32 v22, 4, v22
  v_mfma_f32_16x16x32_bf16 v[156:159], a[100:103], a[156:159], v[156:159]
  v_mov_b32 v23, 0x3f80
  v_mfma_f32_16x16x32_bf16 v[148:151], a[100:103], a[152:155], v[148:151]
  ds_read_b64_tr_b16 a[68:69], v14 offset:40960
  v_lshlrev_b32 v22, v22, v23
  v_mfma_f32_16x16x32_bf16 v[140:143], a[100:103], a[148:151], v[140:143]
  s_add_u32 s70, s78, 1310720
  v_ashrrev_i32 v21, 1, v21
  v_mfma_f32_16x16x32_bf16 v[132:135], a[100:103], a[144:147], v[132:135]
  s_add_u32 m0, s81, 16384
  ds_read_b64_tr_b16 a[70:71], v14 offset:41984
  v_cmp_eq_u32 vcc, 0, v21
  v_mfma_f32_16x16x32_bf16 v[124:127], a[100:103], a[140:143], v[124:127]
  s_nop 0
  buffer_load_dwordx4 v7, s[8:11], s70 offen  lds
  v_mfma_f32_16x16x32_bf16 v[116:119], a[100:103], a[136:139], v[116:119]
  v_cndmask_b32 v23, 0, v22, vcc
  v_mfma_f32_16x16x32_bf16 v[108:111], a[100:103], a[132:135], v[108:111]
  ds_read_b128 a[40:43], v9 offset:36864
  v_accvgpr_write_b32 a220, v23
  v_mfma_f32_16x16x32_bf16 v[100:103], a[100:103], a[128:131], v[100:103]
  v_cmp_eq_u32 vcc, 1, v21
  v_mfma_f32_16x16x32_bf16 v[160:163], a[104:107], a[128:131], v[160:163]
  s_nop 0
  ds_read_b64_tr_b16 a[72:73], v15 offset:40960
  v_cndmask_b32 v23, 0, v22, vcc
  v_mfma_f32_16x16x32_bf16 v[168:171], a[104:107], a[132:135], v[168:171]
  s_add_u32 s70, s74, 8576
  v_accvgpr_write_b32 a221, v23
  v_mfma_f32_16x16x32_bf16 v[176:179], a[104:107], a[136:139], v[176:179]
  s_add_u32 m0, s80, 1024
  ds_read_b64_tr_b16 a[74:75], v15 offset:41984
  v_cmp_eq_u32 vcc, 2, v21
  v_mfma_f32_16x16x32_bf16 v[184:187], a[104:107], a[140:143], v[184:187]
  s_nop 0
  buffer_load_dwordx4 v4, s[4:7], s70 offen  lds
  v_mfma_f32_16x16x32_bf16 v[192:195], a[104:107], a[144:147], v[192:195]
  v_cndmask_b32 v23, 0, v22, vcc
  v_mfma_f32_16x16x32_bf16 v[200:203], a[104:107], a[148:151], v[200:203]
  ds_read_b128 a[44:47], v9 offset:38912
  v_accvgpr_write_b32 a222, v23
  v_mfma_f32_16x16x32_bf16 v[208:211], a[104:107], a[152:155], v[208:211]
  v_cmp_eq_u32 vcc, 3, v21
  v_mfma_f32_16x16x32_bf16 v[216:219], a[104:107], a[156:159], v[216:219]
  s_nop 0
  ds_read_b64_tr_b16 a[76:77], v16 offset:40960
  v_cndmask_b32 v23, 0, v22, vcc
  v_mfma_f32_16x16x32_bf16 v[220:223], a[108:111], a[156:159], v[220:223]
  s_add_u32 s70, s78, 1343488
  v_accvgpr_write_b32 a223, v23
  v_mfma_f32_16x16x32_bf16 v[212:215], a[108:111], a[152:155], v[212:215]
  s_add_u32 m0, s81, 17408
  ds_read_b64_tr_b16 a[78:79], v16 offset:41984
  v_and_b32 v21, 15, v1
  v_mfma_f32_16x16x32_bf16 v[204:207], a[108:111], a[148:151], v[204:207]
  buffer_load_dwordx4 v7, s[8:11], s70 offen  lds
  v_mfma_f32_16x16x32_bf16 v[196:199], a[108:111], a[144:147], v[196:199]
  v_lshrrev_b32 v22, 4, v1
  v_mfma_f32_16x16x32_bf16 v[188:191], a[108:111], a[140:143], v[188:191]
  ds_read_b128 a[48:51], v9 offset:40960
  v_lshlrev_b32 v22, 3, v22
  v_mfma_f32_16x16x32_bf16 v[180:183], a[108:111], a[136:139], v[180:183]
  v_sub_u32 v21, v21, v22
  v_mfma_f32_16x16x32_bf16 v[172:175], a[108:111], a[132:135], v[172:175]
  ds_read_b64_tr_b16 a[80:81], v17 offset:40960
  v_add_u32 v21, 16, v21
  v_mfma_f32_16x16x32_bf16 v[164:167], a[108:111], a[128:131], v[164:167]
  s_add_u32 s70, s74, 16768
  v_and_b32 v22, 1, v21
  v_mfma_f32_16x16x32_bf16 v[224:227], a[112:115], a[128:131], v[224:227]
  s_add_u32 m0, s80, 2048
  ds_read_b64_tr_b16 a[82:83], v17 offset:41984
  v_lshlrev_b32 v22, 4, v22
  v_mfma_f32_16x16x32_bf16 v[232:235], a[112:115], a[132:135], v[232:235]
  buffer_load_dwordx4 v3, s[4:7], s70 offen  lds
  v_mfma_f32_16x16x32_bf16 v[240:243], a[112:115], a[136:139], v[240:243]
  v_mov_b32 v23, 0x3f80
  v_mfma_f32_16x16x32_bf16 v[248:251], a[112:115], a[140:143], v[248:251]
  ds_read_b128 a[52:55], v9 offset:43008
  v_lshlrev_b32 v22, v22, v23
  v_mfma_f32_16x16x32_bf16 v[88:91], a[112:115], a[144:147], v[88:91]
  v_ashrrev_i32 v21, 1, v21
  v_mfma_f32_16x16x32_bf16 v[80:83], a[112:115], a[148:151], v[80:83]
  ds_read_b64_tr_b16 a[84:85], v18 offset:40960
  v_cmp_eq_u32 vcc, 0, v21
  v_mfma_f32_16x16x32_bf16 v[72:75], a[112:115], a[152:155], v[72:75]
  s_add_u32 s70, s78, 1376256
  s_nop 0
  v_cndmask_b32 v23, 0, v22, vcc
  v_mfma_f32_16x16x32_bf16 v[64:67], a[112:115], a[156:159], v[64:67]
  s_add_u32 m0, s81, 18432
  ds_read_b64_tr_b16 a[86:87], v18 offset:41984
  v_accvgpr_write_b32 a224, v23
  v_mfma_f32_16x16x32_bf16 v[68:71], a[116:119], a[156:159], v[68:71]
  buffer_load_dwordx4 v8, s[8:11], s70 offen  lds
  v_mfma_f32_16x16x32_bf16 v[76:79], a[116:119], a[152:155], v[76:79]
  v_cmp_eq_u32 vcc, 1, v21
  v_mfma_f32_16x16x32_bf16 v[84:87], a[116:119], a[148:151], v[84:87]
  s_nop 0
  ds_read_b128 a[56:59], v9 offset:45056
  v_cndmask_b32 v23, 0, v22, vcc
  v_mfma_f32_16x16x32_bf16 v[92:95], a[116:119], a[144:147], v[92:95]
  v_accvgpr_write_b32 a225, v23
  v_mfma_f32_16x16x32_bf16 v[252:255], a[116:119], a[140:143], v[252:255]
  ds_read_b64_tr_b16 a[88:89], v19 offset:40960
  v_cmp_eq_u32 vcc, 2, v21
  v_mfma_f32_16x16x32_bf16 v[244:247], a[116:119], a[136:139], v[244:247]
  s_add_u32 s70, s74, 24960
  s_nop 0
  v_cndmask_b32 v23, 0, v22, vcc
  v_mfma_f32_16x16x32_bf16 v[236:239], a[116:119], a[132:135], v[236:239]
  s_add_u32 m0, s80, 3072
  ds_read_b64_tr_b16 a[90:91], v19 offset:41984
  v_accvgpr_write_b32 a226, v23
  v_mfma_f32_16x16x32_bf16 v[228:231], a[116:119], a[128:131], v[228:231]
  buffer_load_dwordx4 v4, s[4:7], s70 offen  lds
  v_mfma_f32_16x16x32_bf16 v[56:59], a[120:123], a[128:131], v[56:59]
  v_cmp_eq_u32 vcc, 3, v21
  v_mfma_f32_16x16x32_bf16 v[48:51], a[120:123], a[132:135], v[48:51]
  s_nop 0
  ds_read_b128 a[60:63], v9 offset:47104
  v_cndmask_b32 v23, 0, v22, vcc
  v_mfma_f32_16x16x32_bf16 v[40:43], a[120:123], a[136:139], v[40:43]
  v_accvgpr_write_b32 a227, v23
  v_mfma_f32_16x16x32_bf16 v[32:35], a[120:123], a[140:143], v[32:35]
  ds_read_b64_tr_b16 a[92:93], v20 offset:40960
  v_and_b32 v21, 15, v1
  v_mfma_f32_16x16x32_bf16 a[0:3], a[120:123], a[144:147], a[0:3]
  s_add_u32 s70, s78, 1409024
  v_lshrrev_b32 v22, 4, v1
  v_mfma_f32_16x16x32_bf16 a[8:11], a[120:123], a[148:151], a[8:11]
  s_add_u32 m0, s81, 19456
  ds_read_b64_tr_b16 a[94:95], v20 offset:41984
  v_lshlrev_b32 v22, 3, v22
  v_mfma_f32_16x16x32_bf16 a[16:19], a[120:123], a[152:155], a[16:19]
  buffer_load_dwordx4 v8, s[8:11], s70 offen  lds
  v_mfma_f32_16x16x32_bf16 a[24:27], a[120:123], a[156:159], a[24:27]
  v_sub_u32 v21, v21, v22
  v_mfma_f32_16x16x32_bf16 a[28:31], a[124:127], a[156:159], a[28:31]
  v_subrev_u32 v21, s71, v21
  v_mfma_f32_16x16x32_bf16 a[20:23], a[124:127], a[152:155], a[20:23]
  v_and_b32 v22, 1, v21
  v_mfma_f32_16x16x32_bf16 a[12:15], a[124:127], a[148:151], a[12:15]
  v_lshlrev_b32 v22, 4, v22
  v_mfma_f32_16x16x32_bf16 a[4:7], a[124:127], a[144:147], a[4:7]
  v_mov_b32 v23, 0x3f80
  v_mfma_f32_16x16x32_bf16 v[36:39], a[124:127], a[140:143], v[36:39]
  v_lshlrev_b32 v22, v22, v23
  v_mfma_f32_16x16x32_bf16 v[44:47], a[124:127], a[136:139], v[44:47]
  v_mfma_f32_16x16x32_bf16 v[52:55], a[124:127], a[132:135], v[52:55]
  s_waitcnt vmcnt(20) lgkmcnt(0)
  v_mfma_f32_16x16x32_bf16 v[60:63], a[124:127], a[128:131], v[60:63]
  s_barrier
  v_mfma_f32_16x16x32_bf16 v[96:99], a[32:35], a[64:67], v[96:99]
  ds_read_b128 a[96:99], v10 offset:32768
  v_ashrrev_i32 v21, 1, v21
  v_mfma_f32_16x16x32_bf16 v[104:107], a[32:35], a[68:71], v[104:107]
  v_cmp_eq_u32 vcc, 0, v21
  v_mfma_f32_16x16x32_bf16 v[112:115], a[32:35], a[72:75], v[112:115]
  s_nop 0
  ds_read_b64_tr_b16 a[128:129], v13 offset:57344
  v_cndmask_b32 v23, 0, v22, vcc
  v_mfma_f32_16x16x32_bf16 v[120:123], a[32:35], a[76:79], v[120:123]
  s_add_u32 s70, s75, 384
  v_accvgpr_write_b32 a228, v23
  v_mfma_f32_16x16x32_bf16 v[128:131], a[32:35], a[80:83], v[128:131]
  s_add_u32 m0, s80, 4096
  ds_read_b64_tr_b16 a[130:131], v13 offset:58368
  v_cmp_eq_u32 vcc, 1, v21
  v_mfma_f32_16x16x32_bf16 v[136:139], a[32:35], a[84:87], v[136:139]
  s_nop 0
  buffer_load_dwordx4 v3, s[4:7], s70 offen  lds
  v_mfma_f32_16x16x32_bf16 v[144:147], a[32:35], a[88:91], v[144:147]
  v_cndmask_b32 v23, 0, v22, vcc
  v_mfma_f32_16x16x32_bf16 v[152:155], a[32:35], a[92:95], v[152:155]
  ds_read_b128 a[100:103], v10 offset:34816
  v_accvgpr_write_b32 a229, v23
  v_mfma_f32_16x16x32_bf16 v[156:159], a[36:39], a[92:95], v[156:159]
  v_cmp_eq_u32 vcc, 2, v21
  v_mfma_f32_16x16x32_bf16 v[148:151], a[36:39], a[88:91], v[148:151]
  s_nop 0
  ds_read_b64_tr_b16 a[132:133], v14 offset:57344
  v_cndmask_b32 v23, 0, v22, vcc
  v_mfma_f32_16x16x32_bf16 v[140:143], a[36:39], a[84:87], v[140:143]
  s_add_u32 s70, s78, 1572864
  v_accvgpr_write_b32 a230, v23
  v_mfma_f32_16x16x32_bf16 v[132:135], a[36:39], a[80:83], v[132:135]
  s_add_u32 m0, s81, 32768
  ds_read_b64_tr_b16 a[134:135], v14 offset:58368
  v_cmp_eq_u32 vcc, 3, v21
  v_mfma_f32_16x16x32_bf16 v[124:127], a[36:39], a[76:79], v[124:127]
  s_nop 0
  buffer_load_dwordx4 v7, s[8:11], s70 offen  lds
  v_mfma_f32_16x16x32_bf16 v[116:119], a[36:39], a[72:75], v[116:119]
  v_cndmask_b32 v23, 0, v22, vcc
  v_mfma_f32_16x16x32_bf16 v[108:111], a[36:39], a[68:71], v[108:111]
  ds_read_b128 a[104:107], v10 offset:36864
  v_accvgpr_write_b32 a231, v23
  v_mfma_f32_16x16x32_bf16 v[100:103], a[36:39], a[64:67], v[100:103]
  v_mfma_f32_16x16x32_bf16 v[160:163], a[40:43], a[64:67], v[160:163]
  ds_read_b64_tr_b16 a[136:137], v15 offset:57344
  v_mfma_f32_16x16x32_bf16 v[168:171], a[40:43], a[68:71], v[168:171]
  s_add_u32 s70, s75, 8576
  v_mfma_f32_16x16x32_bf16 v[176:179], a[40:43], a[72:75], v[176:179]
  s_add_u32 m0, s80, 5120
  ds_read_b64_tr_b16 a[138:139], v15 offset:58368
  v_mfma_f32_16x16x32_bf16 v[184:187], a[40:43], a[76:79], v[184:187]
  buffer_load_dwordx4 v4, s[4:7], s70 offen  lds
  v_mfma_f32_16x16x32_bf16 v[192:195], a[40:43], a[80:83], v[192:195]
  v_mfma_f32_16x16x32_bf16 v[200:203], a[40:43], a[84:87], v[200:203]
  ds_read_b128 a[108:111], v10 offset:38912
  v_mfma_f32_16x16x32_bf16 v[208:211], a[40:43], a[88:91], v[208:211]
  v_mfma_f32_16x16x32_bf16 v[216:219], a[40:43], a[92:95], v[216:219]
  ds_read_b64_tr_b16 a[140:141], v16 offset:57344
  v_mfma_f32_16x16x32_bf16 v[220:223], a[44:47], a[92:95], v[220:223]
  s_add_u32 s70, s78, 1605632
  v_mfma_f32_16x16x32_bf16 v[212:215], a[44:47], a[88:91], v[212:215]
  s_add_u32 m0, s81, 33792
  ds_read_b64_tr_b16 a[142:143], v16 offset:58368
  v_mfma_f32_16x16x32_bf16 v[204:207], a[44:47], a[84:87], v[204:207]
  buffer_load_dwordx4 v7, s[8:11], s70 offen  lds
  v_mfma_f32_16x16x32_bf16 v[196:199], a[44:47], a[80:83], v[196:199]
  v_mfma_f32_16x16x32_bf16 v[188:191], a[44:47], a[76:79], v[188:191]
  ds_read_b128 a[112:115], v10 offset:40960
  v_mfma_f32_16x16x32_bf16 v[180:183], a[44:47], a[72:75], v[180:183]
  v_mfma_f32_16x16x32_bf16 v[172:175], a[44:47], a[68:71], v[172:175]
  ds_read_b64_tr_b16 a[144:145], v17 offset:57344
  v_mfma_f32_16x16x32_bf16 v[164:167], a[44:47], a[64:67], v[164:167]
  s_add_u32 s70, s75, 16768
  v_mfma_f32_16x16x32_bf16 v[224:227], a[48:51], a[64:67], v[224:227]
  s_add_u32 m0, s80, 6144
  ds_read_b64_tr_b16 a[146:147], v17 offset:58368
  v_mfma_f32_16x16x32_bf16 v[232:235], a[48:51], a[68:71], v[232:235]
  buffer_load_dwordx4 v3, s[4:7], s70 offen  lds
  v_mfma_f32_16x16x32_bf16 v[240:243], a[48:51], a[72:75], v[240:243]
  v_mfma_f32_16x16x32_bf16 v[248:251], a[48:51], a[76:79], v[248:251]
  ds_read_b128 a[116:119], v10 offset:43008
  v_mfma_f32_16x16x32_bf16 v[88:91], a[48:51], a[80:83], v[88:91]
  v_mfma_f32_16x16x32_bf16 v[80:83], a[48:51], a[84:87], v[80:83]
  ds_read_b64_tr_b16 a[148:149], v18 offset:57344
  v_mfma_f32_16x16x32_bf16 v[72:75], a[48:51], a[88:91], v[72:75]
  s_add_u32 s70, s78, 1638400
  v_mfma_f32_16x16x32_bf16 v[64:67], a[48:51], a[92:95], v[64:67]
  s_add_u32 m0, s81, 34816
  ds_read_b64_tr_b16 a[150:151], v18 offset:58368
  v_mfma_f32_16x16x32_bf16 v[68:71], a[52:55], a[92:95], v[68:71]
  buffer_load_dwordx4 v8, s[8:11], s70 offen  lds
  v_mfma_f32_16x16x32_bf16 v[76:79], a[52:55], a[88:91], v[76:79]
  v_mfma_f32_16x16x32_bf16 v[84:87], a[52:55], a[84:87], v[84:87]
  ds_read_b128 a[120:123], v10 offset:45056
  v_mfma_f32_16x16x32_bf16 v[92:95], a[52:55], a[80:83], v[92:95]
  v_mfma_f32_16x16x32_bf16 v[252:255], a[52:55], a[76:79], v[252:255]
  ds_read_b64_tr_b16 a[152:153], v19 offset:57344
  v_mfma_f32_16x16x32_bf16 v[244:247], a[52:55], a[72:75], v[244:247]
  s_add_u32 s70, s75, 24960
  v_mfma_f32_16x16x32_bf16 v[236:239], a[52:55], a[68:71], v[236:239]
  s_add_u32 m0, s80, 7168
  ds_read_b64_tr_b16 a[154:155], v19 offset:58368
  v_mfma_f32_16x16x32_bf16 v[228:231], a[52:55], a[64:67], v[228:231]
  buffer_load_dwordx4 v4, s[4:7], s70 offen  lds
  v_mfma_f32_16x16x32_bf16 v[56:59], a[56:59], a[64:67], v[56:59]
  v_mfma_f32_16x16x32_bf16 v[48:51], a[56:59], a[68:71], v[48:51]
  ds_read_b128 a[124:127], v10 offset:47104
  v_mfma_f32_16x16x32_bf16 v[40:43], a[56:59], a[72:75], v[40:43]
  v_mfma_f32_16x16x32_bf16 v[32:35], a[56:59], a[76:79], v[32:35]
  ds_read_b64_tr_b16 a[156:157], v20 offset:57344
  v_mfma_f32_16x16x32_bf16 a[0:3], a[56:59], a[80:83], a[0:3]
  s_add_u32 s70, s78, 1671168
  v_mfma_f32_16x16x32_bf16 a[8:11], a[56:59], a[84:87], a[8:11]
  s_add_u32 m0, s81, 35840
  ds_read_b64_tr_b16 a[158:159], v20 offset:58368
  v_mfma_f32_16x16x32_bf16 a[16:19], a[56:59], a[88:91], a[16:19]
  buffer_load_dwordx4 v8, s[8:11], s70 offen  lds
  v_mfma_f32_16x16x32_bf16 a[24:27], a[56:59], a[92:95], a[24:27]
  v_mfma_f32_16x16x32_bf16 a[28:31], a[60:63], a[92:95], a[28:31]
  v_mfma_f32_16x16x32_bf16 a[20:23], a[60:63], a[88:91], a[20:23]
  v_mfma_f32_16x16x32_bf16 a[12:15], a[60:63], a[84:87], a[12:15]
  v_mfma_f32_16x16x32_bf16 a[4:7], a[60:63], a[80:83], a[4:7]
  v_mfma_f32_16x16x32_bf16 v[36:39], a[60:63], a[76:79], v[36:39]
  v_mfma_f32_16x16x32_bf16 v[44:47], a[60:63], a[72:75], v[44:47]
  v_mfma_f32_16x16x32_bf16 v[52:55], a[60:63], a[68:71], v[52:55]
  s_waitcnt vmcnt(16) lgkmcnt(0)
  v_mfma_f32_16x16x32_bf16 v[60:63], a[60:63], a[64:67], v[60:63]
  s_barrier
  v_mfma_f32_16x16x32_bf16 v[96:99], a[96:99], a[128:131], v[96:99]
  ds_read_b128 a[32:35], v11 offset:0
  v_lshrrev_b32 v21, 4, v1
  v_mfma_f32_16x16x32_bf16 v[104:107], a[96:99], a[132:135], v[104:107]
  v_and_b32 v22, 7, v1
  v_mfma_f32_16x16x32_bf16 v[112:115], a[96:99], a[136:139], v[112:115]
  ds_read_b64_tr_b16 a[64:65], v13 offset:8192
  v_lshl_add_u32 v22, v21, 3, v22
  v_mfma_f32_16x16x32_bf16 v[120:123], a[96:99], a[140:143], v[120:123]
  s_add_u32 s70, s74, 512
  v_lshlrev_b32 v22, 4, v22
  v_mfma_f32_16x16x32_bf16 v[128:131], a[96:99], a[144:147], v[128:131]
  s_add_u32 m0, s80, 32768
  ds_read_b64_tr_b16 a[66:67], v13 offset:9216
  v_add_u32 v21, 1, v21
  v_mfma_f32_16x16x32_bf16 v[136:139], a[96:99], a[148:151], v[136:139]
  buffer_load_dwordx4 v3, s[4:7], s70 offen  lds
  v_mfma_f32_16x16x32_bf16 v[144:147], a[96:99], a[152:155], v[144:147]
  v_lshrrev_b32 v21, 2, v21
  v_mfma_f32_16x16x32_bf16 v[152:155], a[96:99], a[156:159], v[152:155]
  ds_read_b128 a[36:39], v11 offset:2048
  v_lshl_add_u32 v22, v21, 28, v22
  v_mfma_f32_16x16x32_bf16 v[156:159], a[100:103], a[156:159], v[156:159]
  v_bfe_u32 v21, v1, 3, 1
  v_mfma_f32_16x16x32_bf16 v[148:151], a[100:103], a[152:155], v[148:151]
  ds_read_b64_tr_b16 a[68:69], v14 offset:8192
  v_mul_u32_u24 v21, 1152, v21
  v_mfma_f32_16x16x32_bf16 v[140:143], a[100:103], a[148:151], v[140:143]
  s_add_u32 s70, s78, 1835008
  v_add_u32 v21, v21, v22
  v_mfma_f32_16x16x32_bf16 v[132:135], a[100:103], a[144:147], v[132:135]
  s_add_u32 m0, s81, 49152
  s_lshl_b32 s71, s2, 3
  ds_read_b64_tr_b16 a[70:71], v14 offset:9216
  v_mfma_f32_16x16x32_bf16 v[124:127], a[100:103], a[140:143], v[124:127]
  s_lshl_b32 s72, s34, 1
  buffer_load_dwordx4 v7, s[8:11], s70 offen  lds
  v_mfma_f32_16x16x32_bf16 v[116:119], a[100:103], a[136:139], v[116:119]
  s_add_u32 s71, s71, s72
  s_mul_i32 s71, s71, 1152
  v_mfma_f32_16x16x32_bf16 v[108:111], a[100:103], a[132:135], v[108:111]
  ds_read_b128 a[40:43], v11 offset:4096
  v_mfma_f32_16x16x32_bf16 v[100:103], a[100:103], a[128:131], v[100:103]
  buffer_load_dwordx4 a[160:163], v21, s[12:15], s71 offen offset:0
  v_mfma_f32_16x16x32_bf16 v[160:163], a[104:107], a[128:131], v[160:163]
  ds_read_b64_tr_b16 a[72:73], v15 offset:8192
  v_mfma_f32_16x16x32_bf16 v[168:171], a[104:107], a[132:135], v[168:171]
  s_add_u32 s70, s74, 8704
  buffer_load_dwordx4 a[172:175], v22, s[24:27], 0 offen offset:0
  v_mfma_f32_16x16x32_bf16 v[176:179], a[104:107], a[136:139], v[176:179]
  s_add_u32 m0, s80, 33792
  ds_read_b64_tr_b16 a[74:75], v15 offset:9216
  v_mfma_f32_16x16x32_bf16 v[184:187], a[104:107], a[140:143], v[184:187]
  buffer_load_dwordx4 v4, s[4:7], s70 offen  lds
  v_mfma_f32_16x16x32_bf16 v[192:195], a[104:107], a[144:147], v[192:195]
  buffer_load_dwordx4 a[184:187], v22, s[28:31], 0 offen offset:0
  v_mfma_f32_16x16x32_bf16 v[200:203], a[104:107], a[148:151], v[200:203]
  ds_read_b128 a[44:47], v11 offset:6144
  v_mfma_f32_16x16x32_bf16 v[208:211], a[104:107], a[152:155], v[208:211]
  buffer_load_dwordx4 a[164:167], v21, s[12:15], s71 offen offset:384
  v_mfma_f32_16x16x32_bf16 v[216:219], a[104:107], a[156:159], v[216:219]
  ds_read_b64_tr_b16 a[76:77], v16 offset:8192
  v_mfma_f32_16x16x32_bf16 v[220:223], a[108:111], a[156:159], v[220:223]
  s_add_u32 s70, s78, 1867776
  buffer_load_dwordx4 a[176:179], v22, s[24:27], 0 offen offset:384
  v_mfma_f32_16x16x32_bf16 v[212:215], a[108:111], a[152:155], v[212:215]
  s_add_u32 m0, s81, 50176
  ds_read_b64_tr_b16 a[78:79], v16 offset:9216
  v_mfma_f32_16x16x32_bf16 v[204:207], a[108:111], a[148:151], v[204:207]
  buffer_load_dwordx4 v7, s[8:11], s70 offen  lds
  v_mfma_f32_16x16x32_bf16 v[196:199], a[108:111], a[144:147], v[196:199]
  buffer_load_dwordx4 a[188:191], v22, s[28:31], 0 offen offset:384
  v_mfma_f32_16x16x32_bf16 v[188:191], a[108:111], a[140:143], v[188:191]
  ds_read_b128 a[48:51], v11 offset:8192
  v_mfma_f32_16x16x32_bf16 v[180:183], a[108:111], a[136:139], v[180:183]
  buffer_load_dwordx4 a[168:171], v21, s[12:15], s71 offen offset:768
  v_mfma_f32_16x16x32_bf16 v[172:175], a[108:111], a[132:135], v[172:175]
  ds_read_b64_tr_b16 a[80:81], v17 offset:8192
  v_mfma_f32_16x16x32_bf16 v[164:167], a[108:111], a[128:131], v[164:167]
  s_add_u32 s70, s74, 16896
  buffer_load_dwordx4 a[180:183], v22, s[24:27], 0 offen offset:768
  v_mfma_f32_16x16x32_bf16 v[224:227], a[112:115], a[128:131], v[224:227]
  s_add_u32 m0, s80, 34816
  ds_read_b64_tr_b16 a[82:83], v17 offset:9216
  v_mfma_f32_16x16x32_bf16 v[232:235], a[112:115], a[132:135], v[232:235]
  buffer_load_dwordx4 v3, s[4:7], s70 offen  lds
  v_mfma_f32_16x16x32_bf16 v[240:243], a[112:115], a[136:139], v[240:243]
  buffer_load_dwordx4 a[192:195], v22, s[28:31], 0 offen offset:768
  v_mfma_f32_16x16x32_bf16 v[248:251], a[112:115], a[140:143], v[248:251]
  ds_read_b128 a[52:55], v11 offset:10240
  v_mfma_f32_16x16x32_bf16 v[88:91], a[112:115], a[144:147], v[88:91]
  v_mfma_f32_16x16x32_bf16 v[80:83], a[112:115], a[148:151], v[80:83]
  ds_read_b64_tr_b16 a[84:85], v18 offset:8192
  v_mfma_f32_16x16x32_bf16 v[72:75], a[112:115], a[152:155], v[72:75]
  s_add_u32 s70, s78, 1900544
  v_mfma_f32_16x16x32_bf16 v[64:67], a[112:115], a[156:159], v[64:67]
  s_add_u32 m0, s81, 51200
  ds_read_b64_tr_b16 a[86:87], v18 offset:9216
  v_mfma_f32_16x16x32_bf16 v[68:71], a[116:119], a[156:159], v[68:71]
  buffer_load_dwordx4 v8, s[8:11], s70 offen  lds
  v_mfma_f32_16x16x32_bf16 v[76:79], a[116:119], a[152:155], v[76:79]
  v_mfma_f32_16x16x32_bf16 v[84:87], a[116:119], a[148:151], v[84:87]
  ds_read_b128 a[56:59], v11 offset:12288
  v_mfma_f32_16x16x32_bf16 v[92:95], a[116:119], a[144:147], v[92:95]
  v_mfma_f32_16x16x32_bf16 v[252:255], a[116:119], a[140:143], v[252:255]
  ds_read_b64_tr_b16 a[88:89], v19 offset:8192
  v_mfma_f32_16x16x32_bf16 v[244:247], a[116:119], a[136:139], v[244:247]
  s_add_u32 s70, s74, 25088
  v_mfma_f32_16x16x32_bf16 v[236:239], a[116:119], a[132:135], v[236:239]
  s_add_u32 m0, s80, 35840
  ds_read_b64_tr_b16 a[90:91], v19 offset:9216
  v_mfma_f32_16x16x32_bf16 v[228:231], a[116:119], a[128:131], v[228:231]
  buffer_load_dwordx4 v4, s[4:7], s70 offen  lds
  v_mfma_f32_16x16x32_bf16 v[56:59], a[120:123], a[128:131], v[56:59]
  v_mfma_f32_16x16x32_bf16 v[48:51], a[120:123], a[132:135], v[48:51]
  ds_read_b128 a[60:63], v11 offset:14336
  v_mfma_f32_16x16x32_bf16 v[40:43], a[120:123], a[136:139], v[40:43]
  v_mfma_f32_16x16x32_bf16 v[32:35], a[120:123], a[140:143], v[32:35]
  ds_read_b64_tr_b16 a[92:93], v20 offset:8192
  v_mfma_f32_16x16x32_bf16 a[0:3], a[120:123], a[144:147], a[0:3]
  s_add_u32 s70, s78, 1933312
  v_mfma_f32_16x16x32_bf16 a[8:11], a[120:123], a[148:151], a[8:11]
  s_add_u32 m0, s81, 52224
  ds_read_b64_tr_b16 a[94:95], v20 offset:9216
  v_mfma_f32_16x16x32_bf16 a[16:19], a[120:123], a[152:155], a[16:19]
  buffer_load_dwordx4 v8, s[8:11], s70 offen  lds
  v_mfma_f32_16x16x32_bf16 a[24:27], a[120:123], a[156:159], a[24:27]
  v_mfma_f32_16x16x32_bf16 a[28:31], a[124:127], a[156:159], a[28:31]
  v_mfma_f32_16x16x32_bf16 a[20:23], a[124:127], a[152:155], a[20:23]
  v_mfma_f32_16x16x32_bf16 a[12:15], a[124:127], a[148:151], a[12:15]
  v_mfma_f32_16x16x32_bf16 a[4:7], a[124:127], a[144:147], a[4:7]
  v_mfma_f32_16x16x32_bf16 v[36:39], a[124:127], a[140:143], v[36:39]
  v_mfma_f32_16x16x32_bf16 v[44:47], a[124:127], a[136:139], v[44:47]
  v_mfma_f32_16x16x32_bf16 v[52:55], a[124:127], a[132:135], v[52:55]
  s_waitcnt vmcnt(25) lgkmcnt(0)
  v_mfma_f32_16x16x32_bf16 v[60:63], a[124:127], a[128:131], v[60:63]
  s_barrier
  v_mfma_f32_16x16x32_bf16 v[96:99], a[32:35], a[64:67], v[96:99]
  ds_read_b128 a[96:99], v12 offset:0
  v_min_u32 v29, 27, v1
  v_mfma_f32_16x16x32_bf16 v[104:107], a[32:35], a[68:71], v[104:107]
  v_lshlrev_b32 v29, 2, v29
  v_mfma_f32_16x16x32_bf16 v[112:115], a[32:35], a[72:75], v[112:115]
  ds_read_b64_tr_b16 a[128:129], v13 offset:24576
  v_mfma_f32_16x16x32_bf16 v[120:123], a[32:35], a[76:79], v[120:123]
  s_add_u32 s70, s75, 512
  global_load_dword v29, v29, s[66:67] sc1
  v_mfma_f32_16x16x32_bf16 v[128:131], a[32:35], a[80:83], v[128:131]
  s_add_u32 m0, s80, 36864
  s_lshr_b32 s97, s2, 1
  ds_read_b64_tr_b16 a[130:131], v13 offset:25600
  v_mfma_f32_16x16x32_bf16 v[136:139], a[32:35], a[84:87], v[136:139]
  s_mul_i32 s97, s97, 36864
  buffer_load_dwordx4 v3, s[4:7], s70 offen  lds
  v_mfma_f32_16x16x32_bf16 v[144:147], a[32:35], a[88:91], v[144:147]
  s_and_b32 s73, s2, 1
  s_lshl_b32 s73, s73, 2
  s_add_u32 s73, s73, s34
  v_mfma_f32_16x16x32_bf16 v[152:155], a[32:35], a[92:95], v[152:155]
  s_mul_i32 s73, s73, 144
  s_add_u32 s97, s97, s73
  ds_read_b128 a[100:103], v12 offset:2048
  v_mfma_f32_16x16x32_bf16 v[156:159], a[36:39], a[92:95], v[156:159]
  s_add_u32 s32, s97, 18432
  s_mov_b32 s24, s50
  s_mov_b32 s25, s51
  v_mfma_f32_16x16x32_bf16 v[148:151], a[36:39], a[88:91], v[148:151]
  s_mov_b32 s26, 4718592
  ds_read_b64_tr_b16 a[132:133], v14 offset:24576
  v_and_b32 v5, 15, v1
  v_mfma_f32_16x16x32_bf16 v[140:143], a[36:39], a[84:87], v[140:143]
  s_add_u32 s70, s78, 2097152
  v_mul_u32_u24 v5, 1152, v5
  v_mfma_f32_16x16x32_bf16 v[132:135], a[36:39], a[80:83], v[132:135]
  s_add_u32 m0, s81, 0
  ds_read_b64_tr_b16 a[134:135], v14 offset:25600
  v_lshrrev_b32 v6, 4, v1
  v_mfma_f32_16x16x32_bf16 v[124:127], a[36:39], a[76:79], v[124:127]
  buffer_load_dwordx4 v7, s[8:11], s70 offen  lds
  v_mfma_f32_16x16x32_bf16 v[116:119], a[36:39], a[72:75], v[116:119]
  v_lshl_add_u32 v5, v6, 4, v5
  v_mfma_f32_16x16x32_bf16 v[108:111], a[36:39], a[68:71], v[108:111]
  ds_read_b128 a[104:107], v12 offset:4096
  v_lshl_add_u32 v6, v6, 28, v5
  v_mfma_f32_16x16x32_bf16 v[100:103], a[36:39], a[64:67], v[100:103]
  v_mfma_f32_16x16x32_bf16 v[160:163], a[40:43], a[64:67], v[160:163]
  ds_read_b64_tr_b16 a[136:137], v15 offset:24576
  v_mfma_f32_16x16x32_bf16 v[168:171], a[40:43], a[68:71], v[168:171]
  s_add_u32 s70, s75, 8704
  v_mfma_f32_16x16x32_bf16 v[176:179], a[40:43], a[72:75], v[176:179]
  s_add_u32 m0, s80, 37888
  ds_read_b64_tr_b16 a[138:139], v15 offset:25600
  v_mfma_f32_16x16x32_bf16 v[184:187], a[40:43], a[76:79], v[184:187]
  buffer_load_dwordx4 v4, s[4:7], s70 offen  lds
  v_mfma_f32_16x16x32_bf16 v[192:195], a[40:43], a[80:83], v[192:195]
  v_mfma_f32_16x16x32_bf16 v[200:203], a[40:43], a[84:87], v[200:203]
  ds_read_b128 a[108:111], v12 offset:6144
  v_mfma_f32_16x16x32_bf16 v[208:211], a[40:43], a[88:91], v[208:211]
  v_mfma_f32_16x16x32_bf16 v[216:219], a[40:43], a[92:95], v[216:219]
  ds_read_b64_tr_b16 a[140:141], v16 offset:24576
  v_mfma_f32_16x16x32_bf16 v[220:223], a[44:47], a[92:95], v[220:223]
  s_add_u32 s70, s78, 2129920
  v_mfma_f32_16x16x32_bf16 v[212:215], a[44:47], a[88:91], v[212:215]
  s_add_u32 m0, s81, 1024
  ds_read_b64_tr_b16 a[142:143], v16 offset:25600
  v_mfma_f32_16x16x32_bf16 v[204:207], a[44:47], a[84:87], v[204:207]
  buffer_load_dwordx4 v7, s[8:11], s70 offen  lds
  v_mfma_f32_16x16x32_bf16 v[196:199], a[44:47], a[80:83], v[196:199]
  v_mfma_f32_16x16x32_bf16 v[188:191], a[44:47], a[76:79], v[188:191]
  ds_read_b128 a[112:115], v12 offset:8192
  v_mfma_f32_16x16x32_bf16 v[180:183], a[44:47], a[72:75], v[180:183]
  v_mfma_f32_16x16x32_bf16 v[172:175], a[44:47], a[68:71], v[172:175]
  ds_read_b64_tr_b16 a[144:145], v17 offset:24576
  v_mfma_f32_16x16x32_bf16 v[164:167], a[44:47], a[64:67], v[164:167]
  s_add_u32 s70, s75, 16896
  v_mfma_f32_16x16x32_bf16 v[224:227], a[48:51], a[64:67], v[224:227]
  s_add_u32 m0, s80, 38912
  ds_read_b64_tr_b16 a[146:147], v17 offset:25600
  v_mfma_f32_16x16x32_bf16 v[232:235], a[48:51], a[68:71], v[232:235]
  buffer_load_dwordx4 v3, s[4:7], s70 offen  lds
  v_mfma_f32_16x16x32_bf16 v[240:243], a[48:51], a[72:75], v[240:243]
  v_mfma_f32_16x16x32_bf16 v[248:251], a[48:51], a[76:79], v[248:251]
  ds_read_b128 a[116:119], v12 offset:10240
  v_mfma_f32_16x16x32_bf16 v[88:91], a[48:51], a[80:83], v[88:91]
  v_mfma_f32_16x16x32_bf16 v[80:83], a[48:51], a[84:87], v[80:83]
  ds_read_b64_tr_b16 a[148:149], v18 offset:24576
  v_mfma_f32_16x16x32_bf16 v[72:75], a[48:51], a[88:91], v[72:75]
  s_add_u32 s70, s78, 2162688
  v_mfma_f32_16x16x32_bf16 v[64:67], a[48:51], a[92:95], v[64:67]
  s_add_u32 m0, s81, 2048
  ds_read_b64_tr_b16 a[150:151], v18 offset:25600
  v_mfma_f32_16x16x32_bf16 v[68:71], a[52:55], a[92:95], v[68:71]
  buffer_load_dwordx4 v8, s[8:11], s70 offen  lds
  v_mfma_f32_16x16x32_bf16 v[76:79], a[52:55], a[88:91], v[76:79]
  v_mfma_f32_16x16x32_bf16 v[84:87], a[52:55], a[84:87], v[84:87]
  ds_read_b128 a[120:123], v12 offset:12288
  v_mfma_f32_16x16x32_bf16 v[92:95], a[52:55], a[80:83], v[92:95]
  v_mfma_f32_16x16x32_bf16 v[252:255], a[52:55], a[76:79], v[252:255]
  ds_read_b64_tr_b16 a[152:153], v19 offset:24576
  v_mfma_f32_16x16x32_bf16 v[244:247], a[52:55], a[72:75], v[244:247]
  s_add_u32 s70, s75, 25088
  v_mfma_f32_16x16x32_bf16 v[236:239], a[52:55], a[68:71], v[236:239]
  s_add_u32 m0, s80, 39936
  ds_read_b64_tr_b16 a[154:155], v19 offset:25600
  v_mfma_f32_16x16x32_bf16 v[228:231], a[52:55], a[64:67], v[228:231]
  buffer_load_dwordx4 v4, s[4:7], s70 offen  lds
  v_mfma_f32_16x16x32_bf16 v[56:59], a[56:59], a[64:67], v[56:59]
  v_mfma_f32_16x16x32_bf16 v[48:51], a[56:59], a[68:71], v[48:51]
  ds_read_b128 a[124:127], v12 offset:14336
  v_mfma_f32_16x16x32_bf16 v[40:43], a[56:59], a[72:75], v[40:43]
  v_mfma_f32_16x16x32_bf16 v[32:35], a[56:59], a[76:79], v[32:35]
  ds_read_b64_tr_b16 a[156:157], v20 offset:24576
  v_mfma_f32_16x16x32_bf16 a[0:3], a[56:59], a[80:83], a[0:3]
  s_add_u32 s70, s78, 2195456
  v_mfma_f32_16x16x32_bf16 a[8:11], a[56:59], a[84:87], a[8:11]
  s_add_u32 m0, s81, 3072
  ds_read_b64_tr_b16 a[158:159], v20 offset:25600
  v_mfma_f32_16x16x32_bf16 a[16:19], a[56:59], a[88:91], a[16:19]
  buffer_load_dwordx4 v8, s[8:11], s70 offen  lds
  v_mfma_f32_16x16x32_bf16 a[24:27], a[56:59], a[92:95], a[24:27]
  v_mfma_f32_16x16x32_bf16 a[28:31], a[60:63], a[92:95], a[28:31]
  v_mfma_f32_16x16x32_bf16 a[20:23], a[60:63], a[88:91], a[20:23]
  v_mfma_f32_16x16x32_bf16 a[12:15], a[60:63], a[84:87], a[12:15]
  v_mfma_f32_16x16x32_bf16 a[4:7], a[60:63], a[80:83], a[4:7]
  v_mfma_f32_16x16x32_bf16 v[36:39], a[60:63], a[76:79], v[36:39]
  v_mfma_f32_16x16x32_bf16 v[44:47], a[60:63], a[72:75], v[44:47]
  v_mfma_f32_16x16x32_bf16 v[52:55], a[60:63], a[68:71], v[52:55]
  s_waitcnt vmcnt(26) lgkmcnt(0)
  v_mfma_f32_16x16x32_bf16 v[60:63], a[60:63], a[64:67], v[60:63]
  s_barrier
  v_mfma_f32_16x16x32_bf16 v[96:99], a[96:99], a[128:131], v[96:99]
  ds_read_b128 a[32:35], v9 offset:0
  v_mfma_f32_16x16x32_bf16 v[104:107], a[96:99], a[132:135], v[104:107]
  buffer_load_dwordx4 a[196:199], v5, s[24:27], s97 offen offset:0 nt
  v_mfma_f32_16x16x32_bf16 v[112:115], a[96:99], a[136:139], v[112:115]
  ds_read_b64_tr_b16 a[64:65], v13 offset:40960
  v_mfma_f32_16x16x32_bf16 v[120:123], a[96:99], a[140:143], v[120:123]
  s_add_u32 s70, s74, 640
  buffer_load_dwordx4 a[200:203], v5, s[24:27], s97 offen offset:64 nt
  v_mfma_f32_16x16x32_bf16 v[128:131], a[96:99], a[144:147], v[128:131]
  s_add_u32 m0, s80, 65536
  ds_read_b64_tr_b16 a[66:67], v13 offset:41984
  v_mfma_f32_16x16x32_bf16 v[136:139], a[96:99], a[148:151], v[136:139]
  buffer_load_dwordx4 v3, s[4:7], s70 offen  lds
  v_mfma_f32_16x16x32_bf16 v[144:147], a[96:99], a[152:155], v[144:147]
  v_mfma_f32_16x16x32_bf16 v[152:155], a[96:99], a[156:159], v[152:155]
  ds_read_b128 a[36:39], v9 offset:2048
  v_mfma_f32_16x16x32_bf16 v[156:159], a[100:103], a[156:159], v[156:159]
  v_mfma_f32_16x16x32_bf16 v[148:151], a[100:103], a[152:155], v[148:151]
  ds_read_b64_tr_b16 a[68:69], v14 offset:40960
  v_mfma_f32_16x16x32_bf16 v[140:143], a[100:103], a[148:151], v[140:143]
  s_add_u32 s70, s78, 2359296
  v_mfma_f32_16x16x32_bf16 v[132:135], a[100:103], a[144:147], v[132:135]
  s_add_u32 m0, s81, 16384
  ds_read_b64_tr_b16 a[70:71], v14 offset:41984
  v_mfma_f32_16x16x32_bf16 v[124:127], a[100:103], a[140:143], v[124:127]
  buffer_load_dwordx4 v7, s[8:11], s70 offen  lds
  v_mfma_f32_16x16x32_bf16 v[116:119], a[100:103], a[136:139], v[116:119]
  v_mfma_f32_16x16x32_bf16 v[108:111], a[100:103], a[132:135], v[108:111]
  ds_read_b128 a[40:43], v9 offset:4096
  v_mfma_f32_16x16x32_bf16 v[100:103], a[100:103], a[128:131], v[100:103]
  v_mfma_f32_16x16x32_bf16 v[160:163], a[104:107], a[128:131], v[160:163]
  ds_read_b64_tr_b16 a[72:73], v15 offset:40960
  v_mfma_f32_16x16x32_bf16 v[168:171], a[104:107], a[132:135], v[168:171]
  s_add_u32 s70, s74, 8832
  v_mfma_f32_16x16x32_bf16 v[176:179], a[104:107], a[136:139], v[176:179]
  s_add_u32 m0, s80, 66560
  ds_read_b64_tr_b16 a[74:75], v15 offset:41984
  v_mfma_f32_16x16x32_bf16 v[184:187], a[104:107], a[140:143], v[184:187]
  buffer_load_dwordx4 v4, s[4:7], s70 offen  lds
  v_mfma_f32_16x16x32_bf16 v[192:195], a[104:107], a[144:147], v[192:195]
  v_mfma_f32_16x16x32_bf16 v[200:203], a[104:107], a[148:151], v[200:203]
  ds_read_b128 a[44:47], v9 offset:6144
  v_mfma_f32_16x16x32_bf16 v[208:211], a[104:107], a[152:155], v[208:211]
  v_mfma_f32_16x16x32_bf16 v[216:219], a[104:107], a[156:159], v[216:219]
  ds_read_b64_tr_b16 a[76:77], v16 offset:40960
  v_mfma_f32_16x16x32_bf16 v[220:223], a[108:111], a[156:159], v[220:223]
  s_add_u32 s70, s78, 2392064
  v_mfma_f32_16x16x32_bf16 v[212:215], a[108:111], a[152:155], v[212:215]
  s_add_u32 m0, s81, 17408
  ds_read_b64_tr_b16 a[78:79], v16 offset:41984
  v_mfma_f32_16x16x32_bf16 v[204:207], a[108:111], a[148:151], v[204:207]
  buffer_load_dwordx4 v7, s[8:11], s70 offen  lds
  v_mfma_f32_16x16x32_bf16 v[196:199], a[108:111], a[144:147], v[196:199]
  v_mfma_f32_16x16x32_bf16 v[188:191], a[108:111], a[140:143], v[188:191]
  ds_read_b128 a[48:51], v9 offset:8192
  v_mfma_f32_16x16x32_bf16 v[180:183], a[108:111], a[136:139], v[180:183]
  v_mfma_f32_16x16x32_bf16 v[172:175], a[108:111], a[132:135], v[172:175]
  ds_read_b64_tr_b16 a[80:81], v17 offset:40960
  v_mfma_f32_16x16x32_bf16 v[164:167], a[108:111], a[128:131], v[164:167]
  s_add_u32 s70, s74, 17024
  v_mfma_f32_16x16x32_bf16 v[224:227], a[112:115], a[128:131], v[224:227]
  s_add_u32 m0, s80, 67584
  ds_read_b64_tr_b16 a[82:83], v17 offset:41984
  v_mfma_f32_16x16x32_bf16 v[232:235], a[112:115], a[132:135], v[232:235]
  buffer_load_dwordx4 v3, s[4:7], s70 offen  lds
  v_mfma_f32_16x16x32_bf16 v[240:243], a[112:115], a[136:139], v[240:243]
  v_mfma_f32_16x16x32_bf16 v[248:251], a[112:115], a[140:143], v[248:251]
  ds_read_b128 a[52:55], v9 offset:10240
  v_mfma_f32_16x16x32_bf16 v[88:91], a[112:115], a[144:147], v[88:91]
  v_mfma_f32_16x16x32_bf16 v[80:83], a[112:115], a[148:151], v[80:83]
  ds_read_b64_tr_b16 a[84:85], v18 offset:40960
  v_mfma_f32_16x16x32_bf16 v[72:75], a[112:115], a[152:155], v[72:75]
  s_add_u32 s70, s78, 2424832
  v_mfma_f32_16x16x32_bf16 v[64:67], a[112:115], a[156:159], v[64:67]
  s_add_u32 m0, s81, 18432
  ds_read_b64_tr_b16 a[86:87], v18 offset:41984
  v_mfma_f32_16x16x32_bf16 v[68:71], a[116:119], a[156:159], v[68:71]
  buffer_load_dwordx4 v8, s[8:11], s70 offen  lds
  v_mfma_f32_16x16x32_bf16 v[76:79], a[116:119], a[152:155], v[76:79]
  v_mfma_f32_16x16x32_bf16 v[84:87], a[116:119], a[148:151], v[84:87]
  ds_read_b128 a[56:59], v9 offset:12288
  v_mfma_f32_16x16x32_bf16 v[92:95], a[116:119], a[144:147], v[92:95]
  v_mfma_f32_16x16x32_bf16 v[252:255], a[116:119], a[140:143], v[252:255]
  ds_read_b64_tr_b16 a[88:89], v19 offset:40960
  v_mfma_f32_16x16x32_bf16 v[244:247], a[116:119], a[136:139], v[244:247]
  s_add_u32 s70, s74, 25216
  v_mfma_f32_16x16x32_bf16 v[236:239], a[116:119], a[132:135], v[236:239]
  s_add_u32 m0, s80, 68608
  ds_read_b64_tr_b16 a[90:91], v19 offset:41984
  v_mfma_f32_16x16x32_bf16 v[228:231], a[116:119], a[128:131], v[228:231]
  buffer_load_dwordx4 v4, s[4:7], s70 offen  lds
  v_mfma_f32_16x16x32_bf16 v[56:59], a[120:123], a[128:131], v[56:59]
  v_mfma_f32_16x16x32_bf16 v[48:51], a[120:123], a[132:135], v[48:51]
  ds_read_b128 a[60:63], v9 offset:14336
  v_mfma_f32_16x16x32_bf16 v[40:43], a[120:123], a[136:139], v[40:43]
  v_mfma_f32_16x16x32_bf16 v[32:35], a[120:123], a[140:143], v[32:35]
  ds_read_b64_tr_b16 a[92:93], v20 offset:40960
  v_mfma_f32_16x16x32_bf16 a[0:3], a[120:123], a[144:147], a[0:3]
  s_add_u32 s70, s78, 2457600
  v_mfma_f32_16x16x32_bf16 a[8:11], a[120:123], a[148:151], a[8:11]
  s_add_u32 m0, s81, 19456
  ds_read_b64_tr_b16 a[94:95], v20 offset:41984
  v_mfma_f32_16x16x32_bf16 a[16:19], a[120:123], a[152:155], a[16:19]
  buffer_load_dwordx4 v8, s[8:11], s70 offen  lds
  v_mfma_f32_16x16x32_bf16 a[24:27], a[120:123], a[156:159], a[24:27]
  v_mfma_f32_16x16x32_bf16 a[28:31], a[124:127], a[156:159], a[28:31]
  v_mfma_f32_16x16x32_bf16 a[20:23], a[124:127], a[152:155], a[20:23]
  v_mfma_f32_16x16x32_bf16 a[12:15], a[124:127], a[148:151], a[12:15]
  v_mfma_f32_16x16x32_bf16 a[4:7], a[124:127], a[144:147], a[4:7]
  v_mfma_f32_16x16x32_bf16 v[36:39], a[124:127], a[140:143], v[36:39]
  v_mfma_f32_16x16x32_bf16 v[44:47], a[124:127], a[136:139], v[44:47]
  v_mfma_f32_16x16x32_bf16 v[52:55], a[124:127], a[132:135], v[52:55]
  s_waitcnt vmcnt(19) lgkmcnt(0)
  v_mfma_f32_16x16x32_bf16 v[60:63], a[124:127], a[128:131], v[60:63]
  s_barrier
  v_mfma_f32_16x16x32_bf16 v[96:99], a[32:35], a[64:67], v[96:99]
  ds_read_b128 a[96:99], v10 offset:0
  v_mfma_f32_16x16x32_bf16 v[104:107], a[32:35], a[68:71], v[104:107]
  buffer_load_dwordx4 a[204:207], v6, s[24:27], s97 offen offset:128 nt
  v_mfma_f32_16x16x32_bf16 v[112:115], a[32:35], a[72:75], v[112:115]
  ds_read_b64_tr_b16 a[128:129], v13 offset:57344
  v_mfma_f32_16x16x32_bf16 v[120:123], a[32:35], a[76:79], v[120:123]
  s_add_u32 s70, s75, 640
  buffer_load_dwordx4 a[208:211], v5, s[24:27], s32 offen offset:0 nt
  v_mfma_f32_16x16x32_bf16 v[128:131], a[32:35], a[80:83], v[128:131]
  s_add_u32 m0, s80, 69632
  ds_read_b64_tr_b16 a[130:131], v13 offset:58368
  v_mfma_f32_16x16x32_bf16 v[136:139], a[32:35], a[84:87], v[136:139]
  buffer_load_dwordx4 v3, s[4:7], s70 offen  lds
  v_mfma_f32_16x16x32_bf16 v[144:147], a[32:35], a[88:91], v[144:147]
  v_mfma_f32_16x16x32_bf16 v[152:155], a[32:35], a[92:95], v[152:155]
  ds_read_b128 a[100:103], v10 offset:2048
  v_mfma_f32_16x16x32_bf16 v[156:159], a[36:39], a[92:95], v[156:159]
  v_mfma_f32_16x16x32_bf16 v[148:151], a[36:39], a[88:91], v[148:151]
  ds_read_b64_tr_b16 a[132:133], v14 offset:57344
  v_mfma_f32_16x16x32_bf16 v[140:143], a[36:39], a[84:87], v[140:143]
  s_add_u32 s70, s78, 2621440
  v_mfma_f32_16x16x32_bf16 v[132:135], a[36:39], a[80:83], v[132:135]
  s_add_u32 m0, s81, 32768
  ds_read_b64_tr_b16 a[134:135], v14 offset:58368
  v_mfma_f32_16x16x32_bf16 v[124:127], a[36:39], a[76:79], v[124:127]
  buffer_load_dwordx4 v7, s[8:11], s70 offen  lds
  v_mfma_f32_16x16x32_bf16 v[116:119], a[36:39], a[72:75], v[116:119]
  v_mfma_f32_16x16x32_bf16 v[108:111], a[36:39], a[68:71], v[108:111]
  ds_read_b128 a[104:107], v10 offset:4096
  v_mfma_f32_16x16x32_bf16 v[100:103], a[36:39], a[64:67], v[100:103]
  v_mfma_f32_16x16x32_bf16 v[160:163], a[40:43], a[64:67], v[160:163]
  ds_read_b64_tr_b16 a[136:137], v15 offset:57344
  v_mfma_f32_16x16x32_bf16 v[168:171], a[40:43], a[68:71], v[168:171]
  s_add_u32 s70, s75, 8832
  v_mfma_f32_16x16x32_bf16 v[176:179], a[40:43], a[72:75], v[176:179]
  s_add_u32 m0, s80, 70656
  ds_read_b64_tr_b16 a[138:139], v15 offset:58368
  v_mfma_f32_16x16x32_bf16 v[184:187], a[40:43], a[76:79], v[184:187]
  buffer_load_dwordx4 v4, s[4:7], s70 offen  lds
  v_mfma_f32_16x16x32_bf16 v[192:195], a[40:43], a[80:83], v[192:195]
  v_mfma_f32_16x16x32_bf16 v[200:203], a[40:43], a[84:87], v[200:203]
  ds_read_b128 a[108:111], v10 offset:6144
  v_mfma_f32_16x16x32_bf16 v[208:211], a[40:43], a[88:91], v[208:211]
  v_mfma_f32_16x16x32_bf16 v[216:219], a[40:43], a[92:95], v[216:219]
  ds_read_b64_tr_b16 a[140:141], v16 offset:57344
  v_mfma_f32_16x16x32_bf16 v[220:223], a[44:47], a[92:95], v[220:223]
  s_add_u32 s70, s78, 2654208
  v_mfma_f32_16x16x32_bf16 v[212:215], a[44:47], a[88:91], v[212:215]
  s_add_u32 m0, s81, 33792
  ds_read_b64_tr_b16 a[142:143], v16 offset:58368
  v_mfma_f32_16x16x32_bf16 v[204:207], a[44:47], a[84:87], v[204:207]
  buffer_load_dwordx4 v7, s[8:11], s70 offen  lds
  v_mfma_f32_16x16x32_bf16 v[196:199], a[44:47], a[80:83], v[196:199]
  v_mfma_f32_16x16x32_bf16 v[188:191], a[44:47], a[76:79], v[188:191]
  ds_read_b128 a[112:115], v10 offset:8192
  v_mfma_f32_16x16x32_bf16 v[180:183], a[44:47], a[72:75], v[180:183]
  v_mfma_f32_16x16x32_bf16 v[172:175], a[44:47], a[68:71], v[172:175]
  ds_read_b64_tr_b16 a[144:145], v17 offset:57344
  v_mfma_f32_16x16x32_bf16 v[164:167], a[44:47], a[64:67], v[164:167]
  s_add_u32 s70, s75, 17024
  v_mfma_f32_16x16x32_bf16 v[224:227], a[48:51], a[64:67], v[224:227]
  s_add_u32 m0, s80, 71680
  ds_read_b64_tr_b16 a[146:147], v17 offset:58368
  v_mfma_f32_16x16x32_bf16 v[232:235], a[48:51], a[68:71], v[232:235]
  buffer_load_dwordx4 v3, s[4:7], s70 offen  lds
  v_mfma_f32_16x16x32_bf16 v[240:243], a[48:51], a[72:75], v[240:243]
  v_mfma_f32_16x16x32_bf16 v[248:251], a[48:51], a[76:79], v[248:251]
  ds_read_b128 a[116:119], v10 offset:10240
  v_mfma_f32_16x16x32_bf16 v[88:91], a[48:51], a[80:83], v[88:91]
  v_mfma_f32_16x16x32_bf16 v[80:83], a[48:51], a[84:87], v[80:83]
  ds_read_b64_tr_b16 a[148:149], v18 offset:57344
  v_mfma_f32_16x16x32_bf16 v[72:75], a[48:51], a[88:91], v[72:75]
  s_add_u32 s70, s78, 2686976
  v_mfma_f32_16x16x32_bf16 v[64:67], a[48:51], a[92:95], v[64:67]
  s_add_u32 m0, s81, 34816
  ds_read_b64_tr_b16 a[150:151], v18 offset:58368
  v_mfma_f32_16x16x32_bf16 v[68:71], a[52:55], a[92:95], v[68:71]
  buffer_load_dwordx4 v8, s[8:11], s70 offen  lds
  v_mfma_f32_16x16x32_bf16 v[76:79], a[52:55], a[88:91], v[76:79]
  v_mfma_f32_16x16x32_bf16 v[84:87], a[52:55], a[84:87], v[84:87]
  ds_read_b128 a[120:123], v10 offset:12288
  v_mfma_f32_16x16x32_bf16 v[92:95], a[52:55], a[80:83], v[92:95]
  v_mfma_f32_16x16x32_bf16 v[252:255], a[52:55], a[76:79], v[252:255]
  ds_read_b64_tr_b16 a[152:153], v19 offset:57344
  v_mfma_f32_16x16x32_bf16 v[244:247], a[52:55], a[72:75], v[244:247]
  s_add_u32 s70, s75, 25216
  v_mfma_f32_16x16x32_bf16 v[236:239], a[52:55], a[68:71], v[236:239]
  s_add_u32 m0, s80, 72704
  ds_read_b64_tr_b16 a[154:155], v19 offset:58368
  v_mfma_f32_16x16x32_bf16 v[228:231], a[52:55], a[64:67], v[228:231]
  buffer_load_dwordx4 v4, s[4:7], s70 offen  lds
  v_mfma_f32_16x16x32_bf16 v[56:59], a[56:59], a[64:67], v[56:59]
  v_mfma_f32_16x16x32_bf16 v[48:51], a[56:59], a[68:71], v[48:51]
  ds_read_b128 a[124:127], v10 offset:14336
  v_mfma_f32_16x16x32_bf16 v[40:43], a[56:59], a[72:75], v[40:43]
  v_mfma_f32_16x16x32_bf16 v[32:35], a[56:59], a[76:79], v[32:35]
  ds_read_b64_tr_b16 a[156:157], v20 offset:57344
  v_mfma_f32_16x16x32_bf16 a[0:3], a[56:59], a[80:83], a[0:3]
  s_add_u32 s70, s78, 2719744
  v_mfma_f32_16x16x32_bf16 a[8:11], a[56:59], a[84:87], a[8:11]
  s_add_u32 m0, s81, 35840
  ds_read_b64_tr_b16 a[158:159], v20 offset:58368
  v_mfma_f32_16x16x32_bf16 a[16:19], a[56:59], a[88:91], a[16:19]
  buffer_load_dwordx4 v8, s[8:11], s70 offen  lds
  v_mfma_f32_16x16x32_bf16 a[24:27], a[56:59], a[92:95], a[24:27]
  v_mfma_f32_16x16x32_bf16 a[28:31], a[60:63], a[92:95], a[28:31]
  v_mfma_f32_16x16x32_bf16 a[20:23], a[60:63], a[88:91], a[20:23]
  v_mfma_f32_16x16x32_bf16 a[12:15], a[60:63], a[84:87], a[12:15]
  v_mfma_f32_16x16x32_bf16 a[4:7], a[60:63], a[80:83], a[4:7]
  v_mfma_f32_16x16x32_bf16 v[36:39], a[60:63], a[76:79], v[36:39]
  v_mfma_f32_16x16x32_bf16 v[44:47], a[60:63], a[72:75], v[44:47]
  v_mfma_f32_16x16x32_bf16 v[52:55], a[60:63], a[68:71], v[52:55]
  s_waitcnt vmcnt(20) lgkmcnt(0)
  v_mfma_f32_16x16x32_bf16 v[60:63], a[60:63], a[64:67], v[60:63]
  s_barrier
  v_mfma_f32_16x16x32_bf16 v[96:99], a[96:99], a[128:131], v[96:99]
  ds_read_b128 a[32:35], v9 offset:32768
  v_mfma_f32_16x16x32_bf16 v[104:107], a[96:99], a[132:135], v[104:107]
  buffer_load_dwordx4 a[212:215], v5, s[24:27], s32 offen offset:64 nt
  v_mfma_f32_16x16x32_bf16 v[112:115], a[96:99], a[136:139], v[112:115]
  ds_read_b64_tr_b16 a[64:65], v13 offset:8192
  v_mfma_f32_16x16x32_bf16 v[120:123], a[96:99], a[140:143], v[120:123]
  s_add_u32 s70, s74, 768
  buffer_load_dwordx4 a[216:219], v6, s[24:27], s32 offen offset:128 nt
  v_mfma_f32_16x16x32_bf16 v[128:131], a[96:99], a[144:147], v[128:131]
  s_add_u32 m0, s80, 0
  ds_read_b64_tr_b16 a[66:67], v13 offset:9216
  v_cmp_ne_u32 vcc, 1, v29
  s_cbranch_vccnz L_spin_6
L_back_7:
  v_mfma_f32_16x16x32_bf16 v[136:139], a[96:99], a[148:151], v[136:139]
  buffer_load_dwordx4 v3, s[4:7], s70 offen  lds
  v_mfma_f32_16x16x32_bf16 v[22:25], a[160:163], a[172:175], 0
  v_mfma_f32_16x16x32_bf16 v[144:147], a[96:99], a[152:155], v[144:147]
  v_mfma_f32_16x16x32_bf16 v[26:29], a[160:163], a[184:187], 0
  v_mfma_f32_16x16x32_bf16 v[152:155], a[96:99], a[156:159], v[152:155]
  ds_read_b128 a[36:39], v9 offset:34816
  v_mfma_f32_16x16x32_bf16 v[22:25], a[164:167], a[176:179], v[22:25]
  v_mfma_f32_16x16x32_bf16 v[156:159], a[100:103], a[156:159], v[156:159]
  v_mfma_f32_16x16x32_bf16 v[26:29], a[164:167], a[188:191], v[26:29]
  v_mfma_f32_16x16x32_bf16 v[148:151], a[100:103], a[152:155], v[148:151]
  ds_read_b64_tr_b16 a[68:69], v14 offset:8192
  v_mfma_f32_16x16x32_bf16 v[22:25], a[168:171], a[180:183], v[22:25]
  v_mfma_f32_16x16x32_bf16 v[140:143], a[100:103], a[148:151], v[140:143]
  s_add_u32 s70, s78, 2883584
  v_mfma_f32_16x16x32_bf16 v[26:29], a[168:171], a[192:195], v[26:29]
  v_mfma_f32_16x16x32_bf16 v[132:135], a[100:103], a[144:147], v[132:135]
  s_add_u32 m0, s81, 49152
  ds_read_b64_tr_b16 a[70:71], v14 offset:9216
  v_and_b32 v21, 3, v1
  v_mfma_f32_16x16x32_bf16 v[124:127], a[100:103], a[140:143], v[124:127]
  s_nop 0
  buffer_load_dwordx4 v7, s[8:11], s70 offen  lds
  v_mfma_f32_16x16x32_bf16 v[116:119], a[100:103], a[136:139], v[116:119]
  s_nop 0
  v_cmp_eq_u32 vcc, 1, v21
  v_mfma_f32_16x16x32_bf16 v[108:111], a[100:103], a[132:135], v[108:111]
  s_nop 0
  ds_read_b128 a[40:43], v9 offset:36864
  v_cndmask_b32 v22, v22, v23, vcc
  v_mfma_f32_16x16x32_bf16 v[100:103], a[100:103], a[128:131], v[100:103]
  v_cndmask_b32 v26, v26, v27, vcc
  v_mfma_f32_16x16x32_bf16 v[160:163], a[104:107], a[128:131], v[160:163]
  ds_read_b64_tr_b16 a[72:73], v15 offset:8192
  v_cmp_eq_u32 vcc, 2, v21
  v_mfma_f32_16x16x32_bf16 v[168:171], a[104:107], a[132:135], v[168:171]
  s_add_u32 s70, s74, 8960
  s_nop 0
  v_cndmask_b32 v22, v22, v24, vcc
  v_mfma_f32_16x16x32_bf16 v[176:179], a[104:107], a[136:139], v[176:179]
  s_add_u32 m0, s80, 1024
  ds_read_b64_tr_b16 a[74:75], v15 offset:9216
  v_cndmask_b32 v26, v26, v28, vcc
  v_mfma_f32_16x16x32_bf16 v[184:187], a[104:107], a[140:143], v[184:187]
  buffer_load_dwordx4 v4, s[4:7], s70 offen  lds
  v_mfma_f32_16x16x32_bf16 v[192:195], a[104:107], a[144:147], v[192:195]
  v_cmp_eq_u32 vcc, 3, v21
  v_mfma_f32_16x16x32_bf16 v[200:203], a[104:107], a[148:151], v[200:203]
  s_nop 0
  ds_read_b128 a[44:47], v9 offset:38912
  v_cndmask_b32 v22, v22, v25, vcc
  v_mfma_f32_16x16x32_bf16 v[208:211], a[104:107], a[152:155], v[208:211]
  v_cndmask_b32 v26, v26, v29, vcc
  v_mfma_f32_16x16x32_bf16 v[216:219], a[104:107], a[156:159], v[216:219]
  ds_read_b64_tr_b16 a[76:77], v16 offset:8192
  v_lshrrev_b32 v21, 4, v1
  v_mfma_f32_16x16x32_bf16 v[220:223], a[108:111], a[156:159], v[220:223]
  s_add_u32 s70, s78, 2916352
  v_bfe_u32 v23, v1, 2, 2
  v_mfma_f32_16x16x32_bf16 v[212:215], a[108:111], a[152:155], v[212:215]
  s_add_u32 m0, s81, 50176
  ds_read_b64_tr_b16 a[78:79], v16 offset:9216
  v_cmp_eq_u32 vcc, v21, v23
  v_mfma_f32_16x16x32_bf16 v[204:207], a[108:111], a[148:151], v[204:207]
  s_nop 0
  buffer_load_dwordx4 v7, s[8:11], s70 offen  lds
  v_mfma_f32_16x16x32_bf16 v[196:199], a[108:111], a[144:147], v[196:199]
  v_cndmask_b32 v22, 0, v22, vcc
  v_mfma_f32_16x16x32_bf16 v[188:191], a[108:111], a[140:143], v[188:191]
  ds_read_b128 a[48:51], v9 offset:40960
  v_cndmask_b32 v26, 0, v26, vcc
  v_mfma_f32_16x16x32_bf16 v[180:183], a[108:111], a[136:139], v[180:183]
  v_add_f32_dpp v22, v22, v22 row_ror:8 row_mask:0xf bank_mask:0xf
  v_mfma_f32_16x16x32_bf16 v[172:175], a[108:111], a[132:135], v[172:175]
  ds_read_b64_tr_b16 a[80:81], v17 offset:8192
  v_add_f32_dpp v26, v26, v26 row_ror:8 row_mask:0xf bank_mask:0xf
  v_mfma_f32_16x16x32_bf16 v[164:167], a[108:111], a[128:131], v[164:167]
  s_add_u32 s70, s74, 17152
  v_add_f32_dpp v22, v22, v22 row_ror:4 row_mask:0xf bank_mask:0xf
  v_mfma_f32_16x16x32_bf16 v[224:227], a[112:115], a[128:131], v[224:227]
  s_add_u32 m0, s80, 2048
  ds_read_b64_tr_b16 a[82:83], v17 offset:9216
  v_add_f32_dpp v26, v26, v26 row_ror:4 row_mask:0xf bank_mask:0xf
  v_mfma_f32_16x16x32_bf16 v[232:235], a[112:115], a[132:135], v[232:235]
  buffer_load_dwordx4 v3, s[4:7], s70 offen  lds
  v_mfma_f32_16x16x32_bf16 v[240:243], a[112:115], a[136:139], v[240:243]
  v_add_f32_dpp v22, v22, v22 row_ror:2 row_mask:0xf bank_mask:0xf
  v_mfma_f32_16x16x32_bf16 v[248:251], a[112:115], a[140:143], v[248:251]
  ds_read_b128 a[52:55], v9 offset:43008
  v_add_f32_dpp v26, v26, v26 row_ror:2 row_mask:0xf bank_mask:0xf
  v_mfma_f32_16x16x32_bf16 v[88:91], a[112:115], a[144:147], v[88:91]
  v_add_f32_dpp v22, v22, v22 row_ror:1 row_mask:0xf bank_mask:0xf
  v_mfma_f32_16x16x32_bf16 v[80:83], a[112:115], a[148:151], v[80:83]
  ds_read_b64_tr_b16 a[84:85], v18 offset:8192
  v_add_f32_dpp v26, v26, v26 row_ror:1 row_mask:0xf bank_mask:0xf
  v_mfma_f32_16x16x32_bf16 v[72:75], a[112:115], a[152:155], v[72:75]
  s_add_u32 s70, s78, 2949120
  v_mov_b32 v23, v22
  v_mfma_f32_16x16x32_bf16 v[64:67], a[112:115], a[156:159], v[64:67]
  s_add_u32 m0, s81, 51200
  ds_read_b64_tr_b16 a[86:87], v18 offset:9216
  v_mov_b32 v24, v26
  v_mfma_f32_16x16x32_bf16 v[68:71], a[116:119], a[156:159], v[68:71]
  buffer_load_dwordx4 v8, s[8:11], s70 offen  lds
  v_mfma_f32_16x16x32_bf16 v[76:79], a[116:119], a[152:155], v[76:79]
  v_permlane16_swap_b32 v22, v23
  v_mfma_f32_16x16x32_bf16 v[84:87], a[116:119], a[148:151], v[84:87]
  ds_read_b128 a[56:59], v9 offset:45056
  v_mfma_f32_16x16x32_bf16 v[92:95], a[116:119], a[144:147], v[92:95]
  v_permlane16_swap_b32 v26, v24
  v_mfma_f32_16x16x32_bf16 v[252:255], a[116:119], a[140:143], v[252:255]
  ds_read_b64_tr_b16 a[88:89], v19 offset:8192
  v_add_f32 v22, v22, v23
  v_mfma_f32_16x16x32_bf16 v[244:247], a[116:119], a[136:139], v[244:247]
  s_add_u32 s70, s74, 25344
  v_add_f32 v26, v26, v24
  v_mfma_f32_16x16x32_bf16 v[236:239], a[116:119], a[132:135], v[236:239]
  s_add_u32 m0, s80, 3072
  ds_read_b64_tr_b16 a[90:91], v19 offset:9216
  v_lshrrev_b32 v21, 5, v1
  v_mfma_f32_16x16x32_bf16 v[228:231], a[116:119], a[128:131], v[228:231]
  s_lshl_b32 s71, s2, 3
  buffer_load_dwordx4 v4, s[4:7], s70 offen  lds
  v_mfma_f32_16x16x32_bf16 v[56:59], a[120:123], a[128:131], v[56:59]
  s_lshl_b32 s72, s34, 1
  s_add_u32 s71, s71, s72
  v_add_u32 v21, s71, v21
  v_mfma_f32_16x16x32_bf16 v[48:51], a[120:123], a[132:135], v[48:51]
  ds_read_b128 a[60:63], v9 offset:47104
  v_cvt_pk_bf16_f32 v23, v22, v22
  v_mfma_f32_16x16x32_bf16 v[40:43], a[120:123], a[136:139], v[40:43]
  v_cvt_pk_bf16_f32 v24, v26, v26
  v_mfma_f32_16x16x32_bf16 v[32:35], a[120:123], a[140:143], v[32:35]
  ds_read_b64_tr_b16 a[92:93], v20 offset:8192
  v_ashrrev_i32 v25, 31, v23
  v_mfma_f32_16x16x32_bf16 a[0:3], a[120:123], a[144:147], a[0:3]
  s_add_u32 s70, s78, 2981888
  v_or_b32 v25, 0x80000000, v25
  v_mfma_f32_16x16x32_bf16 a[8:11], a[120:123], a[148:151], a[8:11]
  s_add_u32 m0, s81, 52224
  ds_read_b64_tr_b16 a[94:95], v20 offset:9216
  v_xor_b32 v23, v23, v25
  v_mfma_f32_16x16x32_bf16 a[16:19], a[120:123], a[152:155], a[16:19]
  buffer_load_dwordx4 v8, s[8:11], s70 offen  lds
  v_mfma_f32_16x16x32_bf16 a[24:27], a[120:123], a[156:159], a[24:27]
  v_and_b32 v23, 0xffff0000, v23
  v_mfma_f32_16x16x32_bf16 a[28:31], a[124:127], a[156:159], a[28:31]
  v_sub_u32 v25, 0x87ff, v21
  v_mfma_f32_16x16x32_bf16 a[20:23], a[124:127], a[152:155], a[20:23]
  v_or_b32 v23, v23, v25
  v_mfma_f32_16x16x32_bf16 a[12:15], a[124:127], a[148:151], a[12:15]
  v_mov_b32 v25, v23
  v_mfma_f32_16x16x32_bf16 a[4:7], a[124:127], a[144:147], a[4:7]
  s_nop 0
  v_permlane32_swap_b32 v23, v25
  v_mfma_f32_16x16x32_bf16 v[36:39], a[124:127], a[140:143], v[36:39]
  v_max_u32 v23, v23, v25
  v_mfma_f32_16x16x32_bf16 v[44:47], a[124:127], a[136:139], v[44:47]
  v_mfma_f32_16x16x32_bf16 v[52:55], a[124:127], a[132:135], v[52:55]
  s_waitcnt vmcnt(20) lgkmcnt(0)
  v_mfma_f32_16x16x32_bf16 v[60:63], a[124:127], a[128:131], v[60:63]
  s_barrier
  v_mfma_f32_16x16x32_bf16 v[96:99], a[32:35], a[64:67], v[96:99]
  ds_read_b128 a[96:99], v10 offset:32768
  v_and_b32 v24, 0xffff0000, v24
  v_mfma_f32_16x16x32_bf16 v[104:107], a[32:35], a[68:71], v[104:107]
  v_mul_f32 v24, 0xbfb8aa3b, v24
  v_mfma_f32_16x16x32_bf16 v[112:115], a[32:35], a[72:75], v[112:115]
  ds_read_b64_tr_b16 a[128:129], v13 offset:24576
  v_mfma_f32_16x16x32_bf16 v[120:123], a[32:35], a[76:79], v[120:123]
  s_add_u32 s70, s75, 768
  v_exp_f32 v24, v24
  v_mfma_f32_16x16x32_bf16 v[128:131], a[32:35], a[80:83], v[128:131]
  s_add_u32 m0, s80, 4096
  ds_read_b64_tr_b16 a[130:131], v13 offset:25600
  v_add_f32 v24, 1.0, v24
  v_mfma_f32_16x16x32_bf16 v[136:139], a[32:35], a[84:87], v[136:139]
  buffer_load_dwordx4 v3, s[4:7], s70 offen  lds
  v_mfma_f32_16x16x32_bf16 v[144:147], a[32:35], a[88:91], v[144:147]
  v_rcp_f32 v24, v24
  v_mfma_f32_16x16x32_bf16 v[152:155], a[32:35], a[92:95], v[152:155]
  ds_read_b128 a[100:103], v10 offset:34816
  v_cvt_pk_bf16_f32 v24, v24, v24
  v_mfma_f32_16x16x32_bf16 v[156:159], a[36:39], a[92:95], v[156:159]
  v_and_b32 v24, 0xffff0000, v24
  v_mfma_f32_16x16x32_bf16 v[148:151], a[36:39], a[88:91], v[148:151]
  ds_read_b64_tr_b16 a[132:133], v14 offset:24576
  v_lshlrev_b32 v25, 2, v21
  v_mfma_f32_16x16x32_bf16 v[140:143], a[36:39], a[84:87], v[140:143]
  s_add_u32 s70, s78, 3145728
  v_mov_b32 v26, s101
  v_mfma_f32_16x16x32_bf16 v[132:135], a[36:39], a[80:83], v[132:135]
  s_add_u32 m0, s81, 0
  s_add_u32 s72, s89, 12288
  ds_read_b64_tr_b16 a[134:135], v14 offset:25600
  v_mfma_f32_16x16x32_bf16 v[124:127], a[36:39], a[76:79], v[124:127]
  s_mov_b32 s73, 57671680
  buffer_load_dwordx4 v7, s[8:11], s70 offen  lds
  v_mfma_f32_16x16x32_bf16 v[116:119], a[36:39], a[72:75], v[116:119]
  s_add_u32 s71, s100, 16384
  s_mov_b64 exec, 1
  buffer_store_dword v23, off, s[20:23], s72 sc1
  buffer_store_dword v26, off, s[20:23], s71 sc1
  s_mov_b32 exec_hi, 1
  buffer_store_dword v24, v25, s[20:23], s73 offen sc1
  s_mov_b64 exec, -1
  v_mfma_f32_16x16x32_bf16 v[108:111], a[36:39], a[68:71], v[108:111]
  ds_read_b128 a[104:107], v10 offset:36864
  v_mfma_f32_16x16x32_bf16 v[100:103], a[36:39], a[64:67], v[100:103]
  v_mfma_f32_16x16x32_bf16 v[160:163], a[40:43], a[64:67], v[160:163]
  ds_read_b64_tr_b16 a[136:137], v15 offset:24576
  v_mfma_f32_16x16x32_bf16 v[168:171], a[40:43], a[68:71], v[168:171]
  s_add_u32 s70, s75, 8960
  v_mfma_f32_16x16x32_bf16 v[176:179], a[40:43], a[72:75], v[176:179]
  s_add_u32 m0, s80, 5120
  ds_read_b64_tr_b16 a[138:139], v15 offset:25600
  v_mfma_f32_16x16x32_bf16 v[184:187], a[40:43], a[76:79], v[184:187]
  buffer_load_dwordx4 v4, s[4:7], s70 offen  lds
  v_mfma_f32_16x16x32_bf16 v[192:195], a[40:43], a[80:83], v[192:195]
  v_mfma_f32_16x16x32_bf16 v[200:203], a[40:43], a[84:87], v[200:203]
  ds_read_b128 a[108:111], v10 offset:38912
  v_mfma_f32_16x16x32_bf16 v[208:211], a[40:43], a[88:91], v[208:211]
  v_mfma_f32_16x16x32_bf16 v[216:219], a[40:43], a[92:95], v[216:219]
  ds_read_b64_tr_b16 a[140:141], v16 offset:24576
  v_mfma_f32_16x16x32_bf16 v[220:223], a[44:47], a[92:95], v[220:223]
  s_add_u32 s70, s78, 3178496
  v_mfma_f32_16x16x32_bf16 v[212:215], a[44:47], a[88:91], v[212:215]
  s_add_u32 m0, s81, 1024
  ds_read_b64_tr_b16 a[142:143], v16 offset:25600
  v_mfma_f32_16x16x32_bf16 v[204:207], a[44:47], a[84:87], v[204:207]
  buffer_load_dwordx4 v7, s[8:11], s70 offen  lds
  v_mfma_f32_16x16x32_bf16 v[196:199], a[44:47], a[80:83], v[196:199]
  v_mfma_f32_16x16x32_bf16 v[188:191], a[44:47], a[76:79], v[188:191]
  ds_read_b128 a[112:115], v10 offset:40960
  v_mfma_f32_16x16x32_bf16 v[180:183], a[44:47], a[72:75], v[180:183]
  v_mfma_f32_16x16x32_bf16 v[172:175], a[44:47], a[68:71], v[172:175]
  ds_read_b64_tr_b16 a[144:145], v17 offset:24576
  v_mfma_f32_16x16x32_bf16 v[164:167], a[44:47], a[64:67], v[164:167]
  s_add_u32 s70, s75, 17152
  v_mfma_f32_16x16x32_bf16 v[224:227], a[48:51], a[64:67], v[224:227]
  s_add_u32 m0, s80, 6144
  ds_read_b64_tr_b16 a[146:147], v17 offset:25600
  v_mfma_f32_16x16x32_bf16 v[232:235], a[48:51], a[68:71], v[232:235]
  buffer_load_dwordx4 v3, s[4:7], s70 offen  lds
  v_mfma_f32_16x16x32_bf16 v[240:243], a[48:51], a[72:75], v[240:243]
  v_mfma_f32_16x16x32_bf16 v[248:251], a[48:51], a[76:79], v[248:251]
  ds_read_b128 a[116:119], v10 offset:43008
  v_mfma_f32_16x16x32_bf16 v[88:91], a[48:51], a[80:83], v[88:91]
  v_mfma_f32_16x16x32_bf16 v[80:83], a[48:51], a[84:87], v[80:83]
  ds_read_b64_tr_b16 a[148:149], v18 offset:24576
  v_mfma_f32_16x16x32_bf16 v[72:75], a[48:51], a[88:91], v[72:75]
  s_add_u32 s70, s78, 3211264
  v_mfma_f32_16x16x32_bf16 v[64:67], a[48:51], a[92:95], v[64:67]
  s_add_u32 m0, s81, 2048
  ds_read_b64_tr_b16 a[150:151], v18 offset:25600
  v_mfma_f32_16x16x32_bf16 v[68:71], a[52:55], a[92:95], v[68:71]
  buffer_load_dwordx4 v8, s[8:11], s70 offen  lds
  v_mfma_f32_16x16x32_bf16 v[76:79], a[52:55], a[88:91], v[76:79]
  v_mfma_f32_16x16x32_bf16 v[84:87], a[52:55], a[84:87], v[84:87]
  ds_read_b128 a[120:123], v10 offset:45056
  v_mfma_f32_16x16x32_bf16 v[92:95], a[52:55], a[80:83], v[92:95]
  v_mfma_f32_16x16x32_bf16 v[252:255], a[52:55], a[76:79], v[252:255]
  ds_read_b64_tr_b16 a[152:153], v19 offset:24576
  v_mfma_f32_16x16x32_bf16 v[244:247], a[52:55], a[72:75], v[244:247]
  s_add_u32 s70, s75, 25344
  v_mfma_f32_16x16x32_bf16 v[236:239], a[52:55], a[68:71], v[236:239]
  s_add_u32 m0, s80, 7168
  ds_read_b64_tr_b16 a[154:155], v19 offset:25600
  v_mfma_f32_16x16x32_bf16 v[228:231], a[52:55], a[64:67], v[228:231]
  buffer_load_dwordx4 v4, s[4:7], s70 offen  lds
  v_mfma_f32_16x16x32_bf16 v[56:59], a[56:59], a[64:67], v[56:59]
  v_mfma_f32_16x16x32_bf16 v[48:51], a[56:59], a[68:71], v[48:51]
  ds_read_b128 a[124:127], v10 offset:47104
  v_mfma_f32_16x16x32_bf16 v[40:43], a[56:59], a[72:75], v[40:43]
  v_mfma_f32_16x16x32_bf16 v[32:35], a[56:59], a[76:79], v[32:35]
  ds_read_b64_tr_b16 a[156:157], v20 offset:24576
  v_mfma_f32_16x16x32_bf16 a[0:3], a[56:59], a[80:83], a[0:3]
  s_add_u32 s70, s78, 3244032
  v_mfma_f32_16x16x32_bf16 a[8:11], a[56:59], a[84:87], a[8:11]
  s_add_u32 m0, s81, 3072
  ds_read_b64_tr_b16 a[158:159], v20 offset:25600
  v_mfma_f32_16x16x32_bf16 a[16:19], a[56:59], a[88:91], a[16:19]
  buffer_load_dwordx4 v8, s[8:11], s70 offen  lds
  v_mfma_f32_16x16x32_bf16 a[24:27], a[56:59], a[92:95], a[24:27]
  v_mfma_f32_16x16x32_bf16 a[28:31], a[60:63], a[92:95], a[28:31]
  v_mfma_f32_16x16x32_bf16 a[20:23], a[60:63], a[88:91], a[20:23]
  v_mfma_f32_16x16x32_bf16 a[12:15], a[60:63], a[84:87], a[12:15]
  v_mfma_f32_16x16x32_bf16 a[4:7], a[60:63], a[80:83], a[4:7]
  v_mfma_f32_16x16x32_bf16 v[36:39], a[60:63], a[76:79], v[36:39]
  v_mfma_f32_16x16x32_bf16 v[44:47], a[60:63], a[72:75], v[44:47]
  v_mfma_f32_16x16x32_bf16 v[52:55], a[60:63], a[68:71], v[52:55]
  s_waitcnt vmcnt(21) lgkmcnt(0)
  v_mfma_f32_16x16x32_bf16 v[60:63], a[60:63], a[64:67], v[60:63]
  s_barrier
  v_mfma_f32_16x16x32_bf16 v[96:99], a[96:99], a[128:131], v[96:99]
  ds_read_b128 a[32:35], v11 offset:0
  v_lshrrev_b32 v6, 3, v1
  v_mfma_f32_16x16x32_bf16 v[104:107], a[96:99], a[132:135], v[104:107]
  v_lshl_add_u32 v5, v6, 7, v3
  v_mfma_f32_16x16x32_bf16 v[112:115], a[96:99], a[136:139], v[112:115]
  ds_read_b64_tr_b16 a[64:65], v13 offset:40960
  v_lshl_add_u32 v6, v6, 7, v4
  v_mfma_f32_16x16x32_bf16 v[120:123], a[96:99], a[140:143], v[120:123]
  s_add_u32 s70, s74, 896
  v_mfma_f32_16x16x32_bf16 v[128:131], a[96:99], a[144:147], v[128:131]
  s_add_u32 m0, s80, 32768
  ds_read_b64_tr_b16 a[66:67], v13 offset:41984
  v_mfma_f32_16x16x32_bf16 v[136:139], a[96:99], a[148:151], v[136:139]
  buffer_load_dwordx4 v3, s[4:7], s70 offen  lds
  v_mfma_f32_16x16x32_bf16 v[144:147], a[96:99], a[152:155], v[144:147]
  v_mfma_f32_16x16x32_bf16 v[152:155], a[96:99], a[156:159], v[152:155]
  ds_read_b128 a[36:39], v11 offset:2048
  v_mfma_f32_16x16x32_bf16 v[156:159], a[100:103], a[156:159], v[156:159]
  v_mfma_f32_16x16x32_bf16 v[148:151], a[100:103], a[152:155], v[148:151]
  ds_read_b64_tr_b16 a[68:69], v14 offset:40960
  v_mfma_f32_16x16x32_bf16 v[140:143], a[100:103], a[148:151], v[140:143]
  s_add_u32 s70, s78, 3407872
  v_mfma_f32_16x16x32_bf16 v[132:135], a[100:103], a[144:147], v[132:135]
  s_add_u32 m0, s81, 16384
  ds_read_b64_tr_b16 a[70:71], v14 offset:41984
  v_mfma_f32_16x16x32_bf16 v[124:127], a[100:103], a[140:143], v[124:127]
  buffer_load_dwordx4 v7, s[8:11], s70 offen  lds
  v_mfma_f32_16x16x32_bf16 v[116:119], a[100:103], a[136:139], v[116:119]
  v_mfma_f32_16x16x32_bf16 v[108:111], a[100:103], a[132:135], v[108:111]
  ds_read_b128 a[40:43], v11 offset:4096
  v_mfma_f32_16x16x32_bf16 v[100:103], a[100:103], a[128:131], v[100:103]
  v_mfma_f32_16x16x32_bf16 v[160:163], a[104:107], a[128:131], v[160:163]
  ds_read_b64_tr_b16 a[72:73], v15 offset:40960
  v_mfma_f32_16x16x32_bf16 v[168:171], a[104:107], a[132:135], v[168:171]
  s_add_u32 s70, s74, 9088
  v_mfma_f32_16x16x32_bf16 v[176:179], a[104:107], a[136:139], v[176:179]
  s_add_u32 m0, s80, 33792
  ds_read_b64_tr_b16 a[74:75], v15 offset:41984
  v_mfma_f32_16x16x32_bf16 v[184:187], a[104:107], a[140:143], v[184:187]
  buffer_load_dwordx4 v4, s[4:7], s70 offen  lds
  v_mfma_f32_16x16x32_bf16 v[192:195], a[104:107], a[144:147], v[192:195]
  v_mfma_f32_16x16x32_bf16 v[200:203], a[104:107], a[148:151], v[200:203]
  ds_read_b128 a[44:47], v11 offset:6144
  v_mfma_f32_16x16x32_bf16 v[208:211], a[104:107], a[152:155], v[208:211]
  v_mfma_f32_16x16x32_bf16 v[216:219], a[104:107], a[156:159], v[216:219]
  ds_read_b64_tr_b16 a[76:77], v16 offset:40960
  v_mfma_f32_16x16x32_bf16 v[220:223], a[108:111], a[156:159], v[220:223]
  s_add_u32 s70, s78, 3440640
  v_mfma_f32_16x16x32_bf16 v[212:215], a[108:111], a[152:155], v[212:215]
  s_add_u32 m0, s81, 17408
  ds_read_b64_tr_b16 a[78:79], v16 offset:41984
  v_mfma_f32_16x16x32_bf16 v[204:207], a[108:111], a[148:151], v[204:207]
  buffer_load_dwordx4 v7, s[8:11], s70 offen  lds
  v_mfma_f32_16x16x32_bf16 v[196:199], a[108:111], a[144:147], v[196:199]
  v_mfma_f32_16x16x32_bf16 v[188:191], a[108:111], a[140:143], v[188:191]
  ds_read_b128 a[48:51], v11 offset:8192
  v_mfma_f32_16x16x32_bf16 v[180:183], a[108:111], a[136:139], v[180:183]
  v_mfma_f32_16x16x32_bf16 v[172:175], a[108:111], a[132:135], v[172:175]
  ds_read_b64_tr_b16 a[80:81], v17 offset:40960
  v_mfma_f32_16x16x32_bf16 v[164:167], a[108:111], a[128:131], v[164:167]
  s_add_u32 s70, s74, 17280
  v_mfma_f32_16x16x32_bf16 v[224:227], a[112:115], a[128:131], v[224:227]
  s_add_u32 m0, s80, 34816
  ds_read_b64_tr_b16 a[82:83], v17 offset:41984
  v_mfma_f32_16x16x32_bf16 v[232:235], a[112:115], a[132:135], v[232:235]
  buffer_load_dwordx4 v3, s[4:7], s70 offen  lds
  v_mfma_f32_16x16x32_bf16 v[240:243], a[112:115], a[136:139], v[240:243]
  v_mfma_f32_16x16x32_bf16 v[248:251], a[112:115], a[140:143], v[248:251]
  ds_read_b128 a[52:55], v11 offset:10240
  v_mfma_f32_16x16x32_bf16 v[88:91], a[112:115], a[144:147], v[88:91]
  v_mfma_f32_16x16x32_bf16 v[80:83], a[112:115], a[148:151], v[80:83]
  ds_read_b64_tr_b16 a[84:85], v18 offset:40960
  v_mfma_f32_16x16x32_bf16 v[72:75], a[112:115], a[152:155], v[72:75]
  s_add_u32 s70, s78, 3473408
  v_mfma_f32_16x16x32_bf16 v[64:67], a[112:115], a[156:159], v[64:67]
  s_add_u32 m0, s81, 18432
  ds_read_b64_tr_b16 a[86:87], v18 offset:41984
  v_mfma_f32_16x16x32_bf16 v[68:71], a[116:119], a[156:159], v[68:71]
  buffer_load_dwordx4 v8, s[8:11], s70 offen  lds
  v_mfma_f32_16x16x32_bf16 v[76:79], a[116:119], a[152:155], v[76:79]
  v_mfma_f32_16x16x32_bf16 v[84:87], a[116:119], a[148:151], v[84:87]
  ds_read_b128 a[56:59], v11 offset:12288
  v_mfma_f32_16x16x32_bf16 v[92:95], a[116:119], a[144:147], v[92:95]
  v_mfma_f32_16x16x32_bf16 v[252:255], a[116:119], a[140:143], v[252:255]
  ds_read_b64_tr_b16 a[88:89], v19 offset:40960
  v_mfma_f32_16x16x32_bf16 v[244:247], a[116:119], a[136:139], v[244:247]
  s_add_u32 s70, s74, 25472
  v_mfma_f32_16x16x32_bf16 v[236:239], a[116:119], a[132:135], v[236:239]
  s_add_u32 m0, s80, 35840
  ds_read_b64_tr_b16 a[90:91], v19 offset:41984
  v_mfma_f32_16x16x32_bf16 v[228:231], a[116:119], a[128:131], v[228:231]
  buffer_load_dwordx4 v4, s[4:7], s70 offen  lds
  v_mfma_f32_16x16x32_bf16 v[56:59], a[120:123], a[128:131], v[56:59]
  v_mfma_f32_16x16x32_bf16 v[48:51], a[120:123], a[132:135], v[48:51]
  ds_read_b128 a[60:63], v11 offset:14336
  v_mfma_f32_16x16x32_bf16 v[40:43], a[120:123], a[136:139], v[40:43]
  v_mfma_f32_16x16x32_bf16 v[32:35], a[120:123], a[140:143], v[32:35]
  ds_read_b64_tr_b16 a[92:93], v20 offset:40960
  v_mfma_f32_16x16x32_bf16 a[0:3], a[120:123], a[144:147], a[0:3]
  s_add_u32 s70, s78, 3506176
  v_mfma_f32_16x16x32_bf16 a[8:11], a[120:123], a[148:151], a[8:11]
  s_add_u32 m0, s81, 19456
  ds_read_b64_tr_b16 a[94:95], v20 offset:41984
  v_mfma_f32_16x16x32_bf16 a[16:19], a[120:123], a[152:155], a[16:19]
  buffer_load_dwordx4 v8, s[8:11], s70 offen  lds
  v_mfma_f32_16x16x32_bf16 a[24:27], a[120:123], a[156:159], a[24:27]
  v_mfma_f32_16x16x32_bf16 a[28:31], a[124:127], a[156:159], a[28:31]
  v_mfma_f32_16x16x32_bf16 a[20:23], a[124:127], a[152:155], a[20:23]
  v_mfma_f32_16x16x32_bf16 a[12:15], a[124:127], a[148:151], a[12:15]
  v_mfma_f32_16x16x32_bf16 a[4:7], a[124:127], a[144:147], a[4:7]
  v_mfma_f32_16x16x32_bf16 v[36:39], a[124:127], a[140:143], v[36:39]
  v_mfma_f32_16x16x32_bf16 v[44:47], a[124:127], a[136:139], v[44:47]
  v_mfma_f32_16x16x32_bf16 v[52:55], a[124:127], a[132:135], v[52:55]
  s_waitcnt vmcnt(19) lgkmcnt(0)
  v_mfma_f32_16x16x32_bf16 v[60:63], a[124:127], a[128:131], v[60:63]
  s_barrier
  v_mfma_f32_16x16x32_bf16 v[96:99], a[32:35], a[64:67], v[96:99]
  ds_read_b128 a[96:99], v12 offset:0
  v_min_u32 v21, 35, v1
  v_mfma_f32_16x16x32_bf16 v[104:107], a[32:35], a[68:71], v[104:107]
  s_lshr_b32 s71, s2, 3
  s_lshl_b32 s71, s71, 2
  s_add_u32 s71, s71, s34
  v_mfma_f32_16x16x32_bf16 v[112:115], a[32:35], a[72:75], v[112:115]
  s_mul_i32 s71, s71, 36
  ds_read_b64_tr_b16 a[128:129], v13 offset:57344
  v_add_u32 v21, s71, v21
  v_mfma_f32_16x16x32_bf16 v[120:123], a[32:35], a[76:79], v[120:123]
  s_add_u32 s70, s75, 896
  v_lshrrev_b32 v22, 3, v21
  v_mfma_f32_16x16x32_bf16 v[128:131], a[32:35], a[80:83], v[128:131]
  s_add_u32 m0, s80, 36864
  ds_read_b64_tr_b16 a[130:131], v13 offset:58368
  v_lshlrev_b32 v22, 13, v22
  v_mfma_f32_16x16x32_bf16 v[136:139], a[32:35], a[84:87], v[136:139]
  buffer_load_dwordx4 v3, s[4:7], s70 offen  lds
  v_mfma_f32_16x16x32_bf16 v[144:147], a[32:35], a[88:91], v[144:147]
  v_and_b32 v21, 7, v21
  v_mfma_f32_16x16x32_bf16 v[152:155], a[32:35], a[92:95], v[152:155]
  ds_read_b128 a[100:103], v12 offset:2048
  v_lshl_add_u32 v21, v21, 7, v22
  v_mfma_f32_16x16x32_bf16 v[156:159], a[36:39], a[92:95], v[156:159]
  s_and_b32 s71, s2, 7
  s_lshl_b32 s71, s71, 10
  v_mfma_f32_16x16x32_bf16 v[148:151], a[36:39], a[88:91], v[148:151]
  ds_read_b64_tr_b16 a[132:133], v14 offset:57344
  v_mfma_f32_16x16x32_bf16 v[140:143], a[36:39], a[84:87], v[140:143]
  s_add_u32 s70, s78, 3670016
  buffer_load_dword v30, v21, s[16:19], s71 offen
  v_mfma_f32_16x16x32_bf16 v[132:135], a[36:39], a[80:83], v[132:135]
  s_add_u32 m0, s81, 32768
  ds_read_b64_tr_b16 a[134:135], v14 offset:58368
  v_mfma_f32_16x16x32_bf16 v[124:127], a[36:39], a[76:79], v[124:127]
  buffer_load_dwordx4 v7, s[8:11], s70 offen  lds
  v_mfma_f32_16x16x32_bf16 v[116:119], a[36:39], a[72:75], v[116:119]
  v_mfma_f32_16x16x32_bf16 v[108:111], a[36:39], a[68:71], v[108:111]
  ds_read_b128 a[104:107], v12 offset:4096
  v_mfma_f32_16x16x32_bf16 v[100:103], a[36:39], a[64:67], v[100:103]
  v_mfma_f32_16x16x32_bf16 v[160:163], a[40:43], a[64:67], v[160:163]
  ds_read_b64_tr_b16 a[136:137], v15 offset:57344
  v_mfma_f32_16x16x32_bf16 v[168:171], a[40:43], a[68:71], v[168:171]
  s_add_u32 s70, s75, 9088
  v_mfma_f32_16x16x32_bf16 v[176:179], a[40:43], a[72:75], v[176:179]
  s_add_u32 m0, s80, 37888
  ds_read_b64_tr_b16 a[138:139], v15 offset:58368
  v_mfma_f32_16x16x32_bf16 v[184:187], a[40:43], a[76:79], v[184:187]
  buffer_load_dwordx4 v4, s[4:7], s70 offen  lds
  v_mfma_f32_16x16x32_bf16 v[192:195], a[40:43], a[80:83], v[192:195]
  v_mfma_f32_16x16x32_bf16 v[200:203], a[40:43], a[84:87], v[200:203]
  ds_read_b128 a[108:111], v12 offset:6144
  v_mfma_f32_16x16x32_bf16 v[208:211], a[40:43], a[88:91], v[208:211]
  v_mfma_f32_16x16x32_bf16 v[216:219], a[40:43], a[92:95], v[216:219]
  ds_read_b64_tr_b16 a[140:141], v16 offset:57344
  v_mfma_f32_16x16x32_bf16 v[220:223], a[44:47], a[92:95], v[220:223]
  s_add_u32 s70, s78, 3702784
  v_mfma_f32_16x16x32_bf16 v[212:215], a[44:47], a[88:91], v[212:215]
  s_add_u32 m0, s81, 33792
  ds_read_b64_tr_b16 a[142:143], v16 offset:58368
  v_mfma_f32_16x16x32_bf16 v[204:207], a[44:47], a[84:87], v[204:207]
  buffer_load_dwordx4 v7, s[8:11], s70 offen  lds
  v_mfma_f32_16x16x32_bf16 v[196:199], a[44:47], a[80:83], v[196:199]
  v_mfma_f32_16x16x32_bf16 v[188:191], a[44:47], a[76:79], v[188:191]
  ds_read_b128 a[112:115], v12 offset:8192
  v_mfma_f32_16x16x32_bf16 v[180:183], a[44:47], a[72:75], v[180:183]
  v_mfma_f32_16x16x32_bf16 v[172:175], a[44:47], a[68:71], v[172:175]
  ds_read_b64_tr_b16 a[144:145], v17 offset:57344
  v_mfma_f32_16x16x32_bf16 v[164:167], a[44:47], a[64:67], v[164:167]
  s_add_u32 s70, s75, 17280
  v_mfma_f32_16x16x32_bf16 v[224:227], a[48:51], a[64:67], v[224:227]
  s_add_u32 m0, s80, 38912
  ds_read_b64_tr_b16 a[146:147], v17 offset:58368
  v_mfma_f32_16x16x32_bf16 v[232:235], a[48:51], a[68:71], v[232:235]
  buffer_load_dwordx4 v3, s[4:7], s70 offen  lds
  v_mfma_f32_16x16x32_bf16 v[240:243], a[48:51], a[72:75], v[240:243]
  v_mfma_f32_16x16x32_bf16 v[248:251], a[48:51], a[76:79], v[248:251]
  ds_read_b128 a[116:119], v12 offset:10240
  v_mfma_f32_16x16x32_bf16 v[88:91], a[48:51], a[80:83], v[88:91]
  v_mfma_f32_16x16x32_bf16 v[80:83], a[48:51], a[84:87], v[80:83]
  ds_read_b64_tr_b16 a[148:149], v18 offset:57344
  v_mfma_f32_16x16x32_bf16 v[72:75], a[48:51], a[88:91], v[72:75]
  s_add_u32 s70, s78, 3735552
  v_mfma_f32_16x16x32_bf16 v[64:67], a[48:51], a[92:95], v[64:67]
  s_add_u32 m0, s81, 34816
  ds_read_b64_tr_b16 a[150:151], v18 offset:58368
  v_mfma_f32_16x16x32_bf16 v[68:71], a[52:55], a[92:95], v[68:71]
  buffer_load_dwordx4 v8, s[8:11], s70 offen  lds
  v_mfma_f32_16x16x32_bf16 v[76:79], a[52:55], a[88:91], v[76:79]
  v_mfma_f32_16x16x32_bf16 v[84:87], a[52:55], a[84:87], v[84:87]
  ds_read_b128 a[120:123], v12 offset:12288
  v_mfma_f32_16x16x32_bf16 v[92:95], a[52:55], a[80:83], v[92:95]
  v_mfma_f32_16x16x32_bf16 v[252:255], a[52:55], a[76:79], v[252:255]
  ds_read_b64_tr_b16 a[152:153], v19 offset:57344
  v_mfma_f32_16x16x32_bf16 v[244:247], a[52:55], a[72:75], v[244:247]
  s_add_u32 s70, s75, 25472
  v_mfma_f32_16x16x32_bf16 v[236:239], a[52:55], a[68:71], v[236:239]
  s_add_u32 m0, s80, 39936
  ds_read_b64_tr_b16 a[154:155], v19 offset:58368
  v_mfma_f32_16x16x32_bf16 v[228:231], a[52:55], a[64:67], v[228:231]
  buffer_load_dwordx4 v4, s[4:7], s70 offen  lds
  v_mfma_f32_16x16x32_bf16 v[56:59], a[56:59], a[64:67], v[56:59]
  v_mfma_f32_16x16x32_bf16 v[48:51], a[56:59], a[68:71], v[48:51]
  ds_read_b128 a[124:127], v12 offset:14336
  v_mfma_f32_16x16x32_bf16 v[40:43], a[56:59], a[72:75], v[40:43]
  v_mfma_f32_16x16x32_bf16 v[32:35], a[56:59], a[76:79], v[32:35]
  ds_read_b64_tr_b16 a[156:157], v20 offset:57344
  v_mfma_f32_16x16x32_bf16 a[0:3], a[56:59], a[80:83], a[0:3]
  s_add_u32 s70, s78, 3768320
  v_mfma_f32_16x16x32_bf16 a[8:11], a[56:59], a[84:87], a[8:11]
  s_add_u32 m0, s81, 35840
  ds_read_b64_tr_b16 a[158:159], v20 offset:58368
  v_mfma_f32_16x16x32_bf16 a[16:19], a[56:59], a[88:91], a[16:19]
  buffer_load_dwordx4 v8, s[8:11], s70 offen  lds
  v_mfma_f32_16x16x32_bf16 a[24:27], a[56:59], a[92:95], a[24:27]
  v_mfma_f32_16x16x32_bf16 a[28:31], a[60:63], a[92:95], a[28:31]
  v_mfma_f32_16x16x32_bf16 a[20:23], a[60:63], a[88:91], a[20:23]
  v_mfma_f32_16x16x32_bf16 a[12:15], a[60:63], a[84:87], a[12:15]
  v_mfma_f32_16x16x32_bf16 a[4:7], a[60:63], a[80:83], a[4:7]
  v_mfma_f32_16x16x32_bf16 v[36:39], a[60:63], a[76:79], v[36:39]
  v_mfma_f32_16x16x32_bf16 v[44:47], a[60:63], a[72:75], v[44:47]
  v_mfma_f32_16x16x32_bf16 v[52:55], a[60:63], a[68:71], v[52:55]
  s_waitcnt vmcnt(17) lgkmcnt(0)
  v_mfma_f32_16x16x32_bf16 v[60:63], a[60:63], a[64:67], v[60:63]
  s_barrier
  v_mfma_f32_16x16x32_bf16 v[96:99], a[96:99], a[128:131], v[96:99]
  s_and_b32 s72, s2, 1
  s_lshl_b32 s72, s72, 2
  ds_read_b128 a[32:35], v9 offset:0
  v_mfma_f32_16x16x32_bf16 v[104:107], a[96:99], a[132:135], v[104:107]
  s_add_u32 s72, s72, s34
  s_lshl_b32 s72, s72, 6
  s_lshr_b32 s71, s2, 2
  v_mfma_f32_16x16x32_bf16 v[112:115], a[96:99], a[136:139], v[112:115]
  s_add_u32 s72, s72, s71
  s_mul_i32 s72, s72, 9216
  ds_read_b64_tr_b16 a[64:65], v13 offset:8192
  v_mfma_f32_16x16x32_bf16 v[120:123], a[96:99], a[140:143], v[120:123]
  s_add_u32 s70, s76, 0
  s_add_u32 s72, s72, 52428800
  s_bfe_u32 s71, s2, 0x10001
  v_mfma_f32_16x16x32_bf16 v[128:131], a[96:99], a[144:147], v[128:131]
  s_add_u32 m0, s80, 65536
  s_lshl_b32 s97, s71, 12
  ds_read_b64_tr_b16 a[66:67], v13 offset:9216
  v_mfma_f32_16x16x32_bf16 v[136:139], a[96:99], a[148:151], v[136:139]
  s_add_u32 s97, s97, s72
  buffer_load_dwordx4 v5, s[12:15], s70 offen  lds
  v_mfma_f32_16x16x32_bf16 v[144:147], a[96:99], a[152:155], v[144:147]
  s_add_u32 s32, s72, 8192
  s_lshl_b32 s71, s71, 3
  s_lshl_b32 s73, 0x00ff00ff, s71
  v_mfma_f32_16x16x32_bf16 v[22:25], a[196:199], a[220:223], 0
  v_mfma_f32_16x16x32_bf16 v[152:155], a[96:99], a[156:159], v[152:155]
  ds_read_b128 a[36:39], v9 offset:2048
  v_mfma_f32_16x16x32_bf16 v[26:29], a[208:211], a[220:223], 0
  v_mfma_f32_16x16x32_bf16 v[156:159], a[100:103], a[156:159], v[156:159]
  s_nop 1
  v_mfma_f32_16x16x32_bf16 v[148:151], a[100:103], a[152:155], v[148:151]
  s_nop 1
  ds_read_b64_tr_b16 a[68:69], v14 offset:8192
  v_mfma_f32_16x16x32_bf16 v[140:143], a[100:103], a[148:151], v[140:143]
  s_add_u32 s70, s78, 3932160
  s_nop 1
  v_mfma_f32_16x16x32_bf16 v[132:135], a[100:103], a[144:147], v[132:135]
  s_add_u32 m0, s81, 49152
  ds_read_b64_tr_b16 a[70:71], v14 offset:9216
  v_cvt_pk_bf16_f32 v22, v22, v23
  v_mfma_f32_16x16x32_bf16 v[124:127], a[100:103], a[140:143], v[124:127]
  buffer_load_dwordx4 v7, s[8:11], s70 offen  lds
  v_mfma_f32_16x16x32_bf16 v[116:119], a[100:103], a[136:139], v[116:119]
  v_cvt_pk_bf16_f32 v23, v24, v25
  v_mfma_f32_16x16x32_bf16 v[108:111], a[100:103], a[132:135], v[108:111]
  ds_read_b128 a[40:43], v9 offset:4096
  v_cvt_pk_bf16_f32 v24, v26, v27
  v_mfma_f32_16x16x32_bf16 v[100:103], a[100:103], a[128:131], v[100:103]
  v_cvt_pk_bf16_f32 v25, v28, v29
  v_mfma_f32_16x16x32_bf16 v[160:163], a[104:107], a[128:131], v[160:163]
  ds_read_b64_tr_b16 a[72:73], v15 offset:8192
  v_mfma_f32_16x16x32_bf16 v[168:171], a[104:107], a[132:135], v[168:171]
  s_add_u32 s70, s76, 9216
  buffer_store_dwordx4 v[22:25], v2, s[20:23], s97 offen offset:0 sc1
  v_mfma_f32_16x16x32_bf16 v[176:179], a[104:107], a[136:139], v[176:179]
  s_add_u32 m0, s80, 66560
  ds_read_b64_tr_b16 a[74:75], v15 offset:9216
  v_mfma_f32_16x16x32_bf16 v[184:187], a[104:107], a[140:143], v[184:187]
  buffer_load_dwordx4 v6, s[12:15], s70 offen  lds
  v_mfma_f32_16x16x32_bf16 v[192:195], a[104:107], a[144:147], v[192:195]
  s_nop 1
  v_mfma_f32_16x16x32_bf16 v[22:25], a[196:199], a[224:227], 0
  v_mfma_f32_16x16x32_bf16 v[200:203], a[104:107], a[148:151], v[200:203]
  ds_read_b128 a[44:47], v9 offset:6144
  v_mfma_f32_16x16x32_bf16 v[26:29], a[208:211], a[224:227], 0
  v_mfma_f32_16x16x32_bf16 v[208:211], a[104:107], a[152:155], v[208:211]
  s_nop 1
  v_mfma_f32_16x16x32_bf16 v[216:219], a[104:107], a[156:159], v[216:219]
  s_nop 1
  ds_read_b64_tr_b16 a[76:77], v16 offset:8192
  v_mfma_f32_16x16x32_bf16 v[220:223], a[108:111], a[156:159], v[220:223]
  s_add_u32 s70, s78, 3964928
  s_nop 1
  v_mfma_f32_16x16x32_bf16 v[212:215], a[108:111], a[152:155], v[212:215]
  s_add_u32 m0, s81, 50176
  ds_read_b64_tr_b16 a[78:79], v16 offset:9216
  v_cvt_pk_bf16_f32 v22, v22, v23
  v_mfma_f32_16x16x32_bf16 v[204:207], a[108:111], a[148:151], v[204:207]
  buffer_load_dwordx4 v7, s[8:11], s70 offen  lds
  v_mfma_f32_16x16x32_bf16 v[196:199], a[108:111], a[144:147], v[196:199]
  v_cvt_pk_bf16_f32 v23, v24, v25
  v_mfma_f32_16x16x32_bf16 v[188:191], a[108:111], a[140:143], v[188:191]
  ds_read_b128 a[48:51], v9 offset:8192
  v_cvt_pk_bf16_f32 v24, v26, v27
  v_mfma_f32_16x16x32_bf16 v[180:183], a[108:111], a[136:139], v[180:183]
  v_cvt_pk_bf16_f32 v25, v28, v29
  v_mfma_f32_16x16x32_bf16 v[172:175], a[108:111], a[132:135], v[172:175]
  ds_read_b64_tr_b16 a[80:81], v17 offset:8192
  v_mfma_f32_16x16x32_bf16 v[164:167], a[108:111], a[128:131], v[164:167]
  s_add_u32 s70, s76, 18432
  buffer_store_dwordx4 v[22:25], v2, s[20:23], s97 offen offset:1024 sc1
  v_mfma_f32_16x16x32_bf16 v[224:227], a[112:115], a[128:131], v[224:227]
  s_add_u32 m0, s80, 67584
  ds_read_b64_tr_b16 a[82:83], v17 offset:9216
  v_mfma_f32_16x16x32_bf16 v[232:235], a[112:115], a[132:135], v[232:235]
  buffer_load_dwordx4 v5, s[12:15], s70 offen  lds
  v_mfma_f32_16x16x32_bf16 v[240:243], a[112:115], a[136:139], v[240:243]
  s_nop 1
  v_mfma_f32_16x16x32_bf16 v[22:25], a[200:203], a[220:223], 0
  v_mfma_f32_16x16x32_bf16 v[248:251], a[112:115], a[140:143], v[248:251]
  ds_read_b128 a[52:55], v9 offset:10240
  v_mfma_f32_16x16x32_bf16 v[26:29], a[212:215], a[220:223], 0
  v_mfma_f32_16x16x32_bf16 v[88:91], a[112:115], a[144:147], v[88:91]
  s_nop 1
  v_mfma_f32_16x16x32_bf16 v[80:83], a[112:115], a[148:151], v[80:83]
  s_nop 1
  ds_read_b64_tr_b16 a[84:85], v18 offset:8192
  v_mfma_f32_16x16x32_bf16 v[72:75], a[112:115], a[152:155], v[72:75]
  s_add_u32 s70, s78, 3997696
  s_nop 1
  v_mfma_f32_16x16x32_bf16 v[64:67], a[112:115], a[156:159], v[64:67]
  s_add_u32 m0, s81, 51200
  ds_read_b64_tr_b16 a[86:87], v18 offset:9216
  v_cvt_pk_bf16_f32 v22, v22, v23
  v_mfma_f32_16x16x32_bf16 v[68:71], a[116:119], a[156:159], v[68:71]
  buffer_load_dwordx4 v8, s[8:11], s70 offen  lds
  v_mfma_f32_16x16x32_bf16 v[76:79], a[116:119], a[152:155], v[76:79]
  v_cvt_pk_bf16_f32 v23, v24, v25
  v_mfma_f32_16x16x32_bf16 v[84:87], a[116:119], a[148:151], v[84:87]
  ds_read_b128 a[56:59], v9 offset:12288
  v_cvt_pk_bf16_f32 v24, v26, v27
  v_mfma_f32_16x16x32_bf16 v[92:95], a[116:119], a[144:147], v[92:95]
  v_cvt_pk_bf16_f32 v25, v28, v29
  v_mfma_f32_16x16x32_bf16 v[252:255], a[116:119], a[140:143], v[252:255]
  ds_read_b64_tr_b16 a[88:89], v19 offset:8192
  v_mfma_f32_16x16x32_bf16 v[244:247], a[116:119], a[136:139], v[244:247]
  s_add_u32 s70, s76, 27648
  buffer_store_dwordx4 v[22:25], v2, s[20:23], s97 offen offset:2048 sc1
  v_mfma_f32_16x16x32_bf16 v[236:239], a[116:119], a[132:135], v[236:239]
  s_add_u32 m0, s80, 68608
  ds_read_b64_tr_b16 a[90:91], v19 offset:9216
  v_mfma_f32_16x16x32_bf16 v[228:231], a[116:119], a[128:131], v[228:231]
  buffer_load_dwordx4 v6, s[12:15], s70 offen  lds
  v_mfma_f32_16x16x32_bf16 v[56:59], a[120:123], a[128:131], v[56:59]
  s_nop 1
  v_mfma_f32_16x16x32_bf16 v[22:25], a[200:203], a[224:227], 0
  v_mfma_f32_16x16x32_bf16 v[48:51], a[120:123], a[132:135], v[48:51]
  ds_read_b128 a[60:63], v9 offset:14336
  v_mfma_f32_16x16x32_bf16 v[26:29], a[212:215], a[224:227], 0
  v_mfma_f32_16x16x32_bf16 v[40:43], a[120:123], a[136:139], v[40:43]
  s_nop 1
  v_mfma_f32_16x16x32_bf16 v[32:35], a[120:123], a[140:143], v[32:35]
  s_nop 1
  ds_read_b64_tr_b16 a[92:93], v20 offset:8192
  v_mfma_f32_16x16x32_bf16 a[0:3], a[120:123], a[144:147], a[0:3]
  s_add_u32 s70, s78, 4030464
  s_nop 1
  v_mfma_f32_16x16x32_bf16 a[8:11], a[120:123], a[148:151], a[8:11]
  s_add_u32 m0, s81, 52224
  ds_read_b64_tr_b16 a[94:95], v20 offset:9216
  v_cvt_pk_bf16_f32 v22, v22, v23
  v_mfma_f32_16x16x32_bf16 a[16:19], a[120:123], a[152:155], a[16:19]
  buffer_load_dwordx4 v8, s[8:11], s70 offen  lds
  v_mfma_f32_16x16x32_bf16 a[24:27], a[120:123], a[156:159], a[24:27]
  v_cvt_pk_bf16_f32 v23, v24, v25
  v_mfma_f32_16x16x32_bf16 a[28:31], a[124:127], a[156:159], a[28:31]
  v_cvt_pk_bf16_f32 v24, v26, v27
  v_mfma_f32_16x16x32_bf16 a[20:23], a[124:127], a[152:155], a[20:23]
  v_cvt_pk_bf16_f32 v25, v28, v29
  v_mfma_f32_16x16x32_bf16 a[12:15], a[124:127], a[148:151], a[12:15]
  buffer_store_dwordx4 v[22:25], v2, s[20:23], s97 offen offset:3072 sc1
  v_mfma_f32_16x16x32_bf16 a[4:7], a[124:127], a[144:147], a[4:7]
  s_nop 1
  v_mfma_f32_16x16x32_bf16 v[22:25], a[204:207], a[228:231], 0
  v_mfma_f32_16x16x32_bf16 v[36:39], a[124:127], a[140:143], v[36:39]
  v_mfma_f32_16x16x32_bf16 v[26:29], a[216:219], a[228:231], 0
  v_mfma_f32_16x16x32_bf16 v[44:47], a[124:127], a[136:139], v[44:47]
  v_mfma_f32_16x16x32_bf16 v[52:55], a[124:127], a[132:135], v[52:55]
  s_waitcnt vmcnt(21) lgkmcnt(0)
  v_mfma_f32_16x16x32_bf16 v[60:63], a[124:127], a[128:131], v[60:63]
  s_barrier
  v_mfma_f32_16x16x32_bf16 v[96:99], a[32:35], a[64:67], v[96:99]
  s_nop 1
  ds_read_b128 a[96:99], v10 offset:0
  v_mfma_f32_16x16x32_bf16 v[104:107], a[32:35], a[68:71], v[104:107]
  s_nop 1
  v_mfma_f32_16x16x32_bf16 v[112:115], a[32:35], a[72:75], v[112:115]
  s_nop 1
  ds_read_b64_tr_b16 a[128:129], v13 offset:24576
  v_mfma_f32_16x16x32_bf16 v[120:123], a[32:35], a[76:79], v[120:123]
  s_add_u32 s70, s77, 0
  v_cvt_pk_bf16_f32 v22, v22, v23
  v_mfma_f32_16x16x32_bf16 v[128:131], a[32:35], a[80:83], v[128:131]
  s_add_u32 m0, s80, 69632
  ds_read_b64_tr_b16 a[130:131], v13 offset:25600
  v_cvt_pk_bf16_f32 v23, v24, v25
  v_mfma_f32_16x16x32_bf16 v[136:139], a[32:35], a[84:87], v[136:139]
  buffer_load_dwordx4 v5, s[12:15], s70 offen  lds
  v_mfma_f32_16x16x32_bf16 v[144:147], a[32:35], a[88:91], v[144:147]
  v_cvt_pk_bf16_f32 v24, v26, v27
  v_mfma_f32_16x16x32_bf16 v[152:155], a[32:35], a[92:95], v[152:155]
  ds_read_b128 a[100:103], v10 offset:2048
  v_cvt_pk_bf16_f32 v25, v28, v29
  v_mfma_f32_16x16x32_bf16 v[156:159], a[36:39], a[92:95], v[156:159]
  s_mov_b32 exec_lo, s73
  s_mov_b32 exec_hi, s73
  buffer_store_dwordx4 v[22:25], v2, s[20:23], s32 offen sc1
  s_mov_b64 exec, -1
  v_mfma_f32_16x16x32_bf16 v[148:151], a[36:39], a[88:91], v[148:151]
  s_nop 1
  ds_read_b64_tr_b16 a[132:133], v14 offset:24576
  v_mfma_f32_16x16x32_bf16 v[140:143], a[36:39], a[84:87], v[140:143]
  s_add_u32 s70, s79, 0
  v_mfma_f32_16x16x32_bf16 v[132:135], a[36:39], a[80:83], v[132:135]
  s_add_u32 m0, s81, 0
  ds_read_b64_tr_b16 a[134:135], v14 offset:25600
  v_mfma_f32_16x16x32_bf16 v[124:127], a[36:39], a[76:79], v[124:127]
  buffer_load_dwordx4 v7, s[16:19], s70 offen  lds
  v_mfma_f32_16x16x32_bf16 v[116:119], a[36:39], a[72:75], v[116:119]
  v_mfma_f32_16x16x32_bf16 v[108:111], a[36:39], a[68:71], v[108:111]
  ds_read_b128 a[104:107], v10 offset:4096
  v_mfma_f32_16x16x32_bf16 v[100:103], a[36:39], a[64:67], v[100:103]
  v_mfma_f32_16x16x32_bf16 v[160:163], a[40:43], a[64:67], v[160:163]
  ds_read_b64_tr_b16 a[136:137], v15 offset:24576
  v_mfma_f32_16x16x32_bf16 v[168:171], a[40:43], a[68:71], v[168:171]
  s_add_u32 s70, s77, 9216
  v_mfma_f32_16x16x32_bf16 v[176:179], a[40:43], a[72:75], v[176:179]
  s_add_u32 m0, s80, 70656
  ds_read_b64_tr_b16 a[138:139], v15 offset:25600
  v_mfma_f32_16x16x32_bf16 v[184:187], a[40:43], a[76:79], v[184:187]
  buffer_load_dwordx4 v6, s[12:15], s70 offen  lds
  v_mfma_f32_16x16x32_bf16 v[192:195], a[40:43], a[80:83], v[192:195]
  v_mfma_f32_16x16x32_bf16 v[200:203], a[40:43], a[84:87], v[200:203]
  ds_read_b128 a[108:111], v10 offset:6144
  v_mfma_f32_16x16x32_bf16 v[208:211], a[40:43], a[88:91], v[208:211]
  v_mfma_f32_16x16x32_bf16 v[216:219], a[40:43], a[92:95], v[216:219]
  ds_read_b64_tr_b16 a[140:141], v16 offset:24576
  v_mfma_f32_16x16x32_bf16 v[220:223], a[44:47], a[92:95], v[220:223]
  s_add_u32 s70, s79, 32768
  v_mfma_f32_16x16x32_bf16 v[212:215], a[44:47], a[88:91], v[212:215]
  s_add_u32 m0, s81, 1024
  ds_read_b64_tr_b16 a[142:143], v16 offset:25600
  v_mfma_f32_16x16x32_bf16 v[204:207], a[44:47], a[84:87], v[204:207]
  buffer_load_dwordx4 v7, s[16:19], s70 offen  lds
  v_mfma_f32_16x16x32_bf16 v[196:199], a[44:47], a[80:83], v[196:199]
  v_mfma_f32_16x16x32_bf16 v[188:191], a[44:47], a[76:79], v[188:191]
  ds_read_b128 a[112:115], v10 offset:8192
  v_mfma_f32_16x16x32_bf16 v[180:183], a[44:47], a[72:75], v[180:183]
  v_mfma_f32_16x16x32_bf16 v[172:175], a[44:47], a[68:71], v[172:175]
  ds_read_b64_tr_b16 a[144:145], v17 offset:24576
  v_mfma_f32_16x16x32_bf16 v[164:167], a[44:47], a[64:67], v[164:167]
  s_add_u32 s70, s77, 18432
  v_mfma_f32_16x16x32_bf16 v[224:227], a[48:51], a[64:67], v[224:227]
  s_add_u32 m0, s80, 71680
  ds_read_b64_tr_b16 a[146:147], v17 offset:25600
  v_mfma_f32_16x16x32_bf16 v[232:235], a[48:51], a[68:71], v[232:235]
  buffer_load_dwordx4 v5, s[12:15], s70 offen  lds
  v_mfma_f32_16x16x32_bf16 v[240:243], a[48:51], a[72:75], v[240:243]
  v_mfma_f32_16x16x32_bf16 v[248:251], a[48:51], a[76:79], v[248:251]
  ds_read_b128 a[116:119], v10 offset:10240
  v_mfma_f32_16x16x32_bf16 v[88:91], a[48:51], a[80:83], v[88:91]
  v_mfma_f32_16x16x32_bf16 v[80:83], a[48:51], a[84:87], v[80:83]
  ds_read_b64_tr_b16 a[148:149], v18 offset:24576
  v_mfma_f32_16x16x32_bf16 v[72:75], a[48:51], a[88:91], v[72:75]
  s_add_u32 s70, s79, 65536
  v_mfma_f32_16x16x32_bf16 v[64:67], a[48:51], a[92:95], v[64:67]
  s_add_u32 m0, s81, 2048
  ds_read_b64_tr_b16 a[150:151], v18 offset:25600
  v_mfma_f32_16x16x32_bf16 v[68:71], a[52:55], a[92:95], v[68:71]
  buffer_load_dwordx4 v8, s[16:19], s70 offen  lds
  v_mfma_f32_16x16x32_bf16 v[76:79], a[52:55], a[88:91], v[76:79]
  v_mfma_f32_16x16x32_bf16 v[84:87], a[52:55], a[84:87], v[84:87]
  ds_read_b128 a[120:123], v10 offset:12288
  v_mfma_f32_16x16x32_bf16 v[92:95], a[52:55], a[80:83], v[92:95]
  v_mfma_f32_16x16x32_bf16 v[252:255], a[52:55], a[76:79], v[252:255]
  ds_read_b64_tr_b16 a[152:153], v19 offset:24576
  v_mfma_f32_16x16x32_bf16 v[244:247], a[52:55], a[72:75], v[244:247]
  s_add_u32 s70, s77, 27648
  v_mfma_f32_16x16x32_bf16 v[236:239], a[52:55], a[68:71], v[236:239]
  s_add_u32 m0, s80, 72704
  ds_read_b64_tr_b16 a[154:155], v19 offset:25600
  v_mfma_f32_16x16x32_bf16 v[228:231], a[52:55], a[64:67], v[228:231]
  buffer_load_dwordx4 v6, s[12:15], s70 offen  lds
  v_mfma_f32_16x16x32_bf16 v[56:59], a[56:59], a[64:67], v[56:59]
  v_mfma_f32_16x16x32_bf16 v[48:51], a[56:59], a[68:71], v[48:51]
  ds_read_b128 a[124:127], v10 offset:14336
  v_mfma_f32_16x16x32_bf16 v[40:43], a[56:59], a[72:75], v[40:43]
  v_mfma_f32_16x16x32_bf16 v[32:35], a[56:59], a[76:79], v[32:35]
  ds_read_b64_tr_b16 a[156:157], v20 offset:24576
  v_mfma_f32_16x16x32_bf16 a[0:3], a[56:59], a[80:83], a[0:3]
  s_add_u32 s70, s79, 98304
  v_mfma_f32_16x16x32_bf16 a[8:11], a[56:59], a[84:87], a[8:11]
  s_add_u32 m0, s81, 3072
  ds_read_b64_tr_b16 a[158:159], v20 offset:25600
  v_mfma_f32_16x16x32_bf16 a[16:19], a[56:59], a[88:91], a[16:19]
  buffer_load_dwordx4 v8, s[16:19], s70 offen  lds
  v_mfma_f32_16x16x32_bf16 a[24:27], a[56:59], a[92:95], a[24:27]
  v_mfma_f32_16x16x32_bf16 a[28:31], a[60:63], a[92:95], a[28:31]
  v_mfma_f32_16x16x32_bf16 a[20:23], a[60:63], a[88:91], a[20:23]
  v_mfma_f32_16x16x32_bf16 a[12:15], a[60:63], a[84:87], a[12:15]
  v_mfma_f32_16x16x32_bf16 a[4:7], a[60:63], a[80:83], a[4:7]
  v_mfma_f32_16x16x32_bf16 v[36:39], a[60:63], a[76:79], v[36:39]
  v_mfma_f32_16x16x32_bf16 v[44:47], a[60:63], a[72:75], v[44:47]
  v_mfma_f32_16x16x32_bf16 v[52:55], a[60:63], a[68:71], v[52:55]
  s_waitcnt vmcnt(21) lgkmcnt(0)
  v_mfma_f32_16x16x32_bf16 v[60:63], a[60:63], a[64:67], v[60:63]
  s_barrier
  v_mfma_f32_16x16x32_bf16 v[96:99], a[96:99], a[128:131], v[96:99]
  ds_read_b128 a[32:35], v9 offset:32768
  v_and_b32 v23, 31, v1
  v_mfma_f32_16x16x32_bf16 v[104:107], a[96:99], a[132:135], v[104:107]
  v_lshlrev_b32 v23, 2, v23
  v_mfma_f32_16x16x32_bf16 v[112:115], a[96:99], a[136:139], v[112:115]
  s_and_b32 s72, s100, 0xffffff80
  s_add_u32 s72, s72, 16384
  ds_read_b64_tr_b16 a[64:65], v13 offset:40960
  v_mfma_f32_16x16x32_bf16 v[120:123], a[96:99], a[140:143], v[120:123]
  s_add_u32 s70, s76, 128
  buffer_load_dword v23, v23, s[20:23], s72 offen sc1
  v_mfma_f32_16x16x32_bf16 v[128:131], a[96:99], a[144:147], v[128:131]
  s_add_u32 m0, s80, 0
  ds_read_b64_tr_b16 a[66:67], v13 offset:41984
  v_mfma_f32_16x16x32_bf16 v[136:139], a[96:99], a[148:151], v[136:139]
  buffer_load_dwordx4 v5, s[12:15], s70 offen  lds
  v_mfma_f32_16x16x32_bf16 v[144:147], a[96:99], a[152:155], v[144:147]
  v_mfma_f32_16x16x32_bf16 v[152:155], a[96:99], a[156:159], v[152:155]
  ds_read_b128 a[36:39], v9 offset:34816
  v_mfma_f32_16x16x32_bf16 v[156:159], a[100:103], a[156:159], v[156:159]
  v_mfma_f32_16x16x32_bf16 v[148:151], a[100:103], a[152:155], v[148:151]
  ds_read_b64_tr_b16 a[68:69], v14 offset:40960
  v_mfma_f32_16x16x32_bf16 v[140:143], a[100:103], a[148:151], v[140:143]
  s_add_u32 s70, s79, 524288
  v_mfma_f32_16x16x32_bf16 v[132:135], a[100:103], a[144:147], v[132:135]
  s_add_u32 m0, s81, 16384
  ds_read_b64_tr_b16 a[70:71], v14 offset:41984
  v_mfma_f32_16x16x32_bf16 v[124:127], a[100:103], a[140:143], v[124:127]
  buffer_load_dwordx4 v7, s[16:19], s70 offen  lds
  v_mfma_f32_16x16x32_bf16 v[116:119], a[100:103], a[136:139], v[116:119]
  v_mfma_f32_16x16x32_bf16 v[108:111], a[100:103], a[132:135], v[108:111]
  ds_read_b128 a[40:43], v9 offset:36864
  v_mfma_f32_16x16x32_bf16 v[100:103], a[100:103], a[128:131], v[100:103]
  v_mfma_f32_16x16x32_bf16 v[160:163], a[104:107], a[128:131], v[160:163]
  ds_read_b64_tr_b16 a[72:73], v15 offset:40960
  v_mfma_f32_16x16x32_bf16 v[168:171], a[104:107], a[132:135], v[168:171]
  s_add_u32 s70, s76, 9344
  v_mfma_f32_16x16x32_bf16 v[176:179], a[104:107], a[136:139], v[176:179]
  s_add_u32 m0, s80, 1024
  ds_read_b64_tr_b16 a[74:75], v15 offset:41984
  v_mfma_f32_16x16x32_bf16 v[184:187], a[104:107], a[140:143], v[184:187]
  buffer_load_dwordx4 v6, s[12:15], s70 offen  lds
  v_mfma_f32_16x16x32_bf16 v[192:195], a[104:107], a[144:147], v[192:195]
  v_mfma_f32_16x16x32_bf16 v[200:203], a[104:107], a[148:151], v[200:203]
  ds_read_b128 a[44:47], v9 offset:38912
  v_mfma_f32_16x16x32_bf16 v[208:211], a[104:107], a[152:155], v[208:211]
  v_mfma_f32_16x16x32_bf16 v[216:219], a[104:107], a[156:159], v[216:219]
  ds_read_b64_tr_b16 a[76:77], v16 offset:40960
  v_mfma_f32_16x16x32_bf16 v[220:223], a[108:111], a[156:159], v[220:223]
  s_add_u32 s70, s79, 557056
  v_mfma_f32_16x16x32_bf16 v[212:215], a[108:111], a[152:155], v[212:215]
  s_add_u32 m0, s81, 17408
  ds_read_b64_tr_b16 a[78:79], v16 offset:41984
  v_mfma_f32_16x16x32_bf16 v[204:207], a[108:111], a[148:151], v[204:207]
  buffer_load_dwordx4 v7, s[16:19], s70 offen  lds
  v_mfma_f32_16x16x32_bf16 v[196:199], a[108:111], a[144:147], v[196:199]
  v_mfma_f32_16x16x32_bf16 v[188:191], a[108:111], a[140:143], v[188:191]
  ds_read_b128 a[48:51], v9 offset:40960
  v_mfma_f32_16x16x32_bf16 v[180:183], a[108:111], a[136:139], v[180:183]
  v_mfma_f32_16x16x32_bf16 v[172:175], a[108:111], a[132:135], v[172:175]
  ds_read_b64_tr_b16 a[80:81], v17 offset:40960
  v_mfma_f32_16x16x32_bf16 v[164:167], a[108:111], a[128:131], v[164:167]
  s_add_u32 s70, s76, 18560
  v_mfma_f32_16x16x32_bf16 v[224:227], a[112:115], a[128:131], v[224:227]
  s_add_u32 m0, s80, 2048
  ds_read_b64_tr_b16 a[82:83], v17 offset:41984
  v_mfma_f32_16x16x32_bf16 v[232:235], a[112:115], a[132:135], v[232:235]
  buffer_load_dwordx4 v5, s[12:15], s70 offen  lds
  v_mfma_f32_16x16x32_bf16 v[240:243], a[112:115], a[136:139], v[240:243]
  v_mfma_f32_16x16x32_bf16 v[248:251], a[112:115], a[140:143], v[248:251]
  ds_read_b128 a[52:55], v9 offset:43008
  v_mfma_f32_16x16x32_bf16 v[88:91], a[112:115], a[144:147], v[88:91]
  v_mfma_f32_16x16x32_bf16 v[80:83], a[112:115], a[148:151], v[80:83]
  ds_read_b64_tr_b16 a[84:85], v18 offset:40960
  v_mfma_f32_16x16x32_bf16 v[72:75], a[112:115], a[152:155], v[72:75]
  s_add_u32 s70, s79, 589824
  v_mfma_f32_16x16x32_bf16 v[64:67], a[112:115], a[156:159], v[64:67]
  s_add_u32 m0, s81, 18432
  ds_read_b64_tr_b16 a[86:87], v18 offset:41984
  v_mfma_f32_16x16x32_bf16 v[68:71], a[116:119], a[156:159], v[68:71]
  buffer_load_dwordx4 v8, s[16:19], s70 offen  lds
  v_mfma_f32_16x16x32_bf16 v[76:79], a[116:119], a[152:155], v[76:79]
  v_mfma_f32_16x16x32_bf16 v[84:87], a[116:119], a[148:151], v[84:87]
  ds_read_b128 a[56:59], v9 offset:45056
  v_mfma_f32_16x16x32_bf16 v[92:95], a[116:119], a[144:147], v[92:95]
  v_mfma_f32_16x16x32_bf16 v[252:255], a[116:119], a[140:143], v[252:255]
  ds_read_b64_tr_b16 a[88:89], v19 offset:40960
  v_mfma_f32_16x16x32_bf16 v[244:247], a[116:119], a[136:139], v[244:247]
  s_add_u32 s70, s76, 27776
  v_mfma_f32_16x16x32_bf16 v[236:239], a[116:119], a[132:135], v[236:239]
  s_add_u32 m0, s80, 3072
  ds_read_b64_tr_b16 a[90:91], v19 offset:41984
  v_mfma_f32_16x16x32_bf16 v[228:231], a[116:119], a[128:131], v[228:231]
  buffer_load_dwordx4 v6, s[12:15], s70 offen  lds
  v_mfma_f32_16x16x32_bf16 v[56:59], a[120:123], a[128:131], v[56:59]
  v_mfma_f32_16x16x32_bf16 v[48:51], a[120:123], a[132:135], v[48:51]
  ds_read_b128 a[60:63], v9 offset:47104
  v_mfma_f32_16x16x32_bf16 v[40:43], a[120:123], a[136:139], v[40:43]
  v_mfma_f32_16x16x32_bf16 v[32:35], a[120:123], a[140:143], v[32:35]
  ds_read_b64_tr_b16 a[92:93], v20 offset:40960
  v_mfma_f32_16x16x32_bf16 a[0:3], a[120:123], a[144:147], a[0:3]
  s_add_u32 s70, s79, 622592
  v_mfma_f32_16x16x32_bf16 a[8:11], a[120:123], a[148:151], a[8:11]
  s_add_u32 m0, s81, 19456
  ds_read_b64_tr_b16 a[94:95], v20 offset:41984
  v_mfma_f32_16x16x32_bf16 a[16:19], a[120:123], a[152:155], a[16:19]
  buffer_load_dwordx4 v8, s[16:19], s70 offen  lds
  v_mfma_f32_16x16x32_bf16 a[24:27], a[120:123], a[156:159], a[24:27]
  v_mfma_f32_16x16x32_bf16 a[28:31], a[124:127], a[156:159], a[28:31]
  v_mfma_f32_16x16x32_bf16 a[20:23], a[124:127], a[152:155], a[20:23]
  v_mfma_f32_16x16x32_bf16 a[12:15], a[124:127], a[148:151], a[12:15]
  v_mfma_f32_16x16x32_bf16 a[4:7], a[124:127], a[144:147], a[4:7]
  v_mfma_f32_16x16x32_bf16 v[36:39], a[124:127], a[140:143], v[36:39]
  v_mfma_f32_16x16x32_bf16 v[44:47], a[124:127], a[136:139], v[44:47]
  v_mfma_f32_16x16x32_bf16 v[52:55], a[124:127], a[132:135], v[52:55]
  s_waitcnt vmcnt(19) lgkmcnt(0)
  v_mfma_f32_16x16x32_bf16 v[60:63], a[124:127], a[128:131], v[60:63]
  s_barrier
  v_mfma_f32_16x16x32_bf16 v[96:99], a[32:35], a[64:67], v[96:99]
  ds_read_b128 a[96:99], v10 offset:32768
  v_mfma_f32_16x16x32_bf16 v[104:107], a[32:35], a[68:71], v[104:107]
  v_mfma_f32_16x16x32_bf16 v[112:115], a[32:35], a[72:75], v[112:115]
  ds_read_b64_tr_b16 a[128:129], v13 offset:57344
  v_mfma_f32_16x16x32_bf16 v[120:123], a[32:35], a[76:79], v[120:123]
  s_add_u32 s70, s77, 128
  v_mfma_f32_16x16x32_bf16 v[128:131], a[32:35], a[80:83], v[128:131]
  s_add_u32 m0, s80, 4096
  ds_read_b64_tr_b16 a[130:131], v13 offset:58368
  v_mfma_f32_16x16x32_bf16 v[136:139], a[32:35], a[84:87], v[136:139]
  buffer_load_dwordx4 v5, s[12:15], s70 offen  lds
  v_mfma_f32_16x16x32_bf16 v[144:147], a[32:35], a[88:91], v[144:147]
  v_mfma_f32_16x16x32_bf16 v[152:155], a[32:35], a[92:95], v[152:155]
  ds_read_b128 a[100:103], v10 offset:34816
  v_mfma_f32_16x16x32_bf16 v[156:159], a[36:39], a[92:95], v[156:159]
  v_mfma_f32_16x16x32_bf16 v[148:151], a[36:39], a[88:91], v[148:151]
  ds_read_b64_tr_b16 a[132:133], v14 offset:57344
  v_mfma_f32_16x16x32_bf16 v[140:143], a[36:39], a[84:87], v[140:143]
  s_add_u32 s70, s79, 1048576
  v_mfma_f32_16x16x32_bf16 v[132:135], a[36:39], a[80:83], v[132:135]
  s_add_u32 m0, s81, 32768
  ds_read_b64_tr_b16 a[134:135], v14 offset:58368
  v_mfma_f32_16x16x32_bf16 v[124:127], a[36:39], a[76:79], v[124:127]
  buffer_load_dwordx4 v7, s[16:19], s70 offen  lds
  v_mfma_f32_16x16x32_bf16 v[116:119], a[36:39], a[72:75], v[116:119]
  v_mfma_f32_16x16x32_bf16 v[108:111], a[36:39], a[68:71], v[108:111]
  ds_read_b128 a[104:107], v10 offset:36864
  v_mfma_f32_16x16x32_bf16 v[100:103], a[36:39], a[64:67], v[100:103]
  v_mfma_f32_16x16x32_bf16 v[160:163], a[40:43], a[64:67], v[160:163]
  ds_read_b64_tr_b16 a[136:137], v15 offset:57344
  v_mfma_f32_16x16x32_bf16 v[168:171], a[40:43], a[68:71], v[168:171]
  s_add_u32 s70, s77, 9344
  v_mfma_f32_16x16x32_bf16 v[176:179], a[40:43], a[72:75], v[176:179]
  s_add_u32 m0, s80, 5120
  ds_read_b64_tr_b16 a[138:139], v15 offset:58368
  v_mfma_f32_16x16x32_bf16 v[184:187], a[40:43], a[76:79], v[184:187]
  buffer_load_dwordx4 v6, s[12:15], s70 offen  lds
  v_mfma_f32_16x16x32_bf16 v[192:195], a[40:43], a[80:83], v[192:195]
  v_mfma_f32_16x16x32_bf16 v[200:203], a[40:43], a[84:87], v[200:203]
  ds_read_b128 a[108:111], v10 offset:38912
  v_mfma_f32_16x16x32_bf16 v[208:211], a[40:43], a[88:91], v[208:211]
  v_mfma_f32_16x16x32_bf16 v[216:219], a[40:43], a[92:95], v[216:219]
  ds_read_b64_tr_b16 a[140:141], v16 offset:57344
  v_mfma_f32_16x16x32_bf16 v[220:223], a[44:47], a[92:95], v[220:223]
  s_add_u32 s70, s79, 1081344
  v_mfma_f32_16x16x32_bf16 v[212:215], a[44:47], a[88:91], v[212:215]
  s_add_u32 m0, s81, 33792
  ds_read_b64_tr_b16 a[142:143], v16 offset:58368
  v_mfma_f32_16x16x32_bf16 v[204:207], a[44:47], a[84:87], v[204:207]
  buffer_load_dwordx4 v7, s[16:19], s70 offen  lds
  v_mfma_f32_16x16x32_bf16 v[196:199], a[44:47], a[80:83], v[196:199]
  v_mfma_f32_16x16x32_bf16 v[188:191], a[44:47], a[76:79], v[188:191]
  ds_read_b128 a[112:115], v10 offset:40960
  v_mfma_f32_16x16x32_bf16 v[180:183], a[44:47], a[72:75], v[180:183]
  v_mfma_f32_16x16x32_bf16 v[172:175], a[44:47], a[68:71], v[172:175]
  ds_read_b64_tr_b16 a[144:145], v17 offset:57344
  v_mfma_f32_16x16x32_bf16 v[164:167], a[44:47], a[64:67], v[164:167]
  s_add_u32 s70, s77, 18560
  v_mfma_f32_16x16x32_bf16 v[224:227], a[48:51], a[64:67], v[224:227]
  s_add_u32 m0, s80, 6144
  ds_read_b64_tr_b16 a[146:147], v17 offset:58368
  v_mfma_f32_16x16x32_bf16 v[232:235], a[48:51], a[68:71], v[232:235]
  buffer_load_dwordx4 v5, s[12:15], s70 offen  lds
  v_mfma_f32_16x16x32_bf16 v[240:243], a[48:51], a[72:75], v[240:243]
  v_mfma_f32_16x16x32_bf16 v[248:251], a[48:51], a[76:79], v[248:251]
  ds_read_b128 a[116:119], v10 offset:43008
  v_mfma_f32_16x16x32_bf16 v[88:91], a[48:51], a[80:83], v[88:91]
  v_mfma_f32_16x16x32_bf16 v[80:83], a[48:51], a[84:87], v[80:83]
  ds_read_b64_tr_b16 a[148:149], v18 offset:57344
  v_mfma_f32_16x16x32_bf16 v[72:75], a[48:51], a[88:91], v[72:75]
  s_add_u32 s70, s79, 1114112
  v_mfma_f32_16x16x32_bf16 v[64:67], a[48:51], a[92:95], v[64:67]
  s_add_u32 m0, s81, 34816
  ds_read_b64_tr_b16 a[150:151], v18 offset:58368
  v_mfma_f32_16x16x32_bf16 v[68:71], a[52:55], a[92:95], v[68:71]
  buffer_load_dwordx4 v8, s[16:19], s70 offen  lds
  v_mfma_f32_16x16x32_bf16 v[76:79], a[52:55], a[88:91], v[76:79]
  v_mfma_f32_16x16x32_bf16 v[84:87], a[52:55], a[84:87], v[84:87]
  ds_read_b128 a[120:123], v10 offset:45056
  v_mfma_f32_16x16x32_bf16 v[92:95], a[52:55], a[80:83], v[92:95]
  v_mfma_f32_16x16x32_bf16 v[252:255], a[52:55], a[76:79], v[252:255]
  ds_read_b64_tr_b16 a[152:153], v19 offset:57344
  v_mfma_f32_16x16x32_bf16 v[244:247], a[52:55], a[72:75], v[244:247]
  s_add_u32 s70, s77, 27776
  v_mfma_f32_16x16x32_bf16 v[236:239], a[52:55], a[68:71], v[236:239]
  s_add_u32 m0, s80, 7168
  ds_read_b64_tr_b16 a[154:155], v19 offset:58368
  v_mfma_f32_16x16x32_bf16 v[228:231], a[52:55], a[64:67], v[228:231]
  buffer_load_dwordx4 v6, s[12:15], s70 offen  lds
  v_mfma_f32_16x16x32_bf16 v[56:59], a[56:59], a[64:67], v[56:59]
  v_mfma_f32_16x16x32_bf16 v[48:51], a[56:59], a[68:71], v[48:51]
  ds_read_b128 a[124:127], v10 offset:47104
  v_mfma_f32_16x16x32_bf16 v[40:43], a[56:59], a[72:75], v[40:43]
  v_mfma_f32_16x16x32_bf16 v[32:35], a[56:59], a[76:79], v[32:35]
  ds_read_b64_tr_b16 a[156:157], v20 offset:57344
  v_mfma_f32_16x16x32_bf16 a[0:3], a[56:59], a[80:83], a[0:3]
  s_add_u32 s70, s79, 1146880
  v_mfma_f32_16x16x32_bf16 a[8:11], a[56:59], a[84:87], a[8:11]
  s_add_u32 m0, s81, 35840
  ds_read_b64_tr_b16 a[158:159], v20 offset:58368
  v_mfma_f32_16x16x32_bf16 a[16:19], a[56:59], a[88:91], a[16:19]
  buffer_load_dwordx4 v8, s[16:19], s70 offen  lds
  v_mfma_f32_16x16x32_bf16 a[24:27], a[56:59], a[92:95], a[24:27]
  v_mfma_f32_16x16x32_bf16 a[28:31], a[60:63], a[92:95], a[28:31]
  v_mfma_f32_16x16x32_bf16 a[20:23], a[60:63], a[88:91], a[20:23]
  v_mfma_f32_16x16x32_bf16 a[12:15], a[60:63], a[84:87], a[12:15]
  v_mfma_f32_16x16x32_bf16 a[4:7], a[60:63], a[80:83], a[4:7]
  v_mfma_f32_16x16x32_bf16 v[36:39], a[60:63], a[76:79], v[36:39]
  v_mfma_f32_16x16x32_bf16 v[44:47], a[60:63], a[72:75], v[44:47]
  v_mfma_f32_16x16x32_bf16 v[52:55], a[60:63], a[68:71], v[52:55]
  s_waitcnt vmcnt(17) lgkmcnt(0)
  v_mfma_f32_16x16x32_bf16 v[60:63], a[60:63], a[64:67], v[60:63]
  s_barrier
  v_mfma_f32_16x16x32_bf16 v[96:99], a[96:99], a[128:131], v[96:99]
  s_lshl_b32 s71, s34, 13
  v_mfma_f32_16x16x32_bf16 v[104:107], a[96:99], a[132:135], v[104:107]
  s_and_b32 s72, s34, 1
  v_mfma_f32_16x16x32_bf16 v[112:115], a[96:99], a[136:139], v[112:115]
  s_lshl_b32 s72, s72, 14
  v_mfma_f32_16x16x32_bf16 v[120:123], a[96:99], a[140:143], v[120:123]
  s_add_u32 s70, s76, 256
  v_mfma_f32_16x16x32_bf16 v[128:131], a[96:99], a[144:147], v[128:131]
  s_add_u32 m0, s80, 32768
  v_mfma_f32_16x16x32_bf16 v[136:139], a[96:99], a[148:151], v[136:139]
  buffer_load_dwordx4 v5, s[12:15], s70 offen  lds
  v_mfma_f32_16x16x32_bf16 v[144:147], a[96:99], a[152:155], v[144:147]
  s_sub_u32 s71, s71, s72
  v_mfma_f32_16x16x32_bf16 v[152:155], a[96:99], a[156:159], v[152:155]
  v_add_u32 v9, s71, v9
  v_add_u32 v10, s71, v10
  v_mfma_f32_16x16x32_bf16 v[156:159], a[100:103], a[156:159], v[156:159]
  v_add_u32 v11, s71, v11
  v_add_u32 v12, s71, v12
  v_mfma_f32_16x16x32_bf16 v[148:151], a[100:103], a[152:155], v[148:151]
  ds_read_b64_tr_b16 a[32:33], v13 offset:0
  v_mfma_f32_16x16x32_bf16 v[140:143], a[100:103], a[148:151], v[140:143]
  s_add_u32 s70, s79, 1572864
  v_mfma_f32_16x16x32_bf16 v[132:135], a[100:103], a[144:147], v[132:135]
  s_add_u32 m0, s81, 49152
  ds_read_b64_tr_b16 a[34:35], v13 offset:1024
  v_mfma_f32_16x16x32_bf16 v[124:127], a[100:103], a[140:143], v[124:127]
  buffer_load_dwordx4 v7, s[16:19], s70 offen  lds
  v_mfma_f32_16x16x32_bf16 v[116:119], a[100:103], a[136:139], v[116:119]
  v_mfma_f32_16x16x32_bf16 v[108:111], a[100:103], a[132:135], v[108:111]
  ds_read_b128 a[64:67], v11 offset:0
  v_mfma_f32_16x16x32_bf16 v[100:103], a[100:103], a[128:131], v[100:103]
  v_mfma_f32_16x16x32_bf16 v[160:163], a[104:107], a[128:131], v[160:163]
  ds_read_b64_tr_b16 a[36:37], v14 offset:0
  v_mfma_f32_16x16x32_bf16 v[168:171], a[104:107], a[132:135], v[168:171]
  s_add_u32 s70, s76, 9472
  v_mfma_f32_16x16x32_bf16 v[176:179], a[104:107], a[136:139], v[176:179]
  s_add_u32 m0, s80, 33792
  ds_read_b64_tr_b16 a[38:39], v14 offset:1024
  v_mfma_f32_16x16x32_bf16 v[184:187], a[104:107], a[140:143], v[184:187]
  buffer_load_dwordx4 v6, s[12:15], s70 offen  lds
  v_mfma_f32_16x16x32_bf16 v[192:195], a[104:107], a[144:147], v[192:195]
  v_mfma_f32_16x16x32_bf16 v[200:203], a[104:107], a[148:151], v[200:203]
  ds_read_b128 a[68:71], v11 offset:2048
  v_mfma_f32_16x16x32_bf16 v[208:211], a[104:107], a[152:155], v[208:211]
  v_mfma_f32_16x16x32_bf16 v[216:219], a[104:107], a[156:159], v[216:219]
  ds_read_b64_tr_b16 a[40:41], v15 offset:0
  v_mfma_f32_16x16x32_bf16 v[220:223], a[108:111], a[156:159], v[220:223]
  s_add_u32 s70, s79, 1605632
  v_mfma_f32_16x16x32_bf16 v[212:215], a[108:111], a[152:155], v[212:215]
  s_add_u32 m0, s81, 50176
  ds_read_b64_tr_b16 a[42:43], v15 offset:1024
  v_mfma_f32_16x16x32_bf16 v[204:207], a[108:111], a[148:151], v[204:207]
  buffer_load_dwordx4 v7, s[16:19], s70 offen  lds
  v_mfma_f32_16x16x32_bf16 v[196:199], a[108:111], a[144:147], v[196:199]
  v_mfma_f32_16x16x32_bf16 v[188:191], a[108:111], a[140:143], v[188:191]
  ds_read_b128 a[72:75], v11 offset:4096
  v_mfma_f32_16x16x32_bf16 v[180:183], a[108:111], a[136:139], v[180:183]
  v_mfma_f32_16x16x32_bf16 v[172:175], a[108:111], a[132:135], v[172:175]
  ds_read_b64_tr_b16 a[44:45], v16 offset:0
  v_mfma_f32_16x16x32_bf16 v[164:167], a[108:111], a[128:131], v[164:167]
  s_add_u32 s70, s76, 18688
  v_mfma_f32_16x16x32_bf16 v[224:227], a[112:115], a[128:131], v[224:227]
  s_add_u32 m0, s80, 34816
  ds_read_b64_tr_b16 a[46:47], v16 offset:1024
  v_mfma_f32_16x16x32_bf16 v[232:235], a[112:115], a[132:135], v[232:235]
  buffer_load_dwordx4 v5, s[12:15], s70 offen  lds
  v_mfma_f32_16x16x32_bf16 v[240:243], a[112:115], a[136:139], v[240:243]
  v_mfma_f32_16x16x32_bf16 v[248:251], a[112:115], a[140:143], v[248:251]
  ds_read_b128 a[76:79], v11 offset:6144
  v_mfma_f32_16x16x32_bf16 v[88:91], a[112:115], a[144:147], v[88:91]
  v_mfma_f32_16x16x32_bf16 v[80:83], a[112:115], a[148:151], v[80:83]
  ds_read_b64_tr_b16 a[48:49], v17 offset:0
  v_mfma_f32_16x16x32_bf16 v[72:75], a[112:115], a[152:155], v[72:75]
  s_add_u32 s70, s79, 1638400
  v_mfma_f32_16x16x32_bf16 v[64:67], a[112:115], a[156:159], v[64:67]
  s_add_u32 m0, s81, 51200
  ds_read_b64_tr_b16 a[50:51], v17 offset:1024
  v_mfma_f32_16x16x32_bf16 v[68:71], a[116:119], a[156:159], v[68:71]
  buffer_load_dwordx4 v8, s[16:19], s70 offen  lds
  v_mfma_f32_16x16x32_bf16 v[76:79], a[116:119], a[152:155], v[76:79]
  v_mfma_f32_16x16x32_bf16 v[84:87], a[116:119], a[148:151], v[84:87]
  ds_read_b64_tr_b16 a[52:53], v18 offset:0
  v_mfma_f32_16x16x32_bf16 v[92:95], a[116:119], a[144:147], v[92:95]
  v_mfma_f32_16x16x32_bf16 v[252:255], a[116:119], a[140:143], v[252:255]
  ds_read_b64_tr_b16 a[54:55], v18 offset:1024
  v_mfma_f32_16x16x32_bf16 v[244:247], a[116:119], a[136:139], v[244:247]
  s_add_u32 s70, s76, 27904
  v_mfma_f32_16x16x32_bf16 v[236:239], a[116:119], a[132:135], v[236:239]
  s_add_u32 m0, s80, 35840
  ds_read_b64_tr_b16 a[56:57], v19 offset:0
  v_mfma_f32_16x16x32_bf16 v[228:231], a[116:119], a[128:131], v[228:231]
  buffer_load_dwordx4 v6, s[12:15], s70 offen  lds
  v_mfma_f32_16x16x32_bf16 v[56:59], a[120:123], a[128:131], v[56:59]
  v_mfma_f32_16x16x32_bf16 v[48:51], a[120:123], a[132:135], v[48:51]
  ds_read_b64_tr_b16 a[58:59], v19 offset:1024
  v_mfma_f32_16x16x32_bf16 v[40:43], a[120:123], a[136:139], v[40:43]
  v_mfma_f32_16x16x32_bf16 v[32:35], a[120:123], a[140:143], v[32:35]
  ds_read_b64_tr_b16 a[60:61], v20 offset:0
  v_mfma_f32_16x16x32_bf16 a[0:3], a[120:123], a[144:147], a[0:3]
  s_add_u32 s70, s79, 1671168
  v_mfma_f32_16x16x32_bf16 a[8:11], a[120:123], a[148:151], a[8:11]
  s_add_u32 m0, s81, 52224
  ds_read_b64_tr_b16 a[62:63], v20 offset:1024
  v_mfma_f32_16x16x32_bf16 a[16:19], a[120:123], a[152:155], a[16:19]
  buffer_load_dwordx4 v8, s[16:19], s70 offen  lds
  v_mfma_f32_16x16x32_bf16 a[24:27], a[120:123], a[156:159], a[24:27]
  v_mfma_f32_16x16x32_bf16 a[28:31], a[124:127], a[156:159], a[28:31]
  v_mfma_f32_16x16x32_bf16 a[20:23], a[124:127], a[152:155], a[20:23]
  v_mfma_f32_16x16x32_bf16 a[12:15], a[124:127], a[148:151], a[12:15]
  v_mfma_f32_16x16x32_bf16 a[4:7], a[124:127], a[144:147], a[4:7]
  v_mfma_f32_16x16x32_bf16 v[36:39], a[124:127], a[140:143], v[36:39]
  v_mfma_f32_16x16x32_bf16 v[44:47], a[124:127], a[136:139], v[44:47]
  v_mfma_f32_16x16x32_bf16 v[52:55], a[124:127], a[132:135], v[52:55]
  s_waitcnt lgkmcnt(0)
  v_mfma_f32_16x16x32_bf16 v[60:63], a[124:127], a[128:131], v[60:63]
L_phaseB:
  v_mfma_f32_16x16x32_bf16 a[192:195], a[32:35], a[64:67], 0
  ds_read_b64_tr_b16 a[96:97], v13 offset:8192
  v_mfma_f32_16x16x32_bf16 a[224:227], a[32:35], a[68:71], 0
  s_add_u32 s70, s77, 256
  ds_read_b64_tr_b16 a[98:99], v13 offset:9216
  v_mfma_f32_16x16x32_bf16 a[80:83], a[32:35], a[72:75], 0
  s_add_u32 m0, s80, 36864
  ds_read_b128 a[128:131], v12 offset:0
  v_mfma_f32_16x16x32_bf16 a[160:163], a[32:35], a[76:79], 0
  s_add_u32 s3, s82, 0
  buffer_load_dwordx4 v5, s[12:15], s70 offen  lds
  v_mfma_f32_16x16x32_bf16 a[164:167], a[36:39], a[76:79], 0
  ds_read_b64_tr_b16 a[100:101], v14 offset:8192
  v_cvt_pk_bf16_f32 v96, v96, v97
  v_mfma_f32_16x16x32_bf16 a[84:87], a[36:39], a[72:75], 0
  ds_read_b64_tr_b16 a[102:103], v14 offset:9216
  v_cvt_pk_bf16_f32 v97, v98, v99
  v_mfma_f32_16x16x32_bf16 a[228:231], a[36:39], a[68:71], 0
  s_add_u32 s70, s77, 9472
  ds_read_b128 a[132:135], v12 offset:2048
  v_cvt_pk_bf16_f32 v98, v100, v101
  v_mfma_f32_16x16x32_bf16 a[196:199], a[36:39], a[64:67], 0
  s_add_u32 m0, s80, 37888
  ds_read_b64_tr_b16 a[104:105], v15 offset:8192
  v_cvt_pk_bf16_f32 v99, v102, v103
  v_mfma_f32_16x16x32_bf16 a[200:203], a[40:43], a[64:67], 0
  buffer_load_dwordx4 v6, s[12:15], s70 offen  lds
  v_mfma_f32_16x16x32_bf16 a[232:235], a[40:43], a[68:71], 0
  ds_read_b64_tr_b16 a[106:107], v15 offset:9216
  v_mfma_f32_16x16x32_bf16 a[88:91], a[40:43], a[72:75], 0
  ds_read_b128 a[136:139], v12 offset:4096
  v_mfma_f32_16x16x32_bf16 a[168:171], a[40:43], a[76:79], 0
  s_add_u32 s70, s77, 18688
  ds_read_b64_tr_b16 a[108:109], v16 offset:8192
  v_mfma_f32_16x16x32_bf16 a[172:175], a[44:47], a[76:79], 0
  s_add_u32 m0, s80, 38912
  ds_read_b64_tr_b16 a[110:111], v16 offset:9216
  v_mfma_f32_16x16x32_bf16 a[92:95], a[44:47], a[72:75], 0
  buffer_load_dwordx4 v5, s[12:15], s70 offen  lds
  v_mfma_f32_16x16x32_bf16 a[236:239], a[44:47], a[68:71], 0
  ds_read_b128 a[140:143], v12 offset:6144
  v_mfma_f32_16x16x32_bf16 a[204:207], a[44:47], a[64:67], 0
  ds_read_b64_tr_b16 a[112:113], v17 offset:8192
  v_mfma_f32_16x16x32_bf16 a[208:211], a[48:51], a[64:67], 0
  s_add_u32 s70, s77, 27904
  buffer_store_dwordx4 v[96:99], v2, s[20:23], s3 offen offset:0
  v_mfma_f32_16x16x32_bf16 a[240:243], a[48:51], a[68:71], 0
  s_add_u32 m0, s80, 39936
  ds_read_b64_tr_b16 a[114:115], v17 offset:9216
  v_cvt_pk_bf16_f32 v104, v104, v105
  v_mfma_f32_16x16x32_bf16 a[144:147], a[48:51], a[72:75], 0
  buffer_load_dwordx4 v6, s[12:15], s70 offen  lds
  v_mfma_f32_16x16x32_bf16 a[176:179], a[48:51], a[76:79], 0
  ds_read_b64_tr_b16 a[116:117], v18 offset:8192
  v_cvt_pk_bf16_f32 v105, v106, v107
  v_mfma_f32_16x16x32_bf16 a[180:183], a[52:55], a[76:79], 0
  ds_read_b64_tr_b16 a[118:119], v18 offset:9216
  v_cvt_pk_bf16_f32 v106, v108, v109
  v_mfma_f32_16x16x32_bf16 a[148:151], a[52:55], a[72:75], 0
  ds_read_b64_tr_b16 a[120:121], v19 offset:8192
  v_cvt_pk_bf16_f32 v107, v110, v111
  v_mfma_f32_16x16x32_bf16 a[244:247], a[52:55], a[68:71], 0
  ds_read_b64_tr_b16 a[122:123], v19 offset:9216
  v_mfma_f32_16x16x32_bf16 a[212:215], a[52:55], a[64:67], 0
  ds_read_b64_tr_b16 a[124:125], v20 offset:8192
  v_mfma_f32_16x16x32_bf16 a[216:219], a[56:59], a[64:67], 0
  ds_read_b64_tr_b16 a[126:127], v20 offset:9216
  v_mfma_f32_16x16x32_bf16 a[248:251], a[56:59], a[68:71], 0
  v_mfma_f32_16x16x32_bf16 a[152:155], a[56:59], a[72:75], 0
  v_mfma_f32_16x16x32_bf16 a[184:187], a[56:59], a[76:79], 0
  v_mfma_f32_16x16x32_bf16 a[188:191], a[60:63], a[76:79], 0
  buffer_store_dwordx4 v[104:107], v2, s[20:23], s3 offen offset:1024
  v_mfma_f32_16x16x32_bf16 a[156:159], a[60:63], a[72:75], 0
  v_mfma_f32_16x16x32_bf16 a[252:255], a[60:63], a[68:71], 0
  s_waitcnt vmcnt(15) lgkmcnt(0)
  v_mfma_f32_16x16x32_bf16 a[220:223], a[60:63], a[64:67], 0
  s_barrier
  v_mfma_f32_16x16x32_bf16 a[192:195], a[96:99], a[128:131], a[192:195]
  s_lshl_b32 s85, s35, 20
  ds_read_b64_tr_b16 a[32:33], v13 offset:16384
  v_cvt_pk_bf16_f32 v112, v112, v113
  v_mfma_f32_16x16x32_bf16 a[224:227], a[96:99], a[132:135], a[224:227]
  s_add_u32 s70, s76, 384
  ds_read_b64_tr_b16 a[34:35], v13 offset:17408
  v_cvt_pk_bf16_f32 v113, v114, v115
  v_mfma_f32_16x16x32_bf16 a[80:83], a[96:99], a[136:139], a[80:83]
  s_add_u32 m0, s80, 65536
  ds_read_b128 a[64:67], v9 offset:0
  v_cvt_pk_bf16_f32 v114, v116, v117
  v_mfma_f32_16x16x32_bf16 a[160:163], a[96:99], a[140:143], a[160:163]
  s_lshl_b32 s84, s34, 12
  buffer_load_dwordx4 v5, s[12:15], s70 offen  lds
  v_mfma_f32_16x16x32_bf16 a[164:167], a[100:103], a[140:143], a[164:167]
  s_add_u32 s85, s85, s84
  ds_read_b64_tr_b16 a[36:37], v14 offset:16384
  v_cvt_pk_bf16_f32 v115, v118, v119
  v_mfma_f32_16x16x32_bf16 a[84:87], a[100:103], a[136:139], a[84:87]
  s_lshr_b32 s71, s34, 1
  s_lshl_b32 s71, s71, 14
  ds_read_b64_tr_b16 a[38:39], v14 offset:17408
  v_mfma_f32_16x16x32_bf16 a[228:231], a[100:103], a[132:135], a[228:231]
  s_add_u32 s70, s79, 2097152
  s_add_u32 s85, s85, s71
  ds_read_b128 a[68:71], v9 offset:2048
  v_mfma_f32_16x16x32_bf16 a[196:199], a[100:103], a[128:131], a[196:199]
  s_add_u32 m0, s81, 0
  s_add_u32 s85, s85, 40960
  ds_read_b64_tr_b16 a[40:41], v15 offset:16384
  v_mfma_f32_16x16x32_bf16 a[200:203], a[104:107], a[128:131], a[200:203]
  s_mov_b32 s87, 0x49800000
  buffer_load_dwordx4 v7, s[16:19], s70 offen  lds
  v_mfma_f32_16x16x32_bf16 a[232:235], a[104:107], a[132:135], a[232:235]
  s_mov_b32 s83, 0
  s_mov_b32 s86, 32768
  ds_read_b64_tr_b16 a[42:43], v15 offset:17408
  v_mfma_f32_16x16x32_bf16 a[88:91], a[104:107], a[136:139], a[88:91]
  ds_read_b128 a[72:75], v9 offset:4096
  v_add_u32 v3, 32768, v2
  v_mfma_f32_16x16x32_bf16 a[168:171], a[104:107], a[140:143], a[168:171]
  s_add_u32 s70, s76, 9600
  ds_read_b64_tr_b16 a[44:45], v16 offset:16384
  v_add_u32 v4, 16384, v2
  v_mfma_f32_16x16x32_bf16 a[172:175], a[108:111], a[140:143], a[172:175]
  s_add_u32 m0, s80, 66560
  buffer_store_dwordx4 v[112:115], v2, s[20:23], s3 offen offset:2048
  v_mfma_f32_16x16x32_bf16 a[92:95], a[108:111], a[136:139], a[92:95]
  buffer_load_dwordx4 v6, s[12:15], s70 offen  lds
  v_mfma_f32_16x16x32_bf16 a[236:239], a[108:111], a[132:135], a[236:239]
  ds_read_b64_tr_b16 a[46:47], v16 offset:17408
  v_cvt_pk_bf16_f32 v120, v120, v121
  v_mfma_f32_16x16x32_bf16 a[204:207], a[108:111], a[128:131], a[204:207]
  ds_read_b128 a[76:79], v9 offset:6144
  v_cvt_pk_bf16_f32 v121, v122, v123
  v_mfma_f32_16x16x32_bf16 a[208:211], a[112:115], a[128:131], a[208:211]
  s_add_u32 s70, s76, 18816
  ds_read_b64_tr_b16 a[48:49], v17 offset:16384
  v_cvt_pk_bf16_f32 v122, v124, v125
  v_mfma_f32_16x16x32_bf16 a[240:243], a[112:115], a[132:135], a[240:243]
  s_add_u32 m0, s80, 67584
  ds_read_b64_tr_b16 a[50:51], v17 offset:17408
  v_cvt_pk_bf16_f32 v123, v126, v127
  v_mfma_f32_16x16x32_bf16 a[144:147], a[112:115], a[136:139], a[144:147]
  buffer_load_dwordx4 v5, s[12:15], s70 offen  lds
  v_mfma_f32_16x16x32_bf16 a[176:179], a[112:115], a[140:143], a[176:179]
  ds_read_b64_tr_b16 a[52:53], v18 offset:16384
  v_mfma_f32_16x16x32_bf16 a[180:183], a[116:119], a[140:143], a[180:183]
  ds_read_b64_tr_b16 a[54:55], v18 offset:17408
  v_mfma_f32_16x16x32_bf16 a[148:151], a[116:119], a[136:139], a[148:151]
  s_add_u32 s70, s79, 2129920
  ds_read_b64_tr_b16 a[56:57], v19 offset:16384
  v_mfma_f32_16x16x32_bf16 a[244:247], a[116:119], a[132:135], a[244:247]
  s_add_u32 m0, s81, 1024
  ds_read_b64_tr_b16 a[58:59], v19 offset:17408
  v_mfma_f32_16x16x32_bf16 a[212:215], a[116:119], a[128:131], a[212:215]
  buffer_load_dwordx4 v7, s[16:19], s70 offen  lds
  v_mfma_f32_16x16x32_bf16 a[216:219], a[120:123], a[128:131], a[216:219]
  ds_read_b64_tr_b16 a[60:61], v20 offset:16384
  v_mfma_f32_16x16x32_bf16 a[248:251], a[120:123], a[132:135], a[248:251]
  ds_read_b64_tr_b16 a[62:63], v20 offset:17408
  v_mfma_f32_16x16x32_bf16 a[152:155], a[120:123], a[136:139], a[152:155]
  s_add_u32 s70, s76, 28032
  buffer_store_dwordx4 v[120:123], v2, s[20:23], s3 offen offset:3072
  v_mfma_f32_16x16x32_bf16 a[184:187], a[120:123], a[140:143], a[184:187]
  s_add_u32 m0, s80, 68608
  v_mfma_f32_16x16x32_bf16 a[188:191], a[124:127], a[140:143], a[188:191]
  buffer_load_dwordx4 v6, s[12:15], s70 offen  lds
  v_mfma_f32_16x16x32_bf16 a[156:159], a[124:127], a[136:139], a[156:159]
  v_mfma_f32_16x16x32_bf16 a[252:255], a[124:127], a[132:135], a[252:255]
  v_mfma_f32_16x16x32_bf16 a[220:223], a[124:127], a[128:131], a[220:223]
  s_waitcnt lgkmcnt(0)
  v_mfma_f32_16x16x32_bf16 a[192:195], a[32:35], a[64:67], a[192:195]
  s_add_u32 s3, s82, 4096
  ds_read_b64_tr_b16 a[96:97], v13 offset:24576
  v_cvt_pk_bf16_f32 v128, v128, v129
  v_mfma_f32_16x16x32_bf16 a[224:227], a[32:35], a[68:71], a[224:227]
  s_add_u32 s70, s77, 384
  ds_read_b64_tr_b16 a[98:99], v13 offset:25600
  v_cvt_pk_bf16_f32 v129, v130, v131
  v_mfma_f32_16x16x32_bf16 a[80:83], a[32:35], a[72:75], a[80:83]
  s_add_u32 m0, s80, 69632
  ds_read_b128 a[128:131], v10 offset:0
  v_cvt_pk_bf16_f32 v130, v132, v133
  v_mfma_f32_16x16x32_bf16 a[160:163], a[32:35], a[76:79], a[160:163]
  buffer_load_dwordx4 v5, s[12:15], s70 offen  lds
  v_mfma_f32_16x16x32_bf16 a[164:167], a[36:39], a[76:79], a[164:167]
  ds_read_b64_tr_b16 a[100:101], v14 offset:24576
  v_cvt_pk_bf16_f32 v131, v134, v135
  v_mfma_f32_16x16x32_bf16 a[84:87], a[36:39], a[72:75], a[84:87]
  ds_read_b64_tr_b16 a[102:103], v14 offset:25600
  v_and_b32 v21, 1, v1
  v_mfma_f32_16x16x32_bf16 a[228:231], a[36:39], a[68:71], a[228:231]
  s_add_u32 s70, s79, 2162688
  ds_read_b128 a[132:135], v10 offset:2048
  v_subrev_u32 v21, 1, v21
  v_mfma_f32_16x16x32_bf16 a[196:199], a[36:39], a[64:67], a[196:199]
  s_add_u32 m0, s81, 2048
  ds_read_b64_tr_b16 a[104:105], v15 offset:24576
  v_and_b32 v114, 0x3f803f80, v21
  v_mfma_f32_16x16x32_bf16 a[200:203], a[40:43], a[64:67], a[200:203]
  buffer_load_dwordx4 v8, s[16:19], s70 offen  lds
  v_mfma_f32_16x16x32_bf16 a[232:235], a[40:43], a[68:71], a[232:235]
  ds_read_b64_tr_b16 a[106:107], v15 offset:25600
  v_add_u32 v21, 1, v1
  v_mfma_f32_16x16x32_bf16 a[88:91], a[40:43], a[72:75], a[88:91]
  ds_read_b128 a[136:139], v10 offset:4096
  v_bfe_i32 v21, v21, 1, 1
  v_mfma_f32_16x16x32_bf16 a[168:171], a[40:43], a[76:79], a[168:171]
  s_add_u32 s70, s77, 9600
  ds_read_b64_tr_b16 a[108:109], v16 offset:24576
  v_and_b32 v115, 0x3f803f80, v21
  v_mfma_f32_16x16x32_bf16 a[172:175], a[44:47], a[76:79], a[172:175]
  s_add_u32 m0, s80, 70656
  buffer_store_dwordx4 v[128:131], v2, s[20:23], s3 offen offset:0
  v_mfma_f32_16x16x32_bf16 a[92:95], a[44:47], a[72:75], a[92:95]
  buffer_load_dwordx4 v6, s[12:15], s70 offen  lds
  v_mfma_f32_16x16x32_bf16 a[236:239], a[44:47], a[68:71], a[236:239]
  ds_read_b64_tr_b16 a[110:111], v16 offset:25600
  v_cvt_pk_bf16_f32 v136, v136, v137
  v_mfma_f32_16x16x32_bf16 a[204:207], a[44:47], a[64:67], a[204:207]
  ds_read_b128 a[140:143], v10 offset:6144
  v_cvt_pk_bf16_f32 v137, v138, v139
  v_mfma_f32_16x16x32_bf16 a[208:211], a[48:51], a[64:67], a[208:211]
  s_add_u32 s70, s77, 18816
  ds_read_b64_tr_b16 a[112:113], v17 offset:24576
  v_cvt_pk_bf16_f32 v138, v140, v141
  v_mfma_f32_16x16x32_bf16 a[240:243], a[48:51], a[68:71], a[240:243]
  s_add_u32 m0, s80, 71680
  ds_read_b64_tr_b16 a[114:115], v17 offset:25600
  v_cvt_pk_bf16_f32 v139, v142, v143
  v_mfma_f32_16x16x32_bf16 a[144:147], a[48:51], a[72:75], a[144:147]
  buffer_load_dwordx4 v5, s[12:15], s70 offen  lds
  v_mfma_f32_16x16x32_bf16 a[176:179], a[48:51], a[76:79], a[176:179]
  ds_read_b64_tr_b16 a[116:117], v18 offset:24576
  v_and_b32 v21, 15, v1
  v_mfma_f32_16x16x32_bf16 a[180:183], a[52:55], a[76:79], a[180:183]
  ds_read_b64_tr_b16 a[118:119], v18 offset:25600
  v_lshrrev_b32 v22, 4, v1
  v_mfma_f32_16x16x32_bf16 a[148:151], a[52:55], a[72:75], a[148:151]
  s_add_u32 s70, s79, 2195456
  ds_read_b64_tr_b16 a[120:121], v19 offset:24576
  v_lshlrev_b32 v22, 2, v22
  v_mfma_f32_16x16x32_bf16 a[244:247], a[52:55], a[68:71], a[244:247]
  s_add_u32 m0, s81, 3072
  ds_read_b64_tr_b16 a[122:123], v19 offset:25600
  v_sub_u32 v21, v21, v22
  v_mfma_f32_16x16x32_bf16 a[212:215], a[52:55], a[64:67], a[212:215]
  buffer_load_dwordx4 v8, s[16:19], s70 offen  lds
  v_mfma_f32_16x16x32_bf16 a[216:219], a[56:59], a[64:67], a[216:219]
  ds_read_b64_tr_b16 a[124:125], v20 offset:24576
  v_subrev_u32 v22, 0, v21
  v_mfma_f32_16x16x32_bf16 a[248:251], a[56:59], a[68:71], a[248:251]
  ds_read_b64_tr_b16 a[126:127], v20 offset:25600
  v_ashrrev_i32 v22, 31, v22
  v_mfma_f32_16x16x32_bf16 a[152:155], a[56:59], a[72:75], a[152:155]
  s_add_u32 s70, s77, 28032
  buffer_store_dwordx4 v[136:139], v2, s[20:23], s3 offen offset:1024
  v_mfma_f32_16x16x32_bf16 a[184:187], a[56:59], a[76:79], a[184:187]
  s_add_u32 m0, s80, 72704
  v_and_b32 v108, 0xff800000, v22
  v_subrev_u32 v22, 1, v21
  v_mfma_f32_16x16x32_bf16 a[188:191], a[60:63], a[76:79], a[188:191]
  buffer_load_dwordx4 v6, s[12:15], s70 offen  lds
  v_mfma_f32_16x16x32_bf16 a[156:159], a[60:63], a[72:75], a[156:159]
  v_ashrrev_i32 v22, 31, v22
  v_and_b32 v109, 0xff800000, v22
  v_mfma_f32_16x16x32_bf16 a[252:255], a[60:63], a[68:71], a[252:255]
  s_waitcnt vmcnt(17) lgkmcnt(0)
  v_mfma_f32_16x16x32_bf16 a[220:223], a[60:63], a[64:67], a[220:223]
  s_barrier
  v_mfma_f32_16x16x32_bf16 a[192:195], a[96:99], a[128:131], a[192:195]
  ds_read_b64_tr_b16 a[32:33], v13 offset:32768
  v_cvt_pk_bf16_f32 v144, v144, v145
  v_mfma_f32_16x16x32_bf16 a[224:227], a[96:99], a[132:135], a[224:227]
  s_add_u32 s70, s76, 512
  ds_read_b64_tr_b16 a[34:35], v13 offset:33792
  v_cvt_pk_bf16_f32 v145, v146, v147
  v_mfma_f32_16x16x32_bf16 a[80:83], a[96:99], a[136:139], a[80:83]
  s_add_u32 m0, s80, 0
  ds_read_b128 a[64:67], v9 offset:32768
  v_cvt_pk_bf16_f32 v146, v148, v149
  v_mfma_f32_16x16x32_bf16 a[160:163], a[96:99], a[140:143], a[160:163]
  buffer_load_dwordx4 v5, s[12:15], s70 offen  lds
  v_mfma_f32_16x16x32_bf16 a[164:167], a[100:103], a[140:143], a[164:167]
  ds_read_b64_tr_b16 a[36:37], v14 offset:32768
  v_cvt_pk_bf16_f32 v147, v150, v151
  v_mfma_f32_16x16x32_bf16 a[84:87], a[100:103], a[136:139], a[84:87]
  ds_read_b64_tr_b16 a[38:39], v14 offset:33792
  v_subrev_u32 v22, 2, v21
  v_mfma_f32_16x16x32_bf16 a[228:231], a[100:103], a[132:135], a[228:231]
  s_add_u32 s70, s79, 2621440
  ds_read_b128 a[68:71], v9 offset:34816
  v_ashrrev_i32 v22, 31, v22
  v_mfma_f32_16x16x32_bf16 a[196:199], a[100:103], a[128:131], a[196:199]
  s_add_u32 m0, s81, 16384
  ds_read_b64_tr_b16 a[40:41], v15 offset:32768
  v_and_b32 v110, 0xff800000, v22
  v_mfma_f32_16x16x32_bf16 a[200:203], a[104:107], a[128:131], a[200:203]
  buffer_load_dwordx4 v7, s[16:19], s70 offen  lds
  v_mfma_f32_16x16x32_bf16 a[232:235], a[104:107], a[132:135], a[232:235]
  ds_read_b64_tr_b16 a[42:43], v15 offset:33792
  v_subrev_u32 v22, 3, v21
  v_mfma_f32_16x16x32_bf16 a[88:91], a[104:107], a[136:139], a[88:91]
  ds_read_b128 a[72:75], v9 offset:36864
  v_ashrrev_i32 v22, 31, v22
  v_mfma_f32_16x16x32_bf16 a[168:171], a[104:107], a[140:143], a[168:171]
  s_add_u32 s70, s76, 9728
  ds_read_b64_tr_b16 a[44:45], v16 offset:32768
  v_and_b32 v111, 0xff800000, v22
  v_mfma_f32_16x16x32_bf16 a[172:175], a[108:111], a[140:143], a[172:175]
  s_add_u32 m0, s80, 1024
  buffer_store_dwordx4 v[144:147], v2, s[20:23], s3 offen offset:2048
  v_mfma_f32_16x16x32_bf16 a[92:95], a[108:111], a[136:139], a[92:95]
  buffer_load_dwordx4 v6, s[12:15], s70 offen  lds
  v_mfma_f32_16x16x32_bf16 a[236:239], a[108:111], a[132:135], a[236:239]
  ds_read_b64_tr_b16 a[46:47], v16 offset:33792
  v_cvt_pk_bf16_f32 v152, v152, v153
  v_mfma_f32_16x16x32_bf16 a[204:207], a[108:111], a[128:131], a[204:207]
  ds_read_b128 a[76:79], v9 offset:38912
  v_cvt_pk_bf16_f32 v153, v154, v155
  v_mfma_f32_16x16x32_bf16 a[208:211], a[112:115], a[128:131], a[208:211]
  s_add_u32 s70, s76, 18944
  ds_read_b64_tr_b16 a[48:49], v17 offset:32768
  v_cvt_pk_bf16_f32 v154, v156, v157
  v_mfma_f32_16x16x32_bf16 a[240:243], a[112:115], a[132:135], a[240:243]
  s_add_u32 m0, s80, 2048
  ds_read_b64_tr_b16 a[50:51], v17 offset:33792
  v_cvt_pk_bf16_f32 v155, v158, v159
  v_mfma_f32_16x16x32_bf16 a[144:147], a[112:115], a[136:139], a[144:147]
  buffer_load_dwordx4 v5, s[12:15], s70 offen  lds
  v_mfma_f32_16x16x32_bf16 a[176:179], a[112:115], a[140:143], a[176:179]
  ds_read_b64_tr_b16 a[52:53], v18 offset:32768
  v_mov_b32 v96, 0
  v_mfma_f32_16x16x32_bf16 a[180:183], a[116:119], a[140:143], a[180:183]
  ds_read_b64_tr_b16 a[54:55], v18 offset:33792
  v_mov_b32 v97, 0
  v_mfma_f32_16x16x32_bf16 a[148:151], a[116:119], a[136:139], a[148:151]
  s_add_u32 s70, s79, 2654208
  ds_read_b64_tr_b16 a[56:57], v19 offset:32768
  v_mov_b32 v98, 0
  v_mfma_f32_16x16x32_bf16 a[244:247], a[116:119], a[132:135], a[244:247]
  s_add_u32 m0, s81, 17408
  ds_read_b64_tr_b16 a[58:59], v19 offset:33792
  v_mov_b32 v99, 0
  v_mfma_f32_16x16x32_bf16 a[212:215], a[116:119], a[128:131], a[212:215]
  buffer_load_dwordx4 v7, s[16:19], s70 offen  lds
  v_mfma_f32_16x16x32_bf16 a[216:219], a[120:123], a[128:131], a[216:219]
  ds_read_b64_tr_b16 a[60:61], v20 offset:32768
  v_mov_b32 v100, 0
  v_mfma_f32_16x16x32_bf16 a[248:251], a[120:123], a[132:135], a[248:251]
  ds_read_b64_tr_b16 a[62:63], v20 offset:33792
  v_mov_b32 v101, 0
  v_mfma_f32_16x16x32_bf16 a[152:155], a[120:123], a[136:139], a[152:155]
  s_add_u32 s70, s76, 28160
  buffer_store_dwordx4 v[152:155], v2, s[20:23], s3 offen offset:3072
  v_mfma_f32_16x16x32_bf16 a[184:187], a[120:123], a[140:143], a[184:187]
  s_add_u32 m0, s80, 3072
  v_mov_b32 v102, 0
  v_mov_b32 v103, 0
  v_mfma_f32_16x16x32_bf16 a[188:191], a[124:127], a[140:143], a[188:191]
  buffer_load_dwordx4 v6, s[12:15], s70 offen  lds
  v_mfma_f32_16x16x32_bf16 a[156:159], a[124:127], a[136:139], a[156:159]
  v_mov_b32 v104, 0
  v_mov_b32 v105, 0
  v_mfma_f32_16x16x32_bf16 a[252:255], a[124:127], a[132:135], a[252:255]
  v_mfma_f32_16x16x32_bf16 a[220:223], a[124:127], a[128:131], a[220:223]
  s_waitcnt lgkmcnt(0)
  v_mfma_f32_16x16x32_bf16 a[192:195], a[32:35], a[64:67], a[192:195]
  s_add_u32 s3, s82, 262144
  ds_read_b64_tr_b16 a[96:97], v13 offset:40960
  v_cvt_pk_bf16_f32 v160, v160, v161
  v_mfma_f32_16x16x32_bf16 a[224:227], a[32:35], a[68:71], a[224:227]
  s_add_u32 s70, s77, 512
  ds_read_b64_tr_b16 a[98:99], v13 offset:41984
  v_cvt_pk_bf16_f32 v161, v162, v163
  v_mfma_f32_16x16x32_bf16 a[80:83], a[32:35], a[72:75], a[80:83]
  s_add_u32 m0, s80, 4096
  ds_read_b128 a[128:131], v10 offset:32768
  v_cvt_pk_bf16_f32 v162, v164, v165
  v_mfma_f32_16x16x32_bf16 a[160:163], a[32:35], a[76:79], a[160:163]
  buffer_load_dwordx4 v5, s[12:15], s70 offen  lds
  v_mfma_f32_16x16x32_bf16 a[164:167], a[36:39], a[76:79], a[164:167]
  ds_read_b64_tr_b16 a[100:101], v14 offset:40960
  v_cvt_pk_bf16_f32 v163, v166, v167
  v_mfma_f32_16x16x32_bf16 a[84:87], a[36:39], a[72:75], a[84:87]
  ds_read_b64_tr_b16 a[102:103], v14 offset:41984
  v_mov_b32 v106, 0
  v_mfma_f32_16x16x32_bf16 a[228:231], a[36:39], a[68:71], a[228:231]
  s_add_u32 s70, s79, 2686976
  ds_read_b128 a[132:135], v10 offset:34816
  v_mov_b32 v107, 0
  v_mfma_f32_16x16x32_bf16 a[196:199], a[36:39], a[64:67], a[196:199]
  s_add_u32 m0, s81, 18432
  ds_read_b64_tr_b16 a[104:105], v15 offset:40960
  v_and_b32 v21, 15, v1
  v_mfma_f32_16x16x32_bf16 a[200:203], a[40:43], a[64:67], a[200:203]
  buffer_load_dwordx4 v8, s[16:19], s70 offen  lds
  v_mfma_f32_16x16x32_bf16 a[232:235], a[40:43], a[68:71], a[232:235]
  ds_read_b64_tr_b16 a[106:107], v15 offset:41984
  v_lshlrev_b32 v21, 8, v21
  v_mfma_f32_16x16x32_bf16 a[88:91], a[40:43], a[72:75], a[88:91]
  ds_read_b128 a[136:139], v10 offset:36864
  v_bfe_u32 v22, v1, 4, 1
  v_mfma_f32_16x16x32_bf16 a[168:171], a[40:43], a[76:79], a[168:171]
  s_add_u32 s70, s77, 9728
  ds_read_b64_tr_b16 a[108:109], v16 offset:40960
  v_lshl_add_u32 v21, v22, 4, v21
  v_mfma_f32_16x16x32_bf16 a[172:175], a[44:47], a[76:79], a[172:175]
  s_add_u32 m0, s80, 5120
  s_lshl_b32 s71, s34, 5
  ds_read_b64_tr_b16 a[110:111], v16 offset:41984
  v_mfma_f32_16x16x32_bf16 a[92:95], a[44:47], a[72:75], a[92:95]
  s_bfe_u32 s72, s2, 65541
  buffer_load_dwordx4 v6, s[12:15], s70 offen  lds
  v_mfma_f32_16x16x32_bf16 a[236:239], a[44:47], a[68:71], a[236:239]
  s_lshl_b32 s72, s72, 7
  s_add_u32 s71, s71, s72
  ds_read_b128 a[140:143], v10 offset:38912
  v_mfma_f32_16x16x32_bf16 a[204:207], a[44:47], a[64:67], a[204:207]
  s_bfe_u32 s72, s2, 131075
  s_lshl_b32 s72, s72, 2
  ds_read_b64_tr_b16 a[112:113], v17 offset:40960
  v_mfma_f32_16x16x32_bf16 a[208:211], a[48:51], a[64:67], a[208:211]
  s_add_u32 s70, s77, 18944
  s_add_u32 s71, s71, s72
  ds_read_b64_tr_b16 a[114:115], v17 offset:41984
  v_mfma_f32_16x16x32_bf16 a[240:243], a[48:51], a[68:71], a[240:243]
  s_add_u32 m0, s80, 6144
  s_add_u32 s71, s71, 58195968
  ds_read_b64_tr_b16 a[116:117], v18 offset:40960
  v_mfma_f32_16x16x32_bf16 a[144:147], a[48:51], a[72:75], a[144:147]
  buffer_load_dwordx4 v5, s[12:15], s70 offen  lds
  v_mfma_f32_16x16x32_bf16 a[176:179], a[48:51], a[76:79], a[176:179]
  ds_read_b64_tr_b16 a[118:119], v18 offset:41984
  v_add_u32 v124, s71, v21
  v_mfma_f32_16x16x32_bf16 a[180:183], a[52:55], a[76:79], a[180:183]
  s_sub_u32 s33, s2, 96
  ds_read_b64_tr_b16 a[120:121], v19 offset:40960
  v_and_b32 v21, 15, v1
  v_mfma_f32_16x16x32_bf16 a[148:151], a[52:55], a[72:75], a[148:151]
  s_add_u32 s70, s79, 2719744
  ds_read_b64_tr_b16 a[122:123], v19 offset:41984
  v_lshrrev_b32 v22, 4, v1
  v_mfma_f32_16x16x32_bf16 a[244:247], a[52:55], a[68:71], a[244:247]
  s_add_u32 m0, s81, 19456
  buffer_store_dwordx4 v[160:163], v2, s[20:23], s3 offen offset:0
  v_mfma_f32_16x16x32_bf16 a[212:215], a[52:55], a[64:67], a[212:215]
  buffer_load_dwordx4 v8, s[16:19], s70 offen  lds
  v_mfma_f32_16x16x32_bf16 a[216:219], a[56:59], a[64:67], a[216:219]
  ds_read_b64_tr_b16 a[124:125], v20 offset:40960
  v_lshrrev_b32 v24, 3, v21
  v_mfma_f32_16x16x32_bf16 a[248:251], a[56:59], a[68:71], a[248:251]
  ds_read_b64_tr_b16 a[126:127], v20 offset:41984
  v_lshl_add_u32 v24, v24, 2, v22
  v_mfma_f32_16x16x32_bf16 a[152:155], a[56:59], a[72:75], a[152:155]
  s_add_u32 s70, s77, 28160
  v_and_b32 v25, 7, v21
  v_mul_u32_u24 v26, 36864, v24
  v_mfma_f32_16x16x32_bf16 a[184:187], a[56:59], a[76:79], a[184:187]
  s_add_u32 m0, s80, 7168
  v_lshl_add_u32 v26, v25, 4, v26
  v_lshlrev_b32 v29, 3, v24
  v_mfma_f32_16x16x32_bf16 a[188:191], a[60:63], a[76:79], a[188:191]
  buffer_load_dwordx4 v6, s[12:15], s70 offen  lds
  v_mfma_f32_16x16x32_bf16 a[156:159], a[60:63], a[72:75], a[156:159]
  v_mul_u32_u24 v28, 1152, v24
  v_lshl_add_u32 v28, v25, 4, v28
  v_mfma_f32_16x16x32_bf16 a[252:255], a[60:63], a[68:71], a[252:255]
  s_waitcnt vmcnt(8) lgkmcnt(0)
  v_mfma_f32_16x16x32_bf16 a[220:223], a[60:63], a[64:67], a[220:223]
  s_barrier
  v_mfma_f32_16x16x32_bf16 a[192:195], a[96:99], a[128:131], a[192:195]
  ds_read_b64_tr_b16 a[32:33], v13 offset:49152
  v_cvt_pk_bf16_f32 v168, v168, v169
  v_mfma_f32_16x16x32_bf16 a[224:227], a[96:99], a[132:135], a[224:227]
  s_add_u32 s70, s76, 640
  ds_read_b64_tr_b16 a[34:35], v13 offset:50176
  v_cvt_pk_bf16_f32 v169, v170, v171
  v_mfma_f32_16x16x32_bf16 a[80:83], a[96:99], a[136:139], a[80:83]
  s_add_u32 m0, s80, 32768
  ds_read_b128 a[64:67], v11 offset:0
  v_cvt_pk_bf16_f32 v170, v172, v173
  v_mfma_f32_16x16x32_bf16 a[160:163], a[96:99], a[140:143], a[160:163]
  buffer_load_dwordx4 v5, s[12:15], s70 offen  lds
  v_mfma_f32_16x16x32_bf16 a[164:167], a[100:103], a[140:143], a[164:167]
  ds_read_b64_tr_b16 a[36:37], v14 offset:49152
  v_cvt_pk_bf16_f32 v171, v174, v175
  v_mfma_f32_16x16x32_bf16 a[84:87], a[100:103], a[136:139], a[84:87]
  ds_read_b64_tr_b16 a[38:39], v14 offset:50176
  v_lshrrev_b32 v24, 3, v21
  v_mfma_f32_16x16x32_bf16 a[228:231], a[100:103], a[132:135], a[228:231]
  s_add_u32 s70, s79, 3145728
  ds_read_b128 a[68:71], v11 offset:2048
  v_mul_u32_u24 v27, 18432, v24
  v_mfma_f32_16x16x32_bf16 a[196:199], a[100:103], a[128:131], a[196:199]
  s_add_u32 m0, s81, 32768
  ds_read_b64_tr_b16 a[40:41], v15 offset:49152
  v_lshl_add_u32 v27, v25, 5, v27
  v_mfma_f32_16x16x32_bf16 a[200:203], a[104:107], a[128:131], a[200:203]
  buffer_load_dwordx4 v7, s[16:19], s70 offen  lds
  v_mfma_f32_16x16x32_bf16 a[232:235], a[104:107], a[132:135], a[232:235]
  ds_read_b64_tr_b16 a[42:43], v15 offset:50176
  v_and_b32 v24, 1, v22
  v_mfma_f32_16x16x32_bf16 a[88:91], a[104:107], a[136:139], a[88:91]
  ds_read_b128 a[72:75], v11 offset:4096
  v_lshl_add_u32 v27, v24, 4, v27
  s_cmp_lt_u32 s34, 2
  s_cselect_b32 s24, s56, s58
  s_cselect_b32 s25, s57, s59
  v_mfma_f32_16x16x32_bf16 a[168:171], a[104:107], a[140:143], a[168:171]
  s_add_u32 s70, s76, 9856
  s_mov_b32 s26, 5308416
  ds_read_b64_tr_b16 a[44:45], v16 offset:49152
  v_mfma_f32_16x16x32_bf16 a[172:175], a[108:111], a[140:143], a[172:175]
  s_add_u32 m0, s80, 33792
  s_lshr_b32 s97, s33, 3
  ds_read_b64_tr_b16 a[46:47], v16 offset:50176
  v_mfma_f32_16x16x32_bf16 a[92:95], a[108:111], a[136:139], a[92:95]
  s_and_b32 s71, s33, 7
  buffer_load_dwordx4 v6, s[12:15], s70 offen  lds
  v_mfma_f32_16x16x32_bf16 a[236:239], a[108:111], a[132:135], a[236:239]
  s_and_b32 s72, s34, 1
  s_mul_i32 s74, s97, 294912
  ds_read_b128 a[76:79], v11 offset:6144
  v_mfma_f32_16x16x32_bf16 a[204:207], a[108:111], a[128:131], a[204:207]
  s_mul_i32 s73, s71, 1152
  s_add_u32 s74, s74, s73
  ds_read_b64_tr_b16 a[48:49], v17 offset:49152
  v_mfma_f32_16x16x32_bf16 a[208:211], a[112:115], a[128:131], a[208:211]
  s_add_u32 s70, s76, 19072
  s_mul_i32 s73, s72, 640
  ds_read_b64_tr_b16 a[50:51], v17 offset:50176
  v_mfma_f32_16x16x32_bf16 a[240:243], a[112:115], a[132:135], a[240:243]
  s_add_u32 m0, s80, 34816
  s_add_u32 s74, s74, s73
  ds_read_b64_tr_b16 a[52:53], v18 offset:49152
  v_mfma_f32_16x16x32_bf16 a[144:147], a[112:115], a[136:139], a[144:147]
  s_lshl_b32 s0, s97, 6
  buffer_load_dwordx4 v5, s[12:15], s70 offen  lds
  v_mfma_f32_16x16x32_bf16 a[176:179], a[112:115], a[140:143], a[176:179]
  s_lshr_b32 s78, s34, 1
  s_mul_i32 s78, s78, 18
  ds_read_b64_tr_b16 a[54:55], v18 offset:50176
  v_mfma_f32_16x16x32_bf16 a[180:183], a[116:119], a[140:143], a[180:183]
  s_add_u32 s78, s78, s97
  s_mul_i32 s78, s78, 36864
  ds_read_b64_tr_b16 a[56:57], v19 offset:49152
  v_mfma_f32_16x16x32_bf16 a[148:151], a[116:119], a[136:139], a[148:151]
  s_add_u32 s70, s79, 3178496
  s_mul_i32 s71, s71, 2304
  ds_read_b64_tr_b16 a[58:59], v19 offset:50176
  v_mfma_f32_16x16x32_bf16 a[244:247], a[116:119], a[132:135], a[244:247]
  s_add_u32 m0, s81, 33792
  buffer_store_dwordx4 v[168:171], v2, s[20:23], s3 offen offset:1024
  v_mfma_f32_16x16x32_bf16 a[212:215], a[116:119], a[128:131], a[212:215]
  s_add_u32 s78, s78, s71
  buffer_load_dwordx4 v7, s[16:19], s70 offen  lds
  v_mfma_f32_16x16x32_bf16 a[216:219], a[120:123], a[128:131], a[216:219]
  s_mul_i32 s72, s72, 1280
  s_add_u32 s78, s78, s72
  ds_read_b64_tr_b16 a[60:61], v20 offset:49152
  v_mfma_f32_16x16x32_bf16 a[248:251], a[120:123], a[132:135], a[248:251]
  s_add_u32 s78, s78, 65011712
  s_mov_b32 s28, s60
  ds_read_b64_tr_b16 a[62:63], v20 offset:50176
  v_mfma_f32_16x16x32_bf16 a[152:155], a[120:123], a[136:139], a[152:155]
  s_add_u32 s70, s76, 28288
  s_mov_b32 s29, s61
  s_mov_b32 s30, 5308416
  v_mfma_f32_16x16x32_bf16 a[184:187], a[120:123], a[140:143], a[184:187]
  s_add_u32 m0, s80, 35840
  s_mul_i32 s1, s33, 36864
  s_lshl_b32 s75, s34, 7
  v_mfma_f32_16x16x32_bf16 a[188:191], a[124:127], a[140:143], a[188:191]
  s_add_u32 s75, s75, s1
  buffer_load_dwordx4 v6, s[12:15], s70 offen  lds
  v_mfma_f32_16x16x32_bf16 a[156:159], a[124:127], a[136:139], a[156:159]
  s_add_u32 s1, s1, 1024
  s_add_u32 s71, s74, 512
  s_bitcmp1_b32 s34, 0
  s_cselect_b32 s4, s60, s24
  s_cselect_b32 s5, s61, s25
  v_mfma_f32_16x16x32_bf16 a[252:255], a[124:127], a[132:135], a[252:255]
  v_mfma_f32_16x16x32_bf16 a[220:223], a[124:127], a[128:131], a[220:223]
  s_waitcnt lgkmcnt(0)
  v_mfma_f32_16x16x32_bf16 a[192:195], a[32:35], a[64:67], a[192:195]
  ds_read_b64_tr_b16 a[96:97], v13 offset:57344
  v_cvt_pk_bf16_f32 v176, v176, v177
  s_bitcmp1_b32 s34, 0
  s_cselect_b32 s1, s1, s71
  s_cselect_b64 vcc, -1, 0
  v_mfma_f32_16x16x32_bf16 a[224:227], a[32:35], a[68:71], a[224:227]
  s_add_u32 s70, s77, 640
  ds_read_b64_tr_b16 a[98:99], v13 offset:58368
  v_cvt_pk_bf16_f32 v177, v178, v179
  v_mfma_f32_16x16x32_bf16 a[80:83], a[32:35], a[72:75], a[80:83]
  s_add_u32 m0, s80, 36864
  ds_read_b128 a[128:131], v12 offset:0
  v_cvt_pk_bf16_f32 v178, v180, v181
  v_mfma_f32_16x16x32_bf16 a[160:163], a[32:35], a[76:79], a[160:163]
  s_mov_b32 s6, 5308416
  buffer_load_dwordx4 v5, s[12:15], s70 offen  lds
  v_mfma_f32_16x16x32_bf16 a[164:167], a[36:39], a[76:79], a[164:167]
  ds_read_b64_tr_b16 a[100:101], v14 offset:57344
  v_cvt_pk_bf16_f32 v179, v182, v183
  v_mfma_f32_16x16x32_bf16 a[84:87], a[36:39], a[72:75], a[84:87]
  ds_read_b64_tr_b16 a[102:103], v14 offset:58368
  v_cndmask_b32 v112, v26, v28, vcc
  v_mfma_f32_16x16x32_bf16 a[228:231], a[36:39], a[68:71], a[228:231]
  s_add_u32 s70, s79, 3211264
  ds_read_b128 a[132:135], v12 offset:2048
  v_and_b32 v24, 1, v21
  v_mfma_f32_16x16x32_bf16 a[196:199], a[36:39], a[64:67], a[196:199]
  s_add_u32 m0, s81, 34816
  ds_read_b64_tr_b16 a[104:105], v15 offset:57344
  v_lshlrev_b32 v24, 4, v24
  v_mfma_f32_16x16x32_bf16 a[200:203], a[40:43], a[64:67], a[200:203]
  buffer_load_dwordx4 v8, s[16:19], s70 offen  lds
  v_mfma_f32_16x16x32_bf16 a[232:235], a[40:43], a[68:71], a[232:235]
  ds_read_b64_tr_b16 a[106:107], v15 offset:58368
  v_mov_b32 v25, 0xffff
  v_mfma_f32_16x16x32_bf16 a[88:91], a[40:43], a[72:75], a[88:91]
  ds_read_b128 a[136:139], v12 offset:4096
  v_lshlrev_b32 v24, v24, v25
  v_mfma_f32_16x16x32_bf16 a[168:171], a[40:43], a[76:79], a[168:171]
  s_add_u32 s70, s77, 9856
  ds_read_b64_tr_b16 a[108:109], v16 offset:57344
  v_bfe_u32 v25, v21, 1, 2
  v_mfma_f32_16x16x32_bf16 a[172:175], a[44:47], a[76:79], a[172:175]
  s_add_u32 m0, s80, 37888
  ds_read_b64_tr_b16 a[110:111], v16 offset:58368
  v_cmp_eq_u32 vcc, 0, v25
  v_mfma_f32_16x16x32_bf16 a[92:95], a[44:47], a[72:75], a[92:95]
  buffer_load_dwordx4 v6, s[12:15], s70 offen  lds
  v_mfma_f32_16x16x32_bf16 a[236:239], a[44:47], a[68:71], a[236:239]
  s_nop 1
  ds_read_b128 a[140:143], v12 offset:6144
  v_mfma_f32_16x16x32_bf16 a[204:207], a[44:47], a[64:67], a[204:207]
  ds_read_b64_tr_b16 a[112:113], v17 offset:57344
  v_cndmask_b32 v120, 0, v24, vcc
  v_mfma_f32_16x16x32_bf16 a[208:211], a[48:51], a[64:67], a[208:211]
  s_add_u32 s70, s77, 19072
  ds_read_b64_tr_b16 a[114:115], v17 offset:58368
  v_cmp_eq_u32 vcc, 1, v25
  v_mfma_f32_16x16x32_bf16 a[240:243], a[48:51], a[68:71], a[240:243]
  s_add_u32 m0, s80, 38912
  ds_read_b64_tr_b16 a[116:117], v18 offset:57344
  v_mfma_f32_16x16x32_bf16 a[144:147], a[48:51], a[72:75], a[144:147]
  buffer_load_dwordx4 v5, s[12:15], s70 offen  lds
  v_mfma_f32_16x16x32_bf16 a[176:179], a[48:51], a[76:79], a[176:179]
  s_nop 1
  ds_read_b64_tr_b16 a[118:119], v18 offset:58368
  v_mfma_f32_16x16x32_bf16 a[180:183], a[52:55], a[76:79], a[180:183]
  ds_read_b64_tr_b16 a[120:121], v19 offset:57344
  v_cndmask_b32 v121, 0, v24, vcc
  v_mfma_f32_16x16x32_bf16 a[148:151], a[52:55], a[72:75], a[148:151]
  s_add_u32 s70, s79, 3244032
  ds_read_b64_tr_b16 a[122:123], v19 offset:58368
  v_cmp_eq_u32 vcc, 2, v25
  v_mfma_f32_16x16x32_bf16 a[244:247], a[52:55], a[68:71], a[244:247]
  s_add_u32 m0, s81, 35840
  buffer_store_dwordx4 v[176:179], v2, s[20:23], s3 offen offset:2048
  v_mfma_f32_16x16x32_bf16 a[212:215], a[52:55], a[64:67], a[212:215]
  buffer_load_dwordx4 v8, s[16:19], s70 offen  lds
  v_mfma_f32_16x16x32_bf16 a[216:219], a[56:59], a[64:67], a[216:219]
  s_nop 1
  ds_read_b64_tr_b16 a[124:125], v20 offset:57344
  v_mfma_f32_16x16x32_bf16 a[248:251], a[56:59], a[68:71], a[248:251]
  ds_read_b64_tr_b16 a[126:127], v20 offset:58368
  v_cndmask_b32 v122, 0, v24, vcc
  v_mfma_f32_16x16x32_bf16 a[152:155], a[56:59], a[72:75], a[152:155]
  s_add_u32 s70, s77, 28288
  v_cmp_eq_u32 vcc, 3, v25
  v_mfma_f32_16x16x32_bf16 a[184:187], a[56:59], a[76:79], a[184:187]
  s_add_u32 m0, s80, 39936
  s_nop 1
  v_mfma_f32_16x16x32_bf16 a[188:191], a[60:63], a[76:79], a[188:191]
  buffer_load_dwordx4 v6, s[12:15], s70 offen  lds
  v_mfma_f32_16x16x32_bf16 a[156:159], a[60:63], a[72:75], a[156:159]
  v_cndmask_b32 v123, 0, v24, vcc
  v_mfma_f32_16x16x32_bf16 a[252:255], a[60:63], a[68:71], a[252:255]
  s_waitcnt vmcnt(14) lgkmcnt(0)
  v_mfma_f32_16x16x32_bf16 a[220:223], a[60:63], a[64:67], a[220:223]
  s_barrier
  v_mfma_f32_16x16x32_bf16 a[192:195], a[96:99], a[128:131], a[192:195]
  s_mul_i32 s97, s33, 3641
  ds_read_b64_tr_b16 a[32:33], v13 offset:0
  v_cvt_pk_bf16_f32 v184, v184, v185
  v_mfma_f32_16x16x32_bf16 a[224:227], a[96:99], a[132:135], a[224:227]
  s_add_u32 s70, s76, 768
  ds_read_b64_tr_b16 a[34:35], v13 offset:1024
  v_cvt_pk_bf16_f32 v185, v186, v187
  v_mfma_f32_16x16x32_bf16 a[80:83], a[96:99], a[136:139], a[80:83]
  s_add_u32 m0, s80, 65536
  ds_read_b128 a[64:67], v9 offset:0
  v_cvt_pk_bf16_f32 v186, v188, v189
  v_mfma_f32_16x16x32_bf16 a[160:163], a[96:99], a[140:143], a[160:163]
  s_lshr_b32 s97, s97, 16
  buffer_load_dwordx4 v5, s[12:15], s70 offen  lds
  v_mfma_f32_16x16x32_bf16 a[164:167], a[100:103], a[140:143], a[164:167]
  s_add_u32 s97, s97, 96
  ds_read_b64_tr_b16 a[36:37], v14 offset:0
  v_cvt_pk_bf16_f32 v187, v190, v191
  v_mfma_f32_16x16x32_bf16 a[84:87], a[100:103], a[136:139], a[84:87]
  s_lshl_b32 s97, s97, 4
  ds_read_b64_tr_b16 a[38:39], v14 offset:1024
  v_min_u32 v24, 17, v1
  v_mfma_f32_16x16x32_bf16 a[228:231], a[100:103], a[132:135], a[228:231]
  s_add_u32 s70, s79, 3670016
  ds_read_b128 a[68:71], v9 offset:2048
  v_lshlrev_b32 v24, 7, v24
  v_mfma_f32_16x16x32_bf16 a[196:199], a[100:103], a[128:131], a[196:199]
  s_add_u32 m0, s81, 49152
  ds_read_b64_tr_b16 a[40:41], v15 offset:0
  v_add_u32 v126, s97, v24
  v_mfma_f32_16x16x32_bf16 a[200:203], a[104:107], a[128:131], a[200:203]
  buffer_load_dwordx4 v7, s[16:19], s70 offen  lds
  v_mfma_f32_16x16x32_bf16 a[232:235], a[104:107], a[132:135], a[232:235]
  ds_read_b64_tr_b16 a[42:43], v15 offset:1024
  v_mov_b32 v25, v112
  v_mfma_f32_16x16x32_bf16 a[88:91], a[104:107], a[136:139], a[88:91]
  ds_read_b128 a[72:75], v9 offset:4096
  v_cmp_ne_u32 vcc, s101, v23
  s_cbranch_vccnz L_wb_8
L_back_9:
  v_mfma_f32_16x16x32_bf16 a[168:171], a[104:107], a[140:143], a[168:171]
  s_add_u32 s70, s76, 9984
  s_add_u32 s71, s100, 0
  ds_read_b64_tr_b16 a[44:45], v16 offset:0
  v_mfma_f32_16x16x32_bf16 a[172:175], a[108:111], a[140:143], a[172:175]
  s_add_u32 m0, s80, 66560
  ds_read_b64_tr_b16 a[46:47], v16 offset:1024
  v_mov_b32 v30, 1
  v_mfma_f32_16x16x32_bf16 a[92:95], a[108:111], a[136:139], a[92:95]
  buffer_load_dwordx4 v6, s[12:15], s70 offen  lds
  v_mfma_f32_16x16x32_bf16 a[236:239], a[108:111], a[132:135], a[236:239]
  ds_read_b128 a[76:79], v9 offset:6144
  v_mfma_f32_16x16x32_bf16 a[204:207], a[108:111], a[128:131], a[204:207]
  ds_read_b64_tr_b16 a[48:49], v17 offset:0
  v_mfma_f32_16x16x32_bf16 a[208:211], a[112:115], a[128:131], a[208:211]
  s_add_u32 s70, s76, 19200
  ds_read_b64_tr_b16 a[50:51], v17 offset:1024
  v_mfma_f32_16x16x32_bf16 a[240:243], a[112:115], a[132:135], a[240:243]
  s_add_u32 m0, s80, 67584
  ds_read_b64_tr_b16 a[52:53], v18 offset:0
  v_mfma_f32_16x16x32_bf16 a[144:147], a[112:115], a[136:139], a[144:147]
  buffer_load_dwordx4 v5, s[12:15], s70 offen  lds
  v_mfma_f32_16x16x32_bf16 a[176:179], a[112:115], a[140:143], a[176:179]
  ds_read_b64_tr_b16 a[54:55], v18 offset:1024
  v_mfma_f32_16x16x32_bf16 a[180:183], a[116:119], a[140:143], a[180:183]
  ds_read_b64_tr_b16 a[56:57], v19 offset:0
  v_mfma_f32_16x16x32_bf16 a[148:151], a[116:119], a[136:139], a[148:151]
  s_add_u32 s70, s79, 3702784
  ds_read_b64_tr_b16 a[58:59], v19 offset:1024
  v_mfma_f32_16x16x32_bf16 a[244:247], a[116:119], a[132:135], a[244:247]
  s_add_u32 m0, s81, 50176
  buffer_store_dwordx4 v[184:187], v2, s[20:23], s3 offen offset:3072
  v_mfma_f32_16x16x32_bf16 a[212:215], a[116:119], a[128:131], a[212:215]
  buffer_load_dwordx4 v7, s[16:19], s70 offen  lds
  v_mfma_f32_16x16x32_bf16 a[216:219], a[120:123], a[128:131], a[216:219]
  ds_read_b64_tr_b16 a[60:61], v20 offset:0
  v_mfma_f32_16x16x32_bf16 a[248:251], a[120:123], a[132:135], a[248:251]
  ds_read_b64_tr_b16 a[62:63], v20 offset:1024
  v_mfma_f32_16x16x32_bf16 a[152:155], a[120:123], a[136:139], a[152:155]
  s_add_u32 s70, s76, 28416
  s_mov_b64 exec, 1
  buffer_store_dword v30, off, s[20:23], s71 sc1
  s_mov_b64 exec, -1
  v_mfma_f32_16x16x32_bf16 a[184:187], a[120:123], a[140:143], a[184:187]
  s_add_u32 m0, s80, 68608
  v_mov_b32 v128, 0
  v_mov_b32 v129, 0
  v_mfma_f32_16x16x32_bf16 a[188:191], a[124:127], a[140:143], a[188:191]
  buffer_load_dwordx4 v6, s[12:15], s70 offen  lds
  v_mfma_f32_16x16x32_bf16 a[156:159], a[124:127], a[136:139], a[156:159]
  v_mov_b32 v130, 0
  v_mov_b32 v131, 0
  v_mfma_f32_16x16x32_bf16 a[252:255], a[124:127], a[132:135], a[252:255]
  v_mfma_f32_16x16x32_bf16 a[220:223], a[124:127], a[128:131], a[220:223]
  s_waitcnt lgkmcnt(0)
  v_mfma_f32_16x16x32_bf16 a[192:195], a[32:35], a[64:67], a[192:195]
  s_add_u32 s3, s82, 266240
  ds_read_b64_tr_b16 a[96:97], v13 offset:8192
  v_cvt_pk_bf16_f32 v192, v192, v193
  v_mfma_f32_16x16x32_bf16 a[224:227], a[32:35], a[68:71], a[224:227]
  s_add_u32 s70, s77, 768
  ds_read_b64_tr_b16 a[98:99], v13 offset:9216
  v_cvt_pk_bf16_f32 v193, v194, v195
  v_mfma_f32_16x16x32_bf16 a[80:83], a[32:35], a[72:75], a[80:83]
  s_add_u32 m0, s80, 69632
  ds_read_b128 a[128:131], v10 offset:0
  v_cvt_pk_bf16_f32 v194, v196, v197
  v_mfma_f32_16x16x32_bf16 a[160:163], a[32:35], a[76:79], a[160:163]
  buffer_load_dwordx4 v5, s[12:15], s70 offen  lds
  v_mfma_f32_16x16x32_bf16 a[164:167], a[36:39], a[76:79], a[164:167]
  ds_read_b64_tr_b16 a[100:101], v14 offset:8192
  v_cvt_pk_bf16_f32 v195, v198, v199
  v_mfma_f32_16x16x32_bf16 a[84:87], a[36:39], a[72:75], a[84:87]
  ds_read_b64_tr_b16 a[102:103], v14 offset:9216
  v_mov_b32 v132, 0
  v_mfma_f32_16x16x32_bf16 a[228:231], a[36:39], a[68:71], a[228:231]
  s_add_u32 s70, s79, 3735552
  ds_read_b128 a[132:135], v10 offset:2048
  v_mov_b32 v133, 0
  v_mfma_f32_16x16x32_bf16 a[196:199], a[36:39], a[64:67], a[196:199]
  s_add_u32 m0, s81, 51200
  ds_read_b64_tr_b16 a[104:105], v15 offset:8192
  v_mov_b32 v134, 0
  v_mfma_f32_16x16x32_bf16 a[200:203], a[40:43], a[64:67], a[200:203]
  buffer_load_dwordx4 v8, s[16:19], s70 offen  lds
  v_mfma_f32_16x16x32_bf16 a[232:235], a[40:43], a[68:71], a[232:235]
  ds_read_b64_tr_b16 a[106:107], v15 offset:9216
  v_mov_b32 v135, 0
  v_mfma_f32_16x16x32_bf16 a[88:91], a[40:43], a[72:75], a[88:91]
  ds_read_b128 a[136:139], v10 offset:4096
  v_mov_b32 v136, 0
  v_mfma_f32_16x16x32_bf16 a[168:171], a[40:43], a[76:79], a[168:171]
  s_add_u32 s70, s77, 9984
  ds_read_b64_tr_b16 a[108:109], v16 offset:8192
  v_mov_b32 v137, 0
  v_mfma_f32_16x16x32_bf16 a[172:175], a[44:47], a[76:79], a[172:175]
  s_add_u32 m0, s80, 70656
  buffer_store_dwordx4 v[192:195], v2, s[20:23], s3 offen offset:0
  v_mfma_f32_16x16x32_bf16 a[92:95], a[44:47], a[72:75], a[92:95]
  buffer_load_dwordx4 v6, s[12:15], s70 offen  lds
  v_mfma_f32_16x16x32_bf16 a[236:239], a[44:47], a[68:71], a[236:239]
  ds_read_b64_tr_b16 a[110:111], v16 offset:9216
  v_cvt_pk_bf16_f32 v200, v200, v201
  v_mfma_f32_16x16x32_bf16 a[204:207], a[44:47], a[64:67], a[204:207]
  ds_read_b128 a[140:143], v10 offset:6144
  v_cvt_pk_bf16_f32 v201, v202, v203
  v_mfma_f32_16x16x32_bf16 a[208:211], a[48:51], a[64:67], a[208:211]
  s_add_u32 s70, s77, 19200
  ds_read_b64_tr_b16 a[112:113], v17 offset:8192
  v_cvt_pk_bf16_f32 v202, v204, v205
  v_mfma_f32_16x16x32_bf16 a[240:243], a[48:51], a[68:71], a[240:243]
  s_add_u32 m0, s80, 71680
  ds_read_b64_tr_b16 a[114:115], v17 offset:9216
  v_cvt_pk_bf16_f32 v203, v206, v207
  v_mfma_f32_16x16x32_bf16 a[144:147], a[48:51], a[72:75], a[144:147]
  buffer_load_dwordx4 v5, s[12:15], s70 offen  lds
  v_mfma_f32_16x16x32_bf16 a[176:179], a[48:51], a[76:79], a[176:179]
  ds_read_b64_tr_b16 a[116:117], v18 offset:8192
  v_mov_b32 v138, 0
  v_mfma_f32_16x16x32_bf16 a[180:183], a[52:55], a[76:79], a[180:183]
  ds_read_b64_tr_b16 a[118:119], v18 offset:9216
  v_mov_b32 v139, 0
  v_mfma_f32_16x16x32_bf16 a[148:151], a[52:55], a[72:75], a[148:151]
  s_add_u32 s70, s79, 3768320
  ds_read_b64_tr_b16 a[120:121], v19 offset:8192
  v_mov_b32 v140, 0
  v_mfma_f32_16x16x32_bf16 a[244:247], a[52:55], a[68:71], a[244:247]
  s_add_u32 m0, s81, 52224
  ds_read_b64_tr_b16 a[122:123], v19 offset:9216
  v_mov_b32 v141, 0
  v_mfma_f32_16x16x32_bf16 a[212:215], a[52:55], a[64:67], a[212:215]
  buffer_load_dwordx4 v8, s[16:19], s70 offen  lds
  v_mfma_f32_16x16x32_bf16 a[216:219], a[56:59], a[64:67], a[216:219]
  ds_read_b64_tr_b16 a[124:125], v20 offset:8192
  v_mov_b32 v142, 0
  v_mfma_f32_16x16x32_bf16 a[248:251], a[56:59], a[68:71], a[248:251]
  ds_read_b64_tr_b16 a[126:127], v20 offset:9216
  v_mov_b32 v143, 0
  v_mfma_f32_16x16x32_bf16 a[152:155], a[56:59], a[72:75], a[152:155]
  s_add_u32 s70, s77, 28416
  buffer_store_dwordx4 v[200:203], v2, s[20:23], s3 offen offset:1024
  v_mfma_f32_16x16x32_bf16 a[184:187], a[56:59], a[76:79], a[184:187]
  s_add_u32 m0, s80, 72704
  v_mov_b32 v144, 0
  v_mov_b32 v145, 0
  v_mfma_f32_16x16x32_bf16 a[188:191], a[60:63], a[76:79], a[188:191]
  buffer_load_dwordx4 v6, s[12:15], s70 offen  lds
  v_mfma_f32_16x16x32_bf16 a[156:159], a[60:63], a[72:75], a[156:159]
  v_mov_b32 v146, 0
  v_mov_b32 v147, 0
  v_mfma_f32_16x16x32_bf16 a[252:255], a[60:63], a[68:71], a[252:255]
  s_waitcnt vmcnt(16) lgkmcnt(0)
  v_mfma_f32_16x16x32_bf16 a[220:223], a[60:63], a[64:67], a[220:223]
  s_barrier
  v_mfma_f32_16x16x32_bf16 a[192:195], a[96:99], a[128:131], a[192:195]
  ds_read_b64_tr_b16 a[32:33], v13 offset:16384
  v_cvt_pk_bf16_f32 v208, v208, v209
  v_mfma_f32_16x16x32_bf16 a[224:227], a[96:99], a[132:135], a[224:227]
  s_add_u32 s70, s76, 896
  ds_read_b64_tr_b16 a[34:35], v13 offset:17408
  v_cvt_pk_bf16_f32 v209, v210, v211
  v_mfma_f32_16x16x32_bf16 a[80:83], a[96:99], a[136:139], a[80:83]
  s_add_u32 m0, s80, 0
  ds_read_b128 a[64:67], v9 offset:32768
  v_cvt_pk_bf16_f32 v210, v212, v213
  v_mfma_f32_16x16x32_bf16 a[160:163], a[96:99], a[140:143], a[160:163]
  buffer_load_dwordx4 v5, s[12:15], s70 offen  lds
  v_mfma_f32_16x16x32_bf16 a[164:167], a[100:103], a[140:143], a[164:167]
  ds_read_b64_tr_b16 a[36:37], v14 offset:16384
  v_cvt_pk_bf16_f32 v211, v214, v215
  v_mfma_f32_16x16x32_bf16 a[84:87], a[100:103], a[136:139], a[84:87]
  ds_read_b64_tr_b16 a[38:39], v14 offset:17408
  v_mov_b32 v148, 0
  v_mfma_f32_16x16x32_bf16 a[228:231], a[100:103], a[132:135], a[228:231]
  s_add_u32 s70, s79, 4194304
  ds_read_b128 a[68:71], v9 offset:34816
  v_mov_b32 v149, 0
  v_mfma_f32_16x16x32_bf16 a[196:199], a[100:103], a[128:131], a[196:199]
  s_add_u32 m0, s81, 0
  ds_read_b64_tr_b16 a[40:41], v15 offset:16384
  v_mov_b32 v150, 0
  v_mfma_f32_16x16x32_bf16 a[200:203], a[104:107], a[128:131], a[200:203]
  buffer_load_dwordx4 v7, s[16:19], s70 offen  lds
  v_mfma_f32_16x16x32_bf16 a[232:235], a[104:107], a[132:135], a[232:235]
  ds_read_b64_tr_b16 a[42:43], v15 offset:17408
  v_mov_b32 v151, 0
  v_mfma_f32_16x16x32_bf16 a[88:91], a[104:107], a[136:139], a[88:91]
  ds_read_b128 a[72:75], v9 offset:36864
  v_mov_b32 v152, 0
  v_mfma_f32_16x16x32_bf16 a[168:171], a[104:107], a[140:143], a[168:171]
  s_add_u32 s70, s76, 10112
  ds_read_b64_tr_b16 a[44:45], v16 offset:16384
  v_mov_b32 v153, 0
  v_mfma_f32_16x16x32_bf16 a[172:175], a[108:111], a[140:143], a[172:175]
  s_add_u32 m0, s80, 1024
  buffer_store_dwordx4 v[208:211], v2, s[20:23], s3 offen offset:2048
  v_mfma_f32_16x16x32_bf16 a[92:95], a[108:111], a[136:139], a[92:95]
  buffer_load_dwordx4 v6, s[12:15], s70 offen  lds
  v_mfma_f32_16x16x32_bf16 a[236:239], a[108:111], a[132:135], a[236:239]
  ds_read_b64_tr_b16 a[46:47], v16 offset:17408
  v_cvt_pk_bf16_f32 v216, v216, v217
  v_mfma_f32_16x16x32_bf16 a[204:207], a[108:111], a[128:131], a[204:207]
  ds_read_b128 a[76:79], v9 offset:38912
  v_cvt_pk_bf16_f32 v217, v218, v219
  v_mfma_f32_16x16x32_bf16 a[208:211], a[112:115], a[128:131], a[208:211]
  s_add_u32 s70, s76, 19328
  ds_read_b64_tr_b16 a[48:49], v17 offset:16384
  v_cvt_pk_bf16_f32 v218, v220, v221
  v_mfma_f32_16x16x32_bf16 a[240:243], a[112:115], a[132:135], a[240:243]
  s_add_u32 m0, s80, 2048
  ds_read_b64_tr_b16 a[50:51], v17 offset:17408
  v_cvt_pk_bf16_f32 v219, v222, v223
  v_mfma_f32_16x16x32_bf16 a[144:147], a[112:115], a[136:139], a[144:147]
  buffer_load_dwordx4 v5, s[12:15], s70 offen  lds
  v_mfma_f32_16x16x32_bf16 a[176:179], a[112:115], a[140:143], a[176:179]
  ds_read_b64_tr_b16 a[52:53], v18 offset:16384
  v_mov_b32 v154, 0
  v_mfma_f32_16x16x32_bf16 a[180:183], a[116:119], a[140:143], a[180:183]
  ds_read_b64_tr_b16 a[54:55], v18 offset:17408
  v_mov_b32 v155, 0
  v_mfma_f32_16x16x32_bf16 a[148:151], a[116:119], a[136:139], a[148:151]
  s_add_u32 s70, s79, 4227072
  ds_read_b64_tr_b16 a[56:57], v19 offset:16384
  v_mov_b32 v156, 0
  v_mfma_f32_16x16x32_bf16 a[244:247], a[116:119], a[132:135], a[244:247]
  s_add_u32 m0, s81, 1024
  ds_read_b64_tr_b16 a[58:59], v19 offset:17408
  v_mov_b32 v157, 0
  v_mfma_f32_16x16x32_bf16 a[212:215], a[116:119], a[128:131], a[212:215]
  buffer_load_dwordx4 v7, s[16:19], s70 offen  lds
  v_mfma_f32_16x16x32_bf16 a[216:219], a[120:123], a[128:131], a[216:219]
  ds_read_b64_tr_b16 a[60:61], v20 offset:16384
  v_mov_b32 v158, 0
  v_mfma_f32_16x16x32_bf16 a[248:251], a[120:123], a[132:135], a[248:251]
  ds_read_b64_tr_b16 a[62:63], v20 offset:17408
  v_mov_b32 v159, 0
  v_mfma_f32_16x16x32_bf16 a[152:155], a[120:123], a[136:139], a[152:155]
  s_add_u32 s70, s76, 28544
  buffer_store_dwordx4 v[216:219], v2, s[20:23], s3 offen offset:3072
  v_mfma_f32_16x16x32_bf16 a[184:187], a[120:123], a[140:143], a[184:187]
  s_add_u32 m0, s80, 3072
  v_mov_b32 v160, 0
  v_mov_b32 v161, 0
  v_mfma_f32_16x16x32_bf16 a[188:191], a[124:127], a[140:143], a[188:191]
  buffer_load_dwordx4 v6, s[12:15], s70 offen  lds
  v_mfma_f32_16x16x32_bf16 a[156:159], a[124:127], a[136:139], a[156:159]
  v_mov_b32 v162, 0
  v_mov_b32 v163, 0
  v_mfma_f32_16x16x32_bf16 a[252:255], a[124:127], a[132:135], a[252:255]
  v_mfma_f32_16x16x32_bf16 a[220:223], a[124:127], a[128:131], a[220:223]
  s_waitcnt lgkmcnt(0)
  v_mfma_f32_16x16x32_bf16 a[192:195], a[32:35], a[64:67], a[192:195]
  s_add_u32 s3, s82, 524288
  ds_read_b64_tr_b16 a[96:97], v13 offset:24576
  v_cvt_pk_bf16_f32 v224, v224, v225
  v_mfma_f32_16x16x32_bf16 a[224:227], a[32:35], a[68:71], a[224:227]
  s_add_u32 s70, s77, 896
  ds_read_b64_tr_b16 a[98:99], v13 offset:25600
  v_cvt_pk_bf16_f32 v225, v226, v227
  v_mfma_f32_16x16x32_bf16 a[80:83], a[32:35], a[72:75], a[80:83]
  s_add_u32 m0, s80, 4096
  ds_read_b128 a[128:131], v10 offset:32768
  v_cvt_pk_bf16_f32 v226, v228, v229
  v_mfma_f32_16x16x32_bf16 a[160:163], a[32:35], a[76:79], a[160:163]
  buffer_load_dwordx4 v5, s[12:15], s70 offen  lds
  v_mfma_f32_16x16x32_bf16 a[164:167], a[36:39], a[76:79], a[164:167]
  ds_read_b64_tr_b16 a[100:101], v14 offset:24576
  v_cvt_pk_bf16_f32 v227, v230, v231
  v_mfma_f32_16x16x32_bf16 a[84:87], a[36:39], a[72:75], a[84:87]
  ds_read_b64_tr_b16 a[102:103], v14 offset:25600
  v_mov_b32 v164, 0
  v_mfma_f32_16x16x32_bf16 a[228:231], a[36:39], a[68:71], a[228:231]
  s_add_u32 s70, s79, 4259840
  ds_read_b128 a[132:135], v10 offset:34816
  v_mov_b32 v165, 0
  v_mfma_f32_16x16x32_bf16 a[196:199], a[36:39], a[64:67], a[196:199]
  s_add_u32 m0, s81, 2048
  ds_read_b64_tr_b16 a[104:105], v15 offset:24576
  v_mov_b32 v166, 0
  v_mfma_f32_16x16x32_bf16 a[200:203], a[40:43], a[64:67], a[200:203]
  buffer_load_dwordx4 v8, s[16:19], s70 offen  lds
  v_mfma_f32_16x16x32_bf16 a[232:235], a[40:43], a[68:71], a[232:235]
  ds_read_b64_tr_b16 a[106:107], v15 offset:25600
  v_mov_b32 v167, 0
  v_mfma_f32_16x16x32_bf16 a[88:91], a[40:43], a[72:75], a[88:91]
  ds_read_b128 a[136:139], v10 offset:36864
  v_mov_b32 v168, 0
  v_mfma_f32_16x16x32_bf16 a[168:171], a[40:43], a[76:79], a[168:171]
  s_add_u32 s70, s77, 10112
  ds_read_b64_tr_b16 a[108:109], v16 offset:24576
  v_mov_b32 v169, 0
  v_mfma_f32_16x16x32_bf16 a[172:175], a[44:47], a[76:79], a[172:175]
  s_add_u32 m0, s80, 5120
  buffer_store_dwordx4 v[224:227], v2, s[20:23], s3 offen offset:0
  v_mfma_f32_16x16x32_bf16 a[92:95], a[44:47], a[72:75], a[92:95]
  buffer_load_dwordx4 v6, s[12:15], s70 offen  lds
  v_mfma_f32_16x16x32_bf16 a[236:239], a[44:47], a[68:71], a[236:239]
  ds_read_b64_tr_b16 a[110:111], v16 offset:25600
  v_cvt_pk_bf16_f32 v232, v232, v233
  v_mfma_f32_16x16x32_bf16 a[204:207], a[44:47], a[64:67], a[204:207]
  ds_read_b128 a[140:143], v10 offset:38912
  v_cvt_pk_bf16_f32 v233, v234, v235
  v_mfma_f32_16x16x32_bf16 a[208:211], a[48:51], a[64:67], a[208:211]
  s_add_u32 s70, s77, 19328
  ds_read_b64_tr_b16 a[112:113], v17 offset:24576
  v_cvt_pk_bf16_f32 v234, v236, v237
  v_mfma_f32_16x16x32_bf16 a[240:243], a[48:51], a[68:71], a[240:243]
  s_add_u32 m0, s80, 6144
  ds_read_b64_tr_b16 a[114:115], v17 offset:25600
  v_cvt_pk_bf16_f32 v235, v238, v239
  v_mfma_f32_16x16x32_bf16 a[144:147], a[48:51], a[72:75], a[144:147]
  buffer_load_dwordx4 v5, s[12:15], s70 offen  lds
  v_mfma_f32_16x16x32_bf16 a[176:179], a[48:51], a[76:79], a[176:179]
  ds_read_b64_tr_b16 a[116:117], v18 offset:24576
  v_mov_b32 v170, 0
  v_mfma_f32_16x16x32_bf16 a[180:183], a[52:55], a[76:79], a[180:183]
  ds_read_b64_tr_b16 a[118:119], v18 offset:25600
  v_mov_b32 v171, 0
  v_mfma_f32_16x16x32_bf16 a[148:151], a[52:55], a[72:75], a[148:151]
  s_add_u32 s70, s79, 4292608
  ds_read_b64_tr_b16 a[120:121], v19 offset:24576
  v_mov_b32 v172, 0
  v_mfma_f32_16x16x32_bf16 a[244:247], a[52:55], a[68:71], a[244:247]
  s_add_u32 m0, s81, 3072
  ds_read_b64_tr_b16 a[122:123], v19 offset:25600
  v_mov_b32 v173, 0
  v_mfma_f32_16x16x32_bf16 a[212:215], a[52:55], a[64:67], a[212:215]
  buffer_load_dwordx4 v8, s[16:19], s70 offen  lds
  v_mfma_f32_16x16x32_bf16 a[216:219], a[56:59], a[64:67], a[216:219]
  ds_read_b64_tr_b16 a[124:125], v20 offset:24576
  v_mov_b32 v174, 0
  v_mfma_f32_16x16x32_bf16 a[248:251], a[56:59], a[68:71], a[248:251]
  ds_read_b64_tr_b16 a[126:127], v20 offset:25600
  v_mov_b32 v175, 0
  v_mfma_f32_16x16x32_bf16 a[152:155], a[56:59], a[72:75], a[152:155]
  s_add_u32 s70, s77, 28544
  buffer_store_dwordx4 v[232:235], v2, s[20:23], s3 offen offset:1024
  v_mfma_f32_16x16x32_bf16 a[184:187], a[56:59], a[76:79], a[184:187]
  s_add_u32 m0, s80, 7168
  v_mov_b32 v176, 0
  v_mov_b32 v177, 0
  v_mfma_f32_16x16x32_bf16 a[188:191], a[60:63], a[76:79], a[188:191]
  buffer_load_dwordx4 v6, s[12:15], s70 offen  lds
  v_mfma_f32_16x16x32_bf16 a[156:159], a[60:63], a[72:75], a[156:159]
  v_mov_b32 v178, 0
  v_mov_b32 v179, 0
  v_mfma_f32_16x16x32_bf16 a[252:255], a[60:63], a[68:71], a[252:255]
  s_waitcnt vmcnt(16) lgkmcnt(0)
  v_mfma_f32_16x16x32_bf16 a[220:223], a[60:63], a[64:67], a[220:223]
  s_barrier
  v_mfma_f32_16x16x32_bf16 a[192:195], a[96:99], a[128:131], a[192:195]
  ds_read_b64_tr_b16 a[32:33], v13 offset:32768
  v_cvt_pk_bf16_f32 v240, v240, v241
  v_mfma_f32_16x16x32_bf16 a[224:227], a[96:99], a[132:135], a[224:227]
  s_add_u32 s70, s76, 1024
  ds_read_b64_tr_b16 a[34:35], v13 offset:33792
  v_cvt_pk_bf16_f32 v241, v242, v243
  v_mfma_f32_16x16x32_bf16 a[80:83], a[96:99], a[136:139], a[80:83]
  s_add_u32 m0, s80, 32768
  ds_read_b128 a[64:67], v11 offset:0
  v_cvt_pk_bf16_f32 v242, v244, v245
  v_mfma_f32_16x16x32_bf16 a[160:163], a[96:99], a[140:143], a[160:163]
  buffer_load_dwordx4 v5, s[12:15], s70 offen  lds
  v_mfma_f32_16x16x32_bf16 a[164:167], a[100:103], a[140:143], a[164:167]
  ds_read_b64_tr_b16 a[36:37], v14 offset:32768
  v_cvt_pk_bf16_f32 v243, v246, v247
  v_mfma_f32_16x16x32_bf16 a[84:87], a[100:103], a[136:139], a[84:87]
  ds_read_b64_tr_b16 a[38:39], v14 offset:33792
  v_mov_b32 v180, 0
  v_mfma_f32_16x16x32_bf16 a[228:231], a[100:103], a[132:135], a[228:231]
  s_add_u32 s70, s76, 10240
  ds_read_b128 a[68:71], v11 offset:2048
  v_mov_b32 v181, 0
  v_mfma_f32_16x16x32_bf16 a[196:199], a[100:103], a[128:131], a[196:199]
  s_add_u32 m0, s80, 33792
  ds_read_b64_tr_b16 a[40:41], v15 offset:32768
  v_mov_b32 v182, 0
  v_mfma_f32_16x16x32_bf16 a[200:203], a[104:107], a[128:131], a[200:203]
  buffer_load_dwordx4 v6, s[12:15], s70 offen  lds
  v_mfma_f32_16x16x32_bf16 a[232:235], a[104:107], a[132:135], a[232:235]
  ds_read_b64_tr_b16 a[42:43], v15 offset:33792
  v_mov_b32 v183, 0
  v_mfma_f32_16x16x32_bf16 a[88:91], a[104:107], a[136:139], a[88:91]
  ds_read_b128 a[72:75], v11 offset:4096
  v_mov_b32 v184, 0
  v_mfma_f32_16x16x32_bf16 a[168:171], a[104:107], a[140:143], a[168:171]
  s_add_u32 s70, s76, 19456
  ds_read_b64_tr_b16 a[44:45], v16 offset:32768
  v_mov_b32 v185, 0
  v_mfma_f32_16x16x32_bf16 a[172:175], a[108:111], a[140:143], a[172:175]
  s_add_u32 m0, s80, 34816
  ds_read_b64_tr_b16 a[46:47], v16 offset:33792
  v_mov_b32 v186, 0
  v_mfma_f32_16x16x32_bf16 a[92:95], a[108:111], a[136:139], a[92:95]
  buffer_load_dwordx4 v5, s[12:15], s70 offen  lds
  v_mfma_f32_16x16x32_bf16 a[236:239], a[108:111], a[132:135], a[236:239]
  ds_read_b128 a[76:79], v11 offset:6144
  v_mov_b32 v187, 0
  v_mfma_f32_16x16x32_bf16 a[204:207], a[108:111], a[128:131], a[204:207]
  ds_read_b64_tr_b16 a[48:49], v17 offset:32768
  v_mov_b32 v188, 0
  v_mfma_f32_16x16x32_bf16 a[208:211], a[112:115], a[128:131], a[208:211]
  s_add_u32 s70, s76, 28672
  buffer_store_dwordx4 v[240:243], v2, s[20:23], s3 offen offset:2048
  v_mfma_f32_16x16x32_bf16 a[240:243], a[112:115], a[132:135], a[240:243]
  s_add_u32 m0, s80, 35840
  ds_read_b64_tr_b16 a[50:51], v17 offset:33792
  v_cvt_pk_bf16_f32 v248, v248, v249
  v_mfma_f32_16x16x32_bf16 a[144:147], a[112:115], a[136:139], a[144:147]
  buffer_load_dwordx4 v6, s[12:15], s70 offen  lds
  v_mfma_f32_16x16x32_bf16 a[176:179], a[112:115], a[140:143], a[176:179]
  ds_read_b64_tr_b16 a[52:53], v18 offset:32768
  v_cvt_pk_bf16_f32 v249, v250, v251
  v_mfma_f32_16x16x32_bf16 a[180:183], a[116:119], a[140:143], a[180:183]
  ds_read_b64_tr_b16 a[54:55], v18 offset:33792
  v_cvt_pk_bf16_f32 v250, v252, v253
  v_mfma_f32_16x16x32_bf16 a[148:151], a[116:119], a[136:139], a[148:151]
  ds_read_b64_tr_b16 a[56:57], v19 offset:32768
  v_cvt_pk_bf16_f32 v251, v254, v255
  v_mfma_f32_16x16x32_bf16 a[244:247], a[116:119], a[132:135], a[244:247]
  ds_read_b64_tr_b16 a[58:59], v19 offset:33792
  v_mov_b32 v189, 0
  v_mfma_f32_16x16x32_bf16 a[212:215], a[116:119], a[128:131], a[212:215]
  ds_read_b64_tr_b16 a[60:61], v20 offset:32768
  v_mov_b32 v190, 0
  v_mfma_f32_16x16x32_bf16 a[216:219], a[120:123], a[128:131], a[216:219]
  ds_read_b64_tr_b16 a[62:63], v20 offset:33792
  v_mov_b32 v191, 0
  v_mfma_f32_16x16x32_bf16 a[248:251], a[120:123], a[132:135], a[248:251]
  v_mov_b32 v192, 0
  v_mov_b32 v193, 0
  v_mfma_f32_16x16x32_bf16 a[152:155], a[120:123], a[136:139], a[152:155]
  v_mov_b32 v194, 0
  v_mov_b32 v195, 0
  v_mfma_f32_16x16x32_bf16 a[184:187], a[120:123], a[140:143], a[184:187]
  v_mov_b32 v196, 0
  v_mov_b32 v197, 0
  v_mfma_f32_16x16x32_bf16 a[188:191], a[124:127], a[140:143], a[188:191]
  buffer_store_dwordx4 v[248:251], v2, s[20:23], s3 offen offset:3072
  v_mfma_f32_16x16x32_bf16 a[156:159], a[124:127], a[136:139], a[156:159]
  v_mov_b32 v198, 0
  v_mov_b32 v199, 0
  v_mfma_f32_16x16x32_bf16 a[252:255], a[124:127], a[132:135], a[252:255]
  v_mfma_f32_16x16x32_bf16 a[220:223], a[124:127], a[128:131], a[220:223]
  s_waitcnt lgkmcnt(0)
  v_mfma_f32_16x16x32_bf16 a[192:195], a[32:35], a[64:67], a[192:195]
  s_add_u32 s3, s82, 528384
  ds_read_b64_tr_b16 a[96:97], v13 offset:40960
  v_cvt_pk_bf16_f32 v88, v88, v89
  v_mfma_f32_16x16x32_bf16 a[224:227], a[32:35], a[68:71], a[224:227]
  s_add_u32 s70, s77, 1024
  ds_read_b64_tr_b16 a[98:99], v13 offset:41984
  v_cvt_pk_bf16_f32 v89, v90, v91
  v_mfma_f32_16x16x32_bf16 a[80:83], a[32:35], a[72:75], a[80:83]
  s_add_u32 m0, s80, 36864
  ds_read_b128 a[128:131], v12 offset:0
  v_cvt_pk_bf16_f32 v90, v92, v93
  v_mfma_f32_16x16x32_bf16 a[160:163], a[32:35], a[76:79], a[160:163]
  buffer_load_dwordx4 v5, s[12:15], s70 offen  lds
  v_mfma_f32_16x16x32_bf16 a[164:167], a[36:39], a[76:79], a[164:167]
  ds_read_b64_tr_b16 a[100:101], v14 offset:40960
  v_cvt_pk_bf16_f32 v91, v94, v95
  v_mfma_f32_16x16x32_bf16 a[84:87], a[36:39], a[72:75], a[84:87]
  ds_read_b64_tr_b16 a[102:103], v14 offset:41984
  v_mov_b32 v200, 0
  v_mfma_f32_16x16x32_bf16 a[228:231], a[36:39], a[68:71], a[228:231]
  s_add_u32 s70, s77, 10240
  ds_read_b128 a[132:135], v12 offset:2048
  v_mov_b32 v201, 0
  v_mfma_f32_16x16x32_bf16 a[196:199], a[36:39], a[64:67], a[196:199]
  s_add_u32 m0, s80, 37888
  ds_read_b64_tr_b16 a[104:105], v15 offset:40960
  v_mov_b32 v202, 0
  v_mfma_f32_16x16x32_bf16 a[200:203], a[40:43], a[64:67], a[200:203]
  buffer_load_dwordx4 v6, s[12:15], s70 offen  lds
  v_mfma_f32_16x16x32_bf16 a[232:235], a[40:43], a[68:71], a[232:235]
  ds_read_b64_tr_b16 a[106:107], v15 offset:41984
  v_mov_b32 v203, 0
  v_mfma_f32_16x16x32_bf16 a[88:91], a[40:43], a[72:75], a[88:91]
  ds_read_b128 a[136:139], v12 offset:4096
  v_mov_b32 v204, 0
  v_mfma_f32_16x16x32_bf16 a[168:171], a[40:43], a[76:79], a[168:171]
  s_add_u32 s70, s77, 19456
  buffer_store_dwordx4 v[88:91], v2, s[20:23], s3 offen offset:0
  v_mfma_f32_16x16x32_bf16 a[172:175], a[44:47], a[76:79], a[172:175]
  s_add_u32 m0, s80, 38912
  ds_read_b64_tr_b16 a[108:109], v16 offset:40960
  v_cvt_pk_bf16_f32 v80, v80, v81
  v_mfma_f32_16x16x32_bf16 a[92:95], a[44:47], a[72:75], a[92:95]
  buffer_load_dwordx4 v5, s[12:15], s70 offen  lds
  v_mfma_f32_16x16x32_bf16 a[236:239], a[44:47], a[68:71], a[236:239]
  ds_read_b64_tr_b16 a[110:111], v16 offset:41984
  v_cvt_pk_bf16_f32 v81, v82, v83
  v_mfma_f32_16x16x32_bf16 a[204:207], a[44:47], a[64:67], a[204:207]
  ds_read_b128 a[140:143], v12 offset:6144
  v_cvt_pk_bf16_f32 v82, v84, v85
  v_mfma_f32_16x16x32_bf16 a[208:211], a[48:51], a[64:67], a[208:211]
  s_add_u32 s70, s77, 28672
  ds_read_b64_tr_b16 a[112:113], v17 offset:40960
  v_cvt_pk_bf16_f32 v83, v86, v87
  v_mfma_f32_16x16x32_bf16 a[240:243], a[48:51], a[68:71], a[240:243]
  s_add_u32 m0, s80, 39936
  ds_read_b64_tr_b16 a[114:115], v17 offset:41984
  v_mov_b32 v205, 0
  v_mfma_f32_16x16x32_bf16 a[144:147], a[48:51], a[72:75], a[144:147]
  buffer_load_dwordx4 v6, s[12:15], s70 offen  lds
  v_mfma_f32_16x16x32_bf16 a[176:179], a[48:51], a[76:79], a[176:179]
  ds_read_b64_tr_b16 a[116:117], v18 offset:40960
  v_mov_b32 v206, 0
  v_mfma_f32_16x16x32_bf16 a[180:183], a[52:55], a[76:79], a[180:183]
  ds_read_b64_tr_b16 a[118:119], v18 offset:41984
  v_mov_b32 v207, 0
  v_mfma_f32_16x16x32_bf16 a[148:151], a[52:55], a[72:75], a[148:151]
  ds_read_b64_tr_b16 a[120:121], v19 offset:40960
  v_mov_b32 v208, 0
  v_mfma_f32_16x16x32_bf16 a[244:247], a[52:55], a[68:71], a[244:247]
  buffer_store_dwordx4 v[80:83], v2, s[20:23], s3 offen offset:1024
  v_mfma_f32_16x16x32_bf16 a[212:215], a[52:55], a[64:67], a[212:215]
  ds_read_b64_tr_b16 a[122:123], v19 offset:41984
  v_cvt_pk_bf16_f32 v72, v72, v73
  v_mfma_f32_16x16x32_bf16 a[216:219], a[56:59], a[64:67], a[216:219]
  ds_read_b64_tr_b16 a[124:125], v20 offset:40960
  v_cvt_pk_bf16_f32 v73, v74, v75
  v_mfma_f32_16x16x32_bf16 a[248:251], a[56:59], a[68:71], a[248:251]
  ds_read_b64_tr_b16 a[126:127], v20 offset:41984
  v_cvt_pk_bf16_f32 v74, v76, v77
  v_mfma_f32_16x16x32_bf16 a[152:155], a[56:59], a[72:75], a[152:155]
  v_cvt_pk_bf16_f32 v75, v78, v79
  v_mov_b32 v209, 0
  v_mfma_f32_16x16x32_bf16 a[184:187], a[56:59], a[76:79], a[184:187]
  v_mov_b32 v210, 0
  v_mov_b32 v211, 0
  v_mfma_f32_16x16x32_bf16 a[188:191], a[60:63], a[76:79], a[188:191]
  v_mov_b32 v212, 0
  v_mov_b32 v213, 0
  v_mfma_f32_16x16x32_bf16 a[156:159], a[60:63], a[72:75], a[156:159]
  buffer_store_dwordx4 v[72:75], v2, s[20:23], s3 offen offset:2048
  v_mfma_f32_16x16x32_bf16 a[252:255], a[60:63], a[68:71], a[252:255]
  s_waitcnt vmcnt(13) lgkmcnt(0)
  v_mfma_f32_16x16x32_bf16 a[220:223], a[60:63], a[64:67], a[220:223]
  s_barrier
  v_mfma_f32_16x16x32_bf16 a[192:195], a[96:99], a[128:131], a[192:195]
  ds_read_b64_tr_b16 a[32:33], v13 offset:49152
  v_cvt_pk_bf16_f32 v64, v64, v65
  v_mfma_f32_16x16x32_bf16 a[224:227], a[96:99], a[132:135], a[224:227]
  ds_read_b64_tr_b16 a[34:35], v13 offset:50176
  v_cvt_pk_bf16_f32 v65, v66, v67
  v_mfma_f32_16x16x32_bf16 a[80:83], a[96:99], a[136:139], a[80:83]
  ds_read_b128 a[64:67], v9 offset:0
  v_cvt_pk_bf16_f32 v66, v68, v69
  v_mfma_f32_16x16x32_bf16 a[160:163], a[96:99], a[140:143], a[160:163]
  ds_read_b64_tr_b16 a[36:37], v14 offset:49152
  v_cvt_pk_bf16_f32 v67, v70, v71
  v_mfma_f32_16x16x32_bf16 a[164:167], a[100:103], a[140:143], a[164:167]
  ds_read_b64_tr_b16 a[38:39], v14 offset:50176
  v_min_u32 v21, 4, v1
  v_mfma_f32_16x16x32_bf16 a[84:87], a[100:103], a[136:139], a[84:87]
  s_lshr_b32 s73, s2, 3
  s_lshl_b32 s73, s73, 2
  ds_read_b128 a[68:71], v9 offset:2048
  v_mfma_f32_16x16x32_bf16 a[228:231], a[100:103], a[132:135], a[228:231]
  s_add_u32 s73, s73, s34
  s_mul_i32 s73, s73, 5
  ds_read_b64_tr_b16 a[40:41], v15 offset:49152
  v_mfma_f32_16x16x32_bf16 a[196:199], a[100:103], a[128:131], a[196:199]
  ds_read_b64_tr_b16 a[42:43], v15 offset:50176
  v_add_u32 v21, s73, v21
  v_mfma_f32_16x16x32_bf16 a[200:203], a[104:107], a[128:131], a[200:203]
  ds_read_b128 a[72:75], v9 offset:4096
  v_lshlrev_b32 v21, 7, v21
  v_mfma_f32_16x16x32_bf16 a[232:235], a[104:107], a[132:135], a[232:235]
  ds_read_b64_tr_b16 a[44:45], v16 offset:49152
  v_add_u32 v21, L_attn-L_pc, v21
  v_mfma_f32_16x16x32_bf16 a[88:91], a[104:107], a[136:139], a[88:91]
  ds_read_b64_tr_b16 a[46:47], v16 offset:50176
  v_min_u32 v21, L_code_end-L_pc-4, v21
  v_mfma_f32_16x16x32_bf16 a[168:171], a[104:107], a[140:143], a[168:171]
  buffer_store_dwordx4 v[64:67], v2, s[20:23], s3 offen offset:3072
  v_mfma_f32_16x16x32_bf16 a[172:175], a[108:111], a[140:143], a[172:175]
  s_add_u32 s3, s82, 786432
  ds_read_b128 a[76:79], v9 offset:6144
  v_cvt_pk_bf16_f32 v56, v56, v57
  v_mfma_f32_16x16x32_bf16 a[92:95], a[108:111], a[136:139], a[92:95]
  ds_read_b64_tr_b16 a[48:49], v17 offset:49152
  v_cvt_pk_bf16_f32 v57, v58, v59
  v_mfma_f32_16x16x32_bf16 a[236:239], a[108:111], a[132:135], a[236:239]
  ds_read_b64_tr_b16 a[50:51], v17 offset:50176
  v_cvt_pk_bf16_f32 v58, v60, v61
  v_mfma_f32_16x16x32_bf16 a[204:207], a[108:111], a[128:131], a[204:207]
  ds_read_b64_tr_b16 a[52:53], v18 offset:49152
  v_cvt_pk_bf16_f32 v59, v62, v63
  v_mfma_f32_16x16x32_bf16 a[208:211], a[112:115], a[128:131], a[208:211]
  ds_read_b64_tr_b16 a[54:55], v18 offset:50176
  v_and_b32 v21, -4, v21
  v_mfma_f32_16x16x32_bf16 a[240:243], a[112:115], a[132:135], a[240:243]
  ds_read_b64_tr_b16 a[56:57], v19 offset:49152
  v_mfma_f32_16x16x32_bf16 a[144:147], a[112:115], a[136:139], a[144:147]
  ds_read_b64_tr_b16 a[58:59], v19 offset:50176
  v_mfma_f32_16x16x32_bf16 a[176:179], a[112:115], a[140:143], a[176:179]
  buffer_store_dwordx4 v[56:59], v2, s[20:23], s3 offen offset:0
  v_mfma_f32_16x16x32_bf16 a[180:183], a[116:119], a[140:143], a[180:183]
  ds_read_b64_tr_b16 a[60:61], v20 offset:49152
  v_cvt_pk_bf16_f32 v48, v48, v49
  v_mfma_f32_16x16x32_bf16 a[148:151], a[116:119], a[136:139], a[148:151]
  ds_read_b64_tr_b16 a[62:63], v20 offset:50176
  v_cvt_pk_bf16_f32 v49, v50, v51
  v_mfma_f32_16x16x32_bf16 a[244:247], a[116:119], a[132:135], a[244:247]
  v_cvt_pk_bf16_f32 v50, v52, v53
  v_cvt_pk_bf16_f32 v51, v54, v55
  v_mfma_f32_16x16x32_bf16 a[212:215], a[116:119], a[128:131], a[212:215]
  global_load_dword v30, v21, s[92:93]
  v_mfma_f32_16x16x32_bf16 a[216:219], a[120:123], a[128:131], a[216:219]
  s_mov_b32 s72, 58208256
  buffer_load_dwordx4 v[80:83], v2, s[20:23], s72 offen offset:0 sc1
  v_mfma_f32_16x16x32_bf16 a[248:251], a[120:123], a[132:135], a[248:251]
  buffer_load_dwordx4 v[84:87], v2, s[20:23], s72 offen offset:1024 sc1
  v_mfma_f32_16x16x32_bf16 a[152:155], a[120:123], a[136:139], a[152:155]
  buffer_load_dwordx4 v[88:91], v2, s[20:23], s72 offen offset:2048 sc1
  v_mfma_f32_16x16x32_bf16 a[184:187], a[120:123], a[140:143], a[184:187]
  buffer_load_dwordx4 v[92:95], v2, s[20:23], s72 offen offset:3072 sc1
  v_mfma_f32_16x16x32_bf16 a[188:191], a[124:127], a[140:143], a[188:191]
  buffer_store_dwordx4 v[48:51], v2, s[20:23], s3 offen offset:1024
  v_mfma_f32_16x16x32_bf16 a[156:159], a[124:127], a[136:139], a[156:159]
  v_mov_b32 v214, 0
  v_mov_b32 v215, 0
  v_mfma_f32_16x16x32_bf16 a[252:255], a[124:127], a[132:135], a[252:255]
  v_mfma_f32_16x16x32_bf16 a[220:223], a[124:127], a[128:131], a[220:223]
  s_waitcnt lgkmcnt(0)
  v_mfma_f32_16x16x32_bf16 a[192:195], a[32:35], a[64:67], a[192:195]
  ds_read_b64_tr_b16 a[96:97], v13 offset:57344
  v_cvt_pk_bf16_f32 v40, v40, v41
  v_mfma_f32_16x16x32_bf16 a[224:227], a[32:35], a[68:71], a[224:227]
  ds_read_b64_tr_b16 a[98:99], v13 offset:58368
  v_cvt_pk_bf16_f32 v41, v42, v43
  v_mfma_f32_16x16x32_bf16 a[80:83], a[32:35], a[72:75], a[80:83]
  ds_read_b128 a[128:131], v10 offset:0
  v_cvt_pk_bf16_f32 v42, v44, v45
  v_mfma_f32_16x16x32_bf16 a[160:163], a[32:35], a[76:79], a[160:163]
  ds_read_b64_tr_b16 a[100:101], v14 offset:57344
  v_cvt_pk_bf16_f32 v43, v46, v47
  v_mfma_f32_16x16x32_bf16 a[164:167], a[36:39], a[76:79], a[164:167]
  ds_read_b64_tr_b16 a[102:103], v14 offset:58368
  v_and_b32 v113, 7, v1
  v_mfma_f32_16x16x32_bf16 a[84:87], a[36:39], a[72:75], a[84:87]
  ds_read_b128 a[132:135], v10 offset:2048
  v_lshlrev_b32 v113, 4, v113
  v_mfma_f32_16x16x32_bf16 a[228:231], a[36:39], a[68:71], a[228:231]
  s_and_b32 s71, s2, 31
  s_lshl_b32 s71, s71, 7
  ds_read_b64_tr_b16 a[104:105], v15 offset:57344
  v_mfma_f32_16x16x32_bf16 a[196:199], a[36:39], a[64:67], a[196:199]
  ds_read_b64_tr_b16 a[106:107], v15 offset:58368
  v_add_u32 v113, s71, v113
  v_mfma_f32_16x16x32_bf16 a[200:203], a[40:43], a[64:67], a[200:203]
  s_mov_b32 s72, 58195968
  ds_read_b128 a[136:139], v10 offset:4096
  v_mfma_f32_16x16x32_bf16 a[232:235], a[40:43], a[68:71], a[232:235]
  ds_read_b64_tr_b16 a[108:109], v16 offset:57344
  v_mfma_f32_16x16x32_bf16 a[88:91], a[40:43], a[72:75], a[88:91]
  ds_read_b64_tr_b16 a[110:111], v16 offset:58368
  v_mfma_f32_16x16x32_bf16 a[168:171], a[40:43], a[76:79], a[168:171]
  buffer_store_dwordx4 v[40:43], v2, s[20:23], s3 offen offset:2048
  v_mfma_f32_16x16x32_bf16 a[172:175], a[44:47], a[76:79], a[172:175]
  ds_read_b128 a[140:143], v10 offset:6144
  v_cvt_pk_bf16_f32 v32, v32, v33
  v_mfma_f32_16x16x32_bf16 a[92:95], a[44:47], a[72:75], a[92:95]
  ds_read_b64_tr_b16 a[112:113], v17 offset:57344
  v_cvt_pk_bf16_f32 v33, v34, v35
  v_mfma_f32_16x16x32_bf16 a[236:239], a[44:47], a[68:71], a[236:239]
  ds_read_b64_tr_b16 a[114:115], v17 offset:58368
  v_cvt_pk_bf16_f32 v34, v36, v37
  v_mfma_f32_16x16x32_bf16 a[204:207], a[44:47], a[64:67], a[204:207]
  ds_read_b64_tr_b16 a[116:117], v18 offset:57344
  v_cvt_pk_bf16_f32 v35, v38, v39
  v_mfma_f32_16x16x32_bf16 a[208:211], a[48:51], a[64:67], a[208:211]
  ds_read_b64_tr_b16 a[118:119], v18 offset:58368
  v_mfma_f32_16x16x32_bf16 a[240:243], a[48:51], a[68:71], a[240:243]
  ds_read_b64_tr_b16 a[120:121], v19 offset:57344
  v_mfma_f32_16x16x32_bf16 a[144:147], a[48:51], a[72:75], a[144:147]
  ds_read_b64_tr_b16 a[122:123], v19 offset:58368
  v_mfma_f32_16x16x32_bf16 a[176:179], a[48:51], a[76:79], a[176:179]
  buffer_store_dwordx4 v[32:35], v2, s[20:23], s3 offen offset:3072
  v_mfma_f32_16x16x32_bf16 a[180:183], a[52:55], a[76:79], a[180:183]
  s_add_u32 s3, s82, 790528
  ds_read_b64_tr_b16 a[124:125], v20 offset:57344
  v_accvgpr_read_b32 v64, a0
  v_mfma_f32_16x16x32_bf16 a[148:151], a[52:55], a[72:75], a[148:151]
  ds_read_b64_tr_b16 a[126:127], v20 offset:58368
  v_accvgpr_read_b32 v65, a1
  v_mfma_f32_16x16x32_bf16 a[244:247], a[52:55], a[68:71], a[244:247]
  v_accvgpr_read_b32 v66, a2
  v_accvgpr_read_b32 v67, a3
  v_mfma_f32_16x16x32_bf16 a[212:215], a[52:55], a[64:67], a[212:215]
  v_accvgpr_read_b32 v68, a4
  v_accvgpr_read_b32 v69, a5
  v_mfma_f32_16x16x32_bf16 a[216:219], a[56:59], a[64:67], a[216:219]
  v_accvgpr_read_b32 v70, a6
  v_accvgpr_read_b32 v71, a7
  v_mfma_f32_16x16x32_bf16 a[248:251], a[56:59], a[68:71], a[248:251]
  v_cvt_pk_bf16_f32 v64, v64, v65
  v_cvt_pk_bf16_f32 v65, v66, v67
  v_mfma_f32_16x16x32_bf16 a[152:155], a[56:59], a[72:75], a[152:155]
  v_cvt_pk_bf16_f32 v66, v68, v69
  v_cvt_pk_bf16_f32 v67, v70, v71
  v_mfma_f32_16x16x32_bf16 a[184:187], a[56:59], a[76:79], a[184:187]
  buffer_load_dwordx4 v[116:119], v113, s[20:23], s72 offen sc1
  v_mfma_f32_16x16x32_bf16 a[188:191], a[60:63], a[76:79], a[188:191]
  buffer_store_dwordx4 v[64:67], v2, s[20:23], s3 offen offset:0
  v_mfma_f32_16x16x32_bf16 a[156:159], a[60:63], a[72:75], a[156:159]
  v_mov_b32 v216, 0
  v_mov_b32 v217, 0
  v_mfma_f32_16x16x32_bf16 a[252:255], a[60:63], a[68:71], a[252:255]
  s_waitcnt vmcnt(14) lgkmcnt(0)
  v_mfma_f32_16x16x32_bf16 a[220:223], a[60:63], a[64:67], a[220:223]
  s_barrier
  v_mfma_f32_16x16x32_bf16 a[192:195], a[96:99], a[128:131], a[192:195]
  ds_read_b64_tr_b16 a[32:33], v13 offset:0
  v_accvgpr_read_b32 v56, a8
  v_mfma_f32_16x16x32_bf16 a[224:227], a[96:99], a[132:135], a[224:227]
  ds_read_b64_tr_b16 a[34:35], v13 offset:1024
  v_accvgpr_read_b32 v57, a9
  v_mfma_f32_16x16x32_bf16 a[80:83], a[96:99], a[136:139], a[80:83]
  ds_read_b128 a[64:67], v9 offset:32768
  v_accvgpr_read_b32 v58, a10
  v_mfma_f32_16x16x32_bf16 a[160:163], a[96:99], a[140:143], a[160:163]
  ds_read_b64_tr_b16 a[36:37], v14 offset:0
  v_accvgpr_read_b32 v59, a11
  v_mfma_f32_16x16x32_bf16 a[164:167], a[100:103], a[140:143], a[164:167]
  ds_read_b64_tr_b16 a[38:39], v14 offset:1024
  v_accvgpr_read_b32 v60, a12
  v_mfma_f32_16x16x32_bf16 a[84:87], a[100:103], a[136:139], a[84:87]
  ds_read_b128 a[68:71], v9 offset:34816
  v_accvgpr_read_b32 v61, a13
  v_mfma_f32_16x16x32_bf16 a[228:231], a[100:103], a[132:135], a[228:231]
  ds_read_b64_tr_b16 a[40:41], v15 offset:0
  v_accvgpr_read_b32 v62, a14
  v_mfma_f32_16x16x32_bf16 a[196:199], a[100:103], a[128:131], a[196:199]
  ds_read_b64_tr_b16 a[42:43], v15 offset:1024
  v_accvgpr_read_b32 v63, a15
  v_mfma_f32_16x16x32_bf16 a[200:203], a[104:107], a[128:131], a[200:203]
  ds_read_b128 a[72:75], v9 offset:36864
  v_cvt_pk_bf16_f32 v56, v56, v57
  v_mfma_f32_16x16x32_bf16 a[232:235], a[104:107], a[132:135], a[232:235]
  ds_read_b64_tr_b16 a[44:45], v16 offset:0
  v_cvt_pk_bf16_f32 v57, v58, v59
  v_mfma_f32_16x16x32_bf16 a[88:91], a[104:107], a[136:139], a[88:91]
  ds_read_b64_tr_b16 a[46:47], v16 offset:1024
  v_cvt_pk_bf16_f32 v58, v60, v61
  v_cvt_pk_bf16_f32 v59, v62, v63
  v_mfma_f32_16x16x32_bf16 a[168:171], a[104:107], a[140:143], a[168:171]
  buffer_store_dwordx4 v[56:59], v2, s[20:23], s3 offen offset:1024
  v_mfma_f32_16x16x32_bf16 a[172:175], a[108:111], a[140:143], a[172:175]
  ds_read_b128 a[76:79], v9 offset:38912
  v_accvgpr_read_b32 v48, a16
  v_mfma_f32_16x16x32_bf16 a[92:95], a[108:111], a[136:139], a[92:95]
  ds_read_b64_tr_b16 a[48:49], v17 offset:0
  v_accvgpr_read_b32 v49, a17
  v_mfma_f32_16x16x32_bf16 a[236:239], a[108:111], a[132:135], a[236:239]
  ds_read_b64_tr_b16 a[50:51], v17 offset:1024
  v_accvgpr_read_b32 v50, a18
  v_mfma_f32_16x16x32_bf16 a[204:207], a[108:111], a[128:131], a[204:207]
  ds_read_b64_tr_b16 a[52:53], v18 offset:0
  v_accvgpr_read_b32 v51, a19
  v_mfma_f32_16x16x32_bf16 a[208:211], a[112:115], a[128:131], a[208:211]
  ds_read_b64_tr_b16 a[54:55], v18 offset:1024
  v_accvgpr_read_b32 v52, a20
  v_mfma_f32_16x16x32_bf16 a[240:243], a[112:115], a[132:135], a[240:243]
  ds_read_b64_tr_b16 a[56:57], v19 offset:0
  v_accvgpr_read_b32 v53, a21
  v_mfma_f32_16x16x32_bf16 a[144:147], a[112:115], a[136:139], a[144:147]
  ds_read_b64_tr_b16 a[58:59], v19 offset:1024
  v_accvgpr_read_b32 v54, a22
  v_accvgpr_read_b32 v55, a23
  v_cvt_pk_bf16_f32 v48, v48, v49
  v_cvt_pk_bf16_f32 v49, v50, v51
  v_cvt_pk_bf16_f32 v50, v52, v53
  v_cvt_pk_bf16_f32 v51, v54, v55
  v_mfma_f32_16x16x32_bf16 a[176:179], a[112:115], a[140:143], a[176:179]
  buffer_store_dwordx4 v[48:51], v2, s[20:23], s3 offen offset:2048
  v_mfma_f32_16x16x32_bf16 a[180:183], a[116:119], a[140:143], a[180:183]
  ds_read_b64_tr_b16 a[60:61], v20 offset:0
  v_accvgpr_read_b32 v40, a24
  v_mfma_f32_16x16x32_bf16 a[148:151], a[116:119], a[136:139], a[148:151]
  ds_read_b64_tr_b16 a[62:63], v20 offset:1024
  v_accvgpr_read_b32 v41, a25
  v_mfma_f32_16x16x32_bf16 a[244:247], a[116:119], a[132:135], a[244:247]
  v_accvgpr_read_b32 v42, a26
  v_accvgpr_read_b32 v43, a27
  v_mfma_f32_16x16x32_bf16 a[212:215], a[116:119], a[128:131], a[212:215]
  v_accvgpr_read_b32 v44, a28
  v_accvgpr_read_b32 v45, a29
  v_mfma_f32_16x16x32_bf16 a[216:219], a[120:123], a[128:131], a[216:219]
  v_accvgpr_read_b32 v46, a30
  v_accvgpr_read_b32 v47, a31
  v_mfma_f32_16x16x32_bf16 a[248:251], a[120:123], a[132:135], a[248:251]
  v_cvt_pk_bf16_f32 v40, v40, v41
  v_cvt_pk_bf16_f32 v41, v42, v43
  v_mfma_f32_16x16x32_bf16 a[152:155], a[120:123], a[136:139], a[152:155]
  v_cvt_pk_bf16_f32 v42, v44, v45
  v_cvt_pk_bf16_f32 v43, v46, v47
  v_mfma_f32_16x16x32_bf16 a[184:187], a[120:123], a[140:143], a[184:187]
  v_mov_b32 v218, 0
  v_mov_b32 v219, 0
  v_mfma_f32_16x16x32_bf16 a[188:191], a[124:127], a[140:143], a[188:191]
  buffer_store_dwordx4 v[40:43], v2, s[20:23], s3 offen offset:3072
  v_mfma_f32_16x16x32_bf16 a[156:159], a[124:127], a[136:139], a[156:159]
  v_mov_b32 v220, 0
  v_mov_b32 v221, 0
  v_mfma_f32_16x16x32_bf16 a[252:255], a[124:127], a[132:135], a[252:255]
  v_mfma_f32_16x16x32_bf16 a[220:223], a[124:127], a[128:131], a[220:223]
  s_waitcnt lgkmcnt(0)
  v_mfma_f32_16x16x32_bf16 a[192:195], a[32:35], a[64:67], a[192:195]
  ds_read_b64_tr_b16 a[96:97], v13 offset:8192
  v_mov_b32 v222, 0
  v_mfma_f32_16x16x32_bf16 a[224:227], a[32:35], a[68:71], a[224:227]
  ds_read_b64_tr_b16 a[98:99], v13 offset:9216
  v_mov_b32 v223, 0
  v_mfma_f32_16x16x32_bf16 a[80:83], a[32:35], a[72:75], a[80:83]
  ds_read_b128 a[128:131], v10 offset:32768
  v_mov_b32 v224, 0
  v_mfma_f32_16x16x32_bf16 a[160:163], a[32:35], a[76:79], a[160:163]
  ds_read_b64_tr_b16 a[100:101], v14 offset:8192
  v_mov_b32 v225, 0
  v_mfma_f32_16x16x32_bf16 a[164:167], a[36:39], a[76:79], a[164:167]
  ds_read_b64_tr_b16 a[102:103], v14 offset:9216
  v_mov_b32 v226, 0
  v_mfma_f32_16x16x32_bf16 a[84:87], a[36:39], a[72:75], a[84:87]
  ds_read_b128 a[132:135], v10 offset:34816
  v_mov_b32 v227, 0
  v_mfma_f32_16x16x32_bf16 a[228:231], a[36:39], a[68:71], a[228:231]
  ds_read_b64_tr_b16 a[104:105], v15 offset:8192
  v_mov_b32 v228, 0
  v_mfma_f32_16x16x32_bf16 a[196:199], a[36:39], a[64:67], a[196:199]
  ds_read_b64_tr_b16 a[106:107], v15 offset:9216
  v_mov_b32 v229, 0
  v_mfma_f32_16x16x32_bf16 a[200:203], a[40:43], a[64:67], a[200:203]
  ds_read_b128 a[136:139], v10 offset:36864
  v_mov_b32 v230, 0
  v_mfma_f32_16x16x32_bf16 a[232:235], a[40:43], a[68:71], a[232:235]
  ds_read_b64_tr_b16 a[108:109], v16 offset:8192
  v_mov_b32 v231, 0
  v_mfma_f32_16x16x32_bf16 a[88:91], a[40:43], a[72:75], a[88:91]
  ds_read_b64_tr_b16 a[110:111], v16 offset:9216
  v_mov_b32 v232, 0
  v_mfma_f32_16x16x32_bf16 a[168:171], a[40:43], a[76:79], a[168:171]
  ds_read_b128 a[140:143], v10 offset:38912
  v_mov_b32 v233, 0
  v_mfma_f32_16x16x32_bf16 a[172:175], a[44:47], a[76:79], a[172:175]
  ds_read_b64_tr_b16 a[112:113], v17 offset:8192
  v_mov_b32 v234, 0
  v_mfma_f32_16x16x32_bf16 a[92:95], a[44:47], a[72:75], a[92:95]
  ds_read_b64_tr_b16 a[114:115], v17 offset:9216
  v_mov_b32 v235, 0
  v_mfma_f32_16x16x32_bf16 a[236:239], a[44:47], a[68:71], a[236:239]
  ds_read_b64_tr_b16 a[116:117], v18 offset:8192
  v_mov_b32 v236, 0
  v_mfma_f32_16x16x32_bf16 a[204:207], a[44:47], a[64:67], a[204:207]
  ds_read_b64_tr_b16 a[118:119], v18 offset:9216
  v_mov_b32 v237, 0
  v_mfma_f32_16x16x32_bf16 a[208:211], a[48:51], a[64:67], a[208:211]
  ds_read_b64_tr_b16 a[120:121], v19 offset:8192
  v_mov_b32 v238, 0
  v_mfma_f32_16x16x32_bf16 a[240:243], a[48:51], a[68:71], a[240:243]
  ds_read_b64_tr_b16 a[122:123], v19 offset:9216
  v_mov_b32 v239, 0
  v_mfma_f32_16x16x32_bf16 a[144:147], a[48:51], a[72:75], a[144:147]
  ds_read_b64_tr_b16 a[124:125], v20 offset:8192
  v_mov_b32 v240, 0
  v_mfma_f32_16x16x32_bf16 a[176:179], a[48:51], a[76:79], a[176:179]
  ds_read_b64_tr_b16 a[126:127], v20 offset:9216
  v_mov_b32 v241, 0
  v_mfma_f32_16x16x32_bf16 a[180:183], a[52:55], a[76:79], a[180:183]
  v_mov_b32 v242, 0
  v_mov_b32 v243, 0
  v_mfma_f32_16x16x32_bf16 a[148:151], a[52:55], a[72:75], a[148:151]
  v_mov_b32 v244, 0
  v_mov_b32 v245, 0
  v_mfma_f32_16x16x32_bf16 a[244:247], a[52:55], a[68:71], a[244:247]
  v_mov_b32 v246, 0
  v_mov_b32 v247, 0
  v_mfma_f32_16x16x32_bf16 a[212:215], a[52:55], a[64:67], a[212:215]
  v_mov_b32 v248, 0
  v_mov_b32 v249, 0
  v_mfma_f32_16x16x32_bf16 a[216:219], a[56:59], a[64:67], a[216:219]
  v_mov_b32 v250, 0
  v_mov_b32 v251, 0
  v_mfma_f32_16x16x32_bf16 a[248:251], a[56:59], a[68:71], a[248:251]
  v_mov_b32 v252, 0
  v_mov_b32 v253, 0
  v_mfma_f32_16x16x32_bf16 a[152:155], a[56:59], a[72:75], a[152:155]
  v_mov_b32 v254, 0
  v_mov_b32 v255, 0
  v_mfma_f32_16x16x32_bf16 a[184:187], a[56:59], a[76:79], a[184:187]
  v_mfma_f32_16x16x32_bf16 a[188:191], a[60:63], a[76:79], a[188:191]
  v_mfma_f32_16x16x32_bf16 a[156:159], a[60:63], a[72:75], a[156:159]
  v_mfma_f32_16x16x32_bf16 a[252:255], a[60:63], a[68:71], a[252:255]
  s_waitcnt vmcnt(4) lgkmcnt(0)
  v_and_b32 v116, v116, v117
  v_and_b32 v118, v118, v119
  v_and_b32 v116, v116, v118
  v_and_b32 v116, 1, v116
  v_cmp_ne_u32 vcc, 1, v116
  s_cbranch_vccnz L_spin_10
L_back_11:
  v_mfma_f32_16x16x32_bf16 a[220:223], a[60:63], a[64:67], a[220:223]
  s_barrier
  v_mfma_f32_16x16x32_bf16 a[192:195], a[96:99], a[128:131], a[192:195]
  v_min_u32 v112, v80, v81
  v_min3_u32 v112, v112, v82, v83
  v_mfma_f32_16x16x32_bf16 a[224:227], a[96:99], a[132:135], a[224:227]
  s_add_u32 s70, s85, 0
  v_min3_u32 v112, v112, v84, v85
  v_min3_u32 v112, v112, v86, v87
  v_mfma_f32_16x16x32_bf16 a[80:83], a[96:99], a[136:139], a[80:83]
  s_add_u32 m0, s84, 0
  v_min3_u32 v112, v112, v88, v89
  v_min3_u32 v112, v112, v90, v91
  v_mfma_f32_16x16x32_bf16 a[160:163], a[96:99], a[140:143], a[160:163]
  buffer_load_dwordx4 v2, s[20:23], s70 offen offset:0  lds
  v_mfma_f32_16x16x32_bf16 a[164:167], a[100:103], a[140:143], a[164:167]
  v_min3_u32 v112, v112, v92, v93
  v_min3_u32 v112, v112, v94, v95
  v_mfma_f32_16x16x32_bf16 a[84:87], a[100:103], a[136:139], a[84:87]
  s_add_u32 s70, s85, 0
  v_cmp_eq_u32 vcc, 0, v112
  s_cbranch_vccnz L_spin_12
L_back_13:
  v_mfma_f32_16x16x32_bf16 a[228:231], a[100:103], a[132:135], a[228:231]
  s_add_u32 m0, s84, 0
  v_max_u32 v80, v80, v81
  v_max3_u32 v80, v80, v82, v83
  v_mfma_f32_16x16x32_bf16 a[196:199], a[100:103], a[128:131], a[196:199]
  buffer_load_dwordx4 v2, s[20:23], s70 offen offset:1024  lds
  v_mfma_f32_16x16x32_bf16 a[200:203], a[104:107], a[128:131], a[200:203]
  v_max3_u32 v80, v80, v84, v85
  v_max3_u32 v80, v80, v86, v87
  v_mfma_f32_16x16x32_bf16 a[232:235], a[104:107], a[132:135], a[232:235]
  s_add_u32 s70, s85, 0
  v_max3_u32 v80, v80, v88, v89
  v_max3_u32 v80, v80, v90, v91
  v_mfma_f32_16x16x32_bf16 a[88:91], a[104:107], a[136:139], a[88:91]
  s_add_u32 m0, s84, 0
  v_max3_u32 v80, v80, v92, v93
  v_max3_u32 v80, v80, v94, v95
  v_mfma_f32_16x16x32_bf16 a[168:171], a[104:107], a[140:143], a[168:171]
  buffer_load_dwordx4 v2, s[20:23], s70 offen offset:2048  lds
  v_mfma_f32_16x16x32_bf16 a[172:175], a[108:111], a[140:143], a[172:175]
  s_nop 1
  v_max_u32_dpp v80, v80, v80 row_ror:8 row_mask:0xf bank_mask:0xf
  v_mfma_f32_16x16x32_bf16 a[92:95], a[108:111], a[136:139], a[92:95]
  s_add_u32 s70, s85, 0
  s_nop 1
  v_mfma_f32_16x16x32_bf16 a[236:239], a[108:111], a[132:135], a[236:239]
  s_add_u32 m0, s84, 0
  v_max_u32_dpp v80, v80, v80 row_ror:4 row_mask:0xf bank_mask:0xf
  v_mfma_f32_16x16x32_bf16 a[204:207], a[108:111], a[128:131], a[204:207]
  buffer_load_dwordx4 v2, s[20:23], s70 offen offset:3072  lds
  v_mfma_f32_16x16x32_bf16 a[208:211], a[112:115], a[128:131], a[208:211]
  s_nop 1
  v_max_u32_dpp v80, v80, v80 row_ror:2 row_mask:0xf bank_mask:0xf
  v_mfma_f32_16x16x32_bf16 a[240:243], a[112:115], a[132:135], a[240:243]
  s_add_u32 s70, s85, 16384
  s_nop 1
  v_mfma_f32_16x16x32_bf16 a[144:147], a[112:115], a[136:139], a[144:147]
  s_add_u32 m0, s84, 16384
  v_max_u32_dpp v80, v80, v80 row_ror:1 row_mask:0xf bank_mask:0xf
  v_mov_b32 v81, v80
  v_mfma_f32_16x16x32_bf16 a[176:179], a[112:115], a[140:143], a[176:179]
  buffer_load_dwordx4 v2, s[20:23], s70 offen offset:0  lds
  v_mfma_f32_16x16x32_bf16 a[180:183], a[116:119], a[140:143], a[180:183]
  s_nop 1
  v_mfma_f32_16x16x32_bf16 a[148:151], a[116:119], a[136:139], a[148:151]
  s_add_u32 s70, s85, 16384
  v_permlane16_swap_b32 v80, v81
  v_mfma_f32_16x16x32_bf16 a[244:247], a[116:119], a[132:135], a[244:247]
  s_add_u32 m0, s84, 16384
  v_max_u32 v80, v80, v81
  v_mov_b32 v81, v80
  v_mfma_f32_16x16x32_bf16 a[212:215], a[116:119], a[128:131], a[212:215]
  buffer_load_dwordx4 v2, s[20:23], s70 offen offset:1024  lds
  v_mfma_f32_16x16x32_bf16 a[216:219], a[120:123], a[128:131], a[216:219]
  s_nop 1
  v_mfma_f32_16x16x32_bf16 a[248:251], a[120:123], a[132:135], a[248:251]
  s_add_u32 s70, s85, 16384
  v_permlane32_swap_b32 v80, v81
  v_mfma_f32_16x16x32_bf16 a[152:155], a[120:123], a[136:139], a[152:155]
  s_add_u32 m0, s84, 16384
  v_max_u32 v80, v80, v81
  v_and_b32 v81, 0x7ff, v80
  v_mfma_f32_16x16x32_bf16 a[184:187], a[120:123], a[140:143], a[184:187]
  buffer_load_dwordx4 v2, s[20:23], s70 offen offset:2048  lds
  v_mfma_f32_16x16x32_bf16 a[188:191], a[124:127], a[140:143], a[188:191]
  v_sub_u32 v81, 0x7ff, v81
  v_ashrrev_i32 v82, 31, v80
  v_mfma_f32_16x16x32_bf16 a[156:159], a[124:127], a[136:139], a[156:159]
  s_add_u32 s70, s85, 16384
  v_not_b32 v82, v82
  v_or_b32 v82, 0x80000000, v82
  v_mfma_f32_16x16x32_bf16 a[252:255], a[124:127], a[132:135], a[252:255]
  s_add_u32 m0, s84, 16384
  v_mfma_f32_16x16x32_bf16 a[220:223], a[124:127], a[128:131], a[220:223]
  buffer_load_dwordx4 v2, s[20:23], s70 offen offset:3072  lds
  v_xor_b32 v82, v82, v80
  v_and_b32 v82, 0xffff0000, v82
  v_mul_f32 v82, 0xbfb8aa3b, v82
  v_exp_f32 v82, v82
  v_readfirstlane_b32 s94, v81
  v_add_f32 v82, 1.0, v82
  v_rcp_f32 v82, v82
  s_nop 0
  v_cvt_pk_bf16_f32 v82, v82, v82
  v_and_b32 v82, 0xffff0000, v82
  s_nop 0
  v_readfirstlane_b32 s95, v82
  s_mul_i32 s73, s94, 1152
  s_add_u32 s0, s0, s73
L_attn:
  s_mov_b32 s90, 0x3e0293ee
  s_mov_b32 s91, 0x3e0293ee
  s_add_u32 s70, s85, 32768
  s_add_u32 m0, s84, 32768
  s_nop 0
  buffer_load_dwordx4 v2, s[20:23], s70 offen offset:0  lds
  v_accvgpr_read_b32 v64, a80
  v_accvgpr_read_b32 v65, a81
  v_accvgpr_read_b32 v66, a82
  v_accvgpr_read_b32 v67, a83
  v_accvgpr_read_b32 v68, a84
  v_accvgpr_read_b32 v69, a85
  v_accvgpr_read_b32 v70, a86
  v_accvgpr_read_b32 v71, a87
  v_pk_mul_f32 v[64:65], v[64:65], s[90:91]
  v_pk_mul_f32 v[66:67], v[66:67], s[90:91]
  v_pk_mul_f32 v[68:69], v[68:69], s[90:91]
  v_pk_mul_f32 v[70:71], v[70:71], s[90:91]
  v_cvt_pk_bf16_f32 v64, v64, v65
  v_cvt_pk_bf16_f32 v65, v66, v67
  v_cvt_pk_bf16_f32 v66, v68, v69
  v_cvt_pk_bf16_f32 v67, v70, v71
  v_accvgpr_write_b32 a0, v64
  v_accvgpr_write_b32 a1, v65
  v_accvgpr_write_b32 a2, v66
  v_accvgpr_write_b32 a3, v67
  s_add_u32 s70, s85, 32768
  s_add_u32 m0, s84, 32768
  s_nop 0
  buffer_load_dwordx4 v2, s[20:23], s70 offen offset:1024  lds
  v_accvgpr_read_b32 v72, a88
  v_accvgpr_read_b32 v73, a89
  v_accvgpr_read_b32 v74, a90
  v_accvgpr_read_b32 v75, a91
  v_accvgpr_read_b32 v76, a92
  v_accvgpr_read_b32 v77, a93
  v_accvgpr_read_b32 v78, a94
  v_accvgpr_read_b32 v79, a95
  v_pk_mul_f32 v[72:73], v[72:73], s[90:91]
  v_pk_mul_f32 v[74:75], v[74:75], s[90:91]
  v_pk_mul_f32 v[76:77], v[76:77], s[90:91]
  v_pk_mul_f32 v[78:79], v[78:79], s[90:91]
  v_cvt_pk_bf16_f32 v72, v72, v73
  v_cvt_pk_bf16_f32 v73, v74, v75
  v_cvt_pk_bf16_f32 v74, v76, v77
  v_cvt_pk_bf16_f32 v75, v78, v79
  v_accvgpr_write_b32 a4, v72
  v_accvgpr_write_b32 a5, v73
  v_accvgpr_write_b32 a6, v74
  v_accvgpr_write_b32 a7, v75
  s_add_u32 s70, s85, 32768
  s_add_u32 m0, s84, 32768
  s_nop 0
  buffer_load_dwordx4 v2, s[20:23], s70 offen offset:2048  lds
  v_accvgpr_read_b32 v64, a144
  v_accvgpr_read_b32 v65, a145
  v_accvgpr_read_b32 v66, a146
  v_accvgpr_read_b32 v67, a147
  v_accvgpr_read_b32 v68, a148
  v_accvgpr_read_b32 v69, a149
  v_accvgpr_read_b32 v70, a150
  v_accvgpr_read_b32 v71, a151
  v_pk_mul_f32 v[64:65], v[64:65], s[90:91]
  v_pk_mul_f32 v[66:67], v[66:67], s[90:91]
  v_pk_mul_f32 v[68:69], v[68:69], s[90:91]
  v_pk_mul_f32 v[70:71], v[70:71], s[90:91]
  v_cvt_pk_bf16_f32 v64, v64, v65
  v_cvt_pk_bf16_f32 v65, v66, v67
  v_cvt_pk_bf16_f32 v66, v68, v69
  v_cvt_pk_bf16_f32 v67, v70, v71
  v_accvgpr_write_b32 a8, v64
  v_accvgpr_write_b32 a9, v65
  v_accvgpr_write_b32 a10, v66
  v_accvgpr_write_b32 a11, v67
  s_add_u32 s70, s85, 32768
  s_add_u32 m0, s84, 32768
  s_nop 0
  buffer_load_dwordx4 v2, s[20:23], s70 offen offset:3072  lds
  v_accvgpr_read_b32 v72, a152
  v_accvgpr_read_b32 v73, a153
  v_accvgpr_read_b32 v74, a154
  v_accvgpr_read_b32 v75, a155
  v_accvgpr_read_b32 v76, a156
  v_accvgpr_read_b32 v77, a157
  v_accvgpr_read_b32 v78, a158
  v_accvgpr_read_b32 v79, a159
  v_pk_mul_f32 v[72:73], v[72:73], s[90:91]
  v_pk_mul_f32 v[74:75], v[74:75], s[90:91]
  v_pk_mul_f32 v[76:77], v[76:77], s[90:91]
  v_pk_mul_f32 v[78:79], v[78:79], s[90:91]
  v_cvt_pk_bf16_f32 v72, v72, v73
  v_cvt_pk_bf16_f32 v73, v74, v75
  v_cvt_pk_bf16_f32 v74, v76, v77
  v_cvt_pk_bf16_f32 v75, v78, v79
  v_accvgpr_write_b32 a12, v72
  v_accvgpr_write_b32 a13, v73
  v_accvgpr_write_b32 a14, v74
  v_accvgpr_write_b32 a15, v75
  s_add_u32 s70, s85, 49152
  s_add_u32 m0, s84, 49152
  s_nop 0
  buffer_load_dwordx4 v2, s[20:23], s70 offen offset:0  lds
  v_accvgpr_read_b32 v64, a160
  v_accvgpr_read_b32 v65, a161
  v_accvgpr_read_b32 v66, a162
  v_accvgpr_read_b32 v67, a163
  v_accvgpr_read_b32 v68, a164
  v_accvgpr_read_b32 v69, a165
  v_accvgpr_read_b32 v70, a166
  v_accvgpr_read_b32 v71, a167
  v_pk_mul_f32 v[64:65], v[64:65], s[90:91]
  v_pk_mul_f32 v[66:67], v[66:67], s[90:91]
  v_pk_mul_f32 v[68:69], v[68:69], s[90:91]
  v_pk_mul_f32 v[70:71], v[70:71], s[90:91]
  v_cvt_pk_bf16_f32 v64, v64, v65
  v_cvt_pk_bf16_f32 v65, v66, v67
  v_cvt_pk_bf16_f32 v66, v68, v69
  v_cvt_pk_bf16_f32 v67, v70, v71
  v_accvgpr_write_b32 a16, v64
  v_accvgpr_write_b32 a17, v65
  v_accvgpr_write_b32 a18, v66
  v_accvgpr_write_b32 a19, v67
  s_add_u32 s70, s85, 49152
  s_add_u32 m0, s84, 49152
  s_nop 0
  buffer_load_dwordx4 v2, s[20:23], s70 offen offset:1024  lds
  v_accvgpr_read_b32 v72, a168
  v_accvgpr_read_b32 v73, a169
  v_accvgpr_read_b32 v74, a170
  v_accvgpr_read_b32 v75, a171
  v_accvgpr_read_b32 v76, a172
  v_accvgpr_read_b32 v77, a173
  v_accvgpr_read_b32 v78, a174
  v_accvgpr_read_b32 v79, a175
  v_pk_mul_f32 v[72:73], v[72:73], s[90:91]
  v_pk_mul_f32 v[74:75], v[74:75], s[90:91]
  v_pk_mul_f32 v[76:77], v[76:77], s[90:91]
  v_pk_mul_f32 v[78:79], v[78:79], s[90:91]
  v_cvt_pk_bf16_f32 v72, v72, v73
  v_cvt_pk_bf16_f32 v73, v74, v75
  v_cvt_pk_bf16_f32 v74, v76, v77
  v_cvt_pk_bf16_f32 v75, v78, v79
  v_accvgpr_write_b32 a20, v72
  v_accvgpr_write_b32 a21, v73
  v_accvgpr_write_b32 a22, v74
  v_accvgpr_write_b32 a23, v75
  s_add_u32 s70, s85, 49152
  s_add_u32 m0, s84, 49152
  s_nop 0
  buffer_load_dwordx4 v2, s[20:23], s70 offen offset:2048  lds
  v_accvgpr_read_b32 v64, a176
  v_accvgpr_read_b32 v65, a177
  v_accvgpr_read_b32 v66, a178
  v_accvgpr_read_b32 v67, a179
  v_accvgpr_read_b32 v68, a180
  v_accvgpr_read_b32 v69, a181
  v_accvgpr_read_b32 v70, a182
  v_accvgpr_read_b32 v71, a183
  v_pk_mul_f32 v[64:65], v[64:65], s[90:91]
  v_pk_mul_f32 v[66:67], v[66:67], s[90:91]
  v_pk_mul_f32 v[68:69], v[68:69], s[90:91]
  v_pk_mul_f32 v[70:71], v[70:71], s[90:91]
  v_cvt_pk_bf16_f32 v64, v64, v65
  v_cvt_pk_bf16_f32 v65, v66, v67
  v_cvt_pk_bf16_f32 v66, v68, v69
  v_cvt_pk_bf16_f32 v67, v70, v71
  v_accvgpr_write_b32 a24, v64
  v_accvgpr_write_b32 a25, v65
  v_accvgpr_write_b32 a26, v66
  v_accvgpr_write_b32 a27, v67
  s_add_u32 s70, s85, 49152
  s_add_u32 m0, s84, 49152
  s_nop 0
  buffer_load_dwordx4 v2, s[20:23], s70 offen offset:3072  lds
  v_accvgpr_read_b32 v72, a184
  v_accvgpr_read_b32 v73, a185
  v_accvgpr_read_b32 v74, a186
  v_accvgpr_read_b32 v75, a187
  v_accvgpr_read_b32 v76, a188
  v_accvgpr_read_b32 v77, a189
  v_accvgpr_read_b32 v78, a190
  v_accvgpr_read_b32 v79, a191
  v_pk_mul_f32 v[72:73], v[72:73], s[90:91]
  v_pk_mul_f32 v[74:75], v[74:75], s[90:91]
  v_pk_mul_f32 v[76:77], v[76:77], s[90:91]
  v_pk_mul_f32 v[78:79], v[78:79], s[90:91]
  v_cvt_pk_bf16_f32 v72, v72, v73
  v_cvt_pk_bf16_f32 v73, v74, v75
  v_cvt_pk_bf16_f32 v74, v76, v77
  v_cvt_pk_bf16_f32 v75, v78, v79
  v_accvgpr_write_b32 a28, v72
  v_accvgpr_write_b32 a29, v73
  v_accvgpr_write_b32 a30, v74
  v_accvgpr_write_b32 a31, v75
  s_add_u32 s85, s85, 65536
  s_add_u32 s84, s84, 65536
  s_cmp_lg_u32 s39, 0
  s_cbranch_scc1 L_14
  s_mov_b32 m0, s84
  s_nop 0
  buffer_load_dwordx4 v2, s[20:23], s85 offen offset:0  lds
  buffer_load_dwordx4 v2, s[20:23], s85 offen offset:1024  lds
  buffer_load_dwordx4 v2, s[20:23], s85 offen offset:2048  lds
  buffer_load_dwordx4 v2, s[20:23], s85 offen offset:3072  lds
  s_add_u32 s85, s85, 16384
  s_add_u32 s84, s84, 16384
  s_cmp_ge_u32 s84, 147456
  s_cselect_b32 s70, 147456, 0
  s_sub_u32 s84, s84, s70
L_14:
  s_waitcnt vmcnt(12)
  v_cmp_ne_u32 vcc, s101, v23
  s_cbranch_vccnz L_wb_15
L_back_16:
  s_add_u32 s71, s100, 8192
  v_mov_b32 v30, 1
  s_mov_b64 exec, 1
  buffer_store_dword v30, off, s[20:23], s71 sc1
  s_mov_b64 exec, -1
  s_barrier
  ds_read_b128 a[64:67], v2 offset:8192
  ds_read_b128 a[68:71], v2 offset:9216
  ds_read_b128 a[72:75], v2 offset:10240
  ds_read_b128 a[76:79], v2 offset:11264
  ds_read_b128 a[80:83], v2 offset:12288
  ds_read_b128 a[84:87], v2 offset:13312
  ds_read_b128 a[88:91], v2 offset:14336
  ds_read_b128 a[92:95], v2 offset:15360
  v_accvgpr_read_b32 v64, a192
  v_accvgpr_read_b32 v65, a193
  v_accvgpr_read_b32 v66, a194
  v_accvgpr_read_b32 v67, a195
  v_accvgpr_read_b32 v68, a196
  v_accvgpr_read_b32 v69, a197
  v_accvgpr_read_b32 v70, a198
  v_accvgpr_read_b32 v71, a199
  v_pk_mul_f32 v[64:65], v[64:65], s[90:91]
  v_pk_mul_f32 v[66:67], v[66:67], s[90:91]
  v_pk_mul_f32 v[68:69], v[68:69], s[90:91]
  v_pk_mul_f32 v[70:71], v[70:71], s[90:91]
  v_cvt_pk_bf16_f32 v64, v64, v65
  v_cvt_pk_bf16_f32 v65, v66, v67
  v_cvt_pk_bf16_f32 v66, v68, v69
  v_cvt_pk_bf16_f32 v67, v70, v71
  v_accvgpr_write_b32 a32, v64
  v_accvgpr_write_b32 a33, v65
  v_accvgpr_write_b32 a34, v66
  v_accvgpr_write_b32 a35, v67
  v_accvgpr_read_b32 v72, a200
  v_accvgpr_read_b32 v73, a201
  v_accvgpr_read_b32 v74, a202
  v_accvgpr_read_b32 v75, a203
  v_accvgpr_read_b32 v76, a204
  v_accvgpr_read_b32 v77, a205
  v_accvgpr_read_b32 v78, a206
  v_accvgpr_read_b32 v79, a207
  v_pk_mul_f32 v[72:73], v[72:73], s[90:91]
  v_pk_mul_f32 v[74:75], v[74:75], s[90:91]
  v_pk_mul_f32 v[76:77], v[76:77], s[90:91]
  v_pk_mul_f32 v[78:79], v[78:79], s[90:91]
  v_cvt_pk_bf16_f32 v72, v72, v73
  v_cvt_pk_bf16_f32 v73, v74, v75
  v_cvt_pk_bf16_f32 v74, v76, v77
  v_cvt_pk_bf16_f32 v75, v78, v79
  v_accvgpr_write_b32 a36, v72
  v_accvgpr_write_b32 a37, v73
  v_accvgpr_write_b32 a38, v74
  v_accvgpr_write_b32 a39, v75
  s_waitcnt lgkmcnt(0)
  v_mfma_f32_16x16x32_bf16 v[32:35], a[64:67], a[0:3], 0
  v_mfma_f32_16x16x32_bf16 v[32:35], a[68:71], a[4:7], v[32:35]
  v_accvgpr_read_b32 v64, a208
  v_accvgpr_read_b32 v65, a209
  v_accvgpr_read_b32 v66, a210
  v_accvgpr_read_b32 v67, a211
  v_accvgpr_read_b32 v68, a212
  v_accvgpr_read_b32 v69, a213
  v_accvgpr_read_b32 v70, a214
  v_accvgpr_read_b32 v71, a215
  v_pk_mul_f32 v[64:65], v[64:65], s[90:91]
  v_pk_mul_f32 v[66:67], v[66:67], s[90:91]
  v_pk_mul_f32 v[68:69], v[68:69], s[90:91]
  v_pk_mul_f32 v[70:71], v[70:71], s[90:91]
  v_cvt_pk_bf16_f32 v64, v64, v65
  v_cvt_pk_bf16_f32 v65, v66, v67
  v_cvt_pk_bf16_f32 v66, v68, v69
  v_cvt_pk_bf16_f32 v67, v70, v71
  v_accvgpr_write_b32 a40, v64
  v_accvgpr_write_b32 a41, v65
  v_accvgpr_write_b32 a42, v66
  v_accvgpr_write_b32 a43, v67
  v_mfma_f32_16x16x32_bf16 v[32:35], a[72:75], a[8:11], v[32:35]
  v_mfma_f32_16x16x32_bf16 v[32:35], a[76:79], a[12:15], v[32:35]
  v_mfma_f32_16x16x32_bf16 v[40:43], a[76:79], a[28:31], 0
  v_accvgpr_read_b32 v72, a216
  v_accvgpr_read_b32 v73, a217
  v_accvgpr_read_b32 v74, a218
  v_accvgpr_read_b32 v75, a219
  v_accvgpr_read_b32 v76, a220
  v_accvgpr_read_b32 v77, a221
  v_accvgpr_read_b32 v78, a222
  v_accvgpr_read_b32 v79, a223
  v_pk_mul_f32 v[72:73], v[72:73], s[90:91]
  v_pk_mul_f32 v[74:75], v[74:75], s[90:91]
  v_pk_mul_f32 v[76:77], v[76:77], s[90:91]
  v_pk_mul_f32 v[78:79], v[78:79], s[90:91]
  v_cvt_pk_bf16_f32 v72, v72, v73
  v_cvt_pk_bf16_f32 v73, v74, v75
  v_cvt_pk_bf16_f32 v74, v76, v77
  v_cvt_pk_bf16_f32 v75, v78, v79
  v_accvgpr_write_b32 a44, v72
  v_accvgpr_write_b32 a45, v73
  v_accvgpr_write_b32 a46, v74
  v_accvgpr_write_b32 a47, v75
  v_mfma_f32_16x16x32_bf16 v[40:43], a[72:75], a[24:27], v[40:43]
  v_mfma_f32_16x16x32_bf16 v[40:43], a[68:71], a[20:23], v[40:43]
  v_mfma_f32_16x16x32_bf16 v[40:43], a[64:67], a[16:19], v[40:43]
  v_accvgpr_read_b32 v64, a224
  v_accvgpr_read_b32 v65, a225
  v_accvgpr_read_b32 v66, a226
  v_accvgpr_read_b32 v67, a227
  v_accvgpr_read_b32 v68, a228
  v_accvgpr_read_b32 v69, a229
  v_accvgpr_read_b32 v70, a230
  v_accvgpr_read_b32 v71, a231
  v_pk_mul_f32 v[64:65], v[64:65], s[90:91]
  v_pk_mul_f32 v[66:67], v[66:67], s[90:91]
  v_pk_mul_f32 v[68:69], v[68:69], s[90:91]
  v_pk_mul_f32 v[70:71], v[70:71], s[90:91]
  v_cvt_pk_bf16_f32 v64, v64, v65
  v_cvt_pk_bf16_f32 v65, v66, v67
  v_cvt_pk_bf16_f32 v66, v68, v69
  v_cvt_pk_bf16_f32 v67, v70, v71
  v_accvgpr_write_b32 a48, v64
  v_accvgpr_write_b32 a49, v65
  v_accvgpr_write_b32 a50, v66
  v_accvgpr_write_b32 a51, v67
  v_mfma_f32_16x16x32_bf16 v[36:39], a[80:83], a[0:3], 0
  v_mfma_f32_16x16x32_bf16 v[36:39], a[84:87], a[4:7], v[36:39]
  v_accvgpr_read_b32 v72, a232
  v_accvgpr_read_b32 v73, a233
  v_accvgpr_read_b32 v74, a234
  v_accvgpr_read_b32 v75, a235
  v_accvgpr_read_b32 v76, a236
  v_accvgpr_read_b32 v77, a237
  v_accvgpr_read_b32 v78, a238
  v_accvgpr_read_b32 v79, a239
  v_pk_mul_f32 v[72:73], v[72:73], s[90:91]
  v_pk_mul_f32 v[74:75], v[74:75], s[90:91]
  v_pk_mul_f32 v[76:77], v[76:77], s[90:91]
  v_pk_mul_f32 v[78:79], v[78:79], s[90:91]
  v_cvt_pk_bf16_f32 v72, v72, v73
  v_cvt_pk_bf16_f32 v73, v74, v75
  v_cvt_pk_bf16_f32 v74, v76, v77
  v_cvt_pk_bf16_f32 v75, v78, v79
  v_accvgpr_write_b32 a52, v72
  v_accvgpr_write_b32 a53, v73
  v_accvgpr_write_b32 a54, v74
  v_accvgpr_write_b32 a55, v75
  v_mfma_f32_16x16x32_bf16 v[36:39], a[88:91], a[8:11], v[36:39]
  v_mfma_f32_16x16x32_bf16 v[36:39], a[92:95], a[12:15], v[36:39]
  v_mfma_f32_16x16x32_bf16 v[44:47], a[92:95], a[28:31], 0
  v_accvgpr_read_b32 v64, a240
  v_accvgpr_read_b32 v65, a241
  v_accvgpr_read_b32 v66, a242
  v_accvgpr_read_b32 v67, a243
  v_accvgpr_read_b32 v68, a244
  v_accvgpr_read_b32 v69, a245
  v_accvgpr_read_b32 v70, a246
  v_accvgpr_read_b32 v71, a247
  v_pk_mul_f32 v[64:65], v[64:65], s[90:91]
  v_pk_mul_f32 v[66:67], v[66:67], s[90:91]
  v_pk_mul_f32 v[68:69], v[68:69], s[90:91]
  v_pk_mul_f32 v[70:71], v[70:71], s[90:91]
  v_cvt_pk_bf16_f32 v64, v64, v65
  v_cvt_pk_bf16_f32 v65, v66, v67
  v_cvt_pk_bf16_f32 v66, v68, v69
  v_cvt_pk_bf16_f32 v67, v70, v71
  v_accvgpr_write_b32 a56, v64
  v_accvgpr_write_b32 a57, v65
  v_accvgpr_write_b32 a58, v66
  v_accvgpr_write_b32 a59, v67
  v_mfma_f32_16x16x32_bf16 v[44:47], a[88:91], a[24:27], v[44:47]
  v_mfma_f32_16x16x32_bf16 v[44:47], a[84:87], a[20:23], v[44:47]
  v_mfma_f32_16x16x32_bf16 v[44:47], a[80:83], a[16:19], v[44:47]
  v_accvgpr_read_b32 v72, a248
  v_accvgpr_read_b32 v73, a249
  v_accvgpr_read_b32 v74, a250
  v_accvgpr_read_b32 v75, a251
  v_accvgpr_read_b32 v76, a252
  v_accvgpr_read_b32 v77, a253
  v_accvgpr_read_b32 v78, a254
  v_accvgpr_read_b32 v79, a255
  v_pk_mul_f32 v[72:73], v[72:73], s[90:91]
  v_pk_mul_f32 v[74:75], v[74:75], s[90:91]
  v_pk_mul_f32 v[76:77], v[76:77], s[90:91]
  v_pk_mul_f32 v[78:79], v[78:79], s[90:91]
  v_cvt_pk_bf16_f32 v72, v72, v73
  v_cvt_pk_bf16_f32 v73, v74, v75
  v_cvt_pk_bf16_f32 v74, v76, v77
  v_cvt_pk_bf16_f32 v75, v78, v79
  v_accvgpr_write_b32 a60, v72
  v_accvgpr_write_b32 a61, v73
  v_accvgpr_write_b32 a62, v74
  v_accvgpr_write_b32 a63, v75
  v_accvgpr_write_b32 a128, v114
  v_accvgpr_write_b32 a132, v115
  v_accvgpr_write_b32 a129, v114
  v_accvgpr_write_b32 a133, v115
  v_accvgpr_write_b32 a130, v114
  v_accvgpr_write_b32 a134, v115
  v_accvgpr_write_b32 a131, v114
  v_accvgpr_write_b32 a135, v115
  s_cmp_eq_u32 s37, 0
  s_cselect_b32 s88, -1, 0
  s_and_b32 s71, s88, 0xff800000
  v_and_b32 v48, s88, v108
  v_and_b32 v49, s88, v109
  v_and_b32 v50, s88, v110
  v_and_b32 v51, s88, v111
  v_mov_b32 v52, s71
  v_mov_b32 v53, s71
  v_mov_b32 v54, s71
  v_mov_b32 v55, s71
  v_mov_b32 v56, 0
  v_mov_b32 v57, 0
  v_mov_b32 v58, 0
  v_mov_b32 v59, 0
  v_and_b32 v60, s88, v108
  v_and_b32 v61, s88, v109
  v_and_b32 v62, s88, v110
  v_and_b32 v63, s88, v111
  s_nop 1
  v_and_b32 v127, 31, v1
  v_lshlrev_b32 v127, 2, v127
  s_and_b32 s71, s100, 0xffffff80
  s_add_u32 s71, s71, 8192
  buffer_load_dword v127, v127, s[20:23], s71 offen sc1
  v_mfma_f32_16x16x32_bf16 v[48:51], a[64:67], a[32:35], v[48:51]
  v_max3_f32 v5, v32, v33, v34
  v_max3_f32 v5, v5, v35, v36
  v_mfma_f32_16x16x32_bf16 v[48:51], a[68:71], a[36:39], v[48:51]
  v_max3_f32 v5, v5, v37, v38
  v_max_f32 v5, v5, v39
  v_mfma_f32_16x16x32_bf16 v[48:51], a[72:75], a[40:43], v[48:51]
  v_max3_f32 v6, v40, v41, v42
  v_max3_f32 v6, v6, v43, v44
  v_mfma_f32_16x16x32_bf16 v[48:51], a[76:79], a[44:47], v[48:51]
  v_max3_f32 v6, v6, v45, v46
  v_max_f32 v6, v6, v47
  v_mfma_f32_16x16x32_bf16 v[56:59], a[76:79], a[60:63], v[56:59]
  v_mov_b32 v9, v5
  v_mov_b32 v10, v6
  v_mfma_f32_16x16x32_bf16 v[56:59], a[72:75], a[56:59], v[56:59]
  s_nop 1
  v_mfma_f32_16x16x32_bf16 v[56:59], a[68:71], a[52:55], v[56:59]
  v_permlane16_swap_b32 v5, v9
  v_mfma_f32_16x16x32_bf16 v[56:59], a[64:67], a[48:51], v[56:59]
  v_permlane16_swap_b32 v6, v10
  v_mfma_f32_16x16x32_bf16 v[52:55], a[80:83], a[32:35], v[52:55]
  v_max_f32 v5, v5, v9
  v_max_f32 v6, v6, v10
  v_mfma_f32_16x16x32_bf16 v[52:55], a[84:87], a[36:39], v[52:55]
  v_mov_b32 v9, v5
  v_mov_b32 v10, v6
  v_mfma_f32_16x16x32_bf16 v[52:55], a[88:91], a[40:43], v[52:55]
  s_nop 1
  v_mfma_f32_16x16x32_bf16 v[52:55], a[92:95], a[44:47], v[52:55]
  v_permlane32_swap_b32 v5, v9
  v_mfma_f32_16x16x32_bf16 v[60:63], a[92:95], a[60:63], v[60:63]
  v_permlane32_swap_b32 v6, v10
  v_mfma_f32_16x16x32_bf16 v[60:63], a[88:91], a[56:59], v[60:63]
  v_max_f32 v5, v5, v9
  v_max_f32 v6, v6, v10
  v_mfma_f32_16x16x32_bf16 v[60:63], a[84:87], a[52:55], v[60:63]
  v_sub_f32 v32, v32, v5
  v_sub_f32 v33, v33, v5
  v_mfma_f32_16x16x32_bf16 v[60:63], a[80:83], a[48:51], v[60:63]
  v_sub_f32 v34, v34, v5
  v_sub_f32 v35, v35, v5
  v_sub_f32 v36, v36, v5
  v_sub_f32 v37, v37, v5
  v_sub_f32 v38, v38, v5
  v_sub_f32 v39, v39, v5
  v_sub_f32 v40, v40, v6
  v_sub_f32 v41, v41, v6
  v_sub_f32 v42, v42, v6
  v_sub_f32 v43, v43, v6
  v_sub_f32 v44, v44, v6
  v_sub_f32 v45, v45, v6
  v_sub_f32 v46, v46, v6
  v_sub_f32 v47, v47, v6
  v_exp_f32 v112, v32
  v_exp_f32 v113, v33
  v_exp_f32 v114, v34
  v_exp_f32 v115, v35
  v_exp_f32 v116, v40
  v_exp_f32 v117, v41
  v_exp_f32 v118, v42
  v_exp_f32 v119, v43
  v_max3_f32 v7, v48, v49, v50
  v_max3_f32 v7, v7, v51, v52
  v_max3_f32 v7, v7, v53, v54
  v_max_f32 v7, v7, v55
  v_max3_f32 v8, v56, v57, v58
  v_max3_f32 v8, v8, v59, v60
  v_max3_f32 v8, v8, v61, v62
  v_max_f32 v8, v8, v63
  v_cvt_pk_bf16_f32 v64, v112, v113
  v_cvt_pk_bf16_f32 v65, v114, v115
  v_cvt_pk_bf16_f32 v68, v116, v117
  v_cvt_pk_bf16_f32 v69, v118, v119
  v_mov_b32 v11, v7
  v_mov_b32 v12, v8
  s_nop 1
  v_permlane16_swap_b32 v7, v11
  v_permlane16_swap_b32 v8, v12
  v_max_f32 v7, v7, v11
  v_max_f32 v8, v8, v12
  v_mov_b32 v11, v7
  v_mov_b32 v12, v8
  s_nop 1
  v_permlane32_swap_b32 v7, v11
  v_permlane32_swap_b32 v8, v12
  v_max_f32 v7, v7, v11
  v_max_f32 v8, v8, v12
  v_exp_f32 v112, v36
  v_exp_f32 v113, v37
  v_exp_f32 v114, v38
  v_exp_f32 v115, v39
  v_exp_f32 v116, v44
  v_sub_f32 v80, 0, v5
  v_sub_f32 v81, 0, v5
  v_sub_f32 v82, 0, v5
  v_sub_f32 v83, 0, v5
  v_sub_f32 v84, 0, v6
  v_sub_f32 v85, 0, v6
  v_sub_f32 v86, 0, v6
  v_sub_f32 v87, 0, v6
  v_sub_f32 v88, 0, v7
  v_sub_f32 v89, 0, v7
  v_sub_f32 v90, 0, v7
  v_sub_f32 v91, 0, v7
  v_sub_f32 v92, 0, v8
  v_sub_f32 v93, 0, v8
  v_sub_f32 v94, 0, v8
  v_sub_f32 v95, 0, v8
  s_waitcnt vmcnt(0)
  v_cmp_ne_u32 vcc, 1, v127
  s_cbranch_vccnz L_spin_17
L_back_18:
  s_add_u32 s81, s39, 4
  s_mov_b32 s80, 99
  s_sub_u32 s82, s39, 1
  s_cmp_eq_u32 s39, 0
  s_cbranch_scc1 L_dual2c
  s_cmp_lt_u32 s33, 144
  s_cbranch_scc0 L_dual
  s_sub_u32 s82, s36, 3
  s_mul_i32 s82, s82, 4
  s_cmp_lg_u32 s82, 0
  s_cbranch_scc1 L_dual
L_modsteps:
  s_sub_u32 s82, s39, 1
  s_add_u32 s80, s83, 12
  v_mfma_f32_16x16x32_bf16 v[48:51], a[64:67], a[32:35], v[88:91]
  s_barrier
  v_exp_f32 v117, v45
  v_mfma_f32_16x16x32_bf16 v[48:51], a[68:71], a[36:39], v[48:51]
  s_mov_b32 m0, s84
  ds_read_b128 a[96:99], v3 offset:0
  v_cvt_pk_bf16_f32 v66, v112, v113
  v_mfma_f32_16x16x32_bf16 v[48:51], a[72:75], a[40:43], v[48:51]
  s_add_u32 s84, s84, 16384
  v_exp_f32 v118, v46
  v_mfma_f32_16x16x32_bf16 v[48:51], a[76:79], a[44:47], v[48:51]
  s_cmp_ge_u32 s84, 147456
  buffer_load_dwordx4 v2, s[20:23], s85 offen offset:0  lds
  v_mfma_f32_16x16x32_bf16 v[56:59], a[76:79], a[60:63], v[92:95]
  s_cselect_b32 s70, 147456, 0
  v_exp_f32 v119, v47
  v_mfma_f32_16x16x32_bf16 v[56:59], a[72:75], a[56:59], v[56:59]
  s_sub_u32 s84, s84, s70
  ds_read_b128 a[100:103], v3 offset:1024
  v_cvt_pk_bf16_f32 v67, v114, v115
  v_mfma_f32_16x16x32_bf16 v[56:59], a[68:71], a[52:55], v[56:59]
  ds_read_b128 a[104:107], v3 offset:2048
  v_cvt_pk_bf16_f32 v70, v116, v117
  v_mfma_f32_16x16x32_bf16 v[56:59], a[64:67], a[48:51], v[56:59]
  s_waitcnt lgkmcnt(3)
  ds_read_b128 a[108:111], v3 offset:3072
  v_cvt_pk_bf16_f32 v71, v118, v119
  v_mfma_f32_16x16x32_bf16 v[52:55], a[80:83], a[32:35], v[88:91]
  ds_read_b128 a[112:115], v3 offset:4096
  ds_read_b128 a[116:119], v3 offset:5120
  v_mfma_f32_16x16x32_bf16 v[52:55], a[84:87], a[36:39], v[52:55]
  ds_read_b128 a[120:123], v3 offset:6144
  ds_read_b128 a[124:127], v3 offset:7168
  v_mfma_f32_16x16x32_bf16 v[104:107], a[128:131], v[64:67], v[96:99]
  v_exp_f32 v112, v48
  v_mfma_f32_16x16x32_bf16 v[104:107], a[132:135], v[68:71], v[104:107]
  v_exp_f32 v113, v49
  v_mfma_f32_16x16x32_bf16 v[52:55], a[88:91], a[40:43], v[52:55]
  buffer_load_dwordx4 v2, s[20:23], s85 offen offset:1024  lds
  v_mfma_f32_16x16x32_bf16 v[52:55], a[92:95], a[44:47], v[52:55]
  v_exp_f32 v114, v50
  v_mfma_f32_16x16x32_bf16 v[60:63], a[92:95], a[60:63], v[92:95]
  s_nop 0
  v_exp_f32 v115, v51
  v_mfma_f32_16x16x32_bf16 v[60:63], a[88:91], a[56:59], v[60:63]
  ds_read_b128 a[64:67], v4 offset:8192
  v_cmp_nge_f32 vcc, s87, v106
  v_mfma_f32_16x16x32_bf16 v[60:63], a[84:87], a[52:55], v[60:63]
  s_waitcnt lgkmcnt(1)
  v_exp_f32 v116, v56
  v_mfma_f32_16x16x32_bf16 v[60:63], a[80:83], a[48:51], v[60:63]
  s_cbranch_vccnz L_rs_20
L_rr_21:
  v_exp_f32 v117, v57
  v_mfma_f32_16x16x32_bf16 v[128:131], a[96:99], v[64:67], v[128:131]
  ds_read_b128 a[68:71], v4 offset:9216
  v_cvt_pk_bf16_f32 v72, v112, v113
  v_mfma_f32_16x16x32_bf16 v[132:135], a[96:99], v[68:71], v[132:135]
  v_exp_f32 v118, v58
  v_mfma_f32_16x16x32_bf16 v[136:139], a[100:103], v[64:67], v[136:139]
  buffer_load_dwordx4 v2, s[20:23], s85 offen offset:2048  lds
  v_mfma_f32_16x16x32_bf16 v[140:143], a[100:103], v[68:71], v[140:143]
  v_exp_f32 v119, v59
  v_mfma_f32_16x16x32_bf16 v[144:147], a[104:107], v[64:67], v[144:147]
  ds_read_b128 a[72:75], v4 offset:10240
  v_mov_b32 v96, v104
  v_mfma_f32_16x16x32_bf16 v[148:151], a[104:107], v[68:71], v[148:151]
  v_exp_f32 v112, v52
  v_mfma_f32_16x16x32_bf16 v[152:155], a[108:111], v[64:67], v[152:155]
  ds_read_b128 a[76:79], v4 offset:11264
  v_cvt_pk_bf16_f32 v73, v114, v115
  v_mfma_f32_16x16x32_bf16 v[156:159], a[108:111], v[68:71], v[156:159]
  v_exp_f32 v113, v53
  v_mfma_f32_16x16x32_bf16 v[160:163], a[112:115], v[64:67], v[160:163]
  ds_read_b128 a[80:83], v4 offset:12288
  v_cvt_pk_bf16_f32 v76, v116, v117
  v_mfma_f32_16x16x32_bf16 v[164:167], a[112:115], v[68:71], v[164:167]
  v_exp_f32 v114, v54
  v_mfma_f32_16x16x32_bf16 v[168:171], a[116:119], v[64:67], v[168:171]
  buffer_load_dwordx4 v2, s[20:23], s85 offen offset:3072  lds
  v_mfma_f32_16x16x32_bf16 v[172:175], a[116:119], v[68:71], v[172:175]
  s_add_u32 s85, s85, 16384
  v_exp_f32 v115, v55
  v_mfma_f32_16x16x32_bf16 v[176:179], a[120:123], v[64:67], v[176:179]
  ds_read_b128 a[84:87], v4 offset:13312
  v_cvt_pk_bf16_f32 v77, v118, v119
  v_mfma_f32_16x16x32_bf16 v[180:183], a[120:123], v[68:71], v[180:183]
  v_exp_f32 v116, v60
  v_mfma_f32_16x16x32_bf16 v[184:187], a[124:127], v[64:67], v[184:187]
  ds_read_b128 a[88:91], v4 offset:14336
  v_mov_b32 v97, v105
  v_mfma_f32_16x16x32_bf16 v[188:191], a[124:127], v[68:71], v[188:191]
  s_waitcnt lgkmcnt(3)
  ds_read_b128 a[92:95], v4 offset:15360
  v_mfma_f32_16x16x32_bf16 v[32:35], a[64:67], a[0:3], v[80:83]
  v_exp_f32 v117, v61
  v_mfma_f32_16x16x32_bf16 v[32:35], a[68:71], a[4:7], v[32:35]
  s_mov_b32 m0, s84
  v_cvt_pk_bf16_f32 v74, v112, v113
  v_mfma_f32_16x16x32_bf16 v[32:35], a[72:75], a[8:11], v[32:35]
  s_add_u32 s84, s84, 16384
  v_exp_f32 v118, v62
  v_mfma_f32_16x16x32_bf16 v[32:35], a[76:79], a[12:15], v[32:35]
  s_cmp_ge_u32 s84, 147456
  buffer_load_dwordx4 v2, s[20:23], s85 offen offset:0  lds
  v_mfma_f32_16x16x32_bf16 v[40:43], a[76:79], a[28:31], v[84:87]
  s_cselect_b32 s70, 147456, 0
  v_exp_f32 v119, v63
  v_mfma_f32_16x16x32_bf16 v[40:43], a[72:75], a[24:27], v[40:43]
  s_sub_u32 s84, s84, s70
  v_cvt_pk_bf16_f32 v75, v114, v115
  v_mfma_f32_16x16x32_bf16 v[40:43], a[68:71], a[20:23], v[40:43]
  v_cvt_pk_bf16_f32 v78, v116, v117
  v_mfma_f32_16x16x32_bf16 v[40:43], a[64:67], a[16:19], v[40:43]
  s_waitcnt lgkmcnt(0)
  v_cvt_pk_bf16_f32 v79, v118, v119
  v_mfma_f32_16x16x32_bf16 v[36:39], a[80:83], a[0:3], v[80:83]
  s_nop 1
  v_mfma_f32_16x16x32_bf16 v[36:39], a[84:87], a[4:7], v[36:39]
  s_nop 0
  buffer_load_dwordx2 v[22:23], v29, s[12:15], s0 offen
  v_mfma_f32_16x16x32_bf16 v[104:107], a[128:131], v[72:75], v[100:103]
  v_exp_f32 v112, v32
  v_mfma_f32_16x16x32_bf16 v[104:107], a[132:135], v[76:79], v[104:107]
  v_exp_f32 v113, v33
  v_mfma_f32_16x16x32_bf16 v[36:39], a[88:91], a[8:11], v[36:39]
  buffer_load_dwordx4 v2, s[20:23], s85 offen offset:1024  lds
  v_mfma_f32_16x16x32_bf16 v[36:39], a[92:95], a[12:15], v[36:39]
  s_nop 0
  v_exp_f32 v114, v34
  v_mfma_f32_16x16x32_bf16 v[44:47], a[92:95], a[28:31], v[84:87]
  s_nop 0
  v_exp_f32 v115, v35
  v_mfma_f32_16x16x32_bf16 v[44:47], a[88:91], a[24:27], v[44:47]
  buffer_load_dwordx4 a[136:139], v26, s[24:27], s74 offen offset:0 nt
  v_cmp_nge_f32 vcc, s87, v106
  v_mfma_f32_16x16x32_bf16 v[44:47], a[84:87], a[20:23], v[44:47]
  v_exp_f32 v116, v40
  v_mfma_f32_16x16x32_bf16 v[44:47], a[80:83], a[16:19], v[44:47]
  s_cbranch_vccnz L_rs_22
L_rr_23:
  v_exp_f32 v117, v41
  v_mfma_f32_16x16x32_bf16 v[192:195], a[96:99], v[72:75], v[192:195]
  v_cvt_pk_bf16_f32 v64, v112, v113
  v_mfma_f32_16x16x32_bf16 v[196:199], a[96:99], v[76:79], v[196:199]
  s_add_u32 s86, s86, 16384
  v_exp_f32 v118, v42
  v_mfma_f32_16x16x32_bf16 v[200:203], a[100:103], v[72:75], v[200:203]
  s_cmp_ge_u32 s86, 147456
  buffer_load_dwordx4 v2, s[20:23], s85 offen offset:2048  lds
  v_mfma_f32_16x16x32_bf16 v[204:207], a[100:103], v[76:79], v[204:207]
  s_cselect_b32 s86, 0, s86
  v_exp_f32 v119, v43
  v_mfma_f32_16x16x32_bf16 v[208:211], a[104:107], v[72:75], v[208:211]
  v_mov_b32 v100, v104
  v_mfma_f32_16x16x32_bf16 v[212:215], a[104:107], v[76:79], v[212:215]
  v_exp_f32 v112, v36
  v_mfma_f32_16x16x32_bf16 v[216:219], a[108:111], v[72:75], v[216:219]
  buffer_load_dwordx4 a[152:155], v26, s[24:27], s74 offen offset:128 nt
  v_cvt_pk_bf16_f32 v65, v114, v115
  v_mfma_f32_16x16x32_bf16 v[220:223], a[108:111], v[76:79], v[220:223]
  v_exp_f32 v113, v37
  v_mfma_f32_16x16x32_bf16 v[224:227], a[112:115], v[72:75], v[224:227]
  v_cvt_pk_bf16_f32 v68, v116, v117
  v_mfma_f32_16x16x32_bf16 v[228:231], a[112:115], v[76:79], v[228:231]
  v_exp_f32 v114, v38
  v_mfma_f32_16x16x32_bf16 v[232:235], a[116:119], v[72:75], v[232:235]
  buffer_load_dwordx4 v2, s[20:23], s85 offen offset:3072  lds
  v_mfma_f32_16x16x32_bf16 v[236:239], a[116:119], v[76:79], v[236:239]
  s_add_u32 s85, s85, 16384
  v_exp_f32 v115, v39
  v_mfma_f32_16x16x32_bf16 v[240:243], a[120:123], v[72:75], v[240:243]
  s_add_u32 s83, s83, 1
  v_cvt_pk_bf16_f32 v69, v118, v119
  v_mfma_f32_16x16x32_bf16 v[244:247], a[120:123], v[76:79], v[244:247]
  v_exp_f32 v116, v44
  v_mfma_f32_16x16x32_bf16 v[248:251], a[124:127], v[72:75], v[248:251]
  buffer_load_dwordx4 a[168:171], v26, s[24:27], s74 offen offset:256 nt
  v_mov_b32 v101, v105
  v_mfma_f32_16x16x32_bf16 v[252:255], a[124:127], v[76:79], v[252:255]
  s_waitcnt vmcnt(12)
  v_mov_b32 v4, v3
  v_add_u32 v3, s86, v2
  v_mfma_f32_16x16x32_bf16 v[48:51], a[64:67], a[32:35], v[88:91]
  s_barrier
  v_exp_f32 v117, v45
  v_mfma_f32_16x16x32_bf16 v[48:51], a[68:71], a[36:39], v[48:51]
  s_mov_b32 m0, s84
  ds_read_b128 a[96:99], v3 offset:0
  v_cvt_pk_bf16_f32 v66, v112, v113
  v_mfma_f32_16x16x32_bf16 v[48:51], a[72:75], a[40:43], v[48:51]
  s_add_u32 s84, s84, 16384
  v_exp_f32 v118, v46
  v_mfma_f32_16x16x32_bf16 v[48:51], a[76:79], a[44:47], v[48:51]
  s_cmp_ge_u32 s84, 147456
  buffer_load_dwordx4 v2, s[20:23], s85 offen offset:0  lds
  v_mfma_f32_16x16x32_bf16 v[56:59], a[76:79], a[60:63], v[92:95]
  s_cselect_b32 s70, 147456, 0
  v_exp_f32 v119, v47
  v_mfma_f32_16x16x32_bf16 v[56:59], a[72:75], a[56:59], v[56:59]
  s_sub_u32 s84, s84, s70
  ds_read_b128 a[100:103], v3 offset:1024
  v_cvt_pk_bf16_f32 v67, v114, v115
  v_mfma_f32_16x16x32_bf16 v[56:59], a[68:71], a[52:55], v[56:59]
  ds_read_b128 a[104:107], v3 offset:2048
  v_cvt_pk_bf16_f32 v70, v116, v117
  v_mfma_f32_16x16x32_bf16 v[56:59], a[64:67], a[48:51], v[56:59]
  s_waitcnt lgkmcnt(3)
  ds_read_b128 a[108:111], v3 offset:3072
  v_cvt_pk_bf16_f32 v71, v118, v119
  v_mfma_f32_16x16x32_bf16 v[52:55], a[80:83], a[32:35], v[88:91]
  ds_read_b128 a[112:115], v3 offset:4096
  ds_read_b128 a[116:119], v3 offset:5120
  v_mfma_f32_16x16x32_bf16 v[52:55], a[84:87], a[36:39], v[52:55]
  ds_read_b128 a[120:123], v3 offset:6144
  ds_read_b128 a[124:127], v3 offset:7168
  v_mfma_f32_16x16x32_bf16 v[104:107], a[128:131], v[64:67], v[96:99]
  v_exp_f32 v112, v48
  v_mfma_f32_16x16x32_bf16 v[104:107], a[132:135], v[68:71], v[104:107]
  v_exp_f32 v113, v49
  v_mfma_f32_16x16x32_bf16 v[52:55], a[88:91], a[40:43], v[52:55]
  buffer_load_dwordx4 v2, s[20:23], s85 offen offset:1024  lds
  v_mfma_f32_16x16x32_bf16 v[52:55], a[92:95], a[44:47], v[52:55]
  v_exp_f32 v114, v50
  v_mfma_f32_16x16x32_bf16 v[60:63], a[92:95], a[60:63], v[92:95]
  s_nop 0
  v_exp_f32 v115, v51
  v_mfma_f32_16x16x32_bf16 v[60:63], a[88:91], a[56:59], v[60:63]
  ds_read_b128 a[64:67], v4 offset:8192
  v_cmp_nge_f32 vcc, s87, v106
  v_mfma_f32_16x16x32_bf16 v[60:63], a[84:87], a[52:55], v[60:63]
  s_waitcnt lgkmcnt(1)
  v_exp_f32 v116, v56
  v_mfma_f32_16x16x32_bf16 v[60:63], a[80:83], a[48:51], v[60:63]
  s_cbranch_vccnz L_rs_24
L_rr_25:
  v_exp_f32 v117, v57
  v_mfma_f32_16x16x32_bf16 v[128:131], a[96:99], v[64:67], v[128:131]
  ds_read_b128 a[68:71], v4 offset:9216
  v_cvt_pk_bf16_f32 v72, v112, v113
  v_mfma_f32_16x16x32_bf16 v[132:135], a[96:99], v[68:71], v[132:135]
  v_exp_f32 v118, v58
  v_mfma_f32_16x16x32_bf16 v[136:139], a[100:103], v[64:67], v[136:139]
  buffer_load_dwordx4 v2, s[20:23], s85 offen offset:2048  lds
  v_mfma_f32_16x16x32_bf16 v[140:143], a[100:103], v[68:71], v[140:143]
  v_exp_f32 v119, v59
  v_mfma_f32_16x16x32_bf16 v[144:147], a[104:107], v[64:67], v[144:147]
  ds_read_b128 a[72:75], v4 offset:10240
  v_mov_b32 v96, v104
  v_mfma_f32_16x16x32_bf16 v[148:151], a[104:107], v[68:71], v[148:151]
  v_exp_f32 v112, v52
  v_mfma_f32_16x16x32_bf16 v[152:155], a[108:111], v[64:67], v[152:155]
  ds_read_b128 a[76:79], v4 offset:11264
  v_cvt_pk_bf16_f32 v73, v114, v115
  v_mfma_f32_16x16x32_bf16 v[156:159], a[108:111], v[68:71], v[156:159]
  v_exp_f32 v113, v53
  v_mfma_f32_16x16x32_bf16 v[160:163], a[112:115], v[64:67], v[160:163]
  ds_read_b128 a[80:83], v4 offset:12288
  v_cvt_pk_bf16_f32 v76, v116, v117
  v_mfma_f32_16x16x32_bf16 v[164:167], a[112:115], v[68:71], v[164:167]
  v_exp_f32 v114, v54
  v_mfma_f32_16x16x32_bf16 v[168:171], a[116:119], v[64:67], v[168:171]
  buffer_load_dwordx4 v2, s[20:23], s85 offen offset:3072  lds
  v_mfma_f32_16x16x32_bf16 v[172:175], a[116:119], v[68:71], v[172:175]
  s_add_u32 s85, s85, 16384
  v_exp_f32 v115, v55
  v_mfma_f32_16x16x32_bf16 v[176:179], a[120:123], v[64:67], v[176:179]
  ds_read_b128 a[84:87], v4 offset:13312
  v_cvt_pk_bf16_f32 v77, v118, v119
  v_mfma_f32_16x16x32_bf16 v[180:183], a[120:123], v[68:71], v[180:183]
  v_exp_f32 v116, v60
  v_mfma_f32_16x16x32_bf16 v[184:187], a[124:127], v[64:67], v[184:187]
  ds_read_b128 a[88:91], v4 offset:14336
  v_mov_b32 v97, v105
  v_mfma_f32_16x16x32_bf16 v[188:191], a[124:127], v[68:71], v[188:191]
  s_waitcnt lgkmcnt(3)
  ds_read_b128 a[92:95], v4 offset:15360
  v_mfma_f32_16x16x32_bf16 v[32:35], a[64:67], a[0:3], v[80:83]
  v_exp_f32 v117, v61
  v_mfma_f32_16x16x32_bf16 v[32:35], a[68:71], a[4:7], v[32:35]
  v_cvt_pk_bf16_f32 v74, v112, v113
  v_mfma_f32_16x16x32_bf16 v[32:35], a[72:75], a[8:11], v[32:35]
  v_exp_f32 v118, v62
  v_mfma_f32_16x16x32_bf16 v[32:35], a[76:79], a[12:15], v[32:35]
  buffer_load_dwordx4 a[184:187], v26, s[24:27], s74 offen offset:384 nt
  v_mfma_f32_16x16x32_bf16 v[40:43], a[76:79], a[28:31], v[84:87]
  v_exp_f32 v119, v63
  v_mfma_f32_16x16x32_bf16 v[40:43], a[72:75], a[24:27], v[40:43]
  v_cvt_pk_bf16_f32 v75, v114, v115
  v_mfma_f32_16x16x32_bf16 v[40:43], a[68:71], a[20:23], v[40:43]
  v_cvt_pk_bf16_f32 v78, v116, v117
  v_mfma_f32_16x16x32_bf16 v[40:43], a[64:67], a[16:19], v[40:43]
  s_waitcnt lgkmcnt(0)
  v_cvt_pk_bf16_f32 v79, v118, v119
  v_mfma_f32_16x16x32_bf16 v[36:39], a[80:83], a[0:3], v[80:83]
  s_nop 1
  v_mfma_f32_16x16x32_bf16 v[36:39], a[84:87], a[4:7], v[36:39]
  s_nop 0
  buffer_load_dwordx4 a[200:203], v25, s[4:7], s1 offen nt
  v_mfma_f32_16x16x32_bf16 v[104:107], a[128:131], v[72:75], v[100:103]
  v_exp_f32 v112, v32
  v_mfma_f32_16x16x32_bf16 v[104:107], a[132:135], v[76:79], v[104:107]
  v_exp_f32 v113, v33
  v_mfma_f32_16x16x32_bf16 v[36:39], a[88:91], a[8:11], v[36:39]
  s_nop 0
  s_add_u32 s74, s74, 9216
  buffer_load_dwordx4 a[140:143], v26, s[24:27], s74 offen offset:0 nt
  v_mfma_f32_16x16x32_bf16 v[36:39], a[92:95], a[12:15], v[36:39]
  s_nop 0
  v_exp_f32 v114, v34
  v_mfma_f32_16x16x32_bf16 v[44:47], a[92:95], a[28:31], v[84:87]
  s_nop 0
  v_exp_f32 v115, v35
  v_mfma_f32_16x16x32_bf16 v[44:47], a[88:91], a[24:27], v[44:47]
  v_cmp_nge_f32 vcc, s87, v106
  v_mfma_f32_16x16x32_bf16 v[44:47], a[84:87], a[20:23], v[44:47]
  v_exp_f32 v116, v40
  v_mfma_f32_16x16x32_bf16 v[44:47], a[80:83], a[16:19], v[44:47]
  s_cbranch_vccnz L_rs_26
L_rr_27:
  v_exp_f32 v117, v41
  v_mfma_f32_16x16x32_bf16 v[192:195], a[96:99], v[72:75], v[192:195]
  v_cvt_pk_bf16_f32 v64, v112, v113
  v_mfma_f32_16x16x32_bf16 v[196:199], a[96:99], v[76:79], v[196:199]
  s_add_u32 s86, s86, 16384
  v_exp_f32 v118, v42
  v_mfma_f32_16x16x32_bf16 v[200:203], a[100:103], v[72:75], v[200:203]
  s_cmp_ge_u32 s86, 147456
  v_mfma_f32_16x16x32_bf16 v[204:207], a[100:103], v[76:79], v[204:207]
  s_cselect_b32 s86, 0, s86
  v_exp_f32 v119, v43
  v_mfma_f32_16x16x32_bf16 v[208:211], a[104:107], v[72:75], v[208:211]
  v_mov_b32 v100, v104
  v_mfma_f32_16x16x32_bf16 v[212:215], a[104:107], v[76:79], v[212:215]
  v_exp_f32 v112, v36
  v_mfma_f32_16x16x32_bf16 v[216:219], a[108:111], v[72:75], v[216:219]
  v_cvt_pk_bf16_f32 v65, v114, v115
  v_mfma_f32_16x16x32_bf16 v[220:223], a[108:111], v[76:79], v[220:223]
  v_exp_f32 v113, v37
  v_mfma_f32_16x16x32_bf16 v[224:227], a[112:115], v[72:75], v[224:227]
  v_cvt_pk_bf16_f32 v68, v116, v117
  v_mfma_f32_16x16x32_bf16 v[228:231], a[112:115], v[76:79], v[228:231]
  v_exp_f32 v114, v38
  v_mfma_f32_16x16x32_bf16 v[232:235], a[116:119], v[72:75], v[232:235]
  buffer_load_dwordx4 a[156:159], v26, s[24:27], s74 offen offset:128 nt
  v_mfma_f32_16x16x32_bf16 v[236:239], a[116:119], v[76:79], v[236:239]
  v_exp_f32 v115, v39
  v_mfma_f32_16x16x32_bf16 v[240:243], a[120:123], v[72:75], v[240:243]
  s_add_u32 s83, s83, 1
  v_cvt_pk_bf16_f32 v69, v118, v119
  v_mfma_f32_16x16x32_bf16 v[244:247], a[120:123], v[76:79], v[244:247]
  v_exp_f32 v116, v44
  v_mfma_f32_16x16x32_bf16 v[248:251], a[124:127], v[72:75], v[248:251]
  v_mov_b32 v101, v105
  v_mfma_f32_16x16x32_bf16 v[252:255], a[124:127], v[76:79], v[252:255]
  s_waitcnt vmcnt(16)
  v_mov_b32 v4, v3
  v_add_u32 v3, s86, v2
  v_mfma_f32_16x16x32_bf16 v[48:51], a[64:67], a[32:35], v[88:91]
  s_barrier
  v_exp_f32 v117, v45
  v_mfma_f32_16x16x32_bf16 v[48:51], a[68:71], a[36:39], v[48:51]
  s_mov_b32 m0, s84
  ds_read_b128 a[96:99], v3 offset:0
  v_cvt_pk_bf16_f32 v66, v112, v113
  v_mfma_f32_16x16x32_bf16 v[48:51], a[72:75], a[40:43], v[48:51]
  s_add_u32 s84, s84, 16384
  v_exp_f32 v118, v46
  v_mfma_f32_16x16x32_bf16 v[48:51], a[76:79], a[44:47], v[48:51]
  s_cmp_ge_u32 s84, 147456
  buffer_load_dwordx4 v2, s[20:23], s85 offen offset:0  lds
  v_mfma_f32_16x16x32_bf16 v[56:59], a[76:79], a[60:63], v[92:95]
  s_cselect_b32 s70, 147456, 0
  v_exp_f32 v119, v47
  v_mfma_f32_16x16x32_bf16 v[56:59], a[72:75], a[56:59], v[56:59]
  s_sub_u32 s84, s84, s70
  ds_read_b128 a[100:103], v3 offset:1024
  v_cvt_pk_bf16_f32 v67, v114, v115
  v_mfma_f32_16x16x32_bf16 v[56:59], a[68:71], a[52:55], v[56:59]
  ds_read_b128 a[104:107], v3 offset:2048
  v_cvt_pk_bf16_f32 v70, v116, v117
  v_mfma_f32_16x16x32_bf16 v[56:59], a[64:67], a[48:51], v[56:59]
  s_waitcnt lgkmcnt(3)
  ds_read_b128 a[108:111], v3 offset:3072
  v_cvt_pk_bf16_f32 v71, v118, v119
  v_mfma_f32_16x16x32_bf16 v[52:55], a[80:83], a[32:35], v[88:91]
  ds_read_b128 a[112:115], v3 offset:4096
  ds_read_b128 a[116:119], v3 offset:5120
  v_mfma_f32_16x16x32_bf16 v[52:55], a[84:87], a[36:39], v[52:55]
  ds_read_b128 a[120:123], v3 offset:6144
  ds_read_b128 a[124:127], v3 offset:7168
  v_mfma_f32_16x16x32_bf16 v[104:107], a[128:131], v[64:67], v[96:99]
  v_exp_f32 v112, v48
  v_mfma_f32_16x16x32_bf16 v[104:107], a[132:135], v[68:71], v[104:107]
  v_exp_f32 v113, v49
  v_mfma_f32_16x16x32_bf16 v[52:55], a[88:91], a[40:43], v[52:55]
  buffer_load_dwordx4 v2, s[20:23], s85 offen offset:1024  lds
  v_mfma_f32_16x16x32_bf16 v[52:55], a[92:95], a[44:47], v[52:55]
  v_exp_f32 v114, v50
  v_mfma_f32_16x16x32_bf16 v[60:63], a[92:95], a[60:63], v[92:95]
  s_nop 0
  v_exp_f32 v115, v51
  v_mfma_f32_16x16x32_bf16 v[60:63], a[88:91], a[56:59], v[60:63]
  ds_read_b128 a[64:67], v4 offset:8192
  v_cmp_nge_f32 vcc, s87, v106
  v_mfma_f32_16x16x32_bf16 v[60:63], a[84:87], a[52:55], v[60:63]
  s_waitcnt lgkmcnt(1)
  v_exp_f32 v116, v56
  v_mfma_f32_16x16x32_bf16 v[60:63], a[80:83], a[48:51], v[60:63]
  s_cbranch_vccnz L_rs_28
L_rr_29:
  v_exp_f32 v117, v57
  v_mfma_f32_16x16x32_bf16 v[128:131], a[96:99], v[64:67], v[128:131]
  ds_read_b128 a[68:71], v4 offset:9216
  v_cvt_pk_bf16_f32 v72, v112, v113
  v_mfma_f32_16x16x32_bf16 v[132:135], a[96:99], v[68:71], v[132:135]
  v_exp_f32 v118, v58
  v_mfma_f32_16x16x32_bf16 v[136:139], a[100:103], v[64:67], v[136:139]
  buffer_load_dwordx4 v2, s[20:23], s85 offen offset:2048  lds
  v_mfma_f32_16x16x32_bf16 v[140:143], a[100:103], v[68:71], v[140:143]
  v_exp_f32 v119, v59
  v_mfma_f32_16x16x32_bf16 v[144:147], a[104:107], v[64:67], v[144:147]
  ds_read_b128 a[72:75], v4 offset:10240
  v_mov_b32 v96, v104
  v_mfma_f32_16x16x32_bf16 v[148:151], a[104:107], v[68:71], v[148:151]
  v_exp_f32 v112, v52
  v_mfma_f32_16x16x32_bf16 v[152:155], a[108:111], v[64:67], v[152:155]
  ds_read_b128 a[76:79], v4 offset:11264
  v_cvt_pk_bf16_f32 v73, v114, v115
  v_mfma_f32_16x16x32_bf16 v[156:159], a[108:111], v[68:71], v[156:159]
  v_exp_f32 v113, v53
  v_mfma_f32_16x16x32_bf16 v[160:163], a[112:115], v[64:67], v[160:163]
  ds_read_b128 a[80:83], v4 offset:12288
  v_cvt_pk_bf16_f32 v76, v116, v117
  v_mfma_f32_16x16x32_bf16 v[164:167], a[112:115], v[68:71], v[164:167]
  v_exp_f32 v114, v54
  v_mfma_f32_16x16x32_bf16 v[168:171], a[116:119], v[64:67], v[168:171]
  buffer_load_dwordx4 v2, s[20:23], s85 offen offset:3072  lds
  v_mfma_f32_16x16x32_bf16 v[172:175], a[116:119], v[68:71], v[172:175]
  s_add_u32 s85, s85, 16384
  v_exp_f32 v115, v55
  v_mfma_f32_16x16x32_bf16 v[176:179], a[120:123], v[64:67], v[176:179]
  ds_read_b128 a[84:87], v4 offset:13312
  v_cvt_pk_bf16_f32 v77, v118, v119
  v_mfma_f32_16x16x32_bf16 v[180:183], a[120:123], v[68:71], v[180:183]
  v_exp_f32 v116, v60
  v_mfma_f32_16x16x32_bf16 v[184:187], a[124:127], v[64:67], v[184:187]
  ds_read_b128 a[88:91], v4 offset:14336
  v_mov_b32 v97, v105
  v_mfma_f32_16x16x32_bf16 v[188:191], a[124:127], v[68:71], v[188:191]
  s_waitcnt lgkmcnt(3)
  ds_read_b128 a[92:95], v4 offset:15360
  v_mfma_f32_16x16x32_bf16 v[32:35], a[64:67], a[0:3], v[80:83]
  v_exp_f32 v117, v61
  v_mfma_f32_16x16x32_bf16 v[32:35], a[68:71], a[4:7], v[32:35]
  v_cvt_pk_bf16_f32 v74, v112, v113
  v_mfma_f32_16x16x32_bf16 v[32:35], a[72:75], a[8:11], v[32:35]
  v_exp_f32 v118, v62
  v_mfma_f32_16x16x32_bf16 v[32:35], a[76:79], a[12:15], v[32:35]
  buffer_load_dwordx4 a[172:175], v26, s[24:27], s74 offen offset:256 nt
  v_mfma_f32_16x16x32_bf16 v[40:43], a[76:79], a[28:31], v[84:87]
  v_exp_f32 v119, v63
  v_mfma_f32_16x16x32_bf16 v[40:43], a[72:75], a[24:27], v[40:43]
  v_cvt_pk_bf16_f32 v75, v114, v115
  v_mfma_f32_16x16x32_bf16 v[40:43], a[68:71], a[20:23], v[40:43]
  v_cvt_pk_bf16_f32 v78, v116, v117
  v_mfma_f32_16x16x32_bf16 v[40:43], a[64:67], a[16:19], v[40:43]
  s_waitcnt lgkmcnt(0)
  v_cvt_pk_bf16_f32 v79, v118, v119
  v_mfma_f32_16x16x32_bf16 v[36:39], a[80:83], a[0:3], v[80:83]
  s_nop 1
  v_mfma_f32_16x16x32_bf16 v[36:39], a[84:87], a[4:7], v[36:39]
  s_nop 0
  buffer_load_dwordx4 a[188:191], v26, s[24:27], s74 offen offset:384 nt
  v_mfma_f32_16x16x32_bf16 v[104:107], a[128:131], v[72:75], v[100:103]
  v_exp_f32 v112, v32
  v_mfma_f32_16x16x32_bf16 v[104:107], a[132:135], v[76:79], v[104:107]
  v_exp_f32 v113, v33
  v_mfma_f32_16x16x32_bf16 v[36:39], a[88:91], a[8:11], v[36:39]
  s_nop 0
  s_add_u32 s1, s1, 9216
  buffer_load_dwordx4 a[204:207], v25, s[4:7], s1 offen nt
  v_mfma_f32_16x16x32_bf16 v[36:39], a[92:95], a[12:15], v[36:39]
  s_nop 0
  v_exp_f32 v114, v34
  v_mfma_f32_16x16x32_bf16 v[44:47], a[92:95], a[28:31], v[84:87]
  s_nop 0
  v_exp_f32 v115, v35
  v_mfma_f32_16x16x32_bf16 v[44:47], a[88:91], a[24:27], v[44:47]
  v_cmp_nge_f32 vcc, s87, v106
  v_mfma_f32_16x16x32_bf16 v[44:47], a[84:87], a[20:23], v[44:47]
  v_exp_f32 v116, v40
  v_mfma_f32_16x16x32_bf16 v[44:47], a[80:83], a[16:19], v[44:47]
  s_cbranch_vccnz L_rs_30
L_rr_31:
  v_exp_f32 v117, v41
  v_mfma_f32_16x16x32_bf16 v[192:195], a[96:99], v[72:75], v[192:195]
  v_cvt_pk_bf16_f32 v64, v112, v113
  v_mfma_f32_16x16x32_bf16 v[196:199], a[96:99], v[76:79], v[196:199]
  s_add_u32 s86, s86, 16384
  v_exp_f32 v118, v42
  v_mfma_f32_16x16x32_bf16 v[200:203], a[100:103], v[72:75], v[200:203]
  s_cmp_ge_u32 s86, 147456
  v_mfma_f32_16x16x32_bf16 v[204:207], a[100:103], v[76:79], v[204:207]
  s_cselect_b32 s86, 0, s86
  v_exp_f32 v119, v43
  v_mfma_f32_16x16x32_bf16 v[208:211], a[104:107], v[72:75], v[208:211]
  v_mov_b32 v100, v104
  v_mfma_f32_16x16x32_bf16 v[212:215], a[104:107], v[76:79], v[212:215]
  v_exp_f32 v112, v36
  v_mfma_f32_16x16x32_bf16 v[216:219], a[108:111], v[72:75], v[216:219]
  v_cvt_pk_bf16_f32 v65, v114, v115
  v_mfma_f32_16x16x32_bf16 v[220:223], a[108:111], v[76:79], v[220:223]
  v_exp_f32 v113, v37
  v_mfma_f32_16x16x32_bf16 v[224:227], a[112:115], v[72:75], v[224:227]
  v_cvt_pk_bf16_f32 v68, v116, v117
  v_mfma_f32_16x16x32_bf16 v[228:231], a[112:115], v[76:79], v[228:231]
  v_exp_f32 v114, v38
  v_mfma_f32_16x16x32_bf16 v[232:235], a[116:119], v[72:75], v[232:235]
  s_add_u32 s74, s74, 9216
  buffer_load_dwordx4 a[144:147], v26, s[24:27], s74 offen offset:0 nt
  v_mfma_f32_16x16x32_bf16 v[236:239], a[116:119], v[76:79], v[236:239]
  v_exp_f32 v115, v39
  v_mfma_f32_16x16x32_bf16 v[240:243], a[120:123], v[72:75], v[240:243]
  s_add_u32 s83, s83, 1
  v_cvt_pk_bf16_f32 v69, v118, v119
  v_mfma_f32_16x16x32_bf16 v[244:247], a[120:123], v[76:79], v[244:247]
  v_exp_f32 v116, v44
  v_mfma_f32_16x16x32_bf16 v[248:251], a[124:127], v[72:75], v[248:251]
  v_mov_b32 v101, v105
  v_mfma_f32_16x16x32_bf16 v[252:255], a[124:127], v[76:79], v[252:255]
  s_waitcnt vmcnt(17)
  v_mov_b32 v4, v3
  v_add_u32 v3, s86, v2
  v_mfma_f32_16x16x32_bf16 v[48:51], a[64:67], a[32:35], v[88:91]
  s_barrier
  v_exp_f32 v117, v45
  v_mfma_f32_16x16x32_bf16 v[48:51], a[68:71], a[36:39], v[48:51]
  s_mov_b32 m0, s84
  ds_read_b128 a[96:99], v3 offset:0
  v_cvt_pk_bf16_f32 v66, v112, v113
  v_mfma_f32_16x16x32_bf16 v[48:51], a[72:75], a[40:43], v[48:51]
  s_add_u32 s84, s84, 16384
  v_exp_f32 v118, v46
  v_mfma_f32_16x16x32_bf16 v[48:51], a[76:79], a[44:47], v[48:51]
  s_cmp_ge_u32 s84, 147456
  buffer_load_dwordx4 v2, s[20:23], s85 offen offset:0  lds
  v_mfma_f32_16x16x32_bf16 v[56:59], a[76:79], a[60:63], v[92:95]
  s_cselect_b32 s70, 147456, 0
  v_exp_f32 v119, v47
  v_mfma_f32_16x16x32_bf16 v[56:59], a[72:75], a[56:59], v[56:59]
  s_sub_u32 s84, s84, s70
  ds_read_b128 a[100:103], v3 offset:1024
  v_cvt_pk_bf16_f32 v67, v114, v115
  v_mfma_f32_16x16x32_bf16 v[56:59], a[68:71], a[52:55], v[56:59]
  ds_read_b128 a[104:107], v3 offset:2048
  v_cvt_pk_bf16_f32 v70, v116, v117
  v_mfma_f32_16x16x32_bf16 v[56:59], a[64:67], a[48:51], v[56:59]
  s_waitcnt lgkmcnt(3)
  ds_read_b128 a[108:111], v3 offset:3072
  v_cvt_pk_bf16_f32 v71, v118, v119
  v_mfma_f32_16x16x32_bf16 v[52:55], a[80:83], a[32:35], v[88:91]
  ds_read_b128 a[112:115], v3 offset:4096
  ds_read_b128 a[116:119], v3 offset:5120
  v_mfma_f32_16x16x32_bf16 v[52:55], a[84:87], a[36:39], v[52:55]
  ds_read_b128 a[120:123], v3 offset:6144
  ds_read_b128 a[124:127], v3 offset:7168
  v_mfma_f32_16x16x32_bf16 v[104:107], a[128:131], v[64:67], v[96:99]
  v_exp_f32 v112, v48
  v_mfma_f32_16x16x32_bf16 v[104:107], a[132:135], v[68:71], v[104:107]
  v_exp_f32 v113, v49
  v_mfma_f32_16x16x32_bf16 v[52:55], a[88:91], a[40:43], v[52:55]
  buffer_load_dwordx4 v2, s[20:23], s85 offen offset:1024  lds
  v_mfma_f32_16x16x32_bf16 v[52:55], a[92:95], a[44:47], v[52:55]
  v_exp_f32 v114, v50
  v_mfma_f32_16x16x32_bf16 v[60:63], a[92:95], a[60:63], v[92:95]
  s_nop 0
  v_exp_f32 v115, v51
  v_mfma_f32_16x16x32_bf16 v[60:63], a[88:91], a[56:59], v[60:63]
  ds_read_b128 a[64:67], v4 offset:8192
  v_cmp_nge_f32 vcc, s87, v106
  v_mfma_f32_16x16x32_bf16 v[60:63], a[84:87], a[52:55], v[60:63]
  s_waitcnt lgkmcnt(1)
  v_exp_f32 v116, v56
  v_mfma_f32_16x16x32_bf16 v[60:63], a[80:83], a[48:51], v[60:63]
  s_cbranch_vccnz L_rs_32
L_rr_33:
  v_exp_f32 v117, v57
  v_mfma_f32_16x16x32_bf16 v[128:131], a[96:99], v[64:67], v[128:131]
  ds_read_b128 a[68:71], v4 offset:9216
  v_cvt_pk_bf16_f32 v72, v112, v113
  v_mfma_f32_16x16x32_bf16 v[132:135], a[96:99], v[68:71], v[132:135]
  v_exp_f32 v118, v58
  v_mfma_f32_16x16x32_bf16 v[136:139], a[100:103], v[64:67], v[136:139]
  buffer_load_dwordx4 v2, s[20:23], s85 offen offset:2048  lds
  v_mfma_f32_16x16x32_bf16 v[140:143], a[100:103], v[68:71], v[140:143]
  v_exp_f32 v119, v59
  v_mfma_f32_16x16x32_bf16 v[144:147], a[104:107], v[64:67], v[144:147]
  ds_read_b128 a[72:75], v4 offset:10240
  v_mov_b32 v96, v104
  v_mfma_f32_16x16x32_bf16 v[148:151], a[104:107], v[68:71], v[148:151]
  v_exp_f32 v112, v52
  v_mfma_f32_16x16x32_bf16 v[152:155], a[108:111], v[64:67], v[152:155]
  ds_read_b128 a[76:79], v4 offset:11264
  v_cvt_pk_bf16_f32 v73, v114, v115
  v_mfma_f32_16x16x32_bf16 v[156:159], a[108:111], v[68:71], v[156:159]
  v_exp_f32 v113, v53
  v_mfma_f32_16x16x32_bf16 v[160:163], a[112:115], v[64:67], v[160:163]
  ds_read_b128 a[80:83], v4 offset:12288
  v_cvt_pk_bf16_f32 v76, v116, v117
  v_mfma_f32_16x16x32_bf16 v[164:167], a[112:115], v[68:71], v[164:167]
  v_exp_f32 v114, v54
  v_mfma_f32_16x16x32_bf16 v[168:171], a[116:119], v[64:67], v[168:171]
  buffer_load_dwordx4 v2, s[20:23], s85 offen offset:3072  lds
  v_mfma_f32_16x16x32_bf16 v[172:175], a[116:119], v[68:71], v[172:175]
  s_add_u32 s85, s85, 16384
  v_exp_f32 v115, v55
  v_mfma_f32_16x16x32_bf16 v[176:179], a[120:123], v[64:67], v[176:179]
  ds_read_b128 a[84:87], v4 offset:13312
  v_cvt_pk_bf16_f32 v77, v118, v119
  v_mfma_f32_16x16x32_bf16 v[180:183], a[120:123], v[68:71], v[180:183]
  v_exp_f32 v116, v60
  v_mfma_f32_16x16x32_bf16 v[184:187], a[124:127], v[64:67], v[184:187]
  ds_read_b128 a[88:91], v4 offset:14336
  v_mov_b32 v97, v105
  v_mfma_f32_16x16x32_bf16 v[188:191], a[124:127], v[68:71], v[188:191]
  s_waitcnt lgkmcnt(3)
  ds_read_b128 a[92:95], v4 offset:15360
  v_mfma_f32_16x16x32_bf16 v[32:35], a[64:67], a[0:3], v[80:83]
  v_exp_f32 v117, v61
  v_mfma_f32_16x16x32_bf16 v[32:35], a[68:71], a[4:7], v[32:35]
  v_cvt_pk_bf16_f32 v74, v112, v113
  v_mfma_f32_16x16x32_bf16 v[32:35], a[72:75], a[8:11], v[32:35]
  v_exp_f32 v118, v62
  v_mfma_f32_16x16x32_bf16 v[32:35], a[76:79], a[12:15], v[32:35]
  buffer_load_dwordx4 a[160:163], v26, s[24:27], s74 offen offset:128 nt
  v_mfma_f32_16x16x32_bf16 v[40:43], a[76:79], a[28:31], v[84:87]
  v_exp_f32 v119, v63
  v_mfma_f32_16x16x32_bf16 v[40:43], a[72:75], a[24:27], v[40:43]
  v_cvt_pk_bf16_f32 v75, v114, v115
  v_mfma_f32_16x16x32_bf16 v[40:43], a[68:71], a[20:23], v[40:43]
  v_cvt_pk_bf16_f32 v78, v116, v117
  v_mfma_f32_16x16x32_bf16 v[40:43], a[64:67], a[16:19], v[40:43]
  s_waitcnt lgkmcnt(0)
  v_cvt_pk_bf16_f32 v79, v118, v119
  v_mfma_f32_16x16x32_bf16 v[36:39], a[80:83], a[0:3], v[80:83]
  s_nop 1
  v_mfma_f32_16x16x32_bf16 v[36:39], a[84:87], a[4:7], v[36:39]
  s_nop 0
  v_mfma_f32_16x16x32_bf16 v[104:107], a[128:131], v[72:75], v[100:103]
  v_exp_f32 v112, v32
  v_mfma_f32_16x16x32_bf16 v[104:107], a[132:135], v[76:79], v[104:107]
  v_exp_f32 v113, v33
  v_mfma_f32_16x16x32_bf16 v[36:39], a[88:91], a[8:11], v[36:39]
  s_nop 0
  buffer_load_dwordx4 a[176:179], v26, s[24:27], s74 offen offset:256 nt
  v_mfma_f32_16x16x32_bf16 v[36:39], a[92:95], a[12:15], v[36:39]
  s_nop 0
  v_exp_f32 v114, v34
  v_mfma_f32_16x16x32_bf16 v[44:47], a[92:95], a[28:31], v[84:87]
  s_nop 0
  v_exp_f32 v115, v35
  v_mfma_f32_16x16x32_bf16 v[44:47], a[88:91], a[24:27], v[44:47]
  v_cmp_nge_f32 vcc, s87, v106
  v_mfma_f32_16x16x32_bf16 v[44:47], a[84:87], a[20:23], v[44:47]
  v_exp_f32 v116, v40
  v_mfma_f32_16x16x32_bf16 v[44:47], a[80:83], a[16:19], v[44:47]
  s_cbranch_vccnz L_rs_34
L_rr_35:
  v_exp_f32 v117, v41
  v_mfma_f32_16x16x32_bf16 v[192:195], a[96:99], v[72:75], v[192:195]
  v_cvt_pk_bf16_f32 v64, v112, v113
  v_mfma_f32_16x16x32_bf16 v[196:199], a[96:99], v[76:79], v[196:199]
  s_add_u32 s86, s86, 16384
  v_exp_f32 v118, v42
  v_mfma_f32_16x16x32_bf16 v[200:203], a[100:103], v[72:75], v[200:203]
  s_cmp_ge_u32 s86, 147456
  v_mfma_f32_16x16x32_bf16 v[204:207], a[100:103], v[76:79], v[204:207]
  s_cselect_b32 s86, 0, s86
  v_exp_f32 v119, v43
  v_mfma_f32_16x16x32_bf16 v[208:211], a[104:107], v[72:75], v[208:211]
  v_mov_b32 v100, v104
  v_mfma_f32_16x16x32_bf16 v[212:215], a[104:107], v[76:79], v[212:215]
  v_exp_f32 v112, v36
  v_mfma_f32_16x16x32_bf16 v[216:219], a[108:111], v[72:75], v[216:219]
  v_cvt_pk_bf16_f32 v65, v114, v115
  v_mfma_f32_16x16x32_bf16 v[220:223], a[108:111], v[76:79], v[220:223]
  v_exp_f32 v113, v37
  v_mfma_f32_16x16x32_bf16 v[224:227], a[112:115], v[72:75], v[224:227]
  v_cvt_pk_bf16_f32 v68, v116, v117
  v_mfma_f32_16x16x32_bf16 v[228:231], a[112:115], v[76:79], v[228:231]
  v_exp_f32 v114, v38
  v_mfma_f32_16x16x32_bf16 v[232:235], a[116:119], v[72:75], v[232:235]
  buffer_load_dwordx4 a[192:195], v26, s[24:27], s74 offen offset:384 nt
  v_mfma_f32_16x16x32_bf16 v[236:239], a[116:119], v[76:79], v[236:239]
  v_exp_f32 v115, v39
  v_mfma_f32_16x16x32_bf16 v[240:243], a[120:123], v[72:75], v[240:243]
  s_add_u32 s83, s83, 1
  v_cvt_pk_bf16_f32 v69, v118, v119
  v_mfma_f32_16x16x32_bf16 v[244:247], a[120:123], v[76:79], v[244:247]
  v_exp_f32 v116, v44
  v_mfma_f32_16x16x32_bf16 v[248:251], a[124:127], v[72:75], v[248:251]
  v_mov_b32 v101, v105
  v_mfma_f32_16x16x32_bf16 v[252:255], a[124:127], v[76:79], v[252:255]
  s_waitcnt vmcnt(19)
  v_mov_b32 v4, v3
  v_add_u32 v3, s86, v2
  v_mfma_f32_16x16x32_bf16 v[48:51], a[64:67], a[32:35], v[88:91]
  s_barrier
  v_exp_f32 v117, v45
  v_mfma_f32_16x16x32_bf16 v[48:51], a[68:71], a[36:39], v[48:51]
  s_mov_b32 m0, s84
  ds_read_b128 a[96:99], v3 offset:0
  v_cvt_pk_bf16_f32 v66, v112, v113
  v_mfma_f32_16x16x32_bf16 v[48:51], a[72:75], a[40:43], v[48:51]
  s_add_u32 s84, s84, 16384
  v_exp_f32 v118, v46
  v_mfma_f32_16x16x32_bf16 v[48:51], a[76:79], a[44:47], v[48:51]
  s_cmp_ge_u32 s84, 147456
  buffer_load_dwordx4 v2, s[20:23], s85 offen offset:0  lds
  v_mfma_f32_16x16x32_bf16 v[56:59], a[76:79], a[60:63], v[92:95]
  s_cselect_b32 s70, 147456, 0
  v_exp_f32 v119, v47
  v_mfma_f32_16x16x32_bf16 v[56:59], a[72:75], a[56:59], v[56:59]
  s_sub_u32 s84, s84, s70
  ds_read_b128 a[100:103], v3 offset:1024
  v_cvt_pk_bf16_f32 v67, v114, v115
  v_mfma_f32_16x16x32_bf16 v[56:59], a[68:71], a[52:55], v[56:59]
  ds_read_b128 a[104:107], v3 offset:2048
  v_cvt_pk_bf16_f32 v70, v116, v117
  v_mfma_f32_16x16x32_bf16 v[56:59], a[64:67], a[48:51], v[56:59]
  s_waitcnt lgkmcnt(3)
  ds_read_b128 a[108:111], v3 offset:3072
  v_cvt_pk_bf16_f32 v71, v118, v119
  v_mfma_f32_16x16x32_bf16 v[52:55], a[80:83], a[32:35], v[88:91]
  ds_read_b128 a[112:115], v3 offset:4096
  ds_read_b128 a[116:119], v3 offset:5120
  v_mfma_f32_16x16x32_bf16 v[52:55], a[84:87], a[36:39], v[52:55]
  ds_read_b128 a[120:123], v3 offset:6144
  ds_read_b128 a[124:127], v3 offset:7168
  v_mfma_f32_16x16x32_bf16 v[104:107], a[128:131], v[64:67], v[96:99]
  v_exp_f32 v112, v48
  v_mfma_f32_16x16x32_bf16 v[104:107], a[132:135], v[68:71], v[104:107]
  v_exp_f32 v113, v49
  v_mfma_f32_16x16x32_bf16 v[52:55], a[88:91], a[40:43], v[52:55]
  buffer_load_dwordx4 v2, s[20:23], s85 offen offset:1024  lds
  v_mfma_f32_16x16x32_bf16 v[52:55], a[92:95], a[44:47], v[52:55]
  v_exp_f32 v114, v50
  v_mfma_f32_16x16x32_bf16 v[60:63], a[92:95], a[60:63], v[92:95]
  s_nop 0
  v_exp_f32 v115, v51
  v_mfma_f32_16x16x32_bf16 v[60:63], a[88:91], a[56:59], v[60:63]
  ds_read_b128 a[64:67], v4 offset:8192
  v_cmp_nge_f32 vcc, s87, v106
  v_mfma_f32_16x16x32_bf16 v[60:63], a[84:87], a[52:55], v[60:63]
  s_waitcnt lgkmcnt(1)
  v_exp_f32 v116, v56
  v_mfma_f32_16x16x32_bf16 v[60:63], a[80:83], a[48:51], v[60:63]
  s_cbranch_vccnz L_rs_36
L_rr_37:
  v_exp_f32 v117, v57
  v_mfma_f32_16x16x32_bf16 v[128:131], a[96:99], v[64:67], v[128:131]
  ds_read_b128 a[68:71], v4 offset:9216
  v_cvt_pk_bf16_f32 v72, v112, v113
  v_mfma_f32_16x16x32_bf16 v[132:135], a[96:99], v[68:71], v[132:135]
  v_exp_f32 v118, v58
  v_mfma_f32_16x16x32_bf16 v[136:139], a[100:103], v[64:67], v[136:139]
  buffer_load_dwordx4 v2, s[20:23], s85 offen offset:2048  lds
  v_mfma_f32_16x16x32_bf16 v[140:143], a[100:103], v[68:71], v[140:143]
  v_exp_f32 v119, v59
  v_mfma_f32_16x16x32_bf16 v[144:147], a[104:107], v[64:67], v[144:147]
  ds_read_b128 a[72:75], v4 offset:10240
  v_mov_b32 v96, v104
  v_mfma_f32_16x16x32_bf16 v[148:151], a[104:107], v[68:71], v[148:151]
  v_exp_f32 v112, v52
  v_mfma_f32_16x16x32_bf16 v[152:155], a[108:111], v[64:67], v[152:155]
  ds_read_b128 a[76:79], v4 offset:11264
  v_cvt_pk_bf16_f32 v73, v114, v115
  v_mfma_f32_16x16x32_bf16 v[156:159], a[108:111], v[68:71], v[156:159]
  v_exp_f32 v113, v53
  v_mfma_f32_16x16x32_bf16 v[160:163], a[112:115], v[64:67], v[160:163]
  ds_read_b128 a[80:83], v4 offset:12288
  v_cvt_pk_bf16_f32 v76, v116, v117
  v_mfma_f32_16x16x32_bf16 v[164:167], a[112:115], v[68:71], v[164:167]
  v_exp_f32 v114, v54
  v_mfma_f32_16x16x32_bf16 v[168:171], a[116:119], v[64:67], v[168:171]
  buffer_load_dwordx4 v2, s[20:23], s85 offen offset:3072  lds
  v_mfma_f32_16x16x32_bf16 v[172:175], a[116:119], v[68:71], v[172:175]
  s_add_u32 s85, s85, 16384
  v_exp_f32 v115, v55
  v_mfma_f32_16x16x32_bf16 v[176:179], a[120:123], v[64:67], v[176:179]
  ds_read_b128 a[84:87], v4 offset:13312
  v_cvt_pk_bf16_f32 v77, v118, v119
  v_mfma_f32_16x16x32_bf16 v[180:183], a[120:123], v[68:71], v[180:183]
  v_exp_f32 v116, v60
  v_mfma_f32_16x16x32_bf16 v[184:187], a[124:127], v[64:67], v[184:187]
  ds_read_b128 a[88:91], v4 offset:14336
  v_mov_b32 v97, v105
  v_mfma_f32_16x16x32_bf16 v[188:191], a[124:127], v[68:71], v[188:191]
  s_waitcnt lgkmcnt(3)
  ds_read_b128 a[92:95], v4 offset:15360
  v_mfma_f32_16x16x32_bf16 v[32:35], a[64:67], a[0:3], v[80:83]
  v_exp_f32 v117, v61
  v_mfma_f32_16x16x32_bf16 v[32:35], a[68:71], a[4:7], v[32:35]
  v_cvt_pk_bf16_f32 v74, v112, v113
  v_mfma_f32_16x16x32_bf16 v[32:35], a[72:75], a[8:11], v[32:35]
  v_exp_f32 v118, v62
  v_mfma_f32_16x16x32_bf16 v[32:35], a[76:79], a[12:15], v[32:35]
  s_add_u32 s1, s1, 9216
  buffer_load_dwordx4 a[208:211], v25, s[4:7], s1 offen nt
  v_mfma_f32_16x16x32_bf16 v[40:43], a[76:79], a[28:31], v[84:87]
  v_exp_f32 v119, v63
  v_mfma_f32_16x16x32_bf16 v[40:43], a[72:75], a[24:27], v[40:43]
  v_cvt_pk_bf16_f32 v75, v114, v115
  v_mfma_f32_16x16x32_bf16 v[40:43], a[68:71], a[20:23], v[40:43]
  v_cvt_pk_bf16_f32 v78, v116, v117
  v_mfma_f32_16x16x32_bf16 v[40:43], a[64:67], a[16:19], v[40:43]
  s_waitcnt lgkmcnt(0)
  v_cvt_pk_bf16_f32 v79, v118, v119
  v_mfma_f32_16x16x32_bf16 v[36:39], a[80:83], a[0:3], v[80:83]
  s_nop 1
  v_mfma_f32_16x16x32_bf16 v[36:39], a[84:87], a[4:7], v[36:39]
  s_nop 0
  v_mfma_f32_16x16x32_bf16 v[104:107], a[128:131], v[72:75], v[100:103]
  v_exp_f32 v112, v32
  v_mfma_f32_16x16x32_bf16 v[104:107], a[132:135], v[76:79], v[104:107]
  v_exp_f32 v113, v33
  v_mfma_f32_16x16x32_bf16 v[36:39], a[88:91], a[8:11], v[36:39]
  s_nop 0
  s_add_u32 s74, s74, 9216
  buffer_load_dwordx4 a[148:151], v26, s[24:27], s74 offen offset:0 nt
  v_mfma_f32_16x16x32_bf16 v[36:39], a[92:95], a[12:15], v[36:39]
  s_nop 0
  v_exp_f32 v114, v34
  v_mfma_f32_16x16x32_bf16 v[44:47], a[92:95], a[28:31], v[84:87]
  s_nop 0
  v_exp_f32 v115, v35
  v_mfma_f32_16x16x32_bf16 v[44:47], a[88:91], a[24:27], v[44:47]
  v_cmp_nge_f32 vcc, s87, v106
  v_mfma_f32_16x16x32_bf16 v[44:47], a[84:87], a[20:23], v[44:47]
  v_exp_f32 v116, v40
  v_mfma_f32_16x16x32_bf16 v[44:47], a[80:83], a[16:19], v[44:47]
  s_cbranch_vccnz L_rs_38
L_rr_39:
  v_exp_f32 v117, v41
  v_mfma_f32_16x16x32_bf16 v[192:195], a[96:99], v[72:75], v[192:195]
  v_cvt_pk_bf16_f32 v64, v112, v113
  v_mfma_f32_16x16x32_bf16 v[196:199], a[96:99], v[76:79], v[196:199]
  s_add_u32 s86, s86, 16384
  v_exp_f32 v118, v42
  v_mfma_f32_16x16x32_bf16 v[200:203], a[100:103], v[72:75], v[200:203]
  s_cmp_ge_u32 s86, 147456
  v_mfma_f32_16x16x32_bf16 v[204:207], a[100:103], v[76:79], v[204:207]
  s_cselect_b32 s86, 0, s86
  v_exp_f32 v119, v43
  v_mfma_f32_16x16x32_bf16 v[208:211], a[104:107], v[72:75], v[208:211]
  v_mov_b32 v100, v104
  v_mfma_f32_16x16x32_bf16 v[212:215], a[104:107], v[76:79], v[212:215]
  v_exp_f32 v112, v36
  v_mfma_f32_16x16x32_bf16 v[216:219], a[108:111], v[72:75], v[216:219]
  v_cvt_pk_bf16_f32 v65, v114, v115
  v_mfma_f32_16x16x32_bf16 v[220:223], a[108:111], v[76:79], v[220:223]
  v_exp_f32 v113, v37
  v_mfma_f32_16x16x32_bf16 v[224:227], a[112:115], v[72:75], v[224:227]
  v_cvt_pk_bf16_f32 v68, v116, v117
  v_mfma_f32_16x16x32_bf16 v[228:231], a[112:115], v[76:79], v[228:231]
  v_exp_f32 v114, v38
  v_mfma_f32_16x16x32_bf16 v[232:235], a[116:119], v[72:75], v[232:235]
  buffer_load_dwordx4 a[164:167], v26, s[24:27], s74 offen offset:128 nt
  v_mfma_f32_16x16x32_bf16 v[236:239], a[116:119], v[76:79], v[236:239]
  v_exp_f32 v115, v39
  v_mfma_f32_16x16x32_bf16 v[240:243], a[120:123], v[72:75], v[240:243]
  s_add_u32 s83, s83, 1
  v_cvt_pk_bf16_f32 v69, v118, v119
  v_mfma_f32_16x16x32_bf16 v[244:247], a[120:123], v[76:79], v[244:247]
  v_exp_f32 v116, v44
  v_mfma_f32_16x16x32_bf16 v[248:251], a[124:127], v[72:75], v[248:251]
  v_mov_b32 v101, v105
  v_mfma_f32_16x16x32_bf16 v[252:255], a[124:127], v[76:79], v[252:255]
  s_waitcnt vmcnt(18)
  v_mov_b32 v4, v3
  v_add_u32 v3, s86, v2
  v_mfma_f32_16x16x32_bf16 v[48:51], a[64:67], a[32:35], v[88:91]
  s_barrier
  v_exp_f32 v117, v45
  v_mfma_f32_16x16x32_bf16 v[48:51], a[68:71], a[36:39], v[48:51]
  s_mov_b32 m0, s84
  ds_read_b128 a[96:99], v3 offset:0
  v_cvt_pk_bf16_f32 v66, v112, v113
  v_mfma_f32_16x16x32_bf16 v[48:51], a[72:75], a[40:43], v[48:51]
  s_add_u32 s84, s84, 16384
  v_exp_f32 v118, v46
  v_mfma_f32_16x16x32_bf16 v[48:51], a[76:79], a[44:47], v[48:51]
  s_cmp_ge_u32 s84, 147456
  buffer_load_dwordx4 v2, s[20:23], s85 offen offset:0  lds
  v_mfma_f32_16x16x32_bf16 v[56:59], a[76:79], a[60:63], v[92:95]
  s_cselect_b32 s70, 147456, 0
  v_exp_f32 v119, v47
  v_mfma_f32_16x16x32_bf16 v[56:59], a[72:75], a[56:59], v[56:59]
  s_sub_u32 s84, s84, s70
  ds_read_b128 a[100:103], v3 offset:1024
  v_cvt_pk_bf16_f32 v67, v114, v115
  v_mfma_f32_16x16x32_bf16 v[56:59], a[68:71], a[52:55], v[56:59]
  ds_read_b128 a[104:107], v3 offset:2048
  v_cvt_pk_bf16_f32 v70, v116, v117
  v_mfma_f32_16x16x32_bf16 v[56:59], a[64:67], a[48:51], v[56:59]
  s_waitcnt lgkmcnt(3)
  ds_read_b128 a[108:111], v3 offset:3072
  v_cvt_pk_bf16_f32 v71, v118, v119
  v_mfma_f32_16x16x32_bf16 v[52:55], a[80:83], a[32:35], v[88:91]
  ds_read_b128 a[112:115], v3 offset:4096
  ds_read_b128 a[116:119], v3 offset:5120
  v_mfma_f32_16x16x32_bf16 v[52:55], a[84:87], a[36:39], v[52:55]
  ds_read_b128 a[120:123], v3 offset:6144
  ds_read_b128 a[124:127], v3 offset:7168
  v_mfma_f32_16x16x32_bf16 v[104:107], a[128:131], v[64:67], v[96:99]
  v_exp_f32 v112, v48
  v_mfma_f32_16x16x32_bf16 v[104:107], a[132:135], v[68:71], v[104:107]
  v_exp_f32 v113, v49
  v_mfma_f32_16x16x32_bf16 v[52:55], a[88:91], a[40:43], v[52:55]
  buffer_load_dwordx4 v2, s[20:23], s85 offen offset:1024  lds
  v_mfma_f32_16x16x32_bf16 v[52:55], a[92:95], a[44:47], v[52:55]
  v_exp_f32 v114, v50
  v_mfma_f32_16x16x32_bf16 v[60:63], a[92:95], a[60:63], v[92:95]
  s_nop 0
  v_exp_f32 v115, v51
  v_mfma_f32_16x16x32_bf16 v[60:63], a[88:91], a[56:59], v[60:63]
  ds_read_b128 a[64:67], v4 offset:8192
  v_cmp_nge_f32 vcc, s87, v106
  v_mfma_f32_16x16x32_bf16 v[60:63], a[84:87], a[52:55], v[60:63]
  s_waitcnt lgkmcnt(1)
  v_exp_f32 v116, v56
  v_mfma_f32_16x16x32_bf16 v[60:63], a[80:83], a[48:51], v[60:63]
  s_cbranch_vccnz L_rs_40
L_rr_41:
  v_exp_f32 v117, v57
  v_mfma_f32_16x16x32_bf16 v[128:131], a[96:99], v[64:67], v[128:131]
  ds_read_b128 a[68:71], v4 offset:9216
  v_cvt_pk_bf16_f32 v72, v112, v113
  v_mfma_f32_16x16x32_bf16 v[132:135], a[96:99], v[68:71], v[132:135]
  v_exp_f32 v118, v58
  v_mfma_f32_16x16x32_bf16 v[136:139], a[100:103], v[64:67], v[136:139]
  buffer_load_dwordx4 v2, s[20:23], s85 offen offset:2048  lds
  v_mfma_f32_16x16x32_bf16 v[140:143], a[100:103], v[68:71], v[140:143]
  v_exp_f32 v119, v59
  v_mfma_f32_16x16x32_bf16 v[144:147], a[104:107], v[64:67], v[144:147]
  ds_read_b128 a[72:75], v4 offset:10240
  v_mov_b32 v96, v104
  v_mfma_f32_16x16x32_bf16 v[148:151], a[104:107], v[68:71], v[148:151]
  v_exp_f32 v112, v52
  v_mfma_f32_16x16x32_bf16 v[152:155], a[108:111], v[64:67], v[152:155]
  ds_read_b128 a[76:79], v4 offset:11264
  v_cvt_pk_bf16_f32 v73, v114, v115
  v_mfma_f32_16x16x32_bf16 v[156:159], a[108:111], v[68:71], v[156:159]
  v_exp_f32 v113, v53
  v_mfma_f32_16x16x32_bf16 v[160:163], a[112:115], v[64:67], v[160:163]
  ds_read_b128 a[80:83], v4 offset:12288
  v_cvt_pk_bf16_f32 v76, v116, v117
  v_mfma_f32_16x16x32_bf16 v[164:167], a[112:115], v[68:71], v[164:167]
  v_exp_f32 v114, v54
  v_mfma_f32_16x16x32_bf16 v[168:171], a[116:119], v[64:67], v[168:171]
  buffer_load_dwordx4 v2, s[20:23], s85 offen offset:3072  lds
  v_mfma_f32_16x16x32_bf16 v[172:175], a[116:119], v[68:71], v[172:175]
  s_add_u32 s85, s85, 16384
  v_exp_f32 v115, v55
  v_mfma_f32_16x16x32_bf16 v[176:179], a[120:123], v[64:67], v[176:179]
  ds_read_b128 a[84:87], v4 offset:13312
  v_cvt_pk_bf16_f32 v77, v118, v119
  v_mfma_f32_16x16x32_bf16 v[180:183], a[120:123], v[68:71], v[180:183]
  v_exp_f32 v116, v60
  v_mfma_f32_16x16x32_bf16 v[184:187], a[124:127], v[64:67], v[184:187]
  ds_read_b128 a[88:91], v4 offset:14336
  v_mov_b32 v97, v105
  v_mfma_f32_16x16x32_bf16 v[188:191], a[124:127], v[68:71], v[188:191]
  s_waitcnt lgkmcnt(3)
  ds_read_b128 a[92:95], v4 offset:15360
  v_mfma_f32_16x16x32_bf16 v[32:35], a[64:67], a[0:3], v[80:83]
  v_exp_f32 v117, v61
  v_mfma_f32_16x16x32_bf16 v[32:35], a[68:71], a[4:7], v[32:35]
  v_cvt_pk_bf16_f32 v74, v112, v113
  v_mfma_f32_16x16x32_bf16 v[32:35], a[72:75], a[8:11], v[32:35]
  v_exp_f32 v118, v62
  v_mfma_f32_16x16x32_bf16 v[32:35], a[76:79], a[12:15], v[32:35]
  buffer_load_dwordx4 a[180:183], v26, s[24:27], s74 offen offset:256 nt
  v_mfma_f32_16x16x32_bf16 v[40:43], a[76:79], a[28:31], v[84:87]
  v_exp_f32 v119, v63
  v_mfma_f32_16x16x32_bf16 v[40:43], a[72:75], a[24:27], v[40:43]
  v_cvt_pk_bf16_f32 v75, v114, v115
  v_mfma_f32_16x16x32_bf16 v[40:43], a[68:71], a[20:23], v[40:43]
  v_cvt_pk_bf16_f32 v78, v116, v117
  v_mfma_f32_16x16x32_bf16 v[40:43], a[64:67], a[16:19], v[40:43]
  s_waitcnt lgkmcnt(0)
  v_cvt_pk_bf16_f32 v79, v118, v119
  v_mfma_f32_16x16x32_bf16 v[36:39], a[80:83], a[0:3], v[80:83]
  s_nop 1
  v_mfma_f32_16x16x32_bf16 v[36:39], a[84:87], a[4:7], v[36:39]
  s_nop 0
  v_mfma_f32_16x16x32_bf16 v[104:107], a[128:131], v[72:75], v[100:103]
  v_exp_f32 v112, v32
  v_mfma_f32_16x16x32_bf16 v[104:107], a[132:135], v[76:79], v[104:107]
  v_exp_f32 v113, v33
  v_mfma_f32_16x16x32_bf16 v[36:39], a[88:91], a[8:11], v[36:39]
  s_nop 0
  buffer_load_dwordx4 a[196:199], v26, s[24:27], s74 offen offset:384 nt
  v_mfma_f32_16x16x32_bf16 v[36:39], a[92:95], a[12:15], v[36:39]
  s_nop 0
  v_exp_f32 v114, v34
  v_mfma_f32_16x16x32_bf16 v[44:47], a[92:95], a[28:31], v[84:87]
  s_nop 0
  v_exp_f32 v115, v35
  v_mfma_f32_16x16x32_bf16 v[44:47], a[88:91], a[24:27], v[44:47]
  v_cmp_nge_f32 vcc, s87, v106
  v_mfma_f32_16x16x32_bf16 v[44:47], a[84:87], a[20:23], v[44:47]
  v_exp_f32 v116, v40
  v_mfma_f32_16x16x32_bf16 v[44:47], a[80:83], a[16:19], v[44:47]
  s_cbranch_vccnz L_rs_42
L_rr_43:
  v_exp_f32 v117, v41
  v_mfma_f32_16x16x32_bf16 v[192:195], a[96:99], v[72:75], v[192:195]
  v_cvt_pk_bf16_f32 v64, v112, v113
  v_mfma_f32_16x16x32_bf16 v[196:199], a[96:99], v[76:79], v[196:199]
  s_add_u32 s86, s86, 16384
  v_exp_f32 v118, v42
  v_mfma_f32_16x16x32_bf16 v[200:203], a[100:103], v[72:75], v[200:203]
  s_cmp_ge_u32 s86, 147456
  v_mfma_f32_16x16x32_bf16 v[204:207], a[100:103], v[76:79], v[204:207]
  s_cselect_b32 s86, 0, s86
  v_exp_f32 v119, v43
  v_mfma_f32_16x16x32_bf16 v[208:211], a[104:107], v[72:75], v[208:211]
  v_mov_b32 v100, v104
  v_mfma_f32_16x16x32_bf16 v[212:215], a[104:107], v[76:79], v[212:215]
  v_exp_f32 v112, v36
  v_mfma_f32_16x16x32_bf16 v[216:219], a[108:111], v[72:75], v[216:219]
  v_cvt_pk_bf16_f32 v65, v114, v115
  v_mfma_f32_16x16x32_bf16 v[220:223], a[108:111], v[76:79], v[220:223]
  v_exp_f32 v113, v37
  v_mfma_f32_16x16x32_bf16 v[224:227], a[112:115], v[72:75], v[224:227]
  v_cvt_pk_bf16_f32 v68, v116, v117
  v_mfma_f32_16x16x32_bf16 v[228:231], a[112:115], v[76:79], v[228:231]
  v_exp_f32 v114, v38
  v_mfma_f32_16x16x32_bf16 v[232:235], a[116:119], v[72:75], v[232:235]
  s_add_u32 s1, s1, 9216
  buffer_load_dwordx4 a[212:215], v25, s[4:7], s1 offen nt
  v_mfma_f32_16x16x32_bf16 v[236:239], a[116:119], v[76:79], v[236:239]
  v_exp_f32 v115, v39
  v_mfma_f32_16x16x32_bf16 v[240:243], a[120:123], v[72:75], v[240:243]
  s_add_u32 s83, s83, 1
  v_cvt_pk_bf16_f32 v69, v118, v119
  v_mfma_f32_16x16x32_bf16 v[244:247], a[120:123], v[76:79], v[244:247]
  v_exp_f32 v116, v44
  v_mfma_f32_16x16x32_bf16 v[248:251], a[124:127], v[72:75], v[248:251]
  v_mov_b32 v101, v105
  v_mfma_f32_16x16x32_bf16 v[252:255], a[124:127], v[76:79], v[252:255]
  s_waitcnt vmcnt(17)
  v_mov_b32 v4, v3
  v_add_u32 v3, s86, v2
  v_mfma_f32_16x16x32_bf16 v[48:51], a[64:67], a[32:35], v[88:91]
  s_barrier
  v_exp_f32 v117, v45
  v_mfma_f32_16x16x32_bf16 v[48:51], a[68:71], a[36:39], v[48:51]
  s_mov_b32 m0, s84
  ds_read_b128 a[96:99], v3 offset:0
  v_cvt_pk_bf16_f32 v66, v112, v113
  v_mfma_f32_16x16x32_bf16 v[48:51], a[72:75], a[40:43], v[48:51]
  s_add_u32 s84, s84, 16384
  v_exp_f32 v118, v46
  v_mfma_f32_16x16x32_bf16 v[48:51], a[76:79], a[44:47], v[48:51]
  s_cmp_ge_u32 s84, 147456
  buffer_load_dwordx4 v2, s[20:23], s85 offen offset:0  lds
  v_mfma_f32_16x16x32_bf16 v[56:59], a[76:79], a[60:63], v[92:95]
  s_cselect_b32 s70, 147456, 0
  v_exp_f32 v119, v47
  v_mfma_f32_16x16x32_bf16 v[56:59], a[72:75], a[56:59], v[56:59]
  s_sub_u32 s84, s84, s70
  ds_read_b128 a[100:103], v3 offset:1024
  v_cvt_pk_bf16_f32 v67, v114, v115
  v_mfma_f32_16x16x32_bf16 v[56:59], a[68:71], a[52:55], v[56:59]
  ds_read_b128 a[104:107], v3 offset:2048
  v_cvt_pk_bf16_f32 v70, v116, v117
  v_mfma_f32_16x16x32_bf16 v[56:59], a[64:67], a[48:51], v[56:59]
  s_waitcnt lgkmcnt(3)
  ds_read_b128 a[108:111], v3 offset:3072
  v_cvt_pk_bf16_f32 v71, v118, v119
  v_mfma_f32_16x16x32_bf16 v[52:55], a[80:83], a[32:35], v[88:91]
  ds_read_b128 a[112:115], v3 offset:4096
  ds_read_b128 a[116:119], v3 offset:5120
  v_mfma_f32_16x16x32_bf16 v[52:55], a[84:87], a[36:39], v[52:55]
  ds_read_b128 a[120:123], v3 offset:6144
  ds_read_b128 a[124:127], v3 offset:7168
  v_mfma_f32_16x16x32_bf16 v[104:107], a[128:131], v[64:67], v[96:99]
  v_exp_f32 v112, v48
  v_mfma_f32_16x16x32_bf16 v[104:107], a[132:135], v[68:71], v[104:107]
  v_exp_f32 v113, v49
  v_mfma_f32_16x16x32_bf16 v[52:55], a[88:91], a[40:43], v[52:55]
  buffer_load_dwordx4 v2, s[20:23], s85 offen offset:1024  lds
  v_mfma_f32_16x16x32_bf16 v[52:55], a[92:95], a[44:47], v[52:55]
  v_exp_f32 v114, v50
  v_mfma_f32_16x16x32_bf16 v[60:63], a[92:95], a[60:63], v[92:95]
  s_nop 0
  v_exp_f32 v115, v51
  v_mfma_f32_16x16x32_bf16 v[60:63], a[88:91], a[56:59], v[60:63]
  ds_read_b128 a[64:67], v4 offset:8192
  v_cmp_nge_f32 vcc, s87, v106
  v_mfma_f32_16x16x32_bf16 v[60:63], a[84:87], a[52:55], v[60:63]
  s_waitcnt lgkmcnt(1)
  v_exp_f32 v116, v56
  v_mfma_f32_16x16x32_bf16 v[60:63], a[80:83], a[48:51], v[60:63]
  s_cbranch_vccnz L_rs_44
L_rr_45:
  v_exp_f32 v117, v57
  v_mfma_f32_16x16x32_bf16 v[128:131], a[96:99], v[64:67], v[128:131]
  ds_read_b128 a[68:71], v4 offset:9216
  v_cvt_pk_bf16_f32 v72, v112, v113
  v_mfma_f32_16x16x32_bf16 v[132:135], a[96:99], v[68:71], v[132:135]
  v_exp_f32 v118, v58
  v_mfma_f32_16x16x32_bf16 v[136:139], a[100:103], v[64:67], v[136:139]
  buffer_load_dwordx4 v2, s[20:23], s85 offen offset:2048  lds
  v_mfma_f32_16x16x32_bf16 v[140:143], a[100:103], v[68:71], v[140:143]
  v_exp_f32 v119, v59
  v_mfma_f32_16x16x32_bf16 v[144:147], a[104:107], v[64:67], v[144:147]
  ds_read_b128 a[72:75], v4 offset:10240
  v_mov_b32 v96, v104
  v_mfma_f32_16x16x32_bf16 v[148:151], a[104:107], v[68:71], v[148:151]
  v_exp_f32 v112, v52
  v_mfma_f32_16x16x32_bf16 v[152:155], a[108:111], v[64:67], v[152:155]
  ds_read_b128 a[76:79], v4 offset:11264
  v_cvt_pk_bf16_f32 v73, v114, v115
  v_mfma_f32_16x16x32_bf16 v[156:159], a[108:111], v[68:71], v[156:159]
  v_exp_f32 v113, v53
  v_mfma_f32_16x16x32_bf16 v[160:163], a[112:115], v[64:67], v[160:163]
  ds_read_b128 a[80:83], v4 offset:12288
  v_cvt_pk_bf16_f32 v76, v116, v117
  v_mfma_f32_16x16x32_bf16 v[164:167], a[112:115], v[68:71], v[164:167]
  v_exp_f32 v114, v54
  v_mfma_f32_16x16x32_bf16 v[168:171], a[116:119], v[64:67], v[168:171]
  buffer_load_dwordx4 v2, s[20:23], s85 offen offset:3072  lds
  v_mfma_f32_16x16x32_bf16 v[172:175], a[116:119], v[68:71], v[172:175]
  s_add_u32 s85, s85, 16384
  v_exp_f32 v115, v55
  v_mfma_f32_16x16x32_bf16 v[176:179], a[120:123], v[64:67], v[176:179]
  ds_read_b128 a[84:87], v4 offset:13312
  v_cvt_pk_bf16_f32 v77, v118, v119
  v_mfma_f32_16x16x32_bf16 v[180:183], a[120:123], v[68:71], v[180:183]
  v_exp_f32 v116, v60
  v_mfma_f32_16x16x32_bf16 v[184:187], a[124:127], v[64:67], v[184:187]
  ds_read_b128 a[88:91], v4 offset:14336
  v_mov_b32 v97, v105
  v_mfma_f32_16x16x32_bf16 v[188:191], a[124:127], v[68:71], v[188:191]
  s_waitcnt lgkmcnt(3)
  ds_read_b128 a[92:95], v4 offset:15360
  v_mfma_f32_16x16x32_bf16 v[32:35], a[64:67], a[0:3], v[80:83]
  v_exp_f32 v117, v61
  v_mfma_f32_16x16x32_bf16 v[32:35], a[68:71], a[4:7], v[32:35]
  v_cvt_pk_bf16_f32 v74, v112, v113
  v_mfma_f32_16x16x32_bf16 v[32:35], a[72:75], a[8:11], v[32:35]
  v_exp_f32 v118, v62
  v_mfma_f32_16x16x32_bf16 v[32:35], a[76:79], a[12:15], v[32:35]
  buffer_load_dwordx4 a[216:219], v28, s[28:31], s75 offen nt
  v_mfma_f32_16x16x32_bf16 v[40:43], a[76:79], a[28:31], v[84:87]
  v_exp_f32 v119, v63
  v_mfma_f32_16x16x32_bf16 v[40:43], a[72:75], a[24:27], v[40:43]
  v_cvt_pk_bf16_f32 v75, v114, v115
  v_mfma_f32_16x16x32_bf16 v[40:43], a[68:71], a[20:23], v[40:43]
  v_cvt_pk_bf16_f32 v78, v116, v117
  v_mfma_f32_16x16x32_bf16 v[40:43], a[64:67], a[16:19], v[40:43]
  s_waitcnt lgkmcnt(0)
  v_cvt_pk_bf16_f32 v79, v118, v119
  v_mfma_f32_16x16x32_bf16 v[36:39], a[80:83], a[0:3], v[80:83]
  s_nop 1
  v_mfma_f32_16x16x32_bf16 v[36:39], a[84:87], a[4:7], v[36:39]
  s_nop 0
  v_mfma_f32_16x16x32_bf16 v[104:107], a[128:131], v[72:75], v[100:103]
  v_exp_f32 v112, v32
  v_mfma_f32_16x16x32_bf16 v[104:107], a[132:135], v[76:79], v[104:107]
  v_exp_f32 v113, v33
  v_mfma_f32_16x16x32_bf16 v[36:39], a[88:91], a[8:11], v[36:39]
  s_nop 0
  buffer_load_dwordx4 a[220:223], v28, s[28:31], s75 offen offset:512 nt
  v_mfma_f32_16x16x32_bf16 v[36:39], a[92:95], a[12:15], v[36:39]
  s_nop 0
  v_exp_f32 v114, v34
  v_mfma_f32_16x16x32_bf16 v[44:47], a[92:95], a[28:31], v[84:87]
  s_nop 0
  v_exp_f32 v115, v35
  v_mfma_f32_16x16x32_bf16 v[44:47], a[88:91], a[24:27], v[44:47]
  v_cmp_nge_f32 vcc, s87, v106
  v_mfma_f32_16x16x32_bf16 v[44:47], a[84:87], a[20:23], v[44:47]
  v_exp_f32 v116, v40
  v_mfma_f32_16x16x32_bf16 v[44:47], a[80:83], a[16:19], v[44:47]
  s_cbranch_vccnz L_rs_46
L_rr_47:
  v_exp_f32 v117, v41
  v_mfma_f32_16x16x32_bf16 v[192:195], a[96:99], v[72:75], v[192:195]
  v_cvt_pk_bf16_f32 v64, v112, v113
  v_mfma_f32_16x16x32_bf16 v[196:199], a[96:99], v[76:79], v[196:199]
  s_add_u32 s86, s86, 16384
  v_exp_f32 v118, v42
  v_mfma_f32_16x16x32_bf16 v[200:203], a[100:103], v[72:75], v[200:203]
  s_cmp_ge_u32 s86, 147456
  v_mfma_f32_16x16x32_bf16 v[204:207], a[100:103], v[76:79], v[204:207]
  s_cselect_b32 s86, 0, s86
  v_exp_f32 v119, v43
  v_mfma_f32_16x16x32_bf16 v[208:211], a[104:107], v[72:75], v[208:211]
  v_mov_b32 v100, v104
  v_mfma_f32_16x16x32_bf16 v[212:215], a[104:107], v[76:79], v[212:215]
  v_exp_f32 v112, v36
  v_mfma_f32_16x16x32_bf16 v[216:219], a[108:111], v[72:75], v[216:219]
  v_cvt_pk_bf16_f32 v65, v114, v115
  v_mfma_f32_16x16x32_bf16 v[220:223], a[108:111], v[76:79], v[220:223]
  v_exp_f32 v113, v37
  v_mfma_f32_16x16x32_bf16 v[224:227], a[112:115], v[72:75], v[224:227]
  v_cvt_pk_bf16_f32 v68, v116, v117
  v_mfma_f32_16x16x32_bf16 v[228:231], a[112:115], v[76:79], v[228:231]
  v_exp_f32 v114, v38
  v_mfma_f32_16x16x32_bf16 v[232:235], a[116:119], v[72:75], v[232:235]
  s_add_u32 s75, s75, 9216
  buffer_load_dwordx4 a[224:227], v28, s[28:31], s75 offen nt
  v_mfma_f32_16x16x32_bf16 v[236:239], a[116:119], v[76:79], v[236:239]
  v_exp_f32 v115, v39
  v_mfma_f32_16x16x32_bf16 v[240:243], a[120:123], v[72:75], v[240:243]
  s_add_u32 s83, s83, 1
  v_cvt_pk_bf16_f32 v69, v118, v119
  v_mfma_f32_16x16x32_bf16 v[244:247], a[120:123], v[76:79], v[244:247]
  v_exp_f32 v116, v44
  v_mfma_f32_16x16x32_bf16 v[248:251], a[124:127], v[72:75], v[248:251]
  v_mov_b32 v101, v105
  v_mfma_f32_16x16x32_bf16 v[252:255], a[124:127], v[76:79], v[252:255]
  s_waitcnt vmcnt(17)
  v_mov_b32 v4, v3
  v_add_u32 v3, s86, v2
  v_mfma_f32_16x16x32_bf16 v[48:51], a[64:67], a[32:35], v[88:91]
  s_barrier
  v_exp_f32 v117, v45
  v_mfma_f32_16x16x32_bf16 v[48:51], a[68:71], a[36:39], v[48:51]
  s_mov_b32 m0, s84
  ds_read_b128 a[96:99], v3 offset:0
  v_cvt_pk_bf16_f32 v66, v112, v113
  v_mfma_f32_16x16x32_bf16 v[48:51], a[72:75], a[40:43], v[48:51]
  s_add_u32 s84, s84, 16384
  v_exp_f32 v118, v46
  v_mfma_f32_16x16x32_bf16 v[48:51], a[76:79], a[44:47], v[48:51]
  s_cmp_ge_u32 s84, 147456
  buffer_load_dwordx4 v2, s[20:23], s85 offen offset:0  lds
  v_mfma_f32_16x16x32_bf16 v[56:59], a[76:79], a[60:63], v[92:95]
  s_cselect_b32 s70, 147456, 0
  v_exp_f32 v119, v47
  v_mfma_f32_16x16x32_bf16 v[56:59], a[72:75], a[56:59], v[56:59]
  s_sub_u32 s84, s84, s70
  ds_read_b128 a[100:103], v3 offset:1024
  v_cvt_pk_bf16_f32 v67, v114, v115
  v_mfma_f32_16x16x32_bf16 v[56:59], a[68:71], a[52:55], v[56:59]
  ds_read_b128 a[104:107], v3 offset:2048
  v_cvt_pk_bf16_f32 v70, v116, v117
  v_mfma_f32_16x16x32_bf16 v[56:59], a[64:67], a[48:51], v[56:59]
  s_waitcnt lgkmcnt(3)
  ds_read_b128 a[108:111], v3 offset:3072
  v_cvt_pk_bf16_f32 v71, v118, v119
  v_mfma_f32_16x16x32_bf16 v[52:55], a[80:83], a[32:35], v[88:91]
  ds_read_b128 a[112:115], v3 offset:4096
  ds_read_b128 a[116:119], v3 offset:5120
  v_mfma_f32_16x16x32_bf16 v[52:55], a[84:87], a[36:39], v[52:55]
  ds_read_b128 a[120:123], v3 offset:6144
  ds_read_b128 a[124:127], v3 offset:7168
  v_mfma_f32_16x16x32_bf16 v[104:107], a[128:131], v[64:67], v[96:99]
  v_exp_f32 v112, v48
  v_mfma_f32_16x16x32_bf16 v[104:107], a[132:135], v[68:71], v[104:107]
  v_exp_f32 v113, v49
  v_mfma_f32_16x16x32_bf16 v[52:55], a[88:91], a[40:43], v[52:55]
  buffer_load_dwordx4 v2, s[20:23], s85 offen offset:1024  lds
  v_mfma_f32_16x16x32_bf16 v[52:55], a[92:95], a[44:47], v[52:55]
  v_exp_f32 v114, v50
  v_mfma_f32_16x16x32_bf16 v[60:63], a[92:95], a[60:63], v[92:95]
  s_nop 0
  v_exp_f32 v115, v51
  v_mfma_f32_16x16x32_bf16 v[60:63], a[88:91], a[56:59], v[60:63]
  ds_read_b128 a[64:67], v4 offset:8192
  v_cmp_nge_f32 vcc, s87, v106
  v_mfma_f32_16x16x32_bf16 v[60:63], a[84:87], a[52:55], v[60:63]
  s_waitcnt lgkmcnt(1)
  v_exp_f32 v116, v56
  v_mfma_f32_16x16x32_bf16 v[60:63], a[80:83], a[48:51], v[60:63]
  s_cbranch_vccnz L_rs_48
L_rr_49:
  v_exp_f32 v117, v57
  v_mfma_f32_16x16x32_bf16 v[128:131], a[96:99], v[64:67], v[128:131]
  ds_read_b128 a[68:71], v4 offset:9216
  v_cvt_pk_bf16_f32 v72, v112, v113
  v_mfma_f32_16x16x32_bf16 v[132:135], a[96:99], v[68:71], v[132:135]
  v_exp_f32 v118, v58
  v_mfma_f32_16x16x32_bf16 v[136:139], a[100:103], v[64:67], v[136:139]
  buffer_load_dwordx4 v2, s[20:23], s85 offen offset:2048  lds
  v_mfma_f32_16x16x32_bf16 v[140:143], a[100:103], v[68:71], v[140:143]
  v_exp_f32 v119, v59
  v_mfma_f32_16x16x32_bf16 v[144:147], a[104:107], v[64:67], v[144:147]
  ds_read_b128 a[72:75], v4 offset:10240
  v_mov_b32 v96, v104
  v_mfma_f32_16x16x32_bf16 v[148:151], a[104:107], v[68:71], v[148:151]
  v_exp_f32 v112, v52
  v_mfma_f32_16x16x32_bf16 v[152:155], a[108:111], v[64:67], v[152:155]
  ds_read_b128 a[76:79], v4 offset:11264
  v_cvt_pk_bf16_f32 v73, v114, v115
  v_mfma_f32_16x16x32_bf16 v[156:159], a[108:111], v[68:71], v[156:159]
  v_exp_f32 v113, v53
  v_mfma_f32_16x16x32_bf16 v[160:163], a[112:115], v[64:67], v[160:163]
  ds_read_b128 a[80:83], v4 offset:12288
  v_cvt_pk_bf16_f32 v76, v116, v117
  v_mfma_f32_16x16x32_bf16 v[164:167], a[112:115], v[68:71], v[164:167]
  v_exp_f32 v114, v54
  v_mfma_f32_16x16x32_bf16 v[168:171], a[116:119], v[64:67], v[168:171]
  buffer_load_dwordx4 v2, s[20:23], s85 offen offset:3072  lds
  v_mfma_f32_16x16x32_bf16 v[172:175], a[116:119], v[68:71], v[172:175]
  s_add_u32 s85, s85, 16384
  v_exp_f32 v115, v55
  v_mfma_f32_16x16x32_bf16 v[176:179], a[120:123], v[64:67], v[176:179]
  ds_read_b128 a[84:87], v4 offset:13312
  v_cvt_pk_bf16_f32 v77, v118, v119
  v_mfma_f32_16x16x32_bf16 v[180:183], a[120:123], v[68:71], v[180:183]
  v_exp_f32 v116, v60
  v_mfma_f32_16x16x32_bf16 v[184:187], a[124:127], v[64:67], v[184:187]
  ds_read_b128 a[88:91], v4 offset:14336
  v_mov_b32 v97, v105
  v_mfma_f32_16x16x32_bf16 v[188:191], a[124:127], v[68:71], v[188:191]
  s_waitcnt lgkmcnt(3)
  ds_read_b128 a[92:95], v4 offset:15360
  v_mfma_f32_16x16x32_bf16 v[32:35], a[64:67], a[0:3], v[80:83]
  v_exp_f32 v117, v61
  v_mfma_f32_16x16x32_bf16 v[32:35], a[68:71], a[4:7], v[32:35]
  v_cvt_pk_bf16_f32 v74, v112, v113
  v_mfma_f32_16x16x32_bf16 v[32:35], a[72:75], a[8:11], v[32:35]
  v_exp_f32 v118, v62
  v_mfma_f32_16x16x32_bf16 v[32:35], a[76:79], a[12:15], v[32:35]
  buffer_load_dwordx4 a[228:231], v28, s[28:31], s75 offen offset:512 nt
  v_mfma_f32_16x16x32_bf16 v[40:43], a[76:79], a[28:31], v[84:87]
  v_exp_f32 v119, v63
  v_mfma_f32_16x16x32_bf16 v[40:43], a[72:75], a[24:27], v[40:43]
  v_cvt_pk_bf16_f32 v75, v114, v115
  v_mfma_f32_16x16x32_bf16 v[40:43], a[68:71], a[20:23], v[40:43]
  v_cvt_pk_bf16_f32 v78, v116, v117
  v_mfma_f32_16x16x32_bf16 v[40:43], a[64:67], a[16:19], v[40:43]
  s_waitcnt lgkmcnt(0)
  v_cvt_pk_bf16_f32 v79, v118, v119
  v_mfma_f32_16x16x32_bf16 v[36:39], a[80:83], a[0:3], v[80:83]
  s_nop 1
  v_mfma_f32_16x16x32_bf16 v[36:39], a[84:87], a[4:7], v[36:39]
  s_nop 0
  v_mfma_f32_16x16x32_bf16 v[104:107], a[128:131], v[72:75], v[100:103]
  v_exp_f32 v112, v32
  v_mfma_f32_16x16x32_bf16 v[104:107], a[132:135], v[76:79], v[104:107]
  v_exp_f32 v113, v33
  v_mfma_f32_16x16x32_bf16 v[36:39], a[88:91], a[8:11], v[36:39]
  s_nop 0
  s_add_u32 s75, s75, 9216
  buffer_load_dwordx4 a[232:235], v28, s[28:31], s75 offen nt
  v_mfma_f32_16x16x32_bf16 v[36:39], a[92:95], a[12:15], v[36:39]
  s_nop 0
  v_exp_f32 v114, v34
  v_mfma_f32_16x16x32_bf16 v[44:47], a[92:95], a[28:31], v[84:87]
  s_nop 0
  v_exp_f32 v115, v35
  v_mfma_f32_16x16x32_bf16 v[44:47], a[88:91], a[24:27], v[44:47]
  v_cmp_nge_f32 vcc, s87, v106
  v_mfma_f32_16x16x32_bf16 v[44:47], a[84:87], a[20:23], v[44:47]
  v_exp_f32 v116, v40
  v_mfma_f32_16x16x32_bf16 v[44:47], a[80:83], a[16:19], v[44:47]
  s_cbranch_vccnz L_rs_50
L_rr_51:
  v_exp_f32 v117, v41
  v_mfma_f32_16x16x32_bf16 v[192:195], a[96:99], v[72:75], v[192:195]
  v_cvt_pk_bf16_f32 v64, v112, v113
  v_mfma_f32_16x16x32_bf16 v[196:199], a[96:99], v[76:79], v[196:199]
  s_add_u32 s86, s86, 16384
  v_exp_f32 v118, v42
  v_mfma_f32_16x16x32_bf16 v[200:203], a[100:103], v[72:75], v[200:203]
  s_cmp_ge_u32 s86, 147456
  v_mfma_f32_16x16x32_bf16 v[204:207], a[100:103], v[76:79], v[204:207]
  s_cselect_b32 s86, 0, s86
  v_exp_f32 v119, v43
  v_mfma_f32_16x16x32_bf16 v[208:211], a[104:107], v[72:75], v[208:211]
  v_mov_b32 v100, v104
  v_mfma_f32_16x16x32_bf16 v[212:215], a[104:107], v[76:79], v[212:215]
  v_exp_f32 v112, v36
  v_mfma_f32_16x16x32_bf16 v[216:219], a[108:111], v[72:75], v[216:219]
  v_cvt_pk_bf16_f32 v65, v114, v115
  v_mfma_f32_16x16x32_bf16 v[220:223], a[108:111], v[76:79], v[220:223]
  v_exp_f32 v113, v37
  v_mfma_f32_16x16x32_bf16 v[224:227], a[112:115], v[72:75], v[224:227]
  v_cvt_pk_bf16_f32 v68, v116, v117
  v_mfma_f32_16x16x32_bf16 v[228:231], a[112:115], v[76:79], v[228:231]
  v_exp_f32 v114, v38
  v_mfma_f32_16x16x32_bf16 v[232:235], a[116:119], v[72:75], v[232:235]
  buffer_load_dwordx4 a[236:239], v28, s[28:31], s75 offen offset:512 nt
  v_mfma_f32_16x16x32_bf16 v[236:239], a[116:119], v[76:79], v[236:239]
  v_exp_f32 v115, v39
  v_mfma_f32_16x16x32_bf16 v[240:243], a[120:123], v[72:75], v[240:243]
  s_add_u32 s83, s83, 1
  v_cvt_pk_bf16_f32 v69, v118, v119
  v_mfma_f32_16x16x32_bf16 v[244:247], a[120:123], v[76:79], v[244:247]
  v_exp_f32 v116, v44
  v_mfma_f32_16x16x32_bf16 v[248:251], a[124:127], v[72:75], v[248:251]
  v_mov_b32 v101, v105
  v_mfma_f32_16x16x32_bf16 v[252:255], a[124:127], v[76:79], v[252:255]
  s_waitcnt vmcnt(17)
  v_mov_b32 v4, v3
  v_add_u32 v3, s86, v2
  v_mfma_f32_16x16x32_bf16 v[48:51], a[64:67], a[32:35], v[88:91]
  s_barrier
  v_exp_f32 v117, v45
  v_mfma_f32_16x16x32_bf16 v[48:51], a[68:71], a[36:39], v[48:51]
  s_mov_b32 m0, s84
  ds_read_b128 a[96:99], v3 offset:0
  v_cvt_pk_bf16_f32 v66, v112, v113
  v_mfma_f32_16x16x32_bf16 v[48:51], a[72:75], a[40:43], v[48:51]
  s_add_u32 s84, s84, 16384
  v_exp_f32 v118, v46
  v_mfma_f32_16x16x32_bf16 v[48:51], a[76:79], a[44:47], v[48:51]
  s_cmp_ge_u32 s84, 147456
  buffer_load_dwordx4 v2, s[20:23], s85 offen offset:0  lds
  v_mfma_f32_16x16x32_bf16 v[56:59], a[76:79], a[60:63], v[92:95]
  s_cselect_b32 s70, 147456, 0
  v_exp_f32 v119, v47
  v_mfma_f32_16x16x32_bf16 v[56:59], a[72:75], a[56:59], v[56:59]
  s_sub_u32 s84, s84, s70
  ds_read_b128 a[100:103], v3 offset:1024
  v_cvt_pk_bf16_f32 v67, v114, v115
  v_mfma_f32_16x16x32_bf16 v[56:59], a[68:71], a[52:55], v[56:59]
  ds_read_b128 a[104:107], v3 offset:2048
  v_cvt_pk_bf16_f32 v70, v116, v117
  v_mfma_f32_16x16x32_bf16 v[56:59], a[64:67], a[48:51], v[56:59]
  s_waitcnt lgkmcnt(3)
  ds_read_b128 a[108:111], v3 offset:3072
  v_cvt_pk_bf16_f32 v71, v118, v119
  v_mfma_f32_16x16x32_bf16 v[52:55], a[80:83], a[32:35], v[88:91]
  ds_read_b128 a[112:115], v3 offset:4096
  ds_read_b128 a[116:119], v3 offset:5120
  v_mfma_f32_16x16x32_bf16 v[52:55], a[84:87], a[36:39], v[52:55]
  ds_read_b128 a[120:123], v3 offset:6144
  ds_read_b128 a[124:127], v3 offset:7168
  v_mfma_f32_16x16x32_bf16 v[104:107], a[128:131], v[64:67], v[96:99]
  v_exp_f32 v112, v48
  v_mfma_f32_16x16x32_bf16 v[104:107], a[132:135], v[68:71], v[104:107]
  v_exp_f32 v113, v49
  v_mfma_f32_16x16x32_bf16 v[52:55], a[88:91], a[40:43], v[52:55]
  buffer_load_dwordx4 v2, s[20:23], s85 offen offset:1024  lds
  v_mfma_f32_16x16x32_bf16 v[52:55], a[92:95], a[44:47], v[52:55]
  v_exp_f32 v114, v50
  v_mfma_f32_16x16x32_bf16 v[60:63], a[92:95], a[60:63], v[92:95]
  s_nop 0
  v_exp_f32 v115, v51
  v_mfma_f32_16x16x32_bf16 v[60:63], a[88:91], a[56:59], v[60:63]
  ds_read_b128 a[64:67], v4 offset:8192
  v_cmp_nge_f32 vcc, s87, v106
  v_mfma_f32_16x16x32_bf16 v[60:63], a[84:87], a[52:55], v[60:63]
  s_waitcnt lgkmcnt(1)
  v_exp_f32 v116, v56
  v_mfma_f32_16x16x32_bf16 v[60:63], a[80:83], a[48:51], v[60:63]
  s_cbranch_vccnz L_rs_52
L_rr_53:
  v_exp_f32 v117, v57
  v_mfma_f32_16x16x32_bf16 v[128:131], a[96:99], v[64:67], v[128:131]
  ds_read_b128 a[68:71], v4 offset:9216
  v_cvt_pk_bf16_f32 v72, v112, v113
  v_mfma_f32_16x16x32_bf16 v[132:135], a[96:99], v[68:71], v[132:135]
  v_exp_f32 v118, v58
  v_mfma_f32_16x16x32_bf16 v[136:139], a[100:103], v[64:67], v[136:139]
  buffer_load_dwordx4 v2, s[20:23], s85 offen offset:2048  lds
  v_mfma_f32_16x16x32_bf16 v[140:143], a[100:103], v[68:71], v[140:143]
  v_exp_f32 v119, v59
  v_mfma_f32_16x16x32_bf16 v[144:147], a[104:107], v[64:67], v[144:147]
  ds_read_b128 a[72:75], v4 offset:10240
  v_mov_b32 v96, v104
  v_mfma_f32_16x16x32_bf16 v[148:151], a[104:107], v[68:71], v[148:151]
  v_exp_f32 v112, v52
  v_mfma_f32_16x16x32_bf16 v[152:155], a[108:111], v[64:67], v[152:155]
  ds_read_b128 a[76:79], v4 offset:11264
  v_cvt_pk_bf16_f32 v73, v114, v115
  v_mfma_f32_16x16x32_bf16 v[156:159], a[108:111], v[68:71], v[156:159]
  v_exp_f32 v113, v53
  v_mfma_f32_16x16x32_bf16 v[160:163], a[112:115], v[64:67], v[160:163]
  ds_read_b128 a[80:83], v4 offset:12288
  v_cvt_pk_bf16_f32 v76, v116, v117
  v_mfma_f32_16x16x32_bf16 v[164:167], a[112:115], v[68:71], v[164:167]
  v_exp_f32 v114, v54
  v_mfma_f32_16x16x32_bf16 v[168:171], a[116:119], v[64:67], v[168:171]
  buffer_load_dwordx4 v2, s[20:23], s85 offen offset:3072  lds
  v_mfma_f32_16x16x32_bf16 v[172:175], a[116:119], v[68:71], v[172:175]
  s_add_u32 s85, s85, 16384
  v_exp_f32 v115, v55
  v_mfma_f32_16x16x32_bf16 v[176:179], a[120:123], v[64:67], v[176:179]
  ds_read_b128 a[84:87], v4 offset:13312
  v_cvt_pk_bf16_f32 v77, v118, v119
  v_mfma_f32_16x16x32_bf16 v[180:183], a[120:123], v[68:71], v[180:183]
  v_exp_f32 v116, v60
  v_mfma_f32_16x16x32_bf16 v[184:187], a[124:127], v[64:67], v[184:187]
  ds_read_b128 a[88:91], v4 offset:14336
  v_mov_b32 v97, v105
  v_mfma_f32_16x16x32_bf16 v[188:191], a[124:127], v[68:71], v[188:191]
  s_waitcnt lgkmcnt(3)
  ds_read_b128 a[92:95], v4 offset:15360
  v_mfma_f32_16x16x32_bf16 v[32:35], a[64:67], a[0:3], v[80:83]
  v_exp_f32 v117, v61
  v_mfma_f32_16x16x32_bf16 v[32:35], a[68:71], a[4:7], v[32:35]
  v_cvt_pk_bf16_f32 v74, v112, v113
  v_mfma_f32_16x16x32_bf16 v[32:35], a[72:75], a[8:11], v[32:35]
  v_exp_f32 v118, v62
  v_mfma_f32_16x16x32_bf16 v[32:35], a[76:79], a[12:15], v[32:35]
  s_add_u32 s75, s75, 9216
  buffer_load_dwordx4 a[240:243], v28, s[28:31], s75 offen nt
  v_mfma_f32_16x16x32_bf16 v[40:43], a[76:79], a[28:31], v[84:87]
  v_exp_f32 v119, v63
  v_mfma_f32_16x16x32_bf16 v[40:43], a[72:75], a[24:27], v[40:43]
  v_cvt_pk_bf16_f32 v75, v114, v115
  v_mfma_f32_16x16x32_bf16 v[40:43], a[68:71], a[20:23], v[40:43]
  v_cvt_pk_bf16_f32 v78, v116, v117
  v_mfma_f32_16x16x32_bf16 v[40:43], a[64:67], a[16:19], v[40:43]
  s_waitcnt lgkmcnt(0)
  v_cvt_pk_bf16_f32 v79, v118, v119
  v_mfma_f32_16x16x32_bf16 v[36:39], a[80:83], a[0:3], v[80:83]
  s_nop 1
  v_mfma_f32_16x16x32_bf16 v[36:39], a[84:87], a[4:7], v[36:39]
  s_nop 0
  v_mfma_f32_16x16x32_bf16 v[104:107], a[128:131], v[72:75], v[100:103]
  v_exp_f32 v112, v32
  v_mfma_f32_16x16x32_bf16 v[104:107], a[132:135], v[76:79], v[104:107]
  v_exp_f32 v113, v33
  v_mfma_f32_16x16x32_bf16 v[36:39], a[88:91], a[8:11], v[36:39]
  s_nop 0
  buffer_load_dwordx4 a[244:247], v28, s[28:31], s75 offen offset:512 nt
  v_mfma_f32_16x16x32_bf16 v[36:39], a[92:95], a[12:15], v[36:39]
  s_nop 0
  v_exp_f32 v114, v34
  v_mfma_f32_16x16x32_bf16 v[44:47], a[92:95], a[28:31], v[84:87]
  s_nop 0
  v_exp_f32 v115, v35
  v_mfma_f32_16x16x32_bf16 v[44:47], a[88:91], a[24:27], v[44:47]
  v_cmp_nge_f32 vcc, s87, v106
  v_mfma_f32_16x16x32_bf16 v[44:47], a[84:87], a[20:23], v[44:47]
  v_exp_f32 v116, v40
  v_mfma_f32_16x16x32_bf16 v[44:47], a[80:83], a[16:19], v[44:47]
  s_cbranch_vccnz L_rs_54
L_rr_55:
  v_exp_f32 v117, v41
  v_mfma_f32_16x16x32_bf16 v[192:195], a[96:99], v[72:75], v[192:195]
  v_cvt_pk_bf16_f32 v64, v112, v113
  v_mfma_f32_16x16x32_bf16 v[196:199], a[96:99], v[76:79], v[196:199]
  s_add_u32 s86, s86, 16384
  v_exp_f32 v118, v42
  v_mfma_f32_16x16x32_bf16 v[200:203], a[100:103], v[72:75], v[200:203]
  s_cmp_ge_u32 s86, 147456
  v_mfma_f32_16x16x32_bf16 v[204:207], a[100:103], v[76:79], v[204:207]
  s_cselect_b32 s86, 0, s86
  v_exp_f32 v119, v43
  v_mfma_f32_16x16x32_bf16 v[208:211], a[104:107], v[72:75], v[208:211]
  v_mov_b32 v100, v104
  v_mfma_f32_16x16x32_bf16 v[212:215], a[104:107], v[76:79], v[212:215]
  v_exp_f32 v112, v36
  v_mfma_f32_16x16x32_bf16 v[216:219], a[108:111], v[72:75], v[216:219]
  v_cvt_pk_bf16_f32 v65, v114, v115
  v_mfma_f32_16x16x32_bf16 v[220:223], a[108:111], v[76:79], v[220:223]
  v_exp_f32 v113, v37
  v_mfma_f32_16x16x32_bf16 v[224:227], a[112:115], v[72:75], v[224:227]
  v_cvt_pk_bf16_f32 v68, v116, v117
  v_mfma_f32_16x16x32_bf16 v[228:231], a[112:115], v[76:79], v[228:231]
  v_exp_f32 v114, v38
  v_mfma_f32_16x16x32_bf16 v[232:235], a[116:119], v[72:75], v[232:235]
  v_mfma_f32_16x16x32_bf16 v[236:239], a[116:119], v[76:79], v[236:239]
  v_exp_f32 v115, v39
  v_mfma_f32_16x16x32_bf16 v[240:243], a[120:123], v[72:75], v[240:243]
  s_add_u32 s83, s83, 1
  v_cvt_pk_bf16_f32 v69, v118, v119
  v_mfma_f32_16x16x32_bf16 v[244:247], a[120:123], v[76:79], v[244:247]
  v_exp_f32 v116, v44
  v_mfma_f32_16x16x32_bf16 v[248:251], a[124:127], v[72:75], v[248:251]
  v_mov_b32 v101, v105
  v_mfma_f32_16x16x32_bf16 v[252:255], a[124:127], v[76:79], v[252:255]
  s_waitcnt vmcnt(16)
  v_mov_b32 v4, v3
  v_add_u32 v3, s86, v2
  v_mfma_f32_16x16x32_bf16 v[48:51], a[64:67], a[32:35], v[88:91]
  s_barrier
  v_exp_f32 v117, v45
  v_mfma_f32_16x16x32_bf16 v[48:51], a[68:71], a[36:39], v[48:51]
  s_mov_b32 m0, s84
  ds_read_b128 a[96:99], v3 offset:0
  v_cvt_pk_bf16_f32 v66, v112, v113
  v_mfma_f32_16x16x32_bf16 v[48:51], a[72:75], a[40:43], v[48:51]
  s_add_u32 s84, s84, 16384
  v_exp_f32 v118, v46
  v_mfma_f32_16x16x32_bf16 v[48:51], a[76:79], a[44:47], v[48:51]
  s_cmp_ge_u32 s84, 147456
  buffer_load_dwordx4 v2, s[20:23], s85 offen offset:0  lds
  v_mfma_f32_16x16x32_bf16 v[56:59], a[76:79], a[60:63], v[92:95]
  s_cselect_b32 s70, 147456, 0
  v_exp_f32 v119, v47
  v_mfma_f32_16x16x32_bf16 v[56:59], a[72:75], a[56:59], v[56:59]
  s_sub_u32 s84, s84, s70
  ds_read_b128 a[100:103], v3 offset:1024
  v_cvt_pk_bf16_f32 v67, v114, v115
  v_mfma_f32_16x16x32_bf16 v[56:59], a[68:71], a[52:55], v[56:59]
  ds_read_b128 a[104:107], v3 offset:2048
  v_cvt_pk_bf16_f32 v70, v116, v117
  v_mfma_f32_16x16x32_bf16 v[56:59], a[64:67], a[48:51], v[56:59]
  s_waitcnt lgkmcnt(3)
  ds_read_b128 a[108:111], v3 offset:3072
  v_cvt_pk_bf16_f32 v71, v118, v119
  v_mfma_f32_16x16x32_bf16 v[52:55], a[80:83], a[32:35], v[88:91]
  ds_read_b128 a[112:115], v3 offset:4096
  ds_read_b128 a[116:119], v3 offset:5120
  v_mfma_f32_16x16x32_bf16 v[52:55], a[84:87], a[36:39], v[52:55]
  ds_read_b128 a[120:123], v3 offset:6144
  ds_read_b128 a[124:127], v3 offset:7168
  v_mfma_f32_16x16x32_bf16 v[104:107], a[128:131], v[64:67], v[96:99]
  v_exp_f32 v112, v48
  v_mfma_f32_16x16x32_bf16 v[104:107], a[132:135], v[68:71], v[104:107]
  v_exp_f32 v113, v49
  v_mfma_f32_16x16x32_bf16 v[52:55], a[88:91], a[40:43], v[52:55]
  buffer_load_dwordx4 v2, s[20:23], s85 offen offset:1024  lds
  v_mfma_f32_16x16x32_bf16 v[52:55], a[92:95], a[44:47], v[52:55]
  v_exp_f32 v114, v50
  v_mfma_f32_16x16x32_bf16 v[60:63], a[92:95], a[60:63], v[92:95]
  s_nop 0
  v_exp_f32 v115, v51
  v_mfma_f32_16x16x32_bf16 v[60:63], a[88:91], a[56:59], v[60:63]
  ds_read_b128 a[64:67], v4 offset:8192
  v_cmp_nge_f32 vcc, s87, v106
  v_mfma_f32_16x16x32_bf16 v[60:63], a[84:87], a[52:55], v[60:63]
  s_waitcnt lgkmcnt(1)
  v_exp_f32 v116, v56
  v_mfma_f32_16x16x32_bf16 v[60:63], a[80:83], a[48:51], v[60:63]
  s_cbranch_vccnz L_rs_56
L_rr_57:
  v_exp_f32 v117, v57
  v_mfma_f32_16x16x32_bf16 v[128:131], a[96:99], v[64:67], v[128:131]
  ds_read_b128 a[68:71], v4 offset:9216
  v_cvt_pk_bf16_f32 v72, v112, v113
  v_mfma_f32_16x16x32_bf16 v[132:135], a[96:99], v[68:71], v[132:135]
  v_exp_f32 v118, v58
  v_mfma_f32_16x16x32_bf16 v[136:139], a[100:103], v[64:67], v[136:139]
  buffer_load_dwordx4 v2, s[20:23], s85 offen offset:2048  lds
  v_mfma_f32_16x16x32_bf16 v[140:143], a[100:103], v[68:71], v[140:143]
  v_exp_f32 v119, v59
  v_mfma_f32_16x16x32_bf16 v[144:147], a[104:107], v[64:67], v[144:147]
  ds_read_b128 a[72:75], v4 offset:10240
  v_mov_b32 v96, v104
  v_mfma_f32_16x16x32_bf16 v[148:151], a[104:107], v[68:71], v[148:151]
  v_exp_f32 v112, v52
  v_mfma_f32_16x16x32_bf16 v[152:155], a[108:111], v[64:67], v[152:155]
  ds_read_b128 a[76:79], v4 offset:11264
  v_cvt_pk_bf16_f32 v73, v114, v115
  v_mfma_f32_16x16x32_bf16 v[156:159], a[108:111], v[68:71], v[156:159]
  v_exp_f32 v113, v53
  v_mfma_f32_16x16x32_bf16 v[160:163], a[112:115], v[64:67], v[160:163]
  ds_read_b128 a[80:83], v4 offset:12288
  v_cvt_pk_bf16_f32 v76, v116, v117
  v_mfma_f32_16x16x32_bf16 v[164:167], a[112:115], v[68:71], v[164:167]
  v_exp_f32 v114, v54
  v_mfma_f32_16x16x32_bf16 v[168:171], a[116:119], v[64:67], v[168:171]
  buffer_load_dwordx4 v2, s[20:23], s85 offen offset:3072  lds
  v_mfma_f32_16x16x32_bf16 v[172:175], a[116:119], v[68:71], v[172:175]
  s_add_u32 s85, s85, 16384
  v_exp_f32 v115, v55
  v_mfma_f32_16x16x32_bf16 v[176:179], a[120:123], v[64:67], v[176:179]
  ds_read_b128 a[84:87], v4 offset:13312
  v_cvt_pk_bf16_f32 v77, v118, v119
  v_mfma_f32_16x16x32_bf16 v[180:183], a[120:123], v[68:71], v[180:183]
  v_exp_f32 v116, v60
  v_mfma_f32_16x16x32_bf16 v[184:187], a[124:127], v[64:67], v[184:187]
  ds_read_b128 a[88:91], v4 offset:14336
  v_mov_b32 v97, v105
  v_mfma_f32_16x16x32_bf16 v[188:191], a[124:127], v[68:71], v[188:191]
  s_waitcnt lgkmcnt(3)
  ds_read_b128 a[92:95], v4 offset:15360
  v_mfma_f32_16x16x32_bf16 v[32:35], a[64:67], a[0:3], v[80:83]
  v_exp_f32 v117, v61
  v_mfma_f32_16x16x32_bf16 v[32:35], a[68:71], a[4:7], v[32:35]
  v_cvt_pk_bf16_f32 v74, v112, v113
  v_mfma_f32_16x16x32_bf16 v[32:35], a[72:75], a[8:11], v[32:35]
  v_exp_f32 v118, v62
  v_mfma_f32_16x16x32_bf16 v[32:35], a[76:79], a[12:15], v[32:35]
  v_mfma_f32_16x16x32_bf16 v[40:43], a[76:79], a[28:31], v[84:87]
  v_exp_f32 v119, v63
  v_mfma_f32_16x16x32_bf16 v[40:43], a[72:75], a[24:27], v[40:43]
  v_cvt_pk_bf16_f32 v75, v114, v115
  v_mfma_f32_16x16x32_bf16 v[40:43], a[68:71], a[20:23], v[40:43]
  v_cvt_pk_bf16_f32 v78, v116, v117
  v_mfma_f32_16x16x32_bf16 v[40:43], a[64:67], a[16:19], v[40:43]
  s_waitcnt lgkmcnt(0)
  v_cvt_pk_bf16_f32 v79, v118, v119
  v_mfma_f32_16x16x32_bf16 v[36:39], a[80:83], a[0:3], v[80:83]
  s_nop 1
  v_mfma_f32_16x16x32_bf16 v[36:39], a[84:87], a[4:7], v[36:39]
  s_nop 0
  v_mfma_f32_16x16x32_bf16 v[104:107], a[128:131], v[72:75], v[100:103]
  v_exp_f32 v112, v32
  v_mfma_f32_16x16x32_bf16 v[104:107], a[132:135], v[76:79], v[104:107]
  v_exp_f32 v113, v33
  v_mfma_f32_16x16x32_bf16 v[36:39], a[88:91], a[8:11], v[36:39]
  s_nop 0
  v_mfma_f32_16x16x32_bf16 v[36:39], a[92:95], a[12:15], v[36:39]
  s_nop 0
  v_exp_f32 v114, v34
  v_mfma_f32_16x16x32_bf16 v[44:47], a[92:95], a[28:31], v[84:87]
  s_nop 0
  v_exp_f32 v115, v35
  v_mfma_f32_16x16x32_bf16 v[44:47], a[88:91], a[24:27], v[44:47]
  v_cmp_nge_f32 vcc, s87, v106
  v_mfma_f32_16x16x32_bf16 v[44:47], a[84:87], a[20:23], v[44:47]
  v_exp_f32 v116, v40
  v_mfma_f32_16x16x32_bf16 v[44:47], a[80:83], a[16:19], v[44:47]
  s_cbranch_vccnz L_rs_58
L_rr_59:
  v_exp_f32 v117, v41
  v_mfma_f32_16x16x32_bf16 v[192:195], a[96:99], v[72:75], v[192:195]
  v_cvt_pk_bf16_f32 v64, v112, v113
  s_mov_b32 s72, 0x01000100
  s_mov_b32 s73, 0x03020302
  v_mfma_f32_16x16x32_bf16 v[196:199], a[96:99], v[76:79], v[196:199]
  s_add_u32 s86, s86, 16384
  v_exp_f32 v118, v42
  v_mfma_f32_16x16x32_bf16 v[200:203], a[100:103], v[72:75], v[200:203]
  s_cmp_ge_u32 s86, 147456
  v_perm_b32 v5, v22, v22, s72
  v_and_b32 v6, v5, v120
  v_and_b32 v7, v5, v121
  v_and_b32 v8, v5, v122
  v_mfma_f32_16x16x32_bf16 v[204:207], a[100:103], v[76:79], v[204:207]
  s_cselect_b32 s86, 0, s86
  v_exp_f32 v119, v43
  v_mfma_f32_16x16x32_bf16 v[208:211], a[104:107], v[72:75], v[208:211]
  v_mov_b32 v100, v104
  v_and_b32 v9, v5, v123
  v_perm_b32 v5, v22, v22, s73
  v_mfma_f32_16x16x32_bf16 v[212:215], a[104:107], v[76:79], v[212:215]
  v_exp_f32 v112, v36
  v_mfma_f32_16x16x32_bf16 v[216:219], a[108:111], v[72:75], v[216:219]
  v_cvt_pk_bf16_f32 v65, v114, v115
  v_and_b32 v10, v5, v120
  v_and_b32 v11, v5, v121
  v_mfma_f32_16x16x32_bf16 v[220:223], a[108:111], v[76:79], v[220:223]
  v_exp_f32 v113, v37
  v_mfma_f32_16x16x32_bf16 v[224:227], a[112:115], v[72:75], v[224:227]
  v_cvt_pk_bf16_f32 v68, v116, v117
  v_and_b32 v12, v5, v122
  v_and_b32 v13, v5, v123
  v_mfma_f32_16x16x32_bf16 v[228:231], a[112:115], v[76:79], v[228:231]
  v_exp_f32 v114, v38
  v_mfma_f32_16x16x32_bf16 v[232:235], a[116:119], v[72:75], v[232:235]
  v_perm_b32 v5, v23, v23, s72
  v_and_b32 v14, v5, v120
  v_and_b32 v15, v5, v121
  v_and_b32 v16, v5, v122
  v_mfma_f32_16x16x32_bf16 v[236:239], a[116:119], v[76:79], v[236:239]
  v_exp_f32 v115, v39
  v_mfma_f32_16x16x32_bf16 v[240:243], a[120:123], v[72:75], v[240:243]
  s_add_u32 s83, s83, 1
  v_cvt_pk_bf16_f32 v69, v118, v119
  v_and_b32 v17, v5, v123
  v_perm_b32 v5, v23, v23, s73
  v_mfma_f32_16x16x32_bf16 v[244:247], a[120:123], v[76:79], v[244:247]
  v_exp_f32 v116, v44
  v_mfma_f32_16x16x32_bf16 v[248:251], a[124:127], v[72:75], v[248:251]
  v_mov_b32 v101, v105
  v_and_b32 v18, v5, v120
  v_and_b32 v19, v5, v121
  v_mfma_f32_16x16x32_bf16 v[252:255], a[124:127], v[76:79], v[252:255]
  s_waitcnt vmcnt(13)
  v_mov_b32 v4, v3
  v_add_u32 v3, s86, v2
  v_and_b32 v20, v5, v122
  v_and_b32 v21, v5, v123
  v_mfma_f32_16x16x32_bf16 v[48:51], a[64:67], a[32:35], v[88:91]
  s_barrier
  v_exp_f32 v117, v45
  v_mfma_f32_16x16x32_bf16 a[248:251], v[6:9], a[136:139], 0
  v_mfma_f32_16x16x32_bf16 a[248:251], v[10:13], a[140:143], a[248:251]
  v_mfma_f32_16x16x32_bf16 v[48:51], a[68:71], a[36:39], v[48:51]
  ds_read_b128 a[96:99], v3 offset:0
  v_cvt_pk_bf16_f32 v66, v112, v113
  v_mfma_f32_16x16x32_bf16 a[248:251], v[14:17], a[144:147], a[248:251]
  v_mfma_f32_16x16x32_bf16 v[48:51], a[72:75], a[40:43], v[48:51]
  v_exp_f32 v118, v46
  v_mfma_f32_16x16x32_bf16 a[248:251], v[18:21], a[148:151], a[248:251]
  v_mfma_f32_16x16x32_bf16 v[48:51], a[76:79], a[44:47], v[48:51]
  v_mfma_f32_16x16x32_bf16 a[136:139], v[6:9], a[152:155], 0
  v_mfma_f32_16x16x32_bf16 v[56:59], a[76:79], a[60:63], v[92:95]
  v_exp_f32 v119, v47
  v_mfma_f32_16x16x32_bf16 a[136:139], v[10:13], a[156:159], a[136:139]
  v_mfma_f32_16x16x32_bf16 a[136:139], v[14:17], a[160:163], a[136:139]
  v_mfma_f32_16x16x32_bf16 v[56:59], a[72:75], a[56:59], v[56:59]
  ds_read_b128 a[100:103], v3 offset:1024
  v_cvt_pk_bf16_f32 v67, v114, v115
  v_mfma_f32_16x16x32_bf16 a[136:139], v[18:21], a[164:167], a[136:139]
  v_mfma_f32_16x16x32_bf16 v[56:59], a[68:71], a[52:55], v[56:59]
  ds_read_b128 a[104:107], v3 offset:2048
  v_cvt_pk_bf16_f32 v70, v116, v117
  v_mfma_f32_16x16x32_bf16 a[140:143], v[6:9], a[168:171], 0
  v_mfma_f32_16x16x32_bf16 v[56:59], a[64:67], a[48:51], v[56:59]
  s_waitcnt lgkmcnt(3)
  ds_read_b128 a[108:111], v3 offset:3072
  v_cvt_pk_bf16_f32 v71, v118, v119
  v_mfma_f32_16x16x32_bf16 a[140:143], v[10:13], a[172:175], a[140:143]
  v_mfma_f32_16x16x32_bf16 v[52:55], a[80:83], a[32:35], v[88:91]
  ds_read_b128 a[112:115], v3 offset:4096
  ds_read_b128 a[116:119], v3 offset:5120
  v_mfma_f32_16x16x32_bf16 a[140:143], v[14:17], a[176:179], a[140:143]
  v_mfma_f32_16x16x32_bf16 a[140:143], v[18:21], a[180:183], a[140:143]
  v_mfma_f32_16x16x32_bf16 v[52:55], a[84:87], a[36:39], v[52:55]
  ds_read_b128 a[120:123], v3 offset:6144
  ds_read_b128 a[124:127], v3 offset:7168
  v_mfma_f32_16x16x32_bf16 a[144:147], v[6:9], a[184:187], 0
  v_mfma_f32_16x16x32_bf16 v[104:107], a[128:131], v[64:67], v[96:99]
  v_exp_f32 v112, v48
  v_mfma_f32_16x16x32_bf16 a[144:147], v[10:13], a[188:191], a[144:147]
  v_mfma_f32_16x16x32_bf16 v[104:107], a[132:135], v[68:71], v[104:107]
  v_exp_f32 v113, v49
  v_mfma_f32_16x16x32_bf16 a[144:147], v[14:17], a[192:195], a[144:147]
  v_mfma_f32_16x16x32_bf16 v[52:55], a[88:91], a[40:43], v[52:55]
  s_nop 0
  v_mfma_f32_16x16x32_bf16 a[144:147], v[18:21], a[196:199], a[144:147]
  v_mfma_f32_16x16x32_bf16 a[148:151], v[6:9], a[200:203], 0
  v_mfma_f32_16x16x32_bf16 v[52:55], a[92:95], a[44:47], v[52:55]
  v_exp_f32 v114, v50
  v_mfma_f32_16x16x32_bf16 a[148:151], v[10:13], a[204:207], a[148:151]
  v_mfma_f32_16x16x32_bf16 v[60:63], a[92:95], a[60:63], v[92:95]
  s_nop 0
  v_exp_f32 v115, v51
  v_mfma_f32_16x16x32_bf16 a[148:151], v[14:17], a[208:211], a[148:151]
  v_mfma_f32_16x16x32_bf16 v[60:63], a[88:91], a[56:59], v[60:63]
  ds_read_b128 a[64:67], v4 offset:8192
  v_cmp_nge_f32 vcc, s87, v106
  v_mfma_f32_16x16x32_bf16 a[148:151], v[18:21], a[212:215], a[148:151]
  v_mfma_f32_16x16x32_bf16 v[60:63], a[84:87], a[52:55], v[60:63]
  s_waitcnt lgkmcnt(1)
  v_exp_f32 v116, v56
  v_mfma_f32_16x16x32_bf16 v[60:63], a[80:83], a[48:51], v[60:63]
  s_cbranch_vccnz L_rs_60
L_rr_61:
  v_exp_f32 v117, v57
  v_mfma_f32_16x16x32_bf16 v[128:131], a[96:99], v[64:67], v[128:131]
  ds_read_b128 a[68:71], v4 offset:9216
  v_cvt_pk_bf16_f32 v72, v112, v113
  v_mfma_f32_16x16x32_bf16 v[132:135], a[96:99], v[68:71], v[132:135]
  v_exp_f32 v118, v58
  v_mfma_f32_16x16x32_bf16 v[136:139], a[100:103], v[64:67], v[136:139]
  v_mfma_f32_16x16x32_bf16 v[140:143], a[100:103], v[68:71], v[140:143]
  v_exp_f32 v119, v59
  v_mfma_f32_16x16x32_bf16 v[144:147], a[104:107], v[64:67], v[144:147]
  ds_read_b128 a[72:75], v4 offset:10240
  v_mov_b32 v96, v104
  v_mfma_f32_16x16x32_bf16 v[148:151], a[104:107], v[68:71], v[148:151]
  v_exp_f32 v112, v52
  v_mfma_f32_16x16x32_bf16 v[152:155], a[108:111], v[64:67], v[152:155]
  ds_read_b128 a[76:79], v4 offset:11264
  v_cvt_pk_bf16_f32 v73, v114, v115
  v_mfma_f32_16x16x32_bf16 v[156:159], a[108:111], v[68:71], v[156:159]
  v_exp_f32 v113, v53
  v_mfma_f32_16x16x32_bf16 v[160:163], a[112:115], v[64:67], v[160:163]
  ds_read_b128 a[80:83], v4 offset:12288
  v_cvt_pk_bf16_f32 v76, v116, v117
  v_mfma_f32_16x16x32_bf16 v[164:167], a[112:115], v[68:71], v[164:167]
  v_exp_f32 v114, v54
  v_mfma_f32_16x16x32_bf16 v[168:171], a[116:119], v[64:67], v[168:171]
  v_mfma_f32_16x16x32_bf16 v[172:175], a[116:119], v[68:71], v[172:175]
  v_exp_f32 v115, v55
  v_mfma_f32_16x16x32_bf16 v[176:179], a[120:123], v[64:67], v[176:179]
  ds_read_b128 a[84:87], v4 offset:13312
  v_cvt_pk_bf16_f32 v77, v118, v119
  v_mfma_f32_16x16x32_bf16 v[180:183], a[120:123], v[68:71], v[180:183]
  v_exp_f32 v116, v60
  v_mfma_f32_16x16x32_bf16 v[184:187], a[124:127], v[64:67], v[184:187]
  ds_read_b128 a[88:91], v4 offset:14336
  v_mov_b32 v97, v105
  v_mfma_f32_16x16x32_bf16 v[188:191], a[124:127], v[68:71], v[188:191]
  s_waitcnt lgkmcnt(3)
  ds_read_b128 a[92:95], v4 offset:15360
  v_mfma_f32_16x16x32_bf16 v[32:35], a[64:67], a[0:3], v[80:83]
  v_exp_f32 v117, v61
  v_mfma_f32_16x16x32_bf16 v[32:35], a[68:71], a[4:7], v[32:35]
  v_cvt_pk_bf16_f32 v74, v112, v113
  v_mfma_f32_16x16x32_bf16 v[32:35], a[72:75], a[8:11], v[32:35]
  v_exp_f32 v118, v62
  v_mfma_f32_16x16x32_bf16 v[32:35], a[76:79], a[12:15], v[32:35]
  v_mfma_f32_16x16x32_bf16 v[40:43], a[76:79], a[28:31], v[84:87]
  v_exp_f32 v119, v63
  v_mfma_f32_16x16x32_bf16 v[40:43], a[72:75], a[24:27], v[40:43]
  v_cvt_pk_bf16_f32 v75, v114, v115
  v_mfma_f32_16x16x32_bf16 v[40:43], a[68:71], a[20:23], v[40:43]
  v_cvt_pk_bf16_f32 v78, v116, v117
  v_mfma_f32_16x16x32_bf16 v[40:43], a[64:67], a[16:19], v[40:43]
  s_waitcnt lgkmcnt(0)
  v_cvt_pk_bf16_f32 v79, v118, v119
  v_mfma_f32_16x16x32_bf16 v[36:39], a[80:83], a[0:3], v[80:83]
  s_nop 1
  v_mfma_f32_16x16x32_bf16 v[36:39], a[84:87], a[4:7], v[36:39]
  s_nop 0
  s_bitcmp1_b32 s34, 0
  s_cbranch_scc1 L_19
  s_mov_b32 exec_lo, 0x00ff00ff
  s_mov_b32 exec_hi, 0xff00ff00
  buffer_store_dwordx4 a[148:151], v27, s[20:23], s78 offen offset:1024 sc1
  s_mov_b64 exec, -1
L_19:
  v_mfma_f32_16x16x32_bf16 v[104:107], a[128:131], v[72:75], v[100:103]
  v_exp_f32 v112, v32
  v_mfma_f32_16x16x32_bf16 v[104:107], a[132:135], v[76:79], v[104:107]
  v_exp_f32 v113, v33
  v_mfma_f32_16x16x32_bf16 v[36:39], a[88:91], a[8:11], v[36:39]
  s_nop 0
  s_mov_b32 exec_lo, 0x00ff00ff
  s_mov_b32 exec_hi, 0xff00ff00
  buffer_store_dwordx4 a[248:251], v27, s[20:23], s78 offen offset:0 sc1
  s_mov_b64 exec, -1
  v_mfma_f32_16x16x32_bf16 v[36:39], a[92:95], a[12:15], v[36:39]
  s_nop 0
  v_exp_f32 v114, v34
  v_mfma_f32_16x16x32_bf16 v[44:47], a[92:95], a[28:31], v[84:87]
  s_nop 0
  v_exp_f32 v115, v35
  v_mfma_f32_16x16x32_bf16 v[44:47], a[88:91], a[24:27], v[44:47]
  v_cmp_nge_f32 vcc, s87, v106
  v_mfma_f32_16x16x32_bf16 v[44:47], a[84:87], a[20:23], v[44:47]
  v_exp_f32 v116, v40
  v_mfma_f32_16x16x32_bf16 v[44:47], a[80:83], a[16:19], v[44:47]
  s_cbranch_vccnz L_rs_62
L_rr_63:
  v_exp_f32 v117, v41
  v_mfma_f32_16x16x32_bf16 v[192:195], a[96:99], v[72:75], v[192:195]
  v_cvt_pk_bf16_f32 v64, v112, v113
  v_mfma_f32_16x16x32_bf16 v[196:199], a[96:99], v[76:79], v[196:199]
  s_add_u32 s86, s86, 16384
  v_exp_f32 v118, v42
  v_mfma_f32_16x16x32_bf16 v[200:203], a[100:103], v[72:75], v[200:203]
  s_cmp_ge_u32 s86, 147456
  s_mov_b32 exec_lo, 0x00ff00ff
  s_mov_b32 exec_hi, 0xff00ff00
  buffer_store_dwordx4 a[136:139], v27, s[20:23], s78 offen offset:256 sc1
  s_mov_b64 exec, -1
  v_mfma_f32_16x16x32_bf16 v[204:207], a[100:103], v[76:79], v[204:207]
  s_cselect_b32 s86, 0, s86
  v_exp_f32 v119, v43
  v_mfma_f32_16x16x32_bf16 v[208:211], a[104:107], v[72:75], v[208:211]
  v_mov_b32 v100, v104
  v_mfma_f32_16x16x32_bf16 v[212:215], a[104:107], v[76:79], v[212:215]
  v_exp_f32 v112, v36
  v_mfma_f32_16x16x32_bf16 v[216:219], a[108:111], v[72:75], v[216:219]
  v_cvt_pk_bf16_f32 v65, v114, v115
  v_mfma_f32_16x16x32_bf16 v[220:223], a[108:111], v[76:79], v[220:223]
  v_exp_f32 v113, v37
  v_mfma_f32_16x16x32_bf16 v[224:227], a[112:115], v[72:75], v[224:227]
  v_cvt_pk_bf16_f32 v68, v116, v117
  v_mfma_f32_16x16x32_bf16 v[228:231], a[112:115], v[76:79], v[228:231]
  v_exp_f32 v114, v38
  v_mfma_f32_16x16x32_bf16 v[232:235], a[116:119], v[72:75], v[232:235]
  s_mov_b32 exec_lo, 0x00ff00ff
  s_mov_b32 exec_hi, 0xff00ff00
  buffer_store_dwordx4 a[140:143], v27, s[20:23], s78 offen offset:512 sc1
  s_mov_b64 exec, -1
  v_mfma_f32_16x16x32_bf16 v[236:239], a[116:119], v[76:79], v[236:239]
  v_exp_f32 v115, v39
  v_mfma_f32_16x16x32_bf16 v[240:243], a[120:123], v[72:75], v[240:243]
  s_add_u32 s83, s83, 1
  v_cvt_pk_bf16_f32 v69, v118, v119
  v_mfma_f32_16x16x32_bf16 v[244:247], a[120:123], v[76:79], v[244:247]
  v_exp_f32 v116, v44
  v_mfma_f32_16x16x32_bf16 v[248:251], a[124:127], v[72:75], v[248:251]
  s_mov_b32 exec_lo, 0x00ff00ff
  s_mov_b32 exec_hi, 0xff00ff00
  buffer_store_dwordx4 a[144:147], v27, s[20:23], s78 offen offset:768 sc1
  s_mov_b64 exec, -1
  v_mov_b32 v101, v105
  v_mfma_f32_16x16x32_bf16 v[252:255], a[124:127], v[76:79], v[252:255]
  s_waitcnt vmcnt(10)
  v_mov_b32 v4, v3
  v_add_u32 v3, s86, v2
  s_cmp_lt_u32 s83, s82
  s_cbranch_scc0 L_dual2c
.p2align 6
L_dual:
  v_mfma_f32_16x16x32_bf16 v[48:51], a[64:67], a[32:35], v[88:91]
  s_barrier
  v_exp_f32 v117, v45
  v_mfma_f32_16x16x32_bf16 v[48:51], a[68:71], a[36:39], v[48:51]
  s_mov_b32 m0, s84
  ds_read_b128 a[96:99], v3 offset:0
  v_cvt_pk_bf16_f32 v66, v112, v113
  v_mfma_f32_16x16x32_bf16 v[48:51], a[72:75], a[40:43], v[48:51]
  s_add_u32 s84, s84, 16384
  v_exp_f32 v118, v46
  v_mfma_f32_16x16x32_bf16 v[48:51], a[76:79], a[44:47], v[48:51]
  s_cmp_ge_u32 s84, 147456
  buffer_load_dwordx4 v2, s[20:23], s85 offen offset:0  lds
  v_mfma_f32_16x16x32_bf16 v[56:59], a[76:79], a[60:63], v[92:95]
  s_cselect_b32 s70, 147456, 0
  v_exp_f32 v119, v47
  v_mfma_f32_16x16x32_bf16 v[56:59], a[72:75], a[56:59], v[56:59]
  s_sub_u32 s84, s84, s70
  ds_read_b128 a[100:103], v3 offset:1024
  v_cvt_pk_bf16_f32 v67, v114, v115
  v_mfma_f32_16x16x32_bf16 v[56:59], a[68:71], a[52:55], v[56:59]
  ds_read_b128 a[104:107], v3 offset:2048
  v_cvt_pk_bf16_f32 v70, v116, v117
  v_mfma_f32_16x16x32_bf16 v[56:59], a[64:67], a[48:51], v[56:59]
  s_waitcnt lgkmcnt(3)
  ds_read_b128 a[108:111], v3 offset:3072
  v_cvt_pk_bf16_f32 v71, v118, v119
  v_mfma_f32_16x16x32_bf16 v[52:55], a[80:83], a[32:35], v[88:91]
  s_cmp_eq_u32 s83, s80
  ds_read_b128 a[112:115], v3 offset:4096
  ds_read_b128 a[116:119], v3 offset:5120
  v_mfma_f32_16x16x32_bf16 v[52:55], a[84:87], a[36:39], v[52:55]
  s_cbranch_scc1 L_pub_66
L_pubr_67:
  ds_read_b128 a[120:123], v3 offset:6144
  ds_read_b128 a[124:127], v3 offset:7168
  v_mfma_f32_16x16x32_bf16 v[104:107], a[128:131], v[64:67], v[96:99]
  v_exp_f32 v112, v48
  v_mfma_f32_16x16x32_bf16 v[104:107], a[132:135], v[68:71], v[104:107]
  v_exp_f32 v113, v49
  v_mfma_f32_16x16x32_bf16 v[52:55], a[88:91], a[40:43], v[52:55]
  buffer_load_dwordx4 v2, s[20:23], s85 offen offset:1024  lds
  v_mfma_f32_16x16x32_bf16 v[52:55], a[92:95], a[44:47], v[52:55]
  v_exp_f32 v114, v50
  v_mfma_f32_16x16x32_bf16 v[60:63], a[92:95], a[60:63], v[92:95]
  s_nop 0
  v_exp_f32 v115, v51
  v_mfma_f32_16x16x32_bf16 v[60:63], a[88:91], a[56:59], v[60:63]
  ds_read_b128 a[64:67], v4 offset:8192
  v_cmp_nge_f32 vcc, s87, v106
  v_mfma_f32_16x16x32_bf16 v[60:63], a[84:87], a[52:55], v[60:63]
  s_waitcnt lgkmcnt(1)
  v_exp_f32 v116, v56
  v_mfma_f32_16x16x32_bf16 v[60:63], a[80:83], a[48:51], v[60:63]
  s_cbranch_vccnz L_rs_64
L_rr_65:
  v_exp_f32 v117, v57
  v_mfma_f32_16x16x32_bf16 v[128:131], a[96:99], v[64:67], v[128:131]
  ds_read_b128 a[68:71], v4 offset:9216
  v_cvt_pk_bf16_f32 v72, v112, v113
  v_mfma_f32_16x16x32_bf16 v[132:135], a[96:99], v[68:71], v[132:135]
  v_exp_f32 v118, v58
  v_mfma_f32_16x16x32_bf16 v[136:139], a[100:103], v[64:67], v[136:139]
  buffer_load_dwordx4 v2, s[20:23], s85 offen offset:2048  lds
  v_mfma_f32_16x16x32_bf16 v[140:143], a[100:103], v[68:71], v[140:143]
  v_exp_f32 v119, v59
  v_mfma_f32_16x16x32_bf16 v[144:147], a[104:107], v[64:67], v[144:147]
  ds_read_b128 a[72:75], v4 offset:10240
  v_mov_b32 v96, v104
  v_mfma_f32_16x16x32_bf16 v[148:151], a[104:107], v[68:71], v[148:151]
  v_exp_f32 v112, v52
  v_mfma_f32_16x16x32_bf16 v[152:155], a[108:111], v[64:67], v[152:155]
  ds_read_b128 a[76:79], v4 offset:11264
  v_cvt_pk_bf16_f32 v73, v114, v115
  v_mfma_f32_16x16x32_bf16 v[156:159], a[108:111], v[68:71], v[156:159]
  v_exp_f32 v113, v53
  v_mfma_f32_16x16x32_bf16 v[160:163], a[112:115], v[64:67], v[160:163]
  ds_read_b128 a[80:83], v4 offset:12288
  v_cvt_pk_bf16_f32 v76, v116, v117
  v_mfma_f32_16x16x32_bf16 v[164:167], a[112:115], v[68:71], v[164:167]
  v_exp_f32 v114, v54
  v_mfma_f32_16x16x32_bf16 v[168:171], a[116:119], v[64:67], v[168:171]
  buffer_load_dwordx4 v2, s[20:23], s85 offen offset:3072  lds
  v_mfma_f32_16x16x32_bf16 v[172:175], a[116:119], v[68:71], v[172:175]
  s_add_u32 s85, s85, 16384
  v_exp_f32 v115, v55
  v_mfma_f32_16x16x32_bf16 v[176:179], a[120:123], v[64:67], v[176:179]
  ds_read_b128 a[84:87], v4 offset:13312
  v_cvt_pk_bf16_f32 v77, v118, v119
  v_mfma_f32_16x16x32_bf16 v[180:183], a[120:123], v[68:71], v[180:183]
  v_exp_f32 v116, v60
  v_mfma_f32_16x16x32_bf16 v[184:187], a[124:127], v[64:67], v[184:187]
  ds_read_b128 a[88:91], v4 offset:14336
  v_mov_b32 v97, v105
  v_mfma_f32_16x16x32_bf16 v[188:191], a[124:127], v[68:71], v[188:191]
  s_waitcnt lgkmcnt(3)
  ds_read_b128 a[92:95], v4 offset:15360
  v_mfma_f32_16x16x32_bf16 v[32:35], a[64:67], a[0:3], v[80:83]
  v_exp_f32 v117, v61
  v_mfma_f32_16x16x32_bf16 v[32:35], a[68:71], a[4:7], v[32:35]
  v_cvt_pk_bf16_f32 v74, v112, v113
  v_mfma_f32_16x16x32_bf16 v[32:35], a[72:75], a[8:11], v[32:35]
  v_exp_f32 v118, v62
  v_mfma_f32_16x16x32_bf16 v[32:35], a[76:79], a[12:15], v[32:35]
  v_mfma_f32_16x16x32_bf16 v[40:43], a[76:79], a[28:31], v[84:87]
  v_exp_f32 v119, v63
  v_mfma_f32_16x16x32_bf16 v[40:43], a[72:75], a[24:27], v[40:43]
  v_cvt_pk_bf16_f32 v75, v114, v115
  v_mfma_f32_16x16x32_bf16 v[40:43], a[68:71], a[20:23], v[40:43]
  v_cvt_pk_bf16_f32 v78, v116, v117
  v_mfma_f32_16x16x32_bf16 v[40:43], a[64:67], a[16:19], v[40:43]
  s_waitcnt lgkmcnt(0)
  v_cvt_pk_bf16_f32 v79, v118, v119
  v_mfma_f32_16x16x32_bf16 v[36:39], a[80:83], a[0:3], v[80:83]
  s_nop 1
  v_mfma_f32_16x16x32_bf16 v[36:39], a[84:87], a[4:7], v[36:39]
  s_nop 0
  v_mfma_f32_16x16x32_bf16 v[104:107], a[128:131], v[72:75], v[100:103]
  v_exp_f32 v112, v32
  v_mfma_f32_16x16x32_bf16 v[104:107], a[132:135], v[76:79], v[104:107]
  v_exp_f32 v113, v33
  v_mfma_f32_16x16x32_bf16 v[36:39], a[88:91], a[8:11], v[36:39]
  s_nop 0
  v_mfma_f32_16x16x32_bf16 v[36:39], a[92:95], a[12:15], v[36:39]
  s_nop 0
  v_exp_f32 v114, v34
  v_mfma_f32_16x16x32_bf16 v[44:47], a[92:95], a[28:31], v[84:87]
  s_nop 0
  v_exp_f32 v115, v35
  v_mfma_f32_16x16x32_bf16 v[44:47], a[88:91], a[24:27], v[44:47]
  v_cmp_nge_f32 vcc, s87, v106
  v_mfma_f32_16x16x32_bf16 v[44:47], a[84:87], a[20:23], v[44:47]
  v_exp_f32 v116, v40
  v_mfma_f32_16x16x32_bf16 v[44:47], a[80:83], a[16:19], v[44:47]
  s_cbranch_vccnz L_rs_68
L_rr_69:
  v_exp_f32 v117, v41
  v_mfma_f32_16x16x32_bf16 v[192:195], a[96:99], v[72:75], v[192:195]
  v_cvt_pk_bf16_f32 v64, v112, v113
  v_mfma_f32_16x16x32_bf16 v[196:199], a[96:99], v[76:79], v[196:199]
  s_add_u32 s86, s86, 16384
  v_exp_f32 v118, v42
  v_mfma_f32_16x16x32_bf16 v[200:203], a[100:103], v[72:75], v[200:203]
  s_cmp_ge_u32 s86, 147456
  v_mfma_f32_16x16x32_bf16 v[204:207], a[100:103], v[76:79], v[204:207]
  s_cselect_b32 s86, 0, s86
  v_exp_f32 v119, v43
  v_mfma_f32_16x16x32_bf16 v[208:211], a[104:107], v[72:75], v[208:211]
  v_mov_b32 v100, v104
  v_mfma_f32_16x16x32_bf16 v[212:215], a[104:107], v[76:79], v[212:215]
  v_exp_f32 v112, v36
  v_mfma_f32_16x16x32_bf16 v[216:219], a[108:111], v[72:75], v[216:219]
  v_cvt_pk_bf16_f32 v65, v114, v115
  v_mfma_f32_16x16x32_bf16 v[220:223], a[108:111], v[76:79], v[220:223]
  v_exp_f32 v113, v37
  v_mfma_f32_16x16x32_bf16 v[224:227], a[112:115], v[72:75], v[224:227]
  v_cvt_pk_bf16_f32 v68, v116, v117
  v_mfma_f32_16x16x32_bf16 v[228:231], a[112:115], v[76:79], v[228:231]
  v_exp_f32 v114, v38
  v_mfma_f32_16x16x32_bf16 v[232:235], a[116:119], v[72:75], v[232:235]
  v_mfma_f32_16x16x32_bf16 v[236:239], a[116:119], v[76:79], v[236:239]
  v_exp_f32 v115, v39
  v_mfma_f32_16x16x32_bf16 v[240:243], a[120:123], v[72:75], v[240:243]
  s_add_u32 s83, s83, 1
  v_cvt_pk_bf16_f32 v69, v118, v119
  v_mfma_f32_16x16x32_bf16 v[244:247], a[120:123], v[76:79], v[244:247]
  s_cmp_lt_u32 s83, s82
  v_exp_f32 v116, v44
  v_mfma_f32_16x16x32_bf16 v[248:251], a[124:127], v[72:75], v[248:251]
  v_mov_b32 v101, v105
  v_mfma_f32_16x16x32_bf16 v[252:255], a[124:127], v[76:79], v[252:255]
  s_waitcnt vmcnt(4)
  v_mov_b32 v4, v3
  v_add_u32 v3, s86, v2
  s_cbranch_scc1 L_dual
  s_add_u32 s70, s83, 1
  s_cmp_lt_u32 s70, s39
  s_cbranch_scc1 L_modsteps
L_dual2c:
  s_cmp_lt_u32 s83, s37
  s_cbranch_scc0 L_dlast
L_dual2:
  v_mfma_f32_16x16x32_bf16 v[48:51], a[64:67], a[32:35], v[88:91]
  s_barrier
  v_exp_f32 v117, v45
  v_mfma_f32_16x16x32_bf16 v[48:51], a[68:71], a[36:39], v[48:51]
  s_mov_b32 m0, s84
  ds_read_b128 a[96:99], v3 offset:0
  v_cvt_pk_bf16_f32 v66, v112, v113
  v_mfma_f32_16x16x32_bf16 v[48:51], a[72:75], a[40:43], v[48:51]
  s_add_u32 s84, s84, 16384
  v_exp_f32 v118, v46
  v_mfma_f32_16x16x32_bf16 v[48:51], a[76:79], a[44:47], v[48:51]
  s_cmp_ge_u32 s84, 147456
  buffer_load_dwordx4 v2, s[20:23], s85 offen offset:0  lds
  v_mfma_f32_16x16x32_bf16 v[56:59], a[76:79], a[60:63], v[92:95]
  s_cselect_b32 s70, 147456, 0
  v_exp_f32 v119, v47
  v_mfma_f32_16x16x32_bf16 v[56:59], a[72:75], a[56:59], v[56:59]
  s_sub_u32 s84, s84, s70
  ds_read_b128 a[100:103], v3 offset:1024
  v_cvt_pk_bf16_f32 v67, v114, v115
  v_mfma_f32_16x16x32_bf16 v[56:59], a[68:71], a[52:55], v[56:59]
  ds_read_b128 a[104:107], v3 offset:2048
  v_cvt_pk_bf16_f32 v70, v116, v117
  v_mfma_f32_16x16x32_bf16 v[56:59], a[64:67], a[48:51], v[56:59]
  s_waitcnt lgkmcnt(3)
  ds_read_b128 a[108:111], v3 offset:3072
  v_cvt_pk_bf16_f32 v71, v118, v119
  v_mfma_f32_16x16x32_bf16 v[52:55], a[80:83], a[32:35], v[88:91]
  s_cmp_eq_u32 s83, s80
  ds_read_b128 a[112:115], v3 offset:4096
  ds_read_b128 a[116:119], v3 offset:5120
  v_mfma_f32_16x16x32_bf16 v[52:55], a[84:87], a[36:39], v[52:55]
  s_cbranch_scc1 L_pub_72
L_pubr_73:
  ds_read_b128 a[120:123], v3 offset:6144
  ds_read_b128 a[124:127], v3 offset:7168
  v_mfma_f32_16x16x32_bf16 v[104:107], a[128:131], v[64:67], v[96:99]
  v_exp_f32 v112, v48
  v_mfma_f32_16x16x32_bf16 v[104:107], a[132:135], v[68:71], v[104:107]
  v_exp_f32 v113, v49
  v_mfma_f32_16x16x32_bf16 v[52:55], a[88:91], a[40:43], v[52:55]
  buffer_load_dwordx4 v2, s[20:23], s85 offen offset:1024  lds
  v_mfma_f32_16x16x32_bf16 v[52:55], a[92:95], a[44:47], v[52:55]
  v_exp_f32 v114, v50
  v_mfma_f32_16x16x32_bf16 v[60:63], a[92:95], a[60:63], v[92:95]
  s_nop 0
  v_exp_f32 v115, v51
  v_mfma_f32_16x16x32_bf16 v[60:63], a[88:91], a[56:59], v[60:63]
  ds_read_b128 a[64:67], v4 offset:8192
  v_cmp_nge_f32 vcc, s87, v106
  v_mfma_f32_16x16x32_bf16 v[60:63], a[84:87], a[52:55], v[60:63]
  s_waitcnt lgkmcnt(1)
  v_exp_f32 v116, v56
  v_mfma_f32_16x16x32_bf16 v[60:63], a[80:83], a[48:51], v[60:63]
  s_cbranch_vccnz L_rs_70
L_rr_71:
  v_exp_f32 v117, v57
  v_mfma_f32_16x16x32_bf16 v[128:131], a[96:99], v[64:67], v[128:131]
  ds_read_b128 a[68:71], v4 offset:9216
  v_cvt_pk_bf16_f32 v72, v112, v113
  v_mfma_f32_16x16x32_bf16 v[132:135], a[96:99], v[68:71], v[132:135]
  v_exp_f32 v118, v58
  v_mfma_f32_16x16x32_bf16 v[136:139], a[100:103], v[64:67], v[136:139]
  buffer_load_dwordx4 v2, s[20:23], s85 offen offset:2048  lds
  v_mfma_f32_16x16x32_bf16 v[140:143], a[100:103], v[68:71], v[140:143]
  v_exp_f32 v119, v59
  v_mfma_f32_16x16x32_bf16 v[144:147], a[104:107], v[64:67], v[144:147]
  ds_read_b128 a[72:75], v4 offset:10240
  v_mov_b32 v96, v104
  v_mfma_f32_16x16x32_bf16 v[148:151], a[104:107], v[68:71], v[148:151]
  v_exp_f32 v112, v52
  v_mfma_f32_16x16x32_bf16 v[152:155], a[108:111], v[64:67], v[152:155]
  ds_read_b128 a[76:79], v4 offset:11264
  v_cvt_pk_bf16_f32 v73, v114, v115
  v_mfma_f32_16x16x32_bf16 v[156:159], a[108:111], v[68:71], v[156:159]
  v_exp_f32 v113, v53
  v_mfma_f32_16x16x32_bf16 v[160:163], a[112:115], v[64:67], v[160:163]
  ds_read_b128 a[80:83], v4 offset:12288
  v_cvt_pk_bf16_f32 v76, v116, v117
  v_mfma_f32_16x16x32_bf16 v[164:167], a[112:115], v[68:71], v[164:167]
  v_exp_f32 v114, v54
  v_mfma_f32_16x16x32_bf16 v[168:171], a[116:119], v[64:67], v[168:171]
  buffer_load_dwordx4 v2, s[20:23], s85 offen offset:3072  lds
  v_mfma_f32_16x16x32_bf16 v[172:175], a[116:119], v[68:71], v[172:175]
  s_add_u32 s85, s85, 16384
  v_exp_f32 v115, v55
  v_mfma_f32_16x16x32_bf16 v[176:179], a[120:123], v[64:67], v[176:179]
  ds_read_b128 a[84:87], v4 offset:13312
  v_cvt_pk_bf16_f32 v77, v118, v119
  v_mfma_f32_16x16x32_bf16 v[180:183], a[120:123], v[68:71], v[180:183]
  v_exp_f32 v116, v60
  v_mfma_f32_16x16x32_bf16 v[184:187], a[124:127], v[64:67], v[184:187]
  ds_read_b128 a[88:91], v4 offset:14336
  v_mov_b32 v97, v105
  v_mfma_f32_16x16x32_bf16 v[188:191], a[124:127], v[68:71], v[188:191]
  s_waitcnt lgkmcnt(3)
  ds_read_b128 a[92:95], v4 offset:15360
  v_mfma_f32_16x16x32_bf16 v[32:35], a[64:67], a[0:3], v[80:83]
  v_exp_f32 v117, v61
  v_mfma_f32_16x16x32_bf16 v[32:35], a[68:71], a[4:7], v[32:35]
  s_mov_b32 m0, s84
  v_cvt_pk_bf16_f32 v74, v112, v113
  v_mfma_f32_16x16x32_bf16 v[32:35], a[72:75], a[8:11], v[32:35]
  s_add_u32 s84, s84, 16384
  v_exp_f32 v118, v62
  v_mfma_f32_16x16x32_bf16 v[32:35], a[76:79], a[12:15], v[32:35]
  s_cmp_ge_u32 s84, 147456
  buffer_load_dwordx4 v2, s[20:23], s85 offen offset:0  lds
  v_mfma_f32_16x16x32_bf16 v[40:43], a[76:79], a[28:31], v[84:87]
  s_cselect_b32 s70, 147456, 0
  v_exp_f32 v119, v63
  v_mfma_f32_16x16x32_bf16 v[40:43], a[72:75], a[24:27], v[40:43]
  s_sub_u32 s84, s84, s70
  v_cvt_pk_bf16_f32 v75, v114, v115
  v_mfma_f32_16x16x32_bf16 v[40:43], a[68:71], a[20:23], v[40:43]
  v_cvt_pk_bf16_f32 v78, v116, v117
  v_mfma_f32_16x16x32_bf16 v[40:43], a[64:67], a[16:19], v[40:43]
  s_waitcnt lgkmcnt(0)
  v_cvt_pk_bf16_f32 v79, v118, v119
  v_mfma_f32_16x16x32_bf16 v[36:39], a[80:83], a[0:3], v[80:83]
  s_nop 1
  v_mfma_f32_16x16x32_bf16 v[36:39], a[84:87], a[4:7], v[36:39]
  s_nop 0
  v_mfma_f32_16x16x32_bf16 v[104:107], a[128:131], v[72:75], v[100:103]
  v_exp_f32 v112, v32
  v_mfma_f32_16x16x32_bf16 v[104:107], a[132:135], v[76:79], v[104:107]
  v_exp_f32 v113, v33
  v_mfma_f32_16x16x32_bf16 v[36:39], a[88:91], a[8:11], v[36:39]
  buffer_load_dwordx4 v2, s[20:23], s85 offen offset:1024  lds
  v_mfma_f32_16x16x32_bf16 v[36:39], a[92:95], a[12:15], v[36:39]
  s_nop 0
  v_exp_f32 v114, v34
  v_mfma_f32_16x16x32_bf16 v[44:47], a[92:95], a[28:31], v[84:87]
  s_nop 0
  v_exp_f32 v115, v35
  v_mfma_f32_16x16x32_bf16 v[44:47], a[88:91], a[24:27], v[44:47]
  v_cmp_nge_f32 vcc, s87, v106
  v_mfma_f32_16x16x32_bf16 v[44:47], a[84:87], a[20:23], v[44:47]
  v_exp_f32 v116, v40
  v_mfma_f32_16x16x32_bf16 v[44:47], a[80:83], a[16:19], v[44:47]
  s_cbranch_vccnz L_rs_74
L_rr_75:
  v_exp_f32 v117, v41
  v_mfma_f32_16x16x32_bf16 v[192:195], a[96:99], v[72:75], v[192:195]
  v_cvt_pk_bf16_f32 v64, v112, v113
  v_mfma_f32_16x16x32_bf16 v[196:199], a[96:99], v[76:79], v[196:199]
  s_add_u32 s86, s86, 16384
  v_exp_f32 v118, v42
  v_mfma_f32_16x16x32_bf16 v[200:203], a[100:103], v[72:75], v[200:203]
  s_cmp_ge_u32 s86, 147456
  buffer_load_dwordx4 v2, s[20:23], s85 offen offset:2048  lds
  v_mfma_f32_16x16x32_bf16 v[204:207], a[100:103], v[76:79], v[204:207]
  s_cselect_b32 s86, 0, s86
  v_exp_f32 v119, v43
  v_mfma_f32_16x16x32_bf16 v[208:211], a[104:107], v[72:75], v[208:211]
  v_mov_b32 v100, v104
  v_mfma_f32_16x16x32_bf16 v[212:215], a[104:107], v[76:79], v[212:215]
  v_exp_f32 v112, v36
  v_mfma_f32_16x16x32_bf16 v[216:219], a[108:111], v[72:75], v[216:219]
  v_cvt_pk_bf16_f32 v65, v114, v115
  v_mfma_f32_16x16x32_bf16 v[220:223], a[108:111], v[76:79], v[220:223]
  v_exp_f32 v113, v37
  v_mfma_f32_16x16x32_bf16 v[224:227], a[112:115], v[72:75], v[224:227]
  v_cvt_pk_bf16_f32 v68, v116, v117
  v_mfma_f32_16x16x32_bf16 v[228:231], a[112:115], v[76:79], v[228:231]
  v_exp_f32 v114, v38
  v_mfma_f32_16x16x32_bf16 v[232:235], a[116:119], v[72:75], v[232:235]
  buffer_load_dwordx4 v2, s[20:23], s85 offen offset:3072  lds
  v_mfma_f32_16x16x32_bf16 v[236:239], a[116:119], v[76:79], v[236:239]
  s_add_u32 s85, s85, 16384
  v_exp_f32 v115, v39
  v_mfma_f32_16x16x32_bf16 v[240:243], a[120:123], v[72:75], v[240:243]
  s_add_u32 s83, s83, 1
  v_cvt_pk_bf16_f32 v69, v118, v119
  v_mfma_f32_16x16x32_bf16 v[244:247], a[120:123], v[76:79], v[244:247]
  s_cmp_lt_u32 s83, s37
  v_exp_f32 v116, v44
  v_mfma_f32_16x16x32_bf16 v[248:251], a[124:127], v[72:75], v[248:251]
  v_mov_b32 v101, v105
  v_mfma_f32_16x16x32_bf16 v[252:255], a[124:127], v[76:79], v[252:255]
  s_waitcnt vmcnt(8)
  v_mov_b32 v4, v3
  v_add_u32 v3, s86, v2
  s_cbranch_scc1 L_dual2
L_dlast:
  v_add_f32 v48, v108, v88
  v_add_f32 v49, v109, v89
  v_add_f32 v50, v110, v90
  v_add_f32 v51, v111, v91
  v_mov_b32 v52, 0xff800000
  v_mov_b32 v53, 0xff800000
  v_mov_b32 v54, 0xff800000
  v_mov_b32 v55, 0xff800000
  v_mov_b32 v56, v92
  v_mov_b32 v57, v93
  v_mov_b32 v58, v94
  v_mov_b32 v59, v95
  v_add_f32 v60, v108, v92
  v_add_f32 v61, v109, v93
  v_add_f32 v62, v110, v94
  v_add_f32 v63, v111, v95
  s_nop 1
  v_mfma_f32_16x16x32_bf16 v[48:51], a[64:67], a[32:35], v[48:51]
  s_barrier
  v_exp_f32 v117, v45
  v_mfma_f32_16x16x32_bf16 v[48:51], a[68:71], a[36:39], v[48:51]
  s_mov_b32 m0, s84
  ds_read_b128 a[96:99], v3 offset:0
  v_cvt_pk_bf16_f32 v66, v112, v113
  v_mfma_f32_16x16x32_bf16 v[48:51], a[72:75], a[40:43], v[48:51]
  s_add_u32 s84, s84, 16384
  v_exp_f32 v118, v46
  v_mfma_f32_16x16x32_bf16 v[48:51], a[76:79], a[44:47], v[48:51]
  s_cmp_ge_u32 s84, 147456
  buffer_load_dwordx4 v2, s[20:23], s85 offen offset:0  lds
  v_mfma_f32_16x16x32_bf16 v[56:59], a[76:79], a[60:63], v[56:59]
  s_cselect_b32 s70, 147456, 0
  v_exp_f32 v119, v47
  v_mfma_f32_16x16x32_bf16 v[56:59], a[72:75], a[56:59], v[56:59]
  s_sub_u32 s84, s84, s70
  ds_read_b128 a[100:103], v3 offset:1024
  v_cvt_pk_bf16_f32 v67, v114, v115
  v_mfma_f32_16x16x32_bf16 v[56:59], a[68:71], a[52:55], v[56:59]
  ds_read_b128 a[104:107], v3 offset:2048
  v_cvt_pk_bf16_f32 v70, v116, v117
  v_mfma_f32_16x16x32_bf16 v[56:59], a[64:67], a[48:51], v[56:59]
  s_waitcnt lgkmcnt(3)
  ds_read_b128 a[108:111], v3 offset:3072
  v_cvt_pk_bf16_f32 v71, v118, v119
  v_mfma_f32_16x16x32_bf16 v[52:55], a[80:83], a[32:35], v[52:55]
  s_cmp_eq_u32 s83, s80
  ds_read_b128 a[112:115], v3 offset:4096
  ds_read_b128 a[116:119], v3 offset:5120
  v_mfma_f32_16x16x32_bf16 v[52:55], a[84:87], a[36:39], v[52:55]
  s_cbranch_scc1 L_pub_78
L_pubr_79:
  ds_read_b128 a[120:123], v3 offset:6144
  ds_read_b128 a[124:127], v3 offset:7168
  v_mfma_f32_16x16x32_bf16 v[104:107], a[128:131], v[64:67], v[96:99]
  v_exp_f32 v112, v48
  v_mfma_f32_16x16x32_bf16 v[104:107], a[132:135], v[68:71], v[104:107]
  v_exp_f32 v113, v49
  v_mfma_f32_16x16x32_bf16 v[52:55], a[88:91], a[40:43], v[52:55]
  buffer_load_dwordx4 v2, s[20:23], s85 offen offset:1024  lds
  v_mfma_f32_16x16x32_bf16 v[52:55], a[92:95], a[44:47], v[52:55]
  v_exp_f32 v114, v50
  v_mfma_f32_16x16x32_bf16 v[60:63], a[92:95], a[60:63], v[60:63]
  s_nop 0
  v_exp_f32 v115, v51
  v_mfma_f32_16x16x32_bf16 v[60:63], a[88:91], a[56:59], v[60:63]
  ds_read_b128 a[64:67], v4 offset:8192
  v_cmp_nge_f32 vcc, s87, v106
  v_mfma_f32_16x16x32_bf16 v[60:63], a[84:87], a[52:55], v[60:63]
  s_waitcnt lgkmcnt(1)
  v_exp_f32 v116, v56
  v_mfma_f32_16x16x32_bf16 v[60:63], a[80:83], a[48:51], v[60:63]
  s_cbranch_vccnz L_rs_76
L_rr_77:
  v_exp_f32 v117, v57
  v_mfma_f32_16x16x32_bf16 v[128:131], a[96:99], v[64:67], v[128:131]
  ds_read_b128 a[68:71], v4 offset:9216
  v_cvt_pk_bf16_f32 v72, v112, v113
  v_mfma_f32_16x16x32_bf16 v[132:135], a[96:99], v[68:71], v[132:135]
  v_exp_f32 v118, v58
  v_mfma_f32_16x16x32_bf16 v[136:139], a[100:103], v[64:67], v[136:139]
  buffer_load_dwordx4 v2, s[20:23], s85 offen offset:2048  lds
  v_mfma_f32_16x16x32_bf16 v[140:143], a[100:103], v[68:71], v[140:143]
  v_exp_f32 v119, v59
  v_mfma_f32_16x16x32_bf16 v[144:147], a[104:107], v[64:67], v[144:147]
  ds_read_b128 a[72:75], v4 offset:10240
  v_mov_b32 v96, v104
  v_mfma_f32_16x16x32_bf16 v[148:151], a[104:107], v[68:71], v[148:151]
  v_exp_f32 v112, v52
  v_mfma_f32_16x16x32_bf16 v[152:155], a[108:111], v[64:67], v[152:155]
  ds_read_b128 a[76:79], v4 offset:11264
  v_cvt_pk_bf16_f32 v73, v114, v115
  v_mfma_f32_16x16x32_bf16 v[156:159], a[108:111], v[68:71], v[156:159]
  v_exp_f32 v113, v53
  v_mfma_f32_16x16x32_bf16 v[160:163], a[112:115], v[64:67], v[160:163]
  ds_read_b128 a[80:83], v4 offset:12288
  v_cvt_pk_bf16_f32 v76, v116, v117
  v_mfma_f32_16x16x32_bf16 v[164:167], a[112:115], v[68:71], v[164:167]
  v_exp_f32 v114, v54
  v_mfma_f32_16x16x32_bf16 v[168:171], a[116:119], v[64:67], v[168:171]
  buffer_load_dwordx4 v2, s[20:23], s85 offen offset:3072  lds
  v_mfma_f32_16x16x32_bf16 v[172:175], a[116:119], v[68:71], v[172:175]
  s_add_u32 s85, s85, 16384
  v_exp_f32 v115, v55
  v_mfma_f32_16x16x32_bf16 v[176:179], a[120:123], v[64:67], v[176:179]
  ds_read_b128 a[84:87], v4 offset:13312
  v_cvt_pk_bf16_f32 v77, v118, v119
  v_mfma_f32_16x16x32_bf16 v[180:183], a[120:123], v[68:71], v[180:183]
  v_exp_f32 v116, v60
  v_mfma_f32_16x16x32_bf16 v[184:187], a[124:127], v[64:67], v[184:187]
  ds_read_b128 a[88:91], v4 offset:14336
  v_mov_b32 v97, v105
  v_mfma_f32_16x16x32_bf16 v[188:191], a[124:127], v[68:71], v[188:191]
  s_waitcnt lgkmcnt(3)
  ds_read_b128 a[92:95], v4 offset:15360
  s_cmp_eq_u32 s37, 31
  s_cbranch_scc1 L_dlast31
  v_mfma_f32_16x16x32_bf16 v[32:35], a[64:67], a[0:3], v[80:83]
  v_exp_f32 v117, v61
  v_mfma_f32_16x16x32_bf16 v[32:35], a[68:71], a[4:7], v[32:35]
  s_mov_b32 m0, s84
  v_cvt_pk_bf16_f32 v74, v112, v113
  v_mfma_f32_16x16x32_bf16 v[32:35], a[72:75], a[8:11], v[32:35]
  s_add_u32 s84, s84, 16384
  v_exp_f32 v118, v62
  v_mfma_f32_16x16x32_bf16 v[32:35], a[76:79], a[12:15], v[32:35]
  s_cmp_ge_u32 s84, 147456
  buffer_load_dwordx4 v2, s[20:23], s85 offen offset:0  lds
  v_mfma_f32_16x16x32_bf16 v[40:43], a[76:79], a[28:31], v[84:87]
  s_cselect_b32 s70, 147456, 0
  v_exp_f32 v119, v63
  v_mfma_f32_16x16x32_bf16 v[40:43], a[72:75], a[24:27], v[40:43]
  s_sub_u32 s84, s84, s70
  v_cvt_pk_bf16_f32 v75, v114, v115
  v_mfma_f32_16x16x32_bf16 v[40:43], a[68:71], a[20:23], v[40:43]
  v_cvt_pk_bf16_f32 v78, v116, v117
  v_mfma_f32_16x16x32_bf16 v[40:43], a[64:67], a[16:19], v[40:43]
  s_waitcnt lgkmcnt(0)
  v_cvt_pk_bf16_f32 v79, v118, v119
  v_mfma_f32_16x16x32_bf16 v[36:39], a[80:83], a[0:3], v[80:83]
  s_nop 1
  v_mfma_f32_16x16x32_bf16 v[36:39], a[84:87], a[4:7], v[36:39]
  s_nop 0
  v_mfma_f32_16x16x32_bf16 v[104:107], a[128:131], v[72:75], v[100:103]
  v_exp_f32 v112, v32
  v_mfma_f32_16x16x32_bf16 v[104:107], a[132:135], v[76:79], v[104:107]
  v_exp_f32 v113, v33
  v_mfma_f32_16x16x32_bf16 v[36:39], a[88:91], a[8:11], v[36:39]
  buffer_load_dwordx4 v2, s[20:23], s85 offen offset:1024  lds
  v_mfma_f32_16x16x32_bf16 v[36:39], a[92:95], a[12:15], v[36:39]
  v_exp_f32 v114, v34
  v_mfma_f32_16x16x32_bf16 v[44:47], a[92:95], a[28:31], v[84:87]
  s_nop 0
  v_exp_f32 v115, v35
  v_mfma_f32_16x16x32_bf16 v[44:47], a[88:91], a[24:27], v[44:47]
  ds_read_b128 a[64:67], v3 offset:8192
  v_cmp_nge_f32 vcc, s87, v106
  v_mfma_f32_16x16x32_bf16 v[44:47], a[84:87], a[20:23], v[44:47]
  v_exp_f32 v116, v40
  v_mfma_f32_16x16x32_bf16 v[44:47], a[80:83], a[16:19], v[44:47]
  s_cbranch_vccnz L_rs_80
L_rr_81:
  v_exp_f32 v117, v41
  v_mfma_f32_16x16x32_bf16 v[192:195], a[96:99], v[72:75], v[192:195]
  ds_read_b128 a[68:71], v3 offset:9216
  v_cvt_pk_bf16_f32 v64, v112, v113
  v_mfma_f32_16x16x32_bf16 v[196:199], a[96:99], v[76:79], v[196:199]
  s_add_u32 s86, s86, 16384
  v_exp_f32 v118, v42
  v_mfma_f32_16x16x32_bf16 v[200:203], a[100:103], v[72:75], v[200:203]
  s_cmp_ge_u32 s86, 147456
  buffer_load_dwordx4 v2, s[20:23], s85 offen offset:2048  lds
  v_mfma_f32_16x16x32_bf16 v[204:207], a[100:103], v[76:79], v[204:207]
  s_cselect_b32 s86, 0, s86
  v_exp_f32 v119, v43
  v_mfma_f32_16x16x32_bf16 v[208:211], a[104:107], v[72:75], v[208:211]
  ds_read_b128 a[72:75], v3 offset:10240
  v_mov_b32 v100, v104
  v_mfma_f32_16x16x32_bf16 v[212:215], a[104:107], v[76:79], v[212:215]
  v_exp_f32 v112, v36
  v_mfma_f32_16x16x32_bf16 v[216:219], a[108:111], v[72:75], v[216:219]
  ds_read_b128 a[76:79], v3 offset:11264
  v_cvt_pk_bf16_f32 v65, v114, v115
  v_mfma_f32_16x16x32_bf16 v[220:223], a[108:111], v[76:79], v[220:223]
  v_exp_f32 v113, v37
  v_mfma_f32_16x16x32_bf16 v[224:227], a[112:115], v[72:75], v[224:227]
  ds_read_b128 a[80:83], v3 offset:12288
  v_cvt_pk_bf16_f32 v68, v116, v117
  v_mfma_f32_16x16x32_bf16 v[228:231], a[112:115], v[76:79], v[228:231]
  v_exp_f32 v114, v38
  v_mfma_f32_16x16x32_bf16 v[232:235], a[116:119], v[72:75], v[232:235]
  buffer_load_dwordx4 v2, s[20:23], s85 offen offset:3072  lds
  v_mfma_f32_16x16x32_bf16 v[236:239], a[116:119], v[76:79], v[236:239]
  s_add_u32 s85, s85, 16384
  v_exp_f32 v115, v39
  v_mfma_f32_16x16x32_bf16 v[240:243], a[120:123], v[72:75], v[240:243]
  s_add_u32 s83, s83, 1
  ds_read_b128 a[84:87], v3 offset:13312
  v_cvt_pk_bf16_f32 v69, v118, v119
  v_mfma_f32_16x16x32_bf16 v[244:247], a[120:123], v[76:79], v[244:247]
  s_cmp_eq_u32 s83, 31
  v_exp_f32 v116, v44
  v_mfma_f32_16x16x32_bf16 v[248:251], a[124:127], v[72:75], v[248:251]
  ds_read_b128 a[88:91], v3 offset:14336
  v_mov_b32 v101, v105
  v_mfma_f32_16x16x32_bf16 v[252:255], a[124:127], v[76:79], v[252:255]
  s_waitcnt vmcnt(8) lgkmcnt(3)
  ds_read_b128 a[92:95], v3 offset:15360
  v_add_u32 v3, s86, v2
  s_cbranch_scc1 L_slast
.p2align 6
L_single:
  v_mfma_f32_16x16x32_bf16 v[48:51], a[64:67], a[0:3], v[80:83]
  s_barrier
  v_exp_f32 v117, v45
  v_mfma_f32_16x16x32_bf16 v[48:51], a[68:71], a[4:7], v[48:51]
  s_mov_b32 m0, s84
  ds_read_b128 a[96:99], v3 offset:0
  v_cvt_pk_bf16_f32 v66, v112, v113
  v_mfma_f32_16x16x32_bf16 v[48:51], a[72:75], a[8:11], v[48:51]
  s_add_u32 s84, s84, 16384
  v_exp_f32 v118, v46
  v_mfma_f32_16x16x32_bf16 v[48:51], a[76:79], a[12:15], v[48:51]
  s_cmp_ge_u32 s84, 147456
  buffer_load_dwordx4 v2, s[20:23], s85 offen offset:0  lds
  v_mfma_f32_16x16x32_bf16 v[56:59], a[76:79], a[28:31], v[84:87]
  s_cselect_b32 s70, 147456, 0
  v_exp_f32 v119, v47
  v_mfma_f32_16x16x32_bf16 v[56:59], a[72:75], a[24:27], v[56:59]
  s_sub_u32 s84, s84, s70
  ds_read_b128 a[100:103], v3 offset:1024
  v_cvt_pk_bf16_f32 v67, v114, v115
  v_mfma_f32_16x16x32_bf16 v[56:59], a[68:71], a[20:23], v[56:59]
  ds_read_b128 a[104:107], v3 offset:2048
  v_cvt_pk_bf16_f32 v70, v116, v117
  v_mfma_f32_16x16x32_bf16 v[56:59], a[64:67], a[16:19], v[56:59]
  s_waitcnt lgkmcnt(3)
  ds_read_b128 a[108:111], v3 offset:3072
  v_cvt_pk_bf16_f32 v71, v118, v119
  v_mfma_f32_16x16x32_bf16 v[52:55], a[80:83], a[0:3], v[80:83]
  s_cmp_eq_u32 s83, s81
  ds_read_b128 a[112:115], v3 offset:4096
  ds_read_b128 a[116:119], v3 offset:5120
  v_mfma_f32_16x16x32_bf16 v[52:55], a[84:87], a[4:7], v[52:55]
  s_cbranch_scc1 L_pub_84
L_pubr_85:
  ds_read_b128 a[120:123], v3 offset:6144
  ds_read_b128 a[124:127], v3 offset:7168
  v_mfma_f32_16x16x32_bf16 v[104:107], a[128:131], v[64:67], v[96:99]
  v_exp_f32 v112, v48
  v_mfma_f32_16x16x32_bf16 v[104:107], a[132:135], v[68:71], v[104:107]
  v_exp_f32 v113, v49
  v_mfma_f32_16x16x32_bf16 v[52:55], a[88:91], a[8:11], v[52:55]
  buffer_load_dwordx4 v2, s[20:23], s85 offen offset:1024  lds
  v_mfma_f32_16x16x32_bf16 v[52:55], a[92:95], a[12:15], v[52:55]
  v_exp_f32 v114, v50
  v_mfma_f32_16x16x32_bf16 v[60:63], a[92:95], a[28:31], v[84:87]
  s_nop 0
  v_exp_f32 v115, v51
  v_mfma_f32_16x16x32_bf16 v[60:63], a[88:91], a[24:27], v[60:63]
  ds_read_b128 a[64:67], v3 offset:8192
  v_cmp_nge_f32 vcc, s87, v106
  v_mfma_f32_16x16x32_bf16 v[60:63], a[84:87], a[20:23], v[60:63]
  s_waitcnt lgkmcnt(1)
  v_exp_f32 v116, v56
  v_mfma_f32_16x16x32_bf16 v[60:63], a[80:83], a[16:19], v[60:63]
  s_cbranch_vccnz L_rs_82
L_rr_83:
  v_exp_f32 v117, v57
  v_mfma_f32_16x16x32_bf16 v[128:131], a[96:99], v[64:67], v[128:131]
  ds_read_b128 a[68:71], v3 offset:9216
  v_cvt_pk_bf16_f32 v72, v112, v113
  v_mfma_f32_16x16x32_bf16 v[132:135], a[96:99], v[68:71], v[132:135]
  s_add_u32 s86, s86, 16384
  v_exp_f32 v118, v58
  v_mfma_f32_16x16x32_bf16 v[136:139], a[100:103], v[64:67], v[136:139]
  s_cmp_ge_u32 s86, 147456
  buffer_load_dwordx4 v2, s[20:23], s85 offen offset:2048  lds
  v_mfma_f32_16x16x32_bf16 v[140:143], a[100:103], v[68:71], v[140:143]
  s_cselect_b32 s86, 0, s86
  v_exp_f32 v119, v59
  v_mfma_f32_16x16x32_bf16 v[144:147], a[104:107], v[64:67], v[144:147]
  ds_read_b128 a[72:75], v3 offset:10240
  v_mov_b32 v96, v104
  v_mfma_f32_16x16x32_bf16 v[148:151], a[104:107], v[68:71], v[148:151]
  v_exp_f32 v112, v52
  v_mfma_f32_16x16x32_bf16 v[152:155], a[108:111], v[64:67], v[152:155]
  ds_read_b128 a[76:79], v3 offset:11264
  v_cvt_pk_bf16_f32 v73, v114, v115
  v_mfma_f32_16x16x32_bf16 v[156:159], a[108:111], v[68:71], v[156:159]
  v_exp_f32 v113, v53
  v_mfma_f32_16x16x32_bf16 v[160:163], a[112:115], v[64:67], v[160:163]
  ds_read_b128 a[80:83], v3 offset:12288
  v_cvt_pk_bf16_f32 v76, v116, v117
  v_mfma_f32_16x16x32_bf16 v[164:167], a[112:115], v[68:71], v[164:167]
  v_exp_f32 v114, v54
  v_mfma_f32_16x16x32_bf16 v[168:171], a[116:119], v[64:67], v[168:171]
  buffer_load_dwordx4 v2, s[20:23], s85 offen offset:3072  lds
  v_mfma_f32_16x16x32_bf16 v[172:175], a[116:119], v[68:71], v[172:175]
  s_add_u32 s85, s85, 16384
  v_exp_f32 v115, v55
  v_mfma_f32_16x16x32_bf16 v[176:179], a[120:123], v[64:67], v[176:179]
  ds_read_b128 a[84:87], v3 offset:13312
  v_cvt_pk_bf16_f32 v77, v118, v119
  v_mfma_f32_16x16x32_bf16 v[180:183], a[120:123], v[68:71], v[180:183]
  v_exp_f32 v116, v60
  v_mfma_f32_16x16x32_bf16 v[184:187], a[124:127], v[64:67], v[184:187]
  ds_read_b128 a[88:91], v3 offset:14336
  v_mov_b32 v97, v105
  v_mfma_f32_16x16x32_bf16 v[188:191], a[124:127], v[68:71], v[188:191]
  s_waitcnt lgkmcnt(3)
  ds_read_b128 a[92:95], v3 offset:15360
  v_add_u32 v3, s86, v2
  v_mfma_f32_16x16x32_bf16 v[32:35], a[64:67], a[0:3], v[80:83]
  v_exp_f32 v117, v61
  v_mfma_f32_16x16x32_bf16 v[32:35], a[68:71], a[4:7], v[32:35]
  s_mov_b32 m0, s84
  ds_read_b128 a[96:99], v3 offset:0
  v_cvt_pk_bf16_f32 v74, v112, v113
  v_mfma_f32_16x16x32_bf16 v[32:35], a[72:75], a[8:11], v[32:35]
  s_add_u32 s84, s84, 16384
  v_exp_f32 v118, v62
  v_mfma_f32_16x16x32_bf16 v[32:35], a[76:79], a[12:15], v[32:35]
  s_cmp_ge_u32 s84, 147456
  buffer_load_dwordx4 v2, s[20:23], s85 offen offset:0  lds
  v_mfma_f32_16x16x32_bf16 v[40:43], a[76:79], a[28:31], v[84:87]
  s_cselect_b32 s70, 147456, 0
  v_exp_f32 v119, v63
  v_mfma_f32_16x16x32_bf16 v[40:43], a[72:75], a[24:27], v[40:43]
  s_sub_u32 s84, s84, s70
  ds_read_b128 a[100:103], v3 offset:1024
  v_cvt_pk_bf16_f32 v75, v114, v115
  v_mfma_f32_16x16x32_bf16 v[40:43], a[68:71], a[20:23], v[40:43]
  ds_read_b128 a[104:107], v3 offset:2048
  v_cvt_pk_bf16_f32 v78, v116, v117
  v_mfma_f32_16x16x32_bf16 v[40:43], a[64:67], a[16:19], v[40:43]
  s_waitcnt lgkmcnt(3)
  ds_read_b128 a[108:111], v3 offset:3072
  v_cvt_pk_bf16_f32 v79, v118, v119
  v_mfma_f32_16x16x32_bf16 v[36:39], a[80:83], a[0:3], v[80:83]
  ds_read_b128 a[112:115], v3 offset:4096
  ds_read_b128 a[116:119], v3 offset:5120
  v_mfma_f32_16x16x32_bf16 v[36:39], a[84:87], a[4:7], v[36:39]
  ds_read_b128 a[120:123], v3 offset:6144
  ds_read_b128 a[124:127], v3 offset:7168
  v_mfma_f32_16x16x32_bf16 v[104:107], a[128:131], v[72:75], v[96:99]
  v_exp_f32 v112, v32
  v_mfma_f32_16x16x32_bf16 v[104:107], a[132:135], v[76:79], v[104:107]
  v_exp_f32 v113, v33
  v_mfma_f32_16x16x32_bf16 v[36:39], a[88:91], a[8:11], v[36:39]
  buffer_load_dwordx4 v2, s[20:23], s85 offen offset:1024  lds
  v_mfma_f32_16x16x32_bf16 v[36:39], a[92:95], a[12:15], v[36:39]
  v_exp_f32 v114, v34
  v_mfma_f32_16x16x32_bf16 v[44:47], a[92:95], a[28:31], v[84:87]
  s_nop 0
  v_exp_f32 v115, v35
  v_mfma_f32_16x16x32_bf16 v[44:47], a[88:91], a[24:27], v[44:47]
  ds_read_b128 a[64:67], v3 offset:8192
  v_cmp_nge_f32 vcc, s87, v106
  v_mfma_f32_16x16x32_bf16 v[44:47], a[84:87], a[20:23], v[44:47]
  s_waitcnt lgkmcnt(1)
  v_exp_f32 v116, v40
  v_mfma_f32_16x16x32_bf16 v[44:47], a[80:83], a[16:19], v[44:47]
  s_cbranch_vccnz L_rs_86
L_rr_87:
  v_exp_f32 v117, v41
  v_mfma_f32_16x16x32_bf16 v[128:131], a[96:99], v[72:75], v[128:131]
  ds_read_b128 a[68:71], v3 offset:9216
  v_cvt_pk_bf16_f32 v64, v112, v113
  v_mfma_f32_16x16x32_bf16 v[132:135], a[96:99], v[76:79], v[132:135]
  s_add_u32 s86, s86, 16384
  v_exp_f32 v118, v42
  v_mfma_f32_16x16x32_bf16 v[136:139], a[100:103], v[72:75], v[136:139]
  s_cmp_ge_u32 s86, 147456
  buffer_load_dwordx4 v2, s[20:23], s85 offen offset:2048  lds
  v_mfma_f32_16x16x32_bf16 v[140:143], a[100:103], v[76:79], v[140:143]
  s_cselect_b32 s86, 0, s86
  v_exp_f32 v119, v43
  v_mfma_f32_16x16x32_bf16 v[144:147], a[104:107], v[72:75], v[144:147]
  ds_read_b128 a[72:75], v3 offset:10240
  v_mov_b32 v96, v104
  v_mfma_f32_16x16x32_bf16 v[148:151], a[104:107], v[76:79], v[148:151]
  v_exp_f32 v112, v36
  v_mfma_f32_16x16x32_bf16 v[152:155], a[108:111], v[72:75], v[152:155]
  ds_read_b128 a[76:79], v3 offset:11264
  v_cvt_pk_bf16_f32 v65, v114, v115
  v_mfma_f32_16x16x32_bf16 v[156:159], a[108:111], v[76:79], v[156:159]
  v_exp_f32 v113, v37
  v_mfma_f32_16x16x32_bf16 v[160:163], a[112:115], v[72:75], v[160:163]
  ds_read_b128 a[80:83], v3 offset:12288
  v_cvt_pk_bf16_f32 v68, v116, v117
  v_mfma_f32_16x16x32_bf16 v[164:167], a[112:115], v[76:79], v[164:167]
  v_exp_f32 v114, v38
  v_mfma_f32_16x16x32_bf16 v[168:171], a[116:119], v[72:75], v[168:171]
  buffer_load_dwordx4 v2, s[20:23], s85 offen offset:3072  lds
  v_mfma_f32_16x16x32_bf16 v[172:175], a[116:119], v[76:79], v[172:175]
  s_add_u32 s85, s85, 16384
  v_exp_f32 v115, v39
  v_mfma_f32_16x16x32_bf16 v[176:179], a[120:123], v[72:75], v[176:179]
  s_add_u32 s83, s83, 1
  ds_read_b128 a[84:87], v3 offset:13312
  v_cvt_pk_bf16_f32 v69, v118, v119
  v_mfma_f32_16x16x32_bf16 v[180:183], a[120:123], v[76:79], v[180:183]
  s_cmp_lt_u32 s83, 31
  v_exp_f32 v116, v44
  v_mfma_f32_16x16x32_bf16 v[184:187], a[124:127], v[72:75], v[184:187]
  ds_read_b128 a[88:91], v3 offset:14336
  v_mov_b32 v97, v105
  v_mfma_f32_16x16x32_bf16 v[188:191], a[124:127], v[76:79], v[188:191]
  s_waitcnt vmcnt(8) lgkmcnt(3)
  ds_read_b128 a[92:95], v3 offset:15360
  v_add_u32 v3, s86, v2
  s_cbranch_scc1 L_single
L_slast:
  v_mfma_f32_16x16x32_bf16 v[48:51], a[64:67], a[0:3], v[80:83]
  s_barrier
  v_exp_f32 v117, v45
  v_mfma_f32_16x16x32_bf16 v[48:51], a[68:71], a[4:7], v[48:51]
  ds_read_b128 a[96:99], v3 offset:0
  v_cvt_pk_bf16_f32 v66, v112, v113
  v_mfma_f32_16x16x32_bf16 v[48:51], a[72:75], a[8:11], v[48:51]
  v_exp_f32 v118, v46
  v_mfma_f32_16x16x32_bf16 v[48:51], a[76:79], a[12:15], v[48:51]
  buffer_load_dword v125, v124, s[20:23], 0 offen sc1
  v_mfma_f32_16x16x32_bf16 v[56:59], a[76:79], a[28:31], v[84:87]
  v_exp_f32 v119, v47
  v_mfma_f32_16x16x32_bf16 v[56:59], a[72:75], a[24:27], v[56:59]
  ds_read_b128 a[100:103], v3 offset:1024
  v_cvt_pk_bf16_f32 v67, v114, v115
  v_mfma_f32_16x16x32_bf16 v[56:59], a[68:71], a[20:23], v[56:59]
  ds_read_b128 a[104:107], v3 offset:2048
  v_cvt_pk_bf16_f32 v70, v116, v117
  v_mfma_f32_16x16x32_bf16 v[56:59], a[64:67], a[16:19], v[56:59]
  s_waitcnt lgkmcnt(3)
  ds_read_b128 a[108:111], v3 offset:3072
  v_cvt_pk_bf16_f32 v71, v118, v119
  v_mfma_f32_16x16x32_bf16 v[52:55], a[80:83], a[0:3], v[80:83]
  ds_read_b128 a[112:115], v3 offset:4096
  ds_read_b128 a[116:119], v3 offset:5120
  v_mfma_f32_16x16x32_bf16 v[52:55], a[84:87], a[4:7], v[52:55]
  ds_read_b128 a[120:123], v3 offset:6144
  ds_read_b128 a[124:127], v3 offset:7168
  v_mfma_f32_16x16x32_bf16 v[104:107], a[128:131], v[64:67], v[96:99]
  v_exp_f32 v112, v48
  v_mfma_f32_16x16x32_bf16 v[104:107], a[132:135], v[68:71], v[104:107]
  v_exp_f32 v113, v49
  v_mfma_f32_16x16x32_bf16 v[52:55], a[88:91], a[8:11], v[52:55]
  s_nop 0
  s_mov_b32 s72, 58216448
  buffer_load_dwordx4 v[24:27], v126, s[20:23], s72 offen sc1
  v_mfma_f32_16x16x32_bf16 v[52:55], a[92:95], a[12:15], v[52:55]
  v_exp_f32 v114, v50
  v_mfma_f32_16x16x32_bf16 v[60:63], a[92:95], a[28:31], v[84:87]
  s_nop 0
  v_exp_f32 v115, v51
  v_mfma_f32_16x16x32_bf16 v[60:63], a[88:91], a[24:27], v[60:63]
  ds_read_b128 a[64:67], v3 offset:8192
  v_cmp_nge_f32 vcc, s87, v106
  v_mfma_f32_16x16x32_bf16 v[60:63], a[84:87], a[20:23], v[60:63]
  s_waitcnt lgkmcnt(1)
  v_exp_f32 v116, v56
  v_mfma_f32_16x16x32_bf16 v[60:63], a[80:83], a[16:19], v[60:63]
  s_cbranch_vccnz L_rs_88
L_rr_89:
  v_exp_f32 v117, v57
  v_mfma_f32_16x16x32_bf16 v[128:131], a[96:99], v[64:67], v[128:131]
  ds_read_b128 a[68:71], v3 offset:9216
  v_cvt_pk_bf16_f32 v72, v112, v113
  v_mfma_f32_16x16x32_bf16 v[132:135], a[96:99], v[68:71], v[132:135]
  s_add_u32 s86, s86, 16384
  v_exp_f32 v118, v58
  v_mfma_f32_16x16x32_bf16 v[136:139], a[100:103], v[64:67], v[136:139]
  s_cmp_ge_u32 s86, 147456
  v_mfma_f32_16x16x32_bf16 v[140:143], a[100:103], v[68:71], v[140:143]
  s_cselect_b32 s86, 0, s86
  v_exp_f32 v119, v59
  v_mfma_f32_16x16x32_bf16 v[144:147], a[104:107], v[64:67], v[144:147]
  ds_read_b128 a[72:75], v3 offset:10240
  v_mov_b32 v96, v104
  v_mfma_f32_16x16x32_bf16 v[148:151], a[104:107], v[68:71], v[148:151]
  v_exp_f32 v112, v52
  v_mfma_f32_16x16x32_bf16 v[152:155], a[108:111], v[64:67], v[152:155]
  ds_read_b128 a[76:79], v3 offset:11264
  v_cvt_pk_bf16_f32 v73, v114, v115
  v_mfma_f32_16x16x32_bf16 v[156:159], a[108:111], v[68:71], v[156:159]
  v_exp_f32 v113, v53
  v_mfma_f32_16x16x32_bf16 v[160:163], a[112:115], v[64:67], v[160:163]
  ds_read_b128 a[80:83], v3 offset:12288
  v_cvt_pk_bf16_f32 v76, v116, v117
  v_mfma_f32_16x16x32_bf16 v[164:167], a[112:115], v[68:71], v[164:167]
  v_exp_f32 v114, v54
  v_mfma_f32_16x16x32_bf16 v[168:171], a[116:119], v[64:67], v[168:171]
  v_mfma_f32_16x16x32_bf16 v[172:175], a[116:119], v[68:71], v[172:175]
  v_exp_f32 v115, v55
  v_mfma_f32_16x16x32_bf16 v[176:179], a[120:123], v[64:67], v[176:179]
  ds_read_b128 a[84:87], v3 offset:13312
  v_cvt_pk_bf16_f32 v77, v118, v119
  v_mfma_f32_16x16x32_bf16 v[180:183], a[120:123], v[68:71], v[180:183]
  v_exp_f32 v116, v60
  v_mfma_f32_16x16x32_bf16 v[184:187], a[124:127], v[64:67], v[184:187]
  ds_read_b128 a[88:91], v3 offset:14336
  v_mov_b32 v97, v105
  v_mfma_f32_16x16x32_bf16 v[188:191], a[124:127], v[68:71], v[188:191]
  s_waitcnt lgkmcnt(3)
  ds_read_b128 a[92:95], v3 offset:15360
  v_add_u32 v3, s86, v2
  v_add_f32 v32, v108, v80
  v_add_f32 v33, v109, v81
  v_add_f32 v34, v110, v82
  v_add_f32 v35, v111, v83
  v_mov_b32 v36, 0xff800000
  v_mov_b32 v37, 0xff800000
  v_mov_b32 v38, 0xff800000
  v_mov_b32 v39, 0xff800000
  v_mov_b32 v40, v84
  v_mov_b32 v41, v85
  v_mov_b32 v42, v86
  v_mov_b32 v43, v87
  v_add_f32 v44, v108, v84
  v_add_f32 v45, v109, v85
  v_add_f32 v46, v110, v86
  v_add_f32 v47, v111, v87
  s_nop 1
  v_mfma_f32_16x16x32_bf16 v[32:35], a[64:67], a[0:3], v[32:35]
  v_exp_f32 v117, v61
  v_mfma_f32_16x16x32_bf16 v[32:35], a[68:71], a[4:7], v[32:35]
  ds_read_b128 a[96:99], v3 offset:0
  v_cvt_pk_bf16_f32 v74, v112, v113
  v_mfma_f32_16x16x32_bf16 v[32:35], a[72:75], a[8:11], v[32:35]
  v_exp_f32 v118, v62
  v_mfma_f32_16x16x32_bf16 v[32:35], a[76:79], a[12:15], v[32:35]
  v_mfma_f32_16x16x32_bf16 v[40:43], a[76:79], a[28:31], v[40:43]
  v_exp_f32 v119, v63
  v_mfma_f32_16x16x32_bf16 v[40:43], a[72:75], a[24:27], v[40:43]
  ds_read_b128 a[100:103], v3 offset:1024
  v_cvt_pk_bf16_f32 v75, v114, v115
  v_mfma_f32_16x16x32_bf16 v[40:43], a[68:71], a[20:23], v[40:43]
  ds_read_b128 a[104:107], v3 offset:2048
  v_cvt_pk_bf16_f32 v78, v116, v117
  v_mfma_f32_16x16x32_bf16 v[40:43], a[64:67], a[16:19], v[40:43]
  s_waitcnt lgkmcnt(3)
  ds_read_b128 a[108:111], v3 offset:3072
  v_cvt_pk_bf16_f32 v79, v118, v119
  v_mfma_f32_16x16x32_bf16 v[36:39], a[80:83], a[0:3], v[36:39]
  ds_read_b128 a[112:115], v3 offset:4096
  ds_read_b128 a[116:119], v3 offset:5120
  v_mfma_f32_16x16x32_bf16 v[36:39], a[84:87], a[4:7], v[36:39]
  ds_read_b128 a[120:123], v3 offset:6144
  ds_read_b128 a[124:127], v3 offset:7168
  v_mfma_f32_16x16x32_bf16 v[104:107], a[128:131], v[72:75], v[96:99]
  v_exp_f32 v112, v32
  v_mfma_f32_16x16x32_bf16 v[104:107], a[132:135], v[76:79], v[104:107]
  v_exp_f32 v113, v33
  v_mfma_f32_16x16x32_bf16 v[36:39], a[88:91], a[8:11], v[36:39]
  s_nop 0
  v_mfma_f32_16x16x32_bf16 v[36:39], a[92:95], a[12:15], v[36:39]
  s_nop 0
  v_exp_f32 v114, v34
  v_mfma_f32_16x16x32_bf16 v[44:47], a[92:95], a[28:31], v[44:47]
  s_nop 0
  v_exp_f32 v115, v35
  v_mfma_f32_16x16x32_bf16 v[44:47], a[88:91], a[24:27], v[44:47]
  v_cmp_nge_f32 vcc, s87, v106
  v_mfma_f32_16x16x32_bf16 v[44:47], a[84:87], a[20:23], v[44:47]
  s_waitcnt lgkmcnt(0)
  v_exp_f32 v116, v40
  v_mfma_f32_16x16x32_bf16 v[44:47], a[80:83], a[16:19], v[44:47]
  s_cbranch_vccnz L_rs_90
L_rr_91:
  v_exp_f32 v117, v41
  v_mfma_f32_16x16x32_bf16 v[128:131], a[96:99], v[72:75], v[128:131]
  v_cvt_pk_bf16_f32 v64, v112, v113
  v_mfma_f32_16x16x32_bf16 v[132:135], a[96:99], v[76:79], v[132:135]
  s_add_u32 s86, s86, 16384
  v_exp_f32 v118, v42
  v_mfma_f32_16x16x32_bf16 v[136:139], a[100:103], v[72:75], v[136:139]
  s_cmp_ge_u32 s86, 147456
  v_mfma_f32_16x16x32_bf16 v[140:143], a[100:103], v[76:79], v[140:143]
  s_cselect_b32 s86, 0, s86
  v_exp_f32 v119, v43
  v_mfma_f32_16x16x32_bf16 v[144:147], a[104:107], v[72:75], v[144:147]
  v_mov_b32 v96, v104
  v_mfma_f32_16x16x32_bf16 v[148:151], a[104:107], v[76:79], v[148:151]
  v_exp_f32 v112, v36
  v_mfma_f32_16x16x32_bf16 v[152:155], a[108:111], v[72:75], v[152:155]
  v_cvt_pk_bf16_f32 v65, v114, v115
  v_mfma_f32_16x16x32_bf16 v[156:159], a[108:111], v[76:79], v[156:159]
  v_exp_f32 v113, v37
  v_mfma_f32_16x16x32_bf16 v[160:163], a[112:115], v[72:75], v[160:163]
  v_cvt_pk_bf16_f32 v68, v116, v117
  v_mfma_f32_16x16x32_bf16 v[164:167], a[112:115], v[76:79], v[164:167]
  v_exp_f32 v114, v38
  v_mfma_f32_16x16x32_bf16 v[168:171], a[116:119], v[72:75], v[168:171]
  v_mfma_f32_16x16x32_bf16 v[172:175], a[116:119], v[76:79], v[172:175]
  v_exp_f32 v115, v39
  v_mfma_f32_16x16x32_bf16 v[176:179], a[120:123], v[72:75], v[176:179]
  v_cvt_pk_bf16_f32 v69, v118, v119
  v_mfma_f32_16x16x32_bf16 v[180:183], a[120:123], v[76:79], v[180:183]
  v_exp_f32 v116, v44
  v_mfma_f32_16x16x32_bf16 v[184:187], a[124:127], v[72:75], v[184:187]
  v_mov_b32 v97, v105
  v_mfma_f32_16x16x32_bf16 v[188:191], a[124:127], v[76:79], v[188:191]
  s_waitcnt vmcnt(0)
  v_add_u32 v3, s86, v2
L_final:
  s_waitcnt vmcnt(0)
  s_barrier
  ds_read_b128 a[96:99], v3 offset:0
  ds_read_b128 a[100:103], v3 offset:1024
  ds_read_b128 a[104:107], v3 offset:2048
  ds_read_b128 a[108:111], v3 offset:3072
  ds_read_b128 a[112:115], v3 offset:4096
  ds_read_b128 a[116:119], v3 offset:5120
  ds_read_b128 a[120:123], v3 offset:6144
  ds_read_b128 a[124:127], v3 offset:7168
  v_exp_f32 v117, v45
  v_exp_f32 v118, v46
  v_exp_f32 v119, v47
  v_cvt_pk_bf16_f32 v66, v112, v113
  v_cvt_pk_bf16_f32 v67, v114, v115
  v_cvt_pk_bf16_f32 v70, v116, v117
  v_cvt_pk_bf16_f32 v71, v118, v119
  s_nop 1
  v_mfma_f32_16x16x32_bf16 v[104:107], a[128:131], v[64:67], v[96:99]
  v_mfma_f32_16x16x32_bf16 v[104:107], a[132:135], v[68:71], v[104:107]
  s_nop 7
  v_cmp_nge_f32 vcc, s87, v106
  s_waitcnt lgkmcnt(0)
  s_cbranch_vccnz L_rs_94
L_rr_95:
  v_mov_b32 v96, v104
  v_mov_b32 v97, v105
  v_mfma_f32_16x16x32_bf16 v[128:131], a[96:99], v[64:67], v[128:131]
  s_and_b32 s79, s2, 7
  s_lshl_b32 s79, s79, 2
  s_lshr_b32 s70, s2, 6
  v_mfma_f32_16x16x32_bf16 v[132:135], a[96:99], v[68:71], v[132:135]
  s_add_u32 s79, s79, s70
  s_bfe_u32 s32, s2, 0x30003
  v_mfma_f32_16x16x32_bf16 v[136:139], a[100:103], v[64:67], v[136:139]
  v_mfma_f32_16x16x32_bf16 v[140:143], a[100:103], v[68:71], v[140:143]
  v_mfma_f32_16x16x32_bf16 v[144:147], a[104:107], v[64:67], v[144:147]
  v_mfma_f32_16x16x32_bf16 v[148:151], a[104:107], v[68:71], v[148:151]
  v_mfma_f32_16x16x32_bf16 v[152:155], a[108:111], v[64:67], v[152:155]
  v_mfma_f32_16x16x32_bf16 v[156:159], a[108:111], v[68:71], v[156:159]
  v_mfma_f32_16x16x32_bf16 v[160:163], a[112:115], v[64:67], v[160:163]
  v_mfma_f32_16x16x32_bf16 v[164:167], a[112:115], v[68:71], v[164:167]
  v_mfma_f32_16x16x32_bf16 v[168:171], a[116:119], v[64:67], v[168:171]
  v_mfma_f32_16x16x32_bf16 v[172:175], a[116:119], v[68:71], v[172:175]
  v_mfma_f32_16x16x32_bf16 v[176:179], a[120:123], v[64:67], v[176:179]
  v_mfma_f32_16x16x32_bf16 v[180:183], a[120:123], v[68:71], v[180:183]
  v_mfma_f32_16x16x32_bf16 v[184:187], a[124:127], v[64:67], v[184:187]
  v_mfma_f32_16x16x32_bf16 v[188:191], a[124:127], v[68:71], v[188:191]
  s_cmp_le_u32 s81, 30
  s_cbranch_scc1 L_96
  v_rcp_f32 v5, v100
  v_rcp_f32 v7, v101
  s_lshl_b32 s70, s37, 18
  s_lshl_b32 s71, s35, 13
  s_add_u32 s70, s70, s71
  s_add_u32 s70, s70, 34603008
  v_mov_b32 v6, v5
  v_mov_b32 v8, v7
  v_mov_b32 v9, v8
  v_mov_b32 v7, v6
  v_pk_mul_f32 v[192:193], v[192:193], v[6:7]
  v_pk_mul_f32 v[194:195], v[194:195], v[6:7]
  v_pk_mul_f32 v[200:201], v[200:201], v[6:7]
  v_pk_mul_f32 v[202:203], v[202:203], v[6:7]
  v_cvt_pk_bf16_f32 v192, v192, v193
  v_cvt_pk_bf16_f32 v193, v194, v195
  v_cvt_pk_bf16_f32 v194, v200, v201
  v_cvt_pk_bf16_f32 v195, v202, v203
  buffer_store_dwordx4 v[192:195], v2, s[20:23], s70 offen offset:0 sc1
  v_pk_mul_f32 v[196:197], v[196:197], v[8:9]
  v_pk_mul_f32 v[198:199], v[198:199], v[8:9]
  v_pk_mul_f32 v[204:205], v[204:205], v[8:9]
  v_pk_mul_f32 v[206:207], v[206:207], v[8:9]
  v_cvt_pk_bf16_f32 v196, v196, v197
  v_cvt_pk_bf16_f32 v197, v198, v199
  v_cvt_pk_bf16_f32 v198, v204, v205
  v_cvt_pk_bf16_f32 v199, v206, v207
  buffer_store_dwordx4 v[196:199], v2, s[20:23], s70 offen offset:1024 sc1
  v_pk_mul_f32 v[208:209], v[208:209], v[6:7]
  v_pk_mul_f32 v[210:211], v[210:211], v[6:7]
  v_pk_mul_f32 v[216:217], v[216:217], v[6:7]
  v_pk_mul_f32 v[218:219], v[218:219], v[6:7]
  v_cvt_pk_bf16_f32 v208, v208, v209
  v_cvt_pk_bf16_f32 v209, v210, v211
  v_cvt_pk_bf16_f32 v210, v216, v217
  v_cvt_pk_bf16_f32 v211, v218, v219
  buffer_store_dwordx4 v[208:211], v2, s[20:23], s70 offen offset:2048 sc1
  v_pk_mul_f32 v[212:213], v[212:213], v[8:9]
  v_pk_mul_f32 v[214:215], v[214:215], v[8:9]
  v_pk_mul_f32 v[220:221], v[220:221], v[8:9]
  v_pk_mul_f32 v[222:223], v[222:223], v[8:9]
  v_cvt_pk_bf16_f32 v212, v212, v213
  v_cvt_pk_bf16_f32 v213, v214, v215
  v_cvt_pk_bf16_f32 v214, v220, v221
  v_cvt_pk_bf16_f32 v215, v222, v223
  buffer_store_dwordx4 v[212:215], v2, s[20:23], s70 offen offset:3072 sc1
  s_add_u32 s70, s70, 4096
  v_pk_mul_f32 v[224:225], v[224:225], v[6:7]
  v_pk_mul_f32 v[226:227], v[226:227], v[6:7]
  v_pk_mul_f32 v[232:233], v[232:233], v[6:7]
  v_pk_mul_f32 v[234:235], v[234:235], v[6:7]
  v_cvt_pk_bf16_f32 v224, v224, v225
  v_cvt_pk_bf16_f32 v225, v226, v227
  v_cvt_pk_bf16_f32 v226, v232, v233
  v_cvt_pk_bf16_f32 v227, v234, v235
  buffer_store_dwordx4 v[224:227], v2, s[20:23], s70 offen offset:0 sc1
  v_pk_mul_f32 v[228:229], v[228:229], v[8:9]
  v_pk_mul_f32 v[230:231], v[230:231], v[8:9]
  v_pk_mul_f32 v[236:237], v[236:237], v[8:9]
  v_pk_mul_f32 v[238:239], v[238:239], v[8:9]
  v_cvt_pk_bf16_f32 v228, v228, v229
  v_cvt_pk_bf16_f32 v229, v230, v231
  v_cvt_pk_bf16_f32 v230, v236, v237
  v_cvt_pk_bf16_f32 v231, v238, v239
  buffer_store_dwordx4 v[228:231], v2, s[20:23], s70 offen offset:1024 sc1
  v_pk_mul_f32 v[240:241], v[240:241], v[6:7]
  v_pk_mul_f32 v[242:243], v[242:243], v[6:7]
  v_pk_mul_f32 v[248:249], v[248:249], v[6:7]
  v_pk_mul_f32 v[250:251], v[250:251], v[6:7]
  v_cvt_pk_bf16_f32 v240, v240, v241
  v_cvt_pk_bf16_f32 v241, v242, v243
  v_cvt_pk_bf16_f32 v242, v248, v249
  v_cvt_pk_bf16_f32 v243, v250, v251
  buffer_store_dwordx4 v[240:243], v2, s[20:23], s70 offen offset:2048 sc1
  v_pk_mul_f32 v[244:245], v[244:245], v[8:9]
  v_pk_mul_f32 v[246:247], v[246:247], v[8:9]
  v_pk_mul_f32 v[252:253], v[252:253], v[8:9]
  v_pk_mul_f32 v[254:255], v[254:255], v[8:9]
  v_cvt_pk_bf16_f32 v244, v244, v245
  v_cvt_pk_bf16_f32 v245, v246, v247
  v_cvt_pk_bf16_f32 v246, v252, v253
  v_cvt_pk_bf16_f32 v247, v254, v255
  buffer_store_dwordx4 v[244:247], v2, s[20:23], s70 offen offset:3072 sc1
L_96:
  s_nop 4
  v_rcp_f32 v5, v96
  v_rcp_f32 v7, v97
  s_lshl_b32 s70, s38, 18
  s_lshl_b32 s71, s35, 13
  s_add_u32 s70, s70, s71
  s_add_u32 s70, s70, 34603008
  v_mov_b32 v6, v5
  v_mov_b32 v8, v7
  v_mov_b32 v9, v8
  v_mov_b32 v7, v6
  v_pk_mul_f32 v[128:129], v[128:129], v[6:7]
  v_pk_mul_f32 v[130:131], v[130:131], v[6:7]
  v_pk_mul_f32 v[136:137], v[136:137], v[6:7]
  v_pk_mul_f32 v[138:139], v[138:139], v[6:7]
  v_cvt_pk_bf16_f32 v128, v128, v129
  v_cvt_pk_bf16_f32 v129, v130, v131
  v_cvt_pk_bf16_f32 v130, v136, v137
  v_cvt_pk_bf16_f32 v131, v138, v139
  buffer_store_dwordx4 v[128:131], v2, s[20:23], s70 offen offset:0 sc1
  v_pk_mul_f32 v[132:133], v[132:133], v[8:9]
  v_pk_mul_f32 v[134:135], v[134:135], v[8:9]
  v_pk_mul_f32 v[140:141], v[140:141], v[8:9]
  v_pk_mul_f32 v[142:143], v[142:143], v[8:9]
  v_cvt_pk_bf16_f32 v132, v132, v133
  v_cvt_pk_bf16_f32 v133, v134, v135
  v_cvt_pk_bf16_f32 v134, v140, v141
  v_cvt_pk_bf16_f32 v135, v142, v143
  buffer_store_dwordx4 v[132:135], v2, s[20:23], s70 offen offset:1024 sc1
  v_pk_mul_f32 v[144:145], v[144:145], v[6:7]
  v_pk_mul_f32 v[146:147], v[146:147], v[6:7]
  v_pk_mul_f32 v[152:153], v[152:153], v[6:7]
  v_pk_mul_f32 v[154:155], v[154:155], v[6:7]
  v_cvt_pk_bf16_f32 v144, v144, v145
  v_cvt_pk_bf16_f32 v145, v146, v147
  v_cvt_pk_bf16_f32 v146, v152, v153
  v_cvt_pk_bf16_f32 v147, v154, v155
  buffer_store_dwordx4 v[144:147], v2, s[20:23], s70 offen offset:2048 sc1
  v_pk_mul_f32 v[148:149], v[148:149], v[8:9]
  v_pk_mul_f32 v[150:151], v[150:151], v[8:9]
  v_pk_mul_f32 v[156:157], v[156:157], v[8:9]
  v_pk_mul_f32 v[158:159], v[158:159], v[8:9]
  v_cvt_pk_bf16_f32 v148, v148, v149
  v_cvt_pk_bf16_f32 v149, v150, v151
  v_cvt_pk_bf16_f32 v150, v156, v157
  v_cvt_pk_bf16_f32 v151, v158, v159
  buffer_store_dwordx4 v[148:151], v2, s[20:23], s70 offen offset:3072 sc1
  s_add_u32 s70, s70, 4096
  v_pk_mul_f32 v[160:161], v[160:161], v[6:7]
  v_pk_mul_f32 v[162:163], v[162:163], v[6:7]
  v_pk_mul_f32 v[168:169], v[168:169], v[6:7]
  v_pk_mul_f32 v[170:171], v[170:171], v[6:7]
  v_cvt_pk_bf16_f32 v160, v160, v161
  v_cvt_pk_bf16_f32 v161, v162, v163
  v_cvt_pk_bf16_f32 v162, v168, v169
  v_cvt_pk_bf16_f32 v163, v170, v171
  buffer_store_dwordx4 v[160:163], v2, s[20:23], s70 offen offset:0 sc1
  v_pk_mul_f32 v[164:165], v[164:165], v[8:9]
  v_pk_mul_f32 v[166:167], v[166:167], v[8:9]
  v_pk_mul_f32 v[172:173], v[172:173], v[8:9]
  v_pk_mul_f32 v[174:175], v[174:175], v[8:9]
  v_cvt_pk_bf16_f32 v164, v164, v165
  v_cvt_pk_bf16_f32 v165, v166, v167
  v_cvt_pk_bf16_f32 v166, v172, v173
  v_cvt_pk_bf16_f32 v167, v174, v175
  buffer_store_dwordx4 v[164:167], v2, s[20:23], s70 offen offset:1024 sc1
  v_pk_mul_f32 v[176:177], v[176:177], v[6:7]
  v_pk_mul_f32 v[178:179], v[178:179], v[6:7]
  v_pk_mul_f32 v[184:185], v[184:185], v[6:7]
  v_pk_mul_f32 v[186:187], v[186:187], v[6:7]
  v_cvt_pk_bf16_f32 v176, v176, v177
  v_cvt_pk_bf16_f32 v177, v178, v179
  v_cvt_pk_bf16_f32 v178, v184, v185
  v_cvt_pk_bf16_f32 v179, v186, v187
  buffer_store_dwordx4 v[176:179], v2, s[20:23], s70 offen offset:2048 sc1
  v_pk_mul_f32 v[180:181], v[180:181], v[8:9]
  v_pk_mul_f32 v[182:183], v[182:183], v[8:9]
  v_pk_mul_f32 v[188:189], v[188:189], v[8:9]
  v_pk_mul_f32 v[190:191], v[190:191], v[8:9]
  v_cvt_pk_bf16_f32 v180, v180, v181
  v_cvt_pk_bf16_f32 v181, v182, v183
  v_cvt_pk_bf16_f32 v182, v188, v189
  v_cvt_pk_bf16_f32 v183, v190, v191
  buffer_store_dwordx4 v[180:183], v2, s[20:23], s70 offen offset:3072 sc1
  s_lshl_b32 s76, s79, 19
  s_lshl_b32 s70, s34, 16
  s_add_u32 s76, s76, s70
  s_add_u32 s76, s76, 34603008
  s_lshl_b32 s77, s32, 6
  s_lshl_b32 s70, s34, 4
  s_add_u32 s77, s77, s70
  s_mul_i32 s77, s77, 9216
  s_add_u32 s77, s77, 52428800
  s_add_u32 s70, s34, 1
  s_bfe_u32 s71, s70, 0x10001
  s_lshl_b32 s71, s71, 18
  s_and_b32 s70, s70, 1
  s_lshl_b32 s70, s70, 10
  s_add_u32 s70, s70, s71
  s_add_u32 s74, s76, s70
  s_add_u32 s70, s34, 2
  s_bfe_u32 s71, s70, 0x10001
  s_lshl_b32 s71, s71, 18
  s_and_b32 s70, s70, 1
  s_lshl_b32 s70, s70, 10
  s_add_u32 s70, s70, s71
  s_add_u32 s75, s76, s70
  s_add_u32 s70, s34, 3
  s_bfe_u32 s71, s70, 0x10001
  s_lshl_b32 s71, s71, 18
  s_and_b32 s70, s70, 1
  s_lshl_b32 s70, s70, 10
  s_add_u32 s70, s70, s71
  s_add_u32 s78, s76, s70
  s_add_u32 s70, s34, 0
  s_bfe_u32 s71, s70, 0x10001
  s_lshl_b32 s71, s71, 18
  s_and_b32 s70, s70, 1
  s_lshl_b32 s70, s70, 10
  s_add_u32 s70, s70, s71
  s_add_u32 s76, s76, s70
  v_cmp_ne_u32 vcc, 1, v125
  s_cbranch_vccnz L_spin_97
L_back_98:
  s_cmp_lt_u32 s33, 144
  s_cbranch_scc1 L_dmod
  s_add_u32 s70, s77, 0
  buffer_load_dwordx4 a[0:3], v2, s[20:23], s70 offen
  s_add_u32 s70, s77, 1024
  buffer_load_dwordx4 a[4:7], v2, s[20:23], s70 offen
  s_add_u32 s70, s77, 2048
  buffer_load_dwordx4 a[8:11], v2, s[20:23], s70 offen
  s_add_u32 s70, s77, 3072
  buffer_load_dwordx4 a[12:15], v2, s[20:23], s70 offen
  s_add_u32 s70, s77, 4096
  buffer_load_dwordx4 a[16:19], v2, s[20:23], s70 offen
  s_add_u32 s70, s77, 5120
  buffer_load_dwordx4 a[20:23], v2, s[20:23], s70 offen
  s_add_u32 s70, s77, 6144
  buffer_load_dwordx4 a[24:27], v2, s[20:23], s70 offen
  s_add_u32 s70, s77, 7168
  buffer_load_dwordx4 a[28:31], v2, s[20:23], s70 offen
  s_waitcnt vmcnt(8)
  s_barrier
  s_cmp_lg_u32 s34, 0
  s_cbranch_scc1 L_99
  s_lshl_b32 s3, s2, 7
  s_add_u32 s3, s3, 58228736
  v_mov_b32 v21, 1
  s_mov_b64 exec, 1
  buffer_store_dword v21, off, s[20:23], s3 sc1
  s_mov_b64 exec, -1
L_99:
  s_add_u32 s70, s77, 8192
  buffer_load_dwordx4 a[32:35], v2, s[20:23], s70 offen
  s_add_u32 s70, s77, 9216
  buffer_load_dwordx4 a[36:39], v2, s[20:23], s70 offen
  s_add_u32 s70, s77, 10240
  buffer_load_dwordx4 a[40:43], v2, s[20:23], s70 offen
  s_add_u32 s70, s77, 11264
  buffer_load_dwordx4 a[44:47], v2, s[20:23], s70 offen
  s_add_u32 s70, s77, 12288
  buffer_load_dwordx4 a[48:51], v2, s[20:23], s70 offen
  s_add_u32 s70, s77, 13312
  buffer_load_dwordx4 a[52:55], v2, s[20:23], s70 offen
  s_add_u32 s70, s77, 14336
  buffer_load_dwordx4 a[56:59], v2, s[20:23], s70 offen
  s_add_u32 s70, s77, 15360
  buffer_load_dwordx4 a[60:63], v2, s[20:23], s70 offen
  s_add_u32 s70, s77, 16384
  buffer_load_dwordx4 a[64:67], v2, s[20:23], s70 offen
  s_add_u32 s70, s77, 17408
  buffer_load_dwordx4 a[68:71], v2, s[20:23], s70 offen
  s_add_u32 s70, s77, 18432
  buffer_load_dwordx4 a[72:75], v2, s[20:23], s70 offen
  s_add_u32 s70, s77, 19456
  buffer_load_dwordx4 a[76:79], v2, s[20:23], s70 offen
  s_add_u32 s70, s77, 20480
  buffer_load_dwordx4 a[80:83], v2, s[20:23], s70 offen
  s_add_u32 s70, s77, 21504
  buffer_load_dwordx4 a[84:87], v2, s[20:23], s70 offen
  s_add_u32 s70, s77, 22528
  buffer_load_dwordx4 a[88:91], v2, s[20:23], s70 offen
  s_add_u32 s70, s77, 23552
  buffer_load_dwordx4 a[92:95], v2, s[20:23], s70 offen
  s_add_u32 s70, s77, 24576
  buffer_load_dwordx4 a[96:99], v2, s[20:23], s70 offen
  s_add_u32 s70, s77, 25600
  buffer_load_dwordx4 a[100:103], v2, s[20:23], s70 offen
  s_add_u32 s70, s77, 26624
  buffer_load_dwordx4 a[104:107], v2, s[20:23], s70 offen
  s_add_u32 s70, s77, 27648
  buffer_load_dwordx4 a[108:111], v2, s[20:23], s70 offen
  s_add_u32 s70, s77, 28672
  buffer_load_dwordx4 a[112:115], v2, s[20:23], s70 offen
  s_add_u32 s70, s77, 29696
  buffer_load_dwordx4 a[116:119], v2, s[20:23], s70 offen
  s_add_u32 s70, s77, 30720
  buffer_load_dwordx4 a[120:123], v2, s[20:23], s70 offen
  s_add_u32 s70, s77, 31744
  buffer_load_dwordx4 a[124:127], v2, s[20:23], s70 offen
  s_add_u32 s70, s77, 32768
  buffer_load_dwordx4 a[128:131], v2, s[20:23], s70 offen
  s_add_u32 s70, s77, 33792
  buffer_load_dwordx4 a[132:135], v2, s[20:23], s70 offen
  s_branch L_djoin
L_dmod:
  s_add_u32 s70, s77, 0
  buffer_load_dwordx4 a[0:3], v2, s[20:23], s70 offen
  v_and_b32 v24, v24, v25
  v_and_b32 v26, v26, v27
  v_and_b32 v24, v24, v26
  v_and_b32 v24, 1, v24
  v_cmp_ne_u32 vcc, 1, v24
  s_cbranch_vccnz L_spin_100
L_back_101:
  v_lshrrev_b32 v34, 5, v1
  v_mul_u32_u24 v34, 663552, v34
  v_and_b32 v35, 31, v1
  v_lshl_add_u32 v34, v35, 2, v34
  s_mul_i32 s71, s34, 165888
  s_lshl_b32 s72, s33, 7
  s_add_u32 s71, s71, s72
  s_add_u32 s71, s71, 65011712
  buffer_load_dword v40, v34, s[20:23], s71 offen sc1
  s_add_u32 s71, s71, 18432
  buffer_load_dword v41, v34, s[20:23], s71 offen sc1
  s_add_u32 s71, s71, 18432
  buffer_load_dword v42, v34, s[20:23], s71 offen sc1
  s_add_u32 s71, s71, 18432
  buffer_load_dword v43, v34, s[20:23], s71 offen sc1
  s_add_u32 s71, s71, 18432
  buffer_load_dword v44, v34, s[20:23], s71 offen sc1
  s_add_u32 s71, s71, 18432
  buffer_load_dword v45, v34, s[20:23], s71 offen sc1
  s_add_u32 s71, s71, 18432
  buffer_load_dword v46, v34, s[20:23], s71 offen sc1
  s_add_u32 s71, s71, 18432
  buffer_load_dword v47, v34, s[20:23], s71 offen sc1
  s_add_u32 s71, s71, 18432
  buffer_load_dword v48, v34, s[20:23], s71 offen sc1
  s_add_u32 s71, s71, 18432
  s_add_u32 s70, s77, 1024
  buffer_load_dwordx4 a[4:7], v2, s[20:23], s70 offen
  v_and_b32 v32, 15, v1
  v_lshrrev_b32 v33, 4, v1
  v_lshlrev_b32 v35, 2, v1
  v_add_u32 v35, 151552, v35
  s_lshl_b32 s71, s34, 8
  v_add_u32 v34, s71, v35
  s_add_u32 s70, s77, 2048
  buffer_load_dwordx4 a[8:11], v2, s[20:23], s70 offen
  s_add_u32 s70, s77, 3072
  buffer_load_dwordx4 a[12:15], v2, s[20:23], s70 offen
  s_add_u32 s70, s77, 4096
  buffer_load_dwordx4 a[16:19], v2, s[20:23], s70 offen
  s_add_u32 s70, s77, 5120
  buffer_load_dwordx4 a[20:23], v2, s[20:23], s70 offen
  s_add_u32 s70, s77, 6144
  buffer_load_dwordx4 a[24:27], v2, s[20:23], s70 offen
  s_add_u32 s70, s77, 7168
  buffer_load_dwordx4 a[28:31], v2, s[20:23], s70 offen
  s_waitcnt vmcnt(17)
  s_barrier
  s_cmp_lg_u32 s34, 0
  s_cbranch_scc1 L_103
  s_lshl_b32 s3, s2, 7
  s_add_u32 s3, s3, 58228736
  v_mov_b32 v21, 1
  s_mov_b64 exec, 1
  buffer_store_dword v21, off, s[20:23], s3 sc1
  s_mov_b64 exec, -1
L_103:
  s_add_u32 s70, s77, 8192
  buffer_load_dwordx4 a[32:35], v2, s[20:23], s70 offen
  s_add_u32 s70, s77, 9216
  buffer_load_dwordx4 a[36:39], v2, s[20:23], s70 offen
  s_add_u32 s70, s77, 10240
  buffer_load_dwordx4 a[40:43], v2, s[20:23], s70 offen
  s_waitcnt vmcnt(10)
  v_add_f32 v40, v40, v41
  v_add_f32 v42, v42, v43
  v_add_f32 v44, v44, v45
  v_add_f32 v46, v46, v47
  v_add_f32 v40, v40, v42
  v_add_f32 v44, v44, v46
  v_add_f32 v40, v40, v48
  v_add_f32 v40, v40, v44
  ds_write_b32 v34, v40
  s_add_u32 s70, s77, 11264
  buffer_load_dwordx4 a[44:47], v2, s[20:23], s70 offen
  s_waitcnt lgkmcnt(0)
  s_barrier
  ds_read_b32 v68, v35 offset:0
  ds_read_b32 v69, v35 offset:256
  ds_read_b32 v70, v35 offset:512
  ds_read_b32 v71, v35 offset:768
  s_add_u32 s70, s77, 12288
  buffer_load_dwordx4 a[48:51], v2, s[20:23], s70 offen
  s_add_u32 s70, s77, 13312
  buffer_load_dwordx4 a[52:55], v2, s[20:23], s70 offen
  s_waitcnt lgkmcnt(0)
  v_add_f32 v68, v68, v69
  v_add_f32 v70, v70, v71
  v_add_f32 v68, v68, v70
  v_cvt_pk_bf16_f32 v68, v68, v68
  v_and_b32 v68, 0xffff0000, v68
  v_mov_b32 v69, v68
  s_nop 1
  v_permlane32_swap_b32 v68, v69
  s_add_u32 s70, s77, 14336
  buffer_load_dwordx4 a[56:59], v2, s[20:23], s70 offen
  v_mul_f32 v70, 0xbfb8aa3b, v68
  v_exp_f32 v70, v70
  s_nop 0
  v_add_f32 v70, 1.0, v70
  v_rcp_f32 v70, v70
  s_nop 0
  v_mul_f32 v70, v68, v70
  v_cvt_pk_bf16_f32 v70, v70, v70
  v_and_b32 v70, 0xffff0000, v70
  v_mul_f32 v70, v70, v69
  v_cvt_pk_bf16_f32 v70, v70, v70
  v_lshrrev_b32 v34, 3, v32
  v_lshl_add_u32 v34, v34, 2, v33
  v_lshlrev_b32 v34, 2, v34
  ds_bpermute_b32 v72, v34, v70 offset:0
  ds_bpermute_b32 v73, v34, v70 offset:32
  ds_bpermute_b32 v74, v34, v70 offset:64
  ds_bpermute_b32 v75, v34, v70 offset:96
  s_add_u32 s70, s77, 15360
  buffer_load_dwordx4 a[60:63], v2, s[20:23], s70 offen
  s_add_u32 s70, s77, 16384
  buffer_load_dwordx4 a[64:67], v2, s[20:23], s70 offen
  s_waitcnt lgkmcnt(0)
  v_and_b32 v56, v72, v120
  v_and_b32 v57, v72, v121
  v_and_b32 v58, v72, v122
  v_and_b32 v59, v72, v123
  s_nop 1
  v_mfma_f32_16x16x32_bf16 v[76:79], v[56:59], a[216:219], 0
  v_mfma_f32_16x16x32_bf16 v[80:83], v[56:59], a[220:223], 0
  v_mfma_f32_16x16x32_bf16 v[84:87], v[56:59], a[200:203], 0
  s_add_u32 s70, s77, 17408
  buffer_load_dwordx4 a[68:71], v2, s[20:23], s70 offen
  v_and_b32 v60, v73, v120
  v_and_b32 v61, v73, v121
  v_and_b32 v62, v73, v122
  v_and_b32 v63, v73, v123
  s_nop 1
  v_mfma_f32_16x16x32_bf16 v[76:79], v[60:63], a[224:227], v[76:79]
  v_mfma_f32_16x16x32_bf16 v[80:83], v[60:63], a[228:231], v[80:83]
  v_mfma_f32_16x16x32_bf16 v[84:87], v[60:63], a[204:207], v[84:87]
  s_add_u32 s70, s77, 18432
  buffer_load_dwordx4 a[72:75], v2, s[20:23], s70 offen
  v_and_b32 v56, v74, v120
  v_and_b32 v57, v74, v121
  v_and_b32 v58, v74, v122
  v_and_b32 v59, v74, v123
  s_nop 1
  v_mfma_f32_16x16x32_bf16 v[76:79], v[56:59], a[232:235], v[76:79]
  v_mfma_f32_16x16x32_bf16 v[80:83], v[56:59], a[236:239], v[80:83]
  v_mfma_f32_16x16x32_bf16 v[84:87], v[56:59], a[208:211], v[84:87]
  s_add_u32 s70, s77, 19456
  buffer_load_dwordx4 a[76:79], v2, s[20:23], s70 offen
  v_and_b32 v60, v75, v120
  v_and_b32 v61, v75, v121
  v_and_b32 v62, v75, v122
  v_and_b32 v63, v75, v123
  s_nop 1
  v_mfma_f32_16x16x32_bf16 v[76:79], v[60:63], a[240:243], v[76:79]
  v_mfma_f32_16x16x32_bf16 v[80:83], v[60:63], a[244:247], v[80:83]
  v_mfma_f32_16x16x32_bf16 v[84:87], v[60:63], a[212:215], v[84:87]
  s_add_u32 s70, s77, 20480
  buffer_load_dwordx4 a[80:83], v2, s[20:23], s70 offen
  v_lshlrev_b32 v34, 5, v32
  v_lshl_add_u32 v34, v33, 4, v34
  s_mul_i32 s72, s33, 2304
  s_add_u32 s72, s72, 57737216
  s_lshl_b32 s71, s34, 8
  s_add_u32 s71, s71, s72
  s_nop 2
  v_permlane32_swap_b32 v76, v88
  v_permlane32_swap_b32 v77, v89
  v_permlane32_swap_b32 v78, v90
  v_permlane32_swap_b32 v79, v91
  v_permlane32_swap_b32 v80, v92
  v_permlane32_swap_b32 v81, v93
  v_permlane32_swap_b32 v82, v94
  v_permlane32_swap_b32 v83, v95
  v_permlane32_swap_b32 v84, v96
  v_permlane32_swap_b32 v85, v97
  v_permlane32_swap_b32 v86, v98
  v_permlane32_swap_b32 v87, v99
  s_add_u32 s70, s77, 21504
  buffer_load_dwordx4 a[84:87], v2, s[20:23], s70 offen
  s_nop 1
  v_add_f32_dpp v76, v88, v76 row_ror:8 row_mask:0xf bank_mask:0xf
  v_add_f32_dpp v77, v89, v77 row_ror:8 row_mask:0xf bank_mask:0xf
  v_add_f32_dpp v78, v90, v78 row_ror:8 row_mask:0xf bank_mask:0xf
  v_add_f32_dpp v79, v91, v79 row_ror:8 row_mask:0xf bank_mask:0xf
  v_add_f32_dpp v80, v92, v80 row_ror:8 row_mask:0xf bank_mask:0xf
  v_add_f32_dpp v81, v93, v81 row_ror:8 row_mask:0xf bank_mask:0xf
  v_add_f32_dpp v82, v94, v82 row_ror:8 row_mask:0xf bank_mask:0xf
  v_add_f32_dpp v83, v95, v83 row_ror:8 row_mask:0xf bank_mask:0xf
  v_add_f32_dpp v84, v96, v84 row_ror:8 row_mask:0xf bank_mask:0xf
  v_add_f32_dpp v85, v97, v85 row_ror:8 row_mask:0xf bank_mask:0xf
  v_add_f32_dpp v86, v98, v86 row_ror:8 row_mask:0xf bank_mask:0xf
  v_add_f32_dpp v87, v99, v87 row_ror:8 row_mask:0xf bank_mask:0xf
  s_mov_b32 exec_lo, 0x00ff00ff
  s_mov_b32 exec_hi, 0
  s_cmp_lg_u32 s34, 1
  s_cbranch_scc1 L_102
  buffer_store_dwordx4 v[84:87], v34, s[20:23], s72 offen offset:2048 sc1
L_102:
  buffer_store_dwordx4 v[76:79], v34, s[20:23], s71 offen sc1
  buffer_store_dwordx4 v[80:83], v34, s[20:23], s71 offen offset:1024 sc1
  s_mov_b64 exec, -1
  s_add_u32 s70, s77, 22528
  buffer_load_dwordx4 a[88:91], v2, s[20:23], s70 offen
  s_add_u32 s70, s77, 23552
  buffer_load_dwordx4 a[92:95], v2, s[20:23], s70 offen
  s_add_u32 s70, s77, 24576
  buffer_load_dwordx4 a[96:99], v2, s[20:23], s70 offen
  s_add_u32 s70, s77, 25600
  buffer_load_dwordx4 a[100:103], v2, s[20:23], s70 offen
  s_add_u32 s70, s77, 26624
  buffer_load_dwordx4 a[104:107], v2, s[20:23], s70 offen
  s_add_u32 s70, s77, 27648
  buffer_load_dwordx4 a[108:111], v2, s[20:23], s70 offen
  s_add_u32 s70, s77, 28672
  buffer_load_dwordx4 a[112:115], v2, s[20:23], s70 offen
  s_add_u32 s70, s77, 29696
  buffer_load_dwordx4 a[116:119], v2, s[20:23], s70 offen
  s_add_u32 s70, s77, 30720
  buffer_load_dwordx4 a[120:123], v2, s[20:23], s70 offen
  s_add_u32 s70, s77, 31744
  buffer_load_dwordx4 a[124:127], v2, s[20:23], s70 offen
  s_add_u32 s70, s77, 32768
  buffer_load_dwordx4 a[128:131], v2, s[20:23], s70 offen
  s_add_u32 s70, s77, 33792
  buffer_load_dwordx4 a[132:135], v2, s[20:23], s70 offen
L_djoin:
  s_mov_b32 s24, s64
  s_mov_b32 s25, s65
  s_mov_b32 s26, 2359296
  s_mov_b32 s27, 0x20000
  s_lshl_b32 s70, s79, 2
  s_add_u32 s70, s70, s34
  s_lshl_b32 s70, s70, 4
  v_and_b32 v21, 15, v1
  v_add_u32 v21, s70, v21
  v_mul_u32_u24 v6, 1152, v21
  s_mul_i32 s71, s32, 144
  v_add_u32 v6, s71, v6
  v_lshrrev_b32 v22, 4, v1
  v_lshl_add_u32 v6, v22, 3, v6
  v_lshlrev_b32 v7, 2, v21
  s_add_u32 s70, s34, 1
  s_and_b32 s70, s70, 3
  s_mul_i32 s70, s70, 15360
  s_add_u32 s70, s70, 0
  v_add_u32 v3, s70, v2
  s_add_u32 s70, s34, 2
  s_and_b32 s70, s70, 3
  s_mul_i32 s70, s70, 15360
  s_add_u32 s70, s70, 5120
  v_add_u32 v4, s70, v2
  s_add_u32 s70, s34, 3
  s_and_b32 s70, s70, 3
  s_mul_i32 s70, s70, 15360
  s_add_u32 s70, s70, 10240
  v_add_u32 v5, s70, v2
  s_mul_i32 s70, s34, 15360
  v_add_u32 v18, s70, v2
  s_add_u32 s70, s77, 34816
  buffer_load_dwordx4 a[136:139], v2, s[20:23], s70 offen
  s_add_u32 s70, s77, 35840
  buffer_load_dwordx4 a[140:143], v2, s[20:23], s70 offen
  s_add_u32 s70, s77, 36864
  buffer_load_dwordx4 a[144:147], v2, s[20:23], s70 offen
  s_add_u32 s70, s77, 37888
  buffer_load_dwordx4 a[148:151], v2, s[20:23], s70 offen
  s_add_u32 s70, s77, 38912
  buffer_load_dwordx4 a[152:155], v2, s[20:23], s70 offen
  s_add_u32 s70, s77, 39936
  buffer_load_dwordx4 a[156:159], v2, s[20:23], s70 offen
  s_add_u32 s70, s77, 40960
  buffer_load_dwordx4 a[160:163], v2, s[20:23], s70 offen
  s_add_u32 s70, s77, 41984
  buffer_load_dwordx4 a[164:167], v2, s[20:23], s70 offen
  s_add_u32 s70, s77, 43008
  buffer_load_dwordx4 a[168:171], v2, s[20:23], s70 offen
  s_add_u32 s70, s77, 44032
  buffer_load_dwordx4 a[172:175], v2, s[20:23], s70 offen
  s_add_u32 s70, s77, 45056
  buffer_load_dwordx4 a[176:179], v2, s[20:23], s70 offen
  s_add_u32 s70, s77, 46080
  buffer_load_dwordx4 a[180:183], v2, s[20:23], s70 offen
  s_add_u32 s70, s77, 47104
  buffer_load_dwordx4 a[184:187], v2, s[20:23], s70 offen
  s_add_u32 s70, s77, 48128
  buffer_load_dwordx4 a[188:191], v2, s[20:23], s70 offen
  s_add_u32 s70, s77, 49152
  buffer_load_dwordx4 a[192:195], v2, s[20:23], s70 offen
  s_add_u32 s70, s77, 50176
  buffer_load_dwordx4 a[196:199], v2, s[20:23], s70 offen
  s_add_u32 s70, s77, 51200
  buffer_load_dwordx4 a[200:203], v2, s[20:23], s70 offen
  s_add_u32 s70, s77, 52224
  buffer_load_dwordx4 a[204:207], v2, s[20:23], s70 offen
  s_add_u32 s70, s77, 53248
  buffer_load_dwordx4 a[208:211], v2, s[20:23], s70 offen
  s_add_u32 s70, s77, 54272
  buffer_load_dwordx4 a[212:215], v2, s[20:23], s70 offen
  s_add_u32 s70, s77, 55296
  buffer_load_dwordx4 a[216:219], v2, s[20:23], s70 offen
  s_add_u32 s70, s77, 56320
  buffer_load_dwordx4 a[220:223], v2, s[20:23], s70 offen
  s_add_u32 s70, s77, 57344
  buffer_load_dwordx4 a[224:227], v2, s[20:23], s70 offen
  s_add_u32 s70, s77, 58368
  buffer_load_dwordx4 a[228:231], v2, s[20:23], s70 offen
  s_add_u32 s70, s77, 59392
  buffer_load_dwordx4 a[232:235], v2, s[20:23], s70 offen
  s_add_u32 s70, s77, 60416
  buffer_load_dwordx4 a[236:239], v2, s[20:23], s70 offen
  s_lshr_b32 s70, s79, 1
  s_sub_u32 s71, 15, s70
  s_min_u32 s70, s70, s71
  s_lshl_b32 s70, s70, 12
  v_and_b32 v29, 31, v1
  v_lshlrev_b32 v29, 7, v29
  v_add_u32 v29, s70, v29
  s_cmp_lg_u32 s34, 0
  s_cbranch_scc1 L_104
  s_mov_b32 s72, 58228736
  buffer_load_dword v24, v29, s[20:23], s72 offen sc1
L_104:
  s_add_u32 s70, s77, 61440
  buffer_load_dwordx4 a[240:243], v2, s[20:23], s70 offen
  s_add_u32 s70, s77, 62464
  buffer_load_dwordx4 a[244:247], v2, s[20:23], s70 offen
  s_add_u32 s70, s77, 63488
  buffer_load_dwordx4 a[248:251], v2, s[20:23], s70 offen
  s_add_u32 s70, s77, 64512
  buffer_load_dwordx4 a[252:255], v2, s[20:23], s70 offen
  s_add_u32 s70, s77, 65536
  buffer_load_dwordx4 v[224:227], v2, s[20:23], s70 offen
  s_add_u32 s70, s77, 66560
  buffer_load_dwordx4 v[228:231], v2, s[20:23], s70 offen
  s_add_u32 s70, s77, 67584
  buffer_load_dwordx4 v[232:235], v2, s[20:23], s70 offen
  s_add_u32 s70, s77, 68608
  buffer_load_dwordx4 v[236:239], v2, s[20:23], s70 offen
  s_add_u32 s70, s77, 69632
  buffer_load_dwordx4 v[240:243], v2, s[20:23], s70 offen
  s_add_u32 s70, s77, 70656
  buffer_load_dwordx4 v[244:247], v2, s[20:23], s70 offen
  s_add_u32 s70, s77, 71680
  buffer_load_dwordx4 v[248:251], v2, s[20:23], s70 offen
  s_add_u32 s70, s77, 72704
  buffer_load_dwordx4 v[252:255], v2, s[20:23], s70 offen
  s_waitcnt vmcnt(12)
  s_cmp_lt_u32 s33, 144
  s_cbranch_scc0 L_105
  s_barrier
  s_cmp_lg_u32 s34, 0
  s_cbranch_scc1 L_106
  s_lshl_b32 s3, s2, 7
  s_add_u32 s3, s3, 58228736
  v_mov_b32 v21, 3
  s_mov_b64 exec, 1
  buffer_store_dword v21, off, s[20:23], s3 sc1
  s_mov_b64 exec, -1
L_106:
L_105:
  s_cmp_lg_u32 s34, 0
  s_cbranch_scc1 L_107
  v_and_b32 v24, 1, v24
  v_cmp_ne_u32 vcc, 1, v24
  s_cbranch_vccnz L_spin_108
L_back_109:
L_107:
  s_barrier
  s_add_u32 s70, s76, 0
  buffer_load_dwordx4 v[128:131], v2, s[20:23], s70 offen
  s_add_u32 s70, s74, 0
  buffer_load_dwordx4 v[132:135], v2, s[20:23], s70 offen
  s_add_u32 s70, s75, 0
  buffer_load_dwordx4 v[136:139], v2, s[20:23], s70 offen
  s_add_u32 s70, s78, 0
  buffer_load_dwordx4 v[140:143], v2, s[20:23], s70 offen
  s_add_u32 s70, s76, 2048
  buffer_load_dwordx4 v[144:147], v2, s[20:23], s70 offen
  s_add_u32 s70, s74, 2048
  buffer_load_dwordx4 v[148:151], v2, s[20:23], s70 offen
  s_add_u32 s70, s75, 2048
  buffer_load_dwordx4 v[152:155], v2, s[20:23], s70 offen
  s_add_u32 s70, s78, 2048
  buffer_load_dwordx4 v[156:159], v2, s[20:23], s70 offen
  s_add_u32 s70, s76, 4096
  buffer_load_dwordx4 v[160:163], v2, s[20:23], s70 offen
  s_add_u32 s70, s74, 4096
  buffer_load_dwordx4 v[164:167], v2, s[20:23], s70 offen
  s_add_u32 s70, s75, 4096
  buffer_load_dwordx4 v[168:171], v2, s[20:23], s70 offen
  s_add_u32 s70, s78, 4096
  buffer_load_dwordx4 v[172:175], v2, s[20:23], s70 offen
  s_add_u32 s70, s76, 6144
  buffer_load_dwordx4 v[176:179], v2, s[20:23], s70 offen
  s_add_u32 s70, s74, 6144
  buffer_load_dwordx4 v[180:183], v2, s[20:23], s70 offen
  s_add_u32 s70, s75, 6144
  buffer_load_dwordx4 v[184:187], v2, s[20:23], s70 offen
  s_add_u32 s70, s78, 6144
  buffer_load_dwordx4 v[188:191], v2, s[20:23], s70 offen
  s_waitcnt vmcnt(8)
  v_mfma_f32_16x16x32_bf16 v[32:35], a[0:3], v[128:131], 0
  s_add_u32 s70, s76, 8192
  v_mfma_f32_16x16x32_bf16 v[32:35], a[16:19], v[144:147], v[32:35]
  buffer_load_dwordx4 v[192:195], v2, s[20:23], s70 offen
  v_mfma_f32_16x16x32_bf16 v[56:59], a[16:19], v[148:151], 0
  v_mfma_f32_16x16x32_bf16 v[56:59], a[0:3], v[132:135], v[56:59]
  v_mfma_f32_16x16x32_bf16 v[80:83], a[0:3], v[136:139], 0
  s_add_u32 s70, s74, 8192
  v_mfma_f32_16x16x32_bf16 v[80:83], a[16:19], v[152:155], v[80:83]
  buffer_load_dwordx4 v[196:199], v2, s[20:23], s70 offen
  v_mfma_f32_16x16x32_bf16 v[104:107], a[16:19], v[156:159], 0
  v_mfma_f32_16x16x32_bf16 v[104:107], a[0:3], v[140:143], v[104:107]
  v_mfma_f32_16x16x32_bf16 v[108:111], a[4:7], v[140:143], 0
  s_add_u32 s70, s75, 8192
  v_mfma_f32_16x16x32_bf16 v[108:111], a[20:23], v[156:159], v[108:111]
  buffer_load_dwordx4 v[200:203], v2, s[20:23], s70 offen
  v_mfma_f32_16x16x32_bf16 v[84:87], a[20:23], v[152:155], 0
  v_mfma_f32_16x16x32_bf16 v[84:87], a[4:7], v[136:139], v[84:87]
  v_mfma_f32_16x16x32_bf16 v[60:63], a[4:7], v[132:135], 0
  s_add_u32 s70, s78, 8192
  v_mfma_f32_16x16x32_bf16 v[60:63], a[20:23], v[148:151], v[60:63]
  buffer_load_dwordx4 v[204:207], v2, s[20:23], s70 offen
  v_mfma_f32_16x16x32_bf16 v[36:39], a[20:23], v[144:147], 0
  v_mfma_f32_16x16x32_bf16 v[36:39], a[4:7], v[128:131], v[36:39]
  v_mfma_f32_16x16x32_bf16 v[40:43], a[8:11], v[128:131], 0
  s_add_u32 s70, s76, 10240
  v_mfma_f32_16x16x32_bf16 v[40:43], a[24:27], v[144:147], v[40:43]
  buffer_load_dwordx4 v[208:211], v2, s[20:23], s70 offen
  v_mfma_f32_16x16x32_bf16 v[64:67], a[24:27], v[148:151], 0
  v_mfma_f32_16x16x32_bf16 v[64:67], a[8:11], v[132:135], v[64:67]
  v_mfma_f32_16x16x32_bf16 v[88:91], a[8:11], v[136:139], 0
  s_add_u32 s70, s74, 10240
  v_mfma_f32_16x16x32_bf16 v[88:91], a[24:27], v[152:155], v[88:91]
  buffer_load_dwordx4 v[212:215], v2, s[20:23], s70 offen
  v_mfma_f32_16x16x32_bf16 v[112:115], a[24:27], v[156:159], 0
  v_mfma_f32_16x16x32_bf16 v[112:115], a[8:11], v[140:143], v[112:115]
  v_mfma_f32_16x16x32_bf16 v[116:119], a[12:15], v[140:143], 0
  s_add_u32 s70, s75, 10240
  v_mfma_f32_16x16x32_bf16 v[116:119], a[28:31], v[156:159], v[116:119]
  buffer_load_dwordx4 v[216:219], v2, s[20:23], s70 offen
  v_mfma_f32_16x16x32_bf16 v[92:95], a[28:31], v[152:155], 0
  v_mfma_f32_16x16x32_bf16 v[92:95], a[12:15], v[136:139], v[92:95]
  v_mfma_f32_16x16x32_bf16 v[68:71], a[12:15], v[132:135], 0
  s_add_u32 s70, s78, 10240
  v_mfma_f32_16x16x32_bf16 v[68:71], a[28:31], v[148:151], v[68:71]
  buffer_load_dwordx4 v[220:223], v2, s[20:23], s70 offen
  v_mfma_f32_16x16x32_bf16 v[44:47], a[28:31], v[144:147], 0
  v_mfma_f32_16x16x32_bf16 v[44:47], a[12:15], v[128:131], v[44:47]
  v_mfma_f32_16x16x32_bf16 v[48:51], a[32:35], v[128:131], 0
  v_mfma_f32_16x16x32_bf16 v[52:55], a[32:35], v[144:147], 0
  v_mfma_f32_16x16x32_bf16 v[76:79], a[32:35], v[148:151], 0
  v_mfma_f32_16x16x32_bf16 v[72:75], a[32:35], v[132:135], 0
  v_mfma_f32_16x16x32_bf16 v[96:99], a[32:35], v[136:139], 0
  v_mfma_f32_16x16x32_bf16 v[100:103], a[32:35], v[152:155], 0
  v_mfma_f32_16x16x32_bf16 v[124:127], a[32:35], v[156:159], 0
  v_mfma_f32_16x16x32_bf16 v[120:123], a[32:35], v[140:143], 0
  s_waitcnt vmcnt(8)
  v_mfma_f32_16x16x32_bf16 v[32:35], a[36:39], v[160:163], v[32:35]
  s_add_u32 s70, s76, 12288
  v_mfma_f32_16x16x32_bf16 v[32:35], a[52:55], v[176:179], v[32:35]
  buffer_load_dwordx4 v[128:131], v2, s[20:23], s70 offen
  v_mfma_f32_16x16x32_bf16 v[56:59], a[52:55], v[180:183], v[56:59]
  s_add_u32 s70, s74, 12288
  v_mfma_f32_16x16x32_bf16 v[56:59], a[36:39], v[164:167], v[56:59]
  buffer_load_dwordx4 v[132:135], v2, s[20:23], s70 offen
  v_mfma_f32_16x16x32_bf16 v[80:83], a[36:39], v[168:171], v[80:83]
  s_add_u32 s70, s75, 12288
  v_mfma_f32_16x16x32_bf16 v[80:83], a[52:55], v[184:187], v[80:83]
  buffer_load_dwordx4 v[136:139], v2, s[20:23], s70 offen
  v_mfma_f32_16x16x32_bf16 v[104:107], a[52:55], v[188:191], v[104:107]
  s_add_u32 s70, s78, 12288
  v_mfma_f32_16x16x32_bf16 v[104:107], a[36:39], v[172:175], v[104:107]
  buffer_load_dwordx4 v[140:143], v2, s[20:23], s70 offen
  v_mfma_f32_16x16x32_bf16 v[108:111], a[40:43], v[172:175], v[108:111]
  s_add_u32 s70, s76, 14336
  v_mfma_f32_16x16x32_bf16 v[108:111], a[56:59], v[188:191], v[108:111]
  buffer_load_dwordx4 v[144:147], v2, s[20:23], s70 offen
  v_mfma_f32_16x16x32_bf16 v[84:87], a[56:59], v[184:187], v[84:87]
  s_add_u32 s70, s74, 14336
  v_mfma_f32_16x16x32_bf16 v[84:87], a[40:43], v[168:171], v[84:87]
  buffer_load_dwordx4 v[148:151], v2, s[20:23], s70 offen
  v_mfma_f32_16x16x32_bf16 v[60:63], a[40:43], v[164:167], v[60:63]
  s_add_u32 s70, s75, 14336
  v_mfma_f32_16x16x32_bf16 v[60:63], a[56:59], v[180:183], v[60:63]
  buffer_load_dwordx4 v[152:155], v2, s[20:23], s70 offen
  v_mfma_f32_16x16x32_bf16 v[36:39], a[56:59], v[176:179], v[36:39]
  s_add_u32 s70, s78, 14336
  v_mfma_f32_16x16x32_bf16 v[36:39], a[40:43], v[160:163], v[36:39]
  buffer_load_dwordx4 v[156:159], v2, s[20:23], s70 offen
  v_mfma_f32_16x16x32_bf16 v[40:43], a[44:47], v[160:163], v[40:43]
  s_add_u32 s70, s77, 73728
  v_mfma_f32_16x16x32_bf16 v[40:43], a[60:63], v[176:179], v[40:43]
  buffer_load_dwordx4 a[0:3], v2, s[20:23], s70 offen
  v_mfma_f32_16x16x32_bf16 v[64:67], a[60:63], v[180:183], v[64:67]
  s_add_u32 s70, s77, 74752
  v_mfma_f32_16x16x32_bf16 v[64:67], a[44:47], v[164:167], v[64:67]
  buffer_load_dwordx4 a[4:7], v2, s[20:23], s70 offen
  v_mfma_f32_16x16x32_bf16 v[88:91], a[44:47], v[168:171], v[88:91]
  s_add_u32 s70, s77, 75776
  v_mfma_f32_16x16x32_bf16 v[88:91], a[60:63], v[184:187], v[88:91]
  buffer_load_dwordx4 a[8:11], v2, s[20:23], s70 offen
  v_mfma_f32_16x16x32_bf16 v[112:115], a[60:63], v[188:191], v[112:115]
  s_add_u32 s70, s77, 76800
  v_mfma_f32_16x16x32_bf16 v[112:115], a[44:47], v[172:175], v[112:115]
  buffer_load_dwordx4 a[12:15], v2, s[20:23], s70 offen
  v_mfma_f32_16x16x32_bf16 v[116:119], a[48:51], v[172:175], v[116:119]
  s_add_u32 s70, s77, 77824
  v_mfma_f32_16x16x32_bf16 v[116:119], a[64:67], v[188:191], v[116:119]
  buffer_load_dwordx4 a[16:19], v2, s[20:23], s70 offen
  v_mfma_f32_16x16x32_bf16 v[92:95], a[64:67], v[184:187], v[92:95]
  s_add_u32 s70, s77, 78848
  v_mfma_f32_16x16x32_bf16 v[92:95], a[48:51], v[168:171], v[92:95]
  buffer_load_dwordx4 a[20:23], v2, s[20:23], s70 offen
  v_mfma_f32_16x16x32_bf16 v[68:71], a[48:51], v[164:167], v[68:71]
  v_mfma_f32_16x16x32_bf16 v[68:71], a[64:67], v[180:183], v[68:71]
  v_mfma_f32_16x16x32_bf16 v[44:47], a[64:67], v[176:179], v[44:47]
  v_mfma_f32_16x16x32_bf16 v[44:47], a[48:51], v[160:163], v[44:47]
  v_mfma_f32_16x16x32_bf16 v[48:51], a[68:71], v[160:163], v[48:51]
  v_mfma_f32_16x16x32_bf16 v[52:55], a[68:71], v[176:179], v[52:55]
  v_mfma_f32_16x16x32_bf16 v[76:79], a[68:71], v[180:183], v[76:79]
  v_mfma_f32_16x16x32_bf16 v[72:75], a[68:71], v[164:167], v[72:75]
  v_mfma_f32_16x16x32_bf16 v[96:99], a[68:71], v[168:171], v[96:99]
  v_mfma_f32_16x16x32_bf16 v[100:103], a[68:71], v[184:187], v[100:103]
  v_mfma_f32_16x16x32_bf16 v[124:127], a[68:71], v[188:191], v[124:127]
  v_mfma_f32_16x16x32_bf16 v[120:123], a[68:71], v[172:175], v[120:123]
  s_waitcnt vmcnt(14)
  v_mfma_f32_16x16x32_bf16 v[32:35], a[72:75], v[192:195], v[32:35]
  s_add_u32 s70, s76, 16384
  v_mfma_f32_16x16x32_bf16 v[32:35], a[88:91], v[208:211], v[32:35]
  buffer_load_dwordx4 v[160:163], v2, s[20:23], s70 offen
  v_mfma_f32_16x16x32_bf16 v[56:59], a[88:91], v[212:215], v[56:59]
  s_add_u32 s70, s74, 16384
  v_mfma_f32_16x16x32_bf16 v[56:59], a[72:75], v[196:199], v[56:59]
  buffer_load_dwordx4 v[164:167], v2, s[20:23], s70 offen
  v_mfma_f32_16x16x32_bf16 v[80:83], a[72:75], v[200:203], v[80:83]
  s_add_u32 s70, s75, 16384
  v_mfma_f32_16x16x32_bf16 v[80:83], a[88:91], v[216:219], v[80:83]
  buffer_load_dwordx4 v[168:171], v2, s[20:23], s70 offen
  v_mfma_f32_16x16x32_bf16 v[104:107], a[88:91], v[220:223], v[104:107]
  s_add_u32 s70, s78, 16384
  v_mfma_f32_16x16x32_bf16 v[104:107], a[72:75], v[204:207], v[104:107]
  buffer_load_dwordx4 v[172:175], v2, s[20:23], s70 offen
  v_mfma_f32_16x16x32_bf16 v[108:111], a[76:79], v[204:207], v[108:111]
  s_add_u32 s70, s76, 18432
  v_mfma_f32_16x16x32_bf16 v[108:111], a[92:95], v[220:223], v[108:111]
  buffer_load_dwordx4 v[176:179], v2, s[20:23], s70 offen
  v_mfma_f32_16x16x32_bf16 v[84:87], a[92:95], v[216:219], v[84:87]
  s_add_u32 s70, s74, 18432
  v_mfma_f32_16x16x32_bf16 v[84:87], a[76:79], v[200:203], v[84:87]
  buffer_load_dwordx4 v[180:183], v2, s[20:23], s70 offen
  v_mfma_f32_16x16x32_bf16 v[60:63], a[76:79], v[196:199], v[60:63]
  s_add_u32 s70, s75, 18432
  v_mfma_f32_16x16x32_bf16 v[60:63], a[92:95], v[212:215], v[60:63]
  buffer_load_dwordx4 v[184:187], v2, s[20:23], s70 offen
  v_mfma_f32_16x16x32_bf16 v[36:39], a[92:95], v[208:211], v[36:39]
  s_add_u32 s70, s78, 18432
  v_mfma_f32_16x16x32_bf16 v[36:39], a[76:79], v[192:195], v[36:39]
  buffer_load_dwordx4 v[188:191], v2, s[20:23], s70 offen
  v_mfma_f32_16x16x32_bf16 v[40:43], a[80:83], v[192:195], v[40:43]
  s_add_u32 s70, s77, 79872
  v_mfma_f32_16x16x32_bf16 v[40:43], a[96:99], v[208:211], v[40:43]
  buffer_load_dwordx4 a[24:27], v2, s[20:23], s70 offen
  v_mfma_f32_16x16x32_bf16 v[64:67], a[96:99], v[212:215], v[64:67]
  s_add_u32 s70, s77, 80896
  v_mfma_f32_16x16x32_bf16 v[64:67], a[80:83], v[196:199], v[64:67]
  buffer_load_dwordx4 a[28:31], v2, s[20:23], s70 offen
  v_mfma_f32_16x16x32_bf16 v[88:91], a[80:83], v[200:203], v[88:91]
  s_add_u32 s70, s77, 81920
  v_mfma_f32_16x16x32_bf16 v[88:91], a[96:99], v[216:219], v[88:91]
  buffer_load_dwordx4 a[32:35], v2, s[20:23], s70 offen
  v_mfma_f32_16x16x32_bf16 v[112:115], a[96:99], v[220:223], v[112:115]
  s_add_u32 s70, s77, 82944
  v_mfma_f32_16x16x32_bf16 v[112:115], a[80:83], v[204:207], v[112:115]
  buffer_load_dwordx4 a[36:39], v2, s[20:23], s70 offen
  v_mfma_f32_16x16x32_bf16 v[116:119], a[84:87], v[204:207], v[116:119]
  s_add_u32 s70, s77, 83968
  v_mfma_f32_16x16x32_bf16 v[116:119], a[100:103], v[220:223], v[116:119]
  buffer_load_dwordx4 a[40:43], v2, s[20:23], s70 offen
  v_mfma_f32_16x16x32_bf16 v[92:95], a[100:103], v[216:219], v[92:95]
  s_add_u32 s70, s77, 84992
  v_mfma_f32_16x16x32_bf16 v[92:95], a[84:87], v[200:203], v[92:95]
  buffer_load_dwordx4 a[44:47], v2, s[20:23], s70 offen
  v_mfma_f32_16x16x32_bf16 v[68:71], a[84:87], v[196:199], v[68:71]
  v_mfma_f32_16x16x32_bf16 v[68:71], a[100:103], v[212:215], v[68:71]
  v_mfma_f32_16x16x32_bf16 v[44:47], a[100:103], v[208:211], v[44:47]
  v_mfma_f32_16x16x32_bf16 v[44:47], a[84:87], v[192:195], v[44:47]
  v_mfma_f32_16x16x32_bf16 v[48:51], a[104:107], v[192:195], v[48:51]
  v_mfma_f32_16x16x32_bf16 v[52:55], a[104:107], v[208:211], v[52:55]
  v_mfma_f32_16x16x32_bf16 v[76:79], a[104:107], v[212:215], v[76:79]
  v_mfma_f32_16x16x32_bf16 v[72:75], a[104:107], v[196:199], v[72:75]
  v_mfma_f32_16x16x32_bf16 v[96:99], a[104:107], v[200:203], v[96:99]
  v_mfma_f32_16x16x32_bf16 v[100:103], a[104:107], v[216:219], v[100:103]
  v_mfma_f32_16x16x32_bf16 v[124:127], a[104:107], v[220:223], v[124:127]
  v_mfma_f32_16x16x32_bf16 v[120:123], a[104:107], v[204:207], v[120:123]
  s_waitcnt vmcnt(20)
  v_mfma_f32_16x16x32_bf16 v[32:35], a[108:111], v[128:131], v[32:35]
  s_add_u32 s70, s76, 20480
  v_mfma_f32_16x16x32_bf16 v[32:35], a[124:127], v[144:147], v[32:35]
  buffer_load_dwordx4 v[192:195], v2, s[20:23], s70 offen
  v_mfma_f32_16x16x32_bf16 v[56:59], a[124:127], v[148:151], v[56:59]
  s_add_u32 s70, s74, 20480
  v_mfma_f32_16x16x32_bf16 v[56:59], a[108:111], v[132:135], v[56:59]
  buffer_load_dwordx4 v[196:199], v2, s[20:23], s70 offen
  v_mfma_f32_16x16x32_bf16 v[80:83], a[108:111], v[136:139], v[80:83]
  s_add_u32 s70, s75, 20480
  v_mfma_f32_16x16x32_bf16 v[80:83], a[124:127], v[152:155], v[80:83]
  buffer_load_dwordx4 v[200:203], v2, s[20:23], s70 offen
  v_mfma_f32_16x16x32_bf16 v[104:107], a[124:127], v[156:159], v[104:107]
  s_add_u32 s70, s78, 20480
  v_mfma_f32_16x16x32_bf16 v[104:107], a[108:111], v[140:143], v[104:107]
  buffer_load_dwordx4 v[204:207], v2, s[20:23], s70 offen
  v_mfma_f32_16x16x32_bf16 v[108:111], a[112:115], v[140:143], v[108:111]
  s_add_u32 s70, s76, 22528
  v_mfma_f32_16x16x32_bf16 v[108:111], a[128:131], v[156:159], v[108:111]
  buffer_load_dwordx4 v[208:211], v2, s[20:23], s70 offen
  v_mfma_f32_16x16x32_bf16 v[84:87], a[128:131], v[152:155], v[84:87]
  s_add_u32 s70, s74, 22528
  v_mfma_f32_16x16x32_bf16 v[84:87], a[112:115], v[136:139], v[84:87]
  buffer_load_dwordx4 v[212:215], v2, s[20:23], s70 offen
  v_mfma_f32_16x16x32_bf16 v[60:63], a[112:115], v[132:135], v[60:63]
  s_add_u32 s70, s75, 22528
  v_mfma_f32_16x16x32_bf16 v[60:63], a[128:131], v[148:151], v[60:63]
  buffer_load_dwordx4 v[216:219], v2, s[20:23], s70 offen
  v_mfma_f32_16x16x32_bf16 v[36:39], a[128:131], v[144:147], v[36:39]
  s_add_u32 s70, s78, 22528
  v_mfma_f32_16x16x32_bf16 v[36:39], a[112:115], v[128:131], v[36:39]
  buffer_load_dwordx4 v[220:223], v2, s[20:23], s70 offen
  v_mfma_f32_16x16x32_bf16 v[40:43], a[116:119], v[128:131], v[40:43]
  s_add_u32 s70, s77, 86016
  v_mfma_f32_16x16x32_bf16 v[40:43], a[132:135], v[144:147], v[40:43]
  buffer_load_dwordx4 a[48:51], v2, s[20:23], s70 offen
  v_mfma_f32_16x16x32_bf16 v[64:67], a[132:135], v[148:151], v[64:67]
  s_add_u32 s70, s77, 87040
  v_mfma_f32_16x16x32_bf16 v[64:67], a[116:119], v[132:135], v[64:67]
  buffer_load_dwordx4 a[52:55], v2, s[20:23], s70 offen
  v_mfma_f32_16x16x32_bf16 v[88:91], a[116:119], v[136:139], v[88:91]
  s_add_u32 s70, s77, 88064
  v_mfma_f32_16x16x32_bf16 v[88:91], a[132:135], v[152:155], v[88:91]
  buffer_load_dwordx4 a[56:59], v2, s[20:23], s70 offen
  v_mfma_f32_16x16x32_bf16 v[112:115], a[132:135], v[156:159], v[112:115]
  s_add_u32 s70, s77, 89088
  v_mfma_f32_16x16x32_bf16 v[112:115], a[116:119], v[140:143], v[112:115]
  buffer_load_dwordx4 a[60:63], v2, s[20:23], s70 offen
  v_mfma_f32_16x16x32_bf16 v[116:119], a[120:123], v[140:143], v[116:119]
  s_add_u32 s70, s77, 90112
  v_mfma_f32_16x16x32_bf16 v[116:119], a[136:139], v[156:159], v[116:119]
  buffer_load_dwordx4 a[64:67], v2, s[20:23], s70 offen
  v_mfma_f32_16x16x32_bf16 v[92:95], a[136:139], v[152:155], v[92:95]
  s_add_u32 s70, s77, 91136
  v_mfma_f32_16x16x32_bf16 v[92:95], a[120:123], v[136:139], v[92:95]
  buffer_load_dwordx4 a[68:71], v2, s[20:23], s70 offen
  v_mfma_f32_16x16x32_bf16 v[68:71], a[120:123], v[132:135], v[68:71]
  v_mfma_f32_16x16x32_bf16 v[68:71], a[136:139], v[148:151], v[68:71]
  v_mfma_f32_16x16x32_bf16 v[44:47], a[136:139], v[144:147], v[44:47]
  v_mfma_f32_16x16x32_bf16 v[44:47], a[120:123], v[128:131], v[44:47]
  v_mfma_f32_16x16x32_bf16 v[48:51], a[140:143], v[128:131], v[48:51]
  v_mfma_f32_16x16x32_bf16 v[52:55], a[140:143], v[144:147], v[52:55]
  v_mfma_f32_16x16x32_bf16 v[76:79], a[140:143], v[148:151], v[76:79]
  v_mfma_f32_16x16x32_bf16 v[72:75], a[140:143], v[132:135], v[72:75]
  v_mfma_f32_16x16x32_bf16 v[96:99], a[140:143], v[136:139], v[96:99]
  v_mfma_f32_16x16x32_bf16 v[100:103], a[140:143], v[152:155], v[100:103]
  v_mfma_f32_16x16x32_bf16 v[124:127], a[140:143], v[156:159], v[124:127]
  v_mfma_f32_16x16x32_bf16 v[120:123], a[140:143], v[140:143], v[120:123]
  s_waitcnt vmcnt(20)
  v_mfma_f32_16x16x32_bf16 v[32:35], a[144:147], v[160:163], v[32:35]
  s_add_u32 s70, s76, 24576
  v_mfma_f32_16x16x32_bf16 v[32:35], a[160:163], v[176:179], v[32:35]
  buffer_load_dwordx4 v[128:131], v2, s[20:23], s70 offen
  v_mfma_f32_16x16x32_bf16 v[56:59], a[160:163], v[180:183], v[56:59]
  s_add_u32 s70, s74, 24576
  v_mfma_f32_16x16x32_bf16 v[56:59], a[144:147], v[164:167], v[56:59]
  buffer_load_dwordx4 v[132:135], v2, s[20:23], s70 offen
  v_mfma_f32_16x16x32_bf16 v[80:83], a[144:147], v[168:171], v[80:83]
  s_add_u32 s70, s75, 24576
  v_mfma_f32_16x16x32_bf16 v[80:83], a[160:163], v[184:187], v[80:83]
  buffer_load_dwordx4 v[136:139], v2, s[20:23], s70 offen
  v_mfma_f32_16x16x32_bf16 v[104:107], a[160:163], v[188:191], v[104:107]
  s_add_u32 s70, s78, 24576
  v_mfma_f32_16x16x32_bf16 v[104:107], a[144:147], v[172:175], v[104:107]
  buffer_load_dwordx4 v[140:143], v2, s[20:23], s70 offen
  v_mfma_f32_16x16x32_bf16 v[108:111], a[148:151], v[172:175], v[108:111]
  s_add_u32 s70, s76, 26624
  v_mfma_f32_16x16x32_bf16 v[108:111], a[164:167], v[188:191], v[108:111]
  buffer_load_dwordx4 v[144:147], v2, s[20:23], s70 offen
  v_mfma_f32_16x16x32_bf16 v[84:87], a[164:167], v[184:187], v[84:87]
  s_add_u32 s70, s74, 26624
  v_mfma_f32_16x16x32_bf16 v[84:87], a[148:151], v[168:171], v[84:87]
  buffer_load_dwordx4 v[148:151], v2, s[20:23], s70 offen
  v_mfma_f32_16x16x32_bf16 v[60:63], a[148:151], v[164:167], v[60:63]
  s_add_u32 s70, s75, 26624
  v_mfma_f32_16x16x32_bf16 v[60:63], a[164:167], v[180:183], v[60:63]
  buffer_load_dwordx4 v[152:155], v2, s[20:23], s70 offen
  v_mfma_f32_16x16x32_bf16 v[36:39], a[164:167], v[176:179], v[36:39]
  s_add_u32 s70, s78, 26624
  v_mfma_f32_16x16x32_bf16 v[36:39], a[148:151], v[160:163], v[36:39]
  buffer_load_dwordx4 v[156:159], v2, s[20:23], s70 offen
  v_mfma_f32_16x16x32_bf16 v[40:43], a[152:155], v[160:163], v[40:43]
  s_add_u32 s70, s77, 92160
  v_mfma_f32_16x16x32_bf16 v[40:43], a[168:171], v[176:179], v[40:43]
  buffer_load_dwordx4 a[72:75], v2, s[20:23], s70 offen
  v_mfma_f32_16x16x32_bf16 v[64:67], a[168:171], v[180:183], v[64:67]
  s_add_u32 s70, s77, 93184
  v_mfma_f32_16x16x32_bf16 v[64:67], a[152:155], v[164:167], v[64:67]
  buffer_load_dwordx4 a[76:79], v2, s[20:23], s70 offen
  v_mfma_f32_16x16x32_bf16 v[88:91], a[152:155], v[168:171], v[88:91]
  s_add_u32 s70, s77, 94208
  v_mfma_f32_16x16x32_bf16 v[88:91], a[168:171], v[184:187], v[88:91]
  buffer_load_dwordx4 a[80:83], v2, s[20:23], s70 offen
  v_mfma_f32_16x16x32_bf16 v[112:115], a[168:171], v[188:191], v[112:115]
  s_add_u32 s70, s77, 95232
  v_mfma_f32_16x16x32_bf16 v[112:115], a[152:155], v[172:175], v[112:115]
  buffer_load_dwordx4 a[84:87], v2, s[20:23], s70 offen
  v_mfma_f32_16x16x32_bf16 v[116:119], a[156:159], v[172:175], v[116:119]
  s_add_u32 s70, s77, 96256
  v_mfma_f32_16x16x32_bf16 v[116:119], a[172:175], v[188:191], v[116:119]
  buffer_load_dwordx4 a[88:91], v2, s[20:23], s70 offen
  v_mfma_f32_16x16x32_bf16 v[92:95], a[172:175], v[184:187], v[92:95]
  s_add_u32 s70, s77, 97280
  v_mfma_f32_16x16x32_bf16 v[92:95], a[156:159], v[168:171], v[92:95]
  buffer_load_dwordx4 a[92:95], v2, s[20:23], s70 offen
  v_mfma_f32_16x16x32_bf16 v[68:71], a[156:159], v[164:167], v[68:71]
  v_mfma_f32_16x16x32_bf16 v[68:71], a[172:175], v[180:183], v[68:71]
  v_mfma_f32_16x16x32_bf16 v[44:47], a[172:175], v[176:179], v[44:47]
  v_mfma_f32_16x16x32_bf16 v[44:47], a[156:159], v[160:163], v[44:47]
  v_mfma_f32_16x16x32_bf16 v[48:51], a[176:179], v[160:163], v[48:51]
  v_mfma_f32_16x16x32_bf16 v[52:55], a[176:179], v[176:179], v[52:55]
  v_mfma_f32_16x16x32_bf16 v[76:79], a[176:179], v[180:183], v[76:79]
  v_mfma_f32_16x16x32_bf16 v[72:75], a[176:179], v[164:167], v[72:75]
  v_mfma_f32_16x16x32_bf16 v[96:99], a[176:179], v[168:171], v[96:99]
  v_mfma_f32_16x16x32_bf16 v[100:103], a[176:179], v[184:187], v[100:103]
  v_mfma_f32_16x16x32_bf16 v[124:127], a[176:179], v[188:191], v[124:127]
  v_mfma_f32_16x16x32_bf16 v[120:123], a[176:179], v[172:175], v[120:123]
  s_waitcnt vmcnt(20)
  v_mfma_f32_16x16x32_bf16 v[32:35], a[180:183], v[192:195], v[32:35]
  s_add_u32 s70, s76, 28672
  v_mfma_f32_16x16x32_bf16 v[32:35], a[196:199], v[208:211], v[32:35]
  buffer_load_dwordx4 v[160:163], v2, s[20:23], s70 offen
  v_mfma_f32_16x16x32_bf16 v[56:59], a[196:199], v[212:215], v[56:59]
  s_add_u32 s70, s74, 28672
  v_mfma_f32_16x16x32_bf16 v[56:59], a[180:183], v[196:199], v[56:59]
  buffer_load_dwordx4 v[164:167], v2, s[20:23], s70 offen
  v_mfma_f32_16x16x32_bf16 v[80:83], a[180:183], v[200:203], v[80:83]
  s_add_u32 s70, s75, 28672
  v_mfma_f32_16x16x32_bf16 v[80:83], a[196:199], v[216:219], v[80:83]
  buffer_load_dwordx4 v[168:171], v2, s[20:23], s70 offen
  v_mfma_f32_16x16x32_bf16 v[104:107], a[196:199], v[220:223], v[104:107]
  s_add_u32 s70, s78, 28672
  v_mfma_f32_16x16x32_bf16 v[104:107], a[180:183], v[204:207], v[104:107]
  buffer_load_dwordx4 v[172:175], v2, s[20:23], s70 offen
  v_mfma_f32_16x16x32_bf16 v[108:111], a[184:187], v[204:207], v[108:111]
  s_add_u32 s70, s76, 30720
  v_mfma_f32_16x16x32_bf16 v[108:111], a[200:203], v[220:223], v[108:111]
  buffer_load_dwordx4 v[176:179], v2, s[20:23], s70 offen
  v_mfma_f32_16x16x32_bf16 v[84:87], a[200:203], v[216:219], v[84:87]
  s_add_u32 s70, s74, 30720
  v_mfma_f32_16x16x32_bf16 v[84:87], a[184:187], v[200:203], v[84:87]
  buffer_load_dwordx4 v[180:183], v2, s[20:23], s70 offen
  v_mfma_f32_16x16x32_bf16 v[60:63], a[184:187], v[196:199], v[60:63]
  s_add_u32 s70, s75, 30720
  v_mfma_f32_16x16x32_bf16 v[60:63], a[200:203], v[212:215], v[60:63]
  buffer_load_dwordx4 v[184:187], v2, s[20:23], s70 offen
  v_mfma_f32_16x16x32_bf16 v[36:39], a[200:203], v[208:211], v[36:39]
  s_add_u32 s70, s78, 30720
  v_mfma_f32_16x16x32_bf16 v[36:39], a[184:187], v[192:195], v[36:39]
  buffer_load_dwordx4 v[188:191], v2, s[20:23], s70 offen
  v_mfma_f32_16x16x32_bf16 v[40:43], a[188:191], v[192:195], v[40:43]
  s_add_u32 s70, s77, 98304
  v_mfma_f32_16x16x32_bf16 v[40:43], a[204:207], v[208:211], v[40:43]
  buffer_load_dwordx4 a[96:99], v2, s[20:23], s70 offen
  v_mfma_f32_16x16x32_bf16 v[64:67], a[204:207], v[212:215], v[64:67]
  s_add_u32 s70, s77, 99328
  v_mfma_f32_16x16x32_bf16 v[64:67], a[188:191], v[196:199], v[64:67]
  buffer_load_dwordx4 a[100:103], v2, s[20:23], s70 offen
  v_mfma_f32_16x16x32_bf16 v[88:91], a[188:191], v[200:203], v[88:91]
  s_add_u32 s70, s77, 100352
  v_mfma_f32_16x16x32_bf16 v[88:91], a[204:207], v[216:219], v[88:91]
  buffer_load_dwordx4 a[104:107], v2, s[20:23], s70 offen
  v_mfma_f32_16x16x32_bf16 v[112:115], a[204:207], v[220:223], v[112:115]
  s_add_u32 s70, s77, 101376
  v_mfma_f32_16x16x32_bf16 v[112:115], a[188:191], v[204:207], v[112:115]
  buffer_load_dwordx4 a[108:111], v2, s[20:23], s70 offen
  v_mfma_f32_16x16x32_bf16 v[116:119], a[192:195], v[204:207], v[116:119]
  s_add_u32 s70, s77, 102400
  v_mfma_f32_16x16x32_bf16 v[116:119], a[208:211], v[220:223], v[116:119]
  buffer_load_dwordx4 a[112:115], v2, s[20:23], s70 offen
  v_mfma_f32_16x16x32_bf16 v[92:95], a[208:211], v[216:219], v[92:95]
  s_add_u32 s70, s77, 103424
  v_mfma_f32_16x16x32_bf16 v[92:95], a[192:195], v[200:203], v[92:95]
  buffer_load_dwordx4 a[116:119], v2, s[20:23], s70 offen
  v_mfma_f32_16x16x32_bf16 v[68:71], a[192:195], v[196:199], v[68:71]
  v_mfma_f32_16x16x32_bf16 v[68:71], a[208:211], v[212:215], v[68:71]
  v_mfma_f32_16x16x32_bf16 v[44:47], a[208:211], v[208:211], v[44:47]
  v_mfma_f32_16x16x32_bf16 v[44:47], a[192:195], v[192:195], v[44:47]
  v_mfma_f32_16x16x32_bf16 v[48:51], a[212:215], v[192:195], v[48:51]
  v_mfma_f32_16x16x32_bf16 v[52:55], a[212:215], v[208:211], v[52:55]
  v_mfma_f32_16x16x32_bf16 v[76:79], a[212:215], v[212:215], v[76:79]
  v_mfma_f32_16x16x32_bf16 v[72:75], a[212:215], v[196:199], v[72:75]
  v_mfma_f32_16x16x32_bf16 v[96:99], a[212:215], v[200:203], v[96:99]
  v_mfma_f32_16x16x32_bf16 v[100:103], a[212:215], v[216:219], v[100:103]
  v_mfma_f32_16x16x32_bf16 v[124:127], a[212:215], v[220:223], v[124:127]
  v_mfma_f32_16x16x32_bf16 v[120:123], a[212:215], v[204:207], v[120:123]
  s_waitcnt vmcnt(20)
  s_lshr_b32 s70, s94, 6
  s_cmp_eq_u32 s70, s79
  s_cbranch_scc0 L_noy_110
  v_lshlrev_b32 v29, 7, v0
  v_min_u32 v29, 18304, v29
  v_add_u32 v29, 12288, v29
  s_mov_b32 s72, 58228736
  buffer_load_dword v24, v29, s[20:23], s72 offen sc1
L_noy_110:
  v_mfma_f32_16x16x32_bf16 v[32:35], a[216:219], v[128:131], v[32:35]
  s_add_u32 s70, s76, 32768
  v_mfma_f32_16x16x32_bf16 v[32:35], a[232:235], v[144:147], v[32:35]
  buffer_load_dwordx4 v[192:195], v2, s[20:23], s70 offen
  v_mfma_f32_16x16x32_bf16 v[56:59], a[232:235], v[148:151], v[56:59]
  s_add_u32 s70, s74, 32768
  v_mfma_f32_16x16x32_bf16 v[56:59], a[216:219], v[132:135], v[56:59]
  buffer_load_dwordx4 v[196:199], v2, s[20:23], s70 offen
  v_mfma_f32_16x16x32_bf16 v[80:83], a[216:219], v[136:139], v[80:83]
  s_add_u32 s70, s75, 32768
  v_mfma_f32_16x16x32_bf16 v[80:83], a[232:235], v[152:155], v[80:83]
  buffer_load_dwordx4 v[200:203], v2, s[20:23], s70 offen
  v_mfma_f32_16x16x32_bf16 v[104:107], a[232:235], v[156:159], v[104:107]
  s_add_u32 s70, s78, 32768
  v_mfma_f32_16x16x32_bf16 v[104:107], a[216:219], v[140:143], v[104:107]
  buffer_load_dwordx4 v[204:207], v2, s[20:23], s70 offen
  v_mfma_f32_16x16x32_bf16 v[108:111], a[220:223], v[140:143], v[108:111]
  s_add_u32 s70, s76, 34816
  v_mfma_f32_16x16x32_bf16 v[108:111], a[236:239], v[156:159], v[108:111]
  buffer_load_dwordx4 v[208:211], v2, s[20:23], s70 offen
  v_mfma_f32_16x16x32_bf16 v[84:87], a[236:239], v[152:155], v[84:87]
  s_add_u32 s70, s74, 34816
  v_mfma_f32_16x16x32_bf16 v[84:87], a[220:223], v[136:139], v[84:87]
  buffer_load_dwordx4 v[212:215], v2, s[20:23], s70 offen
  v_mfma_f32_16x16x32_bf16 v[60:63], a[220:223], v[132:135], v[60:63]
  s_add_u32 s70, s75, 34816
  v_mfma_f32_16x16x32_bf16 v[60:63], a[236:239], v[148:151], v[60:63]
  buffer_load_dwordx4 v[216:219], v2, s[20:23], s70 offen
  v_mfma_f32_16x16x32_bf16 v[36:39], a[236:239], v[144:147], v[36:39]
  s_add_u32 s70, s78, 34816
  v_mfma_f32_16x16x32_bf16 v[36:39], a[220:223], v[128:131], v[36:39]
  buffer_load_dwordx4 v[220:223], v2, s[20:23], s70 offen
  v_mfma_f32_16x16x32_bf16 v[40:43], a[224:227], v[128:131], v[40:43]
  s_add_u32 s70, s77, 104448
  v_mfma_f32_16x16x32_bf16 v[40:43], a[240:243], v[144:147], v[40:43]
  buffer_load_dwordx4 a[120:123], v2, s[20:23], s70 offen
  v_mfma_f32_16x16x32_bf16 v[64:67], a[240:243], v[148:151], v[64:67]
  s_add_u32 s70, s77, 105472
  v_mfma_f32_16x16x32_bf16 v[64:67], a[224:227], v[132:135], v[64:67]
  buffer_load_dwordx4 a[124:127], v2, s[20:23], s70 offen
  v_mfma_f32_16x16x32_bf16 v[88:91], a[224:227], v[136:139], v[88:91]
  s_add_u32 s70, s77, 106496
  v_mfma_f32_16x16x32_bf16 v[88:91], a[240:243], v[152:155], v[88:91]
  buffer_load_dwordx4 a[128:131], v2, s[20:23], s70 offen
  v_mfma_f32_16x16x32_bf16 v[112:115], a[240:243], v[156:159], v[112:115]
  s_add_u32 s70, s77, 107520
  v_mfma_f32_16x16x32_bf16 v[112:115], a[224:227], v[140:143], v[112:115]
  buffer_load_dwordx4 a[132:135], v2, s[20:23], s70 offen
  v_mfma_f32_16x16x32_bf16 v[116:119], a[228:231], v[140:143], v[116:119]
  s_add_u32 s70, s77, 108544
  v_mfma_f32_16x16x32_bf16 v[116:119], a[244:247], v[156:159], v[116:119]
  buffer_load_dwordx4 a[136:139], v2, s[20:23], s70 offen
  v_mfma_f32_16x16x32_bf16 v[92:95], a[244:247], v[152:155], v[92:95]
  s_add_u32 s70, s77, 109568
  v_mfma_f32_16x16x32_bf16 v[92:95], a[228:231], v[136:139], v[92:95]
  buffer_load_dwordx4 a[140:143], v2, s[20:23], s70 offen
  v_mfma_f32_16x16x32_bf16 v[68:71], a[228:231], v[132:135], v[68:71]
  v_mfma_f32_16x16x32_bf16 v[68:71], a[244:247], v[148:151], v[68:71]
  v_mfma_f32_16x16x32_bf16 v[44:47], a[244:247], v[144:147], v[44:47]
  v_mfma_f32_16x16x32_bf16 v[44:47], a[228:231], v[128:131], v[44:47]
  v_mfma_f32_16x16x32_bf16 v[48:51], a[248:251], v[128:131], v[48:51]
  v_mfma_f32_16x16x32_bf16 v[52:55], a[248:251], v[144:147], v[52:55]
  v_mfma_f32_16x16x32_bf16 v[76:79], a[248:251], v[148:151], v[76:79]
  v_mfma_f32_16x16x32_bf16 v[72:75], a[248:251], v[132:135], v[72:75]
  v_mfma_f32_16x16x32_bf16 v[96:99], a[248:251], v[136:139], v[96:99]
  v_mfma_f32_16x16x32_bf16 v[100:103], a[248:251], v[152:155], v[100:103]
  v_mfma_f32_16x16x32_bf16 v[124:127], a[248:251], v[156:159], v[124:127]
  v_mfma_f32_16x16x32_bf16 v[120:123], a[248:251], v[140:143], v[120:123]
  s_waitcnt vmcnt(20)
  v_mfma_f32_16x16x32_bf16 v[32:35], a[252:255], v[160:163], v[32:35]
  s_add_u32 s70, s76, 36864
  v_mfma_f32_16x16x32_bf16 v[32:35], v[236:239], v[176:179], v[32:35]
  buffer_load_dwordx4 v[128:131], v2, s[20:23], s70 offen
  v_mfma_f32_16x16x32_bf16 v[56:59], v[236:239], v[180:183], v[56:59]
  s_add_u32 s70, s74, 36864
  v_mfma_f32_16x16x32_bf16 v[56:59], a[252:255], v[164:167], v[56:59]
  buffer_load_dwordx4 v[132:135], v2, s[20:23], s70 offen
  v_mfma_f32_16x16x32_bf16 v[80:83], a[252:255], v[168:171], v[80:83]
  s_add_u32 s70, s75, 36864
  v_mfma_f32_16x16x32_bf16 v[80:83], v[236:239], v[184:187], v[80:83]
  buffer_load_dwordx4 v[136:139], v2, s[20:23], s70 offen
  v_mfma_f32_16x16x32_bf16 v[104:107], v[236:239], v[188:191], v[104:107]
  s_add_u32 s70, s78, 36864
  v_mfma_f32_16x16x32_bf16 v[104:107], a[252:255], v[172:175], v[104:107]
  buffer_load_dwordx4 v[140:143], v2, s[20:23], s70 offen
  v_mfma_f32_16x16x32_bf16 v[108:111], v[224:227], v[172:175], v[108:111]
  s_add_u32 s70, s76, 38912
  v_mfma_f32_16x16x32_bf16 v[108:111], v[240:243], v[188:191], v[108:111]
  buffer_load_dwordx4 v[144:147], v2, s[20:23], s70 offen
  v_mfma_f32_16x16x32_bf16 v[84:87], v[240:243], v[184:187], v[84:87]
  s_add_u32 s70, s74, 38912
  v_mfma_f32_16x16x32_bf16 v[84:87], v[224:227], v[168:171], v[84:87]
  buffer_load_dwordx4 v[148:151], v2, s[20:23], s70 offen
  v_mfma_f32_16x16x32_bf16 v[60:63], v[224:227], v[164:167], v[60:63]
  s_add_u32 s70, s75, 38912
  v_mfma_f32_16x16x32_bf16 v[60:63], v[240:243], v[180:183], v[60:63]
  buffer_load_dwordx4 v[152:155], v2, s[20:23], s70 offen
  v_mfma_f32_16x16x32_bf16 v[36:39], v[240:243], v[176:179], v[36:39]
  s_add_u32 s70, s78, 38912
  v_mfma_f32_16x16x32_bf16 v[36:39], v[224:227], v[160:163], v[36:39]
  buffer_load_dwordx4 v[156:159], v2, s[20:23], s70 offen
  v_mfma_f32_16x16x32_bf16 v[40:43], v[228:231], v[160:163], v[40:43]
  s_add_u32 s70, s77, 110592
  v_mfma_f32_16x16x32_bf16 v[40:43], v[244:247], v[176:179], v[40:43]
  buffer_load_dwordx4 a[144:147], v2, s[20:23], s70 offen
  v_mfma_f32_16x16x32_bf16 v[64:67], v[244:247], v[180:183], v[64:67]
  s_add_u32 s70, s77, 111616
  v_mfma_f32_16x16x32_bf16 v[64:67], v[228:231], v[164:167], v[64:67]
  buffer_load_dwordx4 a[148:151], v2, s[20:23], s70 offen
  v_mfma_f32_16x16x32_bf16 v[88:91], v[228:231], v[168:171], v[88:91]
  s_add_u32 s70, s77, 112640
  v_mfma_f32_16x16x32_bf16 v[88:91], v[244:247], v[184:187], v[88:91]
  buffer_load_dwordx4 a[152:155], v2, s[20:23], s70 offen
  v_mfma_f32_16x16x32_bf16 v[112:115], v[244:247], v[188:191], v[112:115]
  s_add_u32 s70, s77, 113664
  v_mfma_f32_16x16x32_bf16 v[112:115], v[228:231], v[172:175], v[112:115]
  buffer_load_dwordx4 a[156:159], v2, s[20:23], s70 offen
  v_mfma_f32_16x16x32_bf16 v[116:119], v[232:235], v[172:175], v[116:119]
  s_add_u32 s70, s77, 114688
  v_mfma_f32_16x16x32_bf16 v[116:119], v[248:251], v[188:191], v[116:119]
  buffer_load_dwordx4 a[160:163], v2, s[20:23], s70 offen
  v_mfma_f32_16x16x32_bf16 v[92:95], v[248:251], v[184:187], v[92:95]
  s_add_u32 s70, s77, 115712
  v_mfma_f32_16x16x32_bf16 v[92:95], v[232:235], v[168:171], v[92:95]
  buffer_load_dwordx4 a[164:167], v2, s[20:23], s70 offen
  v_mfma_f32_16x16x32_bf16 v[68:71], v[232:235], v[164:167], v[68:71]
  v_mfma_f32_16x16x32_bf16 v[68:71], v[248:251], v[180:183], v[68:71]
  v_mfma_f32_16x16x32_bf16 v[44:47], v[248:251], v[176:179], v[44:47]
  v_mfma_f32_16x16x32_bf16 v[44:47], v[232:235], v[160:163], v[44:47]
  v_mfma_f32_16x16x32_bf16 v[48:51], v[252:255], v[160:163], v[48:51]
  v_mfma_f32_16x16x32_bf16 v[52:55], v[252:255], v[176:179], v[52:55]
  v_mfma_f32_16x16x32_bf16 v[76:79], v[252:255], v[180:183], v[76:79]
  v_mfma_f32_16x16x32_bf16 v[72:75], v[252:255], v[164:167], v[72:75]
  v_mfma_f32_16x16x32_bf16 v[96:99], v[252:255], v[168:171], v[96:99]
  v_mfma_f32_16x16x32_bf16 v[100:103], v[252:255], v[184:187], v[100:103]
  v_mfma_f32_16x16x32_bf16 v[124:127], v[252:255], v[188:191], v[124:127]
  v_mfma_f32_16x16x32_bf16 v[120:123], v[252:255], v[172:175], v[120:123]
  s_waitcnt vmcnt(20)
  s_barrier
  v_mfma_f32_16x16x32_bf16 v[32:35], a[0:3], v[192:195], v[32:35]
  s_add_u32 s70, s76, 40960
  v_mfma_f32_16x16x32_bf16 v[32:35], a[16:19], v[208:211], v[32:35]
  buffer_load_dwordx4 v[160:163], v2, s[20:23], s70 offen
  v_mfma_f32_16x16x32_bf16 v[56:59], a[16:19], v[212:215], v[56:59]
  s_add_u32 s70, s74, 40960
  v_mfma_f32_16x16x32_bf16 v[56:59], a[0:3], v[196:199], v[56:59]
  buffer_load_dwordx4 v[164:167], v2, s[20:23], s70 offen
  v_mfma_f32_16x16x32_bf16 v[80:83], a[0:3], v[200:203], v[80:83]
  s_add_u32 s70, s75, 40960
  v_mfma_f32_16x16x32_bf16 v[80:83], a[16:19], v[216:219], v[80:83]
  buffer_load_dwordx4 v[168:171], v2, s[20:23], s70 offen
  v_mfma_f32_16x16x32_bf16 v[104:107], a[16:19], v[220:223], v[104:107]
  s_add_u32 s70, s78, 40960
  v_mfma_f32_16x16x32_bf16 v[104:107], a[0:3], v[204:207], v[104:107]
  buffer_load_dwordx4 v[172:175], v2, s[20:23], s70 offen
  v_mfma_f32_16x16x32_bf16 v[108:111], a[4:7], v[204:207], v[108:111]
  s_add_u32 s70, s76, 43008
  v_mfma_f32_16x16x32_bf16 v[108:111], a[20:23], v[220:223], v[108:111]
  buffer_load_dwordx4 v[176:179], v2, s[20:23], s70 offen
  v_mfma_f32_16x16x32_bf16 v[84:87], a[20:23], v[216:219], v[84:87]
  s_add_u32 s70, s74, 43008
  v_mfma_f32_16x16x32_bf16 v[84:87], a[4:7], v[200:203], v[84:87]
  buffer_load_dwordx4 v[180:183], v2, s[20:23], s70 offen
  v_mfma_f32_16x16x32_bf16 v[60:63], a[4:7], v[196:199], v[60:63]
  s_add_u32 s70, s75, 43008
  v_mfma_f32_16x16x32_bf16 v[60:63], a[20:23], v[212:215], v[60:63]
  buffer_load_dwordx4 v[184:187], v2, s[20:23], s70 offen
  v_mfma_f32_16x16x32_bf16 v[36:39], a[20:23], v[208:211], v[36:39]
  s_add_u32 s70, s78, 43008
  v_mfma_f32_16x16x32_bf16 v[36:39], a[4:7], v[192:195], v[36:39]
  buffer_load_dwordx4 v[188:191], v2, s[20:23], s70 offen
  v_mfma_f32_16x16x32_bf16 v[40:43], a[8:11], v[192:195], v[40:43]
  s_add_u32 s70, s77, 116736
  v_mfma_f32_16x16x32_bf16 v[40:43], a[24:27], v[208:211], v[40:43]
  buffer_load_dwordx4 a[168:171], v2, s[20:23], s70 offen
  v_mfma_f32_16x16x32_bf16 v[64:67], a[24:27], v[212:215], v[64:67]
  s_add_u32 s70, s77, 117760
  v_mfma_f32_16x16x32_bf16 v[64:67], a[8:11], v[196:199], v[64:67]
  buffer_load_dwordx4 a[172:175], v2, s[20:23], s70 offen
  v_mfma_f32_16x16x32_bf16 v[88:91], a[8:11], v[200:203], v[88:91]
  s_add_u32 s70, s77, 118784
  v_mfma_f32_16x16x32_bf16 v[88:91], a[24:27], v[216:219], v[88:91]
  buffer_load_dwordx4 a[176:179], v2, s[20:23], s70 offen
  v_mfma_f32_16x16x32_bf16 v[112:115], a[24:27], v[220:223], v[112:115]
  s_add_u32 s70, s77, 119808
  v_mfma_f32_16x16x32_bf16 v[112:115], a[8:11], v[204:207], v[112:115]
  buffer_load_dwordx4 a[180:183], v2, s[20:23], s70 offen
  v_mfma_f32_16x16x32_bf16 v[116:119], a[12:15], v[204:207], v[116:119]
  s_add_u32 s70, s77, 120832
  v_mfma_f32_16x16x32_bf16 v[116:119], a[28:31], v[220:223], v[116:119]
  buffer_load_dwordx4 a[184:187], v2, s[20:23], s70 offen
  v_mfma_f32_16x16x32_bf16 v[92:95], a[28:31], v[216:219], v[92:95]
  s_add_u32 s70, s77, 121856
  v_mfma_f32_16x16x32_bf16 v[92:95], a[12:15], v[200:203], v[92:95]
  buffer_load_dwordx4 a[188:191], v2, s[20:23], s70 offen
  v_mfma_f32_16x16x32_bf16 v[68:71], a[12:15], v[196:199], v[68:71]
  v_mfma_f32_16x16x32_bf16 v[68:71], a[28:31], v[212:215], v[68:71]
  v_mfma_f32_16x16x32_bf16 v[44:47], a[28:31], v[208:211], v[44:47]
  v_mfma_f32_16x16x32_bf16 v[44:47], a[12:15], v[192:195], v[44:47]
  v_mfma_f32_16x16x32_bf16 v[48:51], a[32:35], v[192:195], v[48:51]
  v_mfma_f32_16x16x32_bf16 v[52:55], a[32:35], v[208:211], v[52:55]
  v_mfma_f32_16x16x32_bf16 v[76:79], a[32:35], v[212:215], v[76:79]
  v_mfma_f32_16x16x32_bf16 v[72:75], a[32:35], v[196:199], v[72:75]
  v_mfma_f32_16x16x32_bf16 v[96:99], a[32:35], v[200:203], v[96:99]
  v_mfma_f32_16x16x32_bf16 v[100:103], a[32:35], v[216:219], v[100:103]
  v_mfma_f32_16x16x32_bf16 v[124:127], a[32:35], v[220:223], v[124:127]
  v_mfma_f32_16x16x32_bf16 v[120:123], a[32:35], v[204:207], v[120:123]
  s_waitcnt vmcnt(20)
  v_mfma_f32_16x16x32_bf16 v[32:35], a[36:39], v[128:131], v[32:35]
  s_add_u32 s70, s76, 45056
  v_mfma_f32_16x16x32_bf16 v[32:35], a[52:55], v[144:147], v[32:35]
  buffer_load_dwordx4 v[192:195], v2, s[20:23], s70 offen
  v_mfma_f32_16x16x32_bf16 v[56:59], a[52:55], v[148:151], v[56:59]
  s_add_u32 s70, s74, 45056
  v_mfma_f32_16x16x32_bf16 v[56:59], a[36:39], v[132:135], v[56:59]
  buffer_load_dwordx4 v[196:199], v2, s[20:23], s70 offen
  v_mfma_f32_16x16x32_bf16 v[80:83], a[36:39], v[136:139], v[80:83]
  s_add_u32 s70, s75, 45056
  v_mfma_f32_16x16x32_bf16 v[80:83], a[52:55], v[152:155], v[80:83]
  buffer_load_dwordx4 v[200:203], v2, s[20:23], s70 offen
  v_mfma_f32_16x16x32_bf16 v[104:107], a[52:55], v[156:159], v[104:107]
  s_add_u32 s70, s78, 45056
  v_mfma_f32_16x16x32_bf16 v[104:107], a[36:39], v[140:143], v[104:107]
  buffer_load_dwordx4 v[204:207], v2, s[20:23], s70 offen
  v_mfma_f32_16x16x32_bf16 v[108:111], a[40:43], v[140:143], v[108:111]
  s_add_u32 s70, s76, 47104
  v_mfma_f32_16x16x32_bf16 v[108:111], a[56:59], v[156:159], v[108:111]
  buffer_load_dwordx4 v[208:211], v2, s[20:23], s70 offen
  v_mfma_f32_16x16x32_bf16 v[84:87], a[56:59], v[152:155], v[84:87]
  s_add_u32 s70, s74, 47104
  v_mfma_f32_16x16x32_bf16 v[84:87], a[40:43], v[136:139], v[84:87]
  buffer_load_dwordx4 v[212:215], v2, s[20:23], s70 offen
  v_mfma_f32_16x16x32_bf16 v[60:63], a[40:43], v[132:135], v[60:63]
  s_add_u32 s70, s75, 47104
  v_mfma_f32_16x16x32_bf16 v[60:63], a[56:59], v[148:151], v[60:63]
  buffer_load_dwordx4 v[216:219], v2, s[20:23], s70 offen
  v_mfma_f32_16x16x32_bf16 v[36:39], a[56:59], v[144:147], v[36:39]
  s_add_u32 s70, s78, 47104
  v_mfma_f32_16x16x32_bf16 v[36:39], a[40:43], v[128:131], v[36:39]
  buffer_load_dwordx4 v[220:223], v2, s[20:23], s70 offen
  v_mfma_f32_16x16x32_bf16 v[40:43], a[44:47], v[128:131], v[40:43]
  s_add_u32 s70, s77, 122880
  v_mfma_f32_16x16x32_bf16 v[40:43], a[60:63], v[144:147], v[40:43]
  buffer_load_dwordx4 a[192:195], v2, s[20:23], s70 offen
  v_mfma_f32_16x16x32_bf16 v[64:67], a[60:63], v[148:151], v[64:67]
  s_add_u32 s70, s77, 123904
  v_mfma_f32_16x16x32_bf16 v[64:67], a[44:47], v[132:135], v[64:67]
  buffer_load_dwordx4 a[196:199], v2, s[20:23], s70 offen
  v_mfma_f32_16x16x32_bf16 v[88:91], a[44:47], v[136:139], v[88:91]
  s_add_u32 s70, s77, 124928
  v_mfma_f32_16x16x32_bf16 v[88:91], a[60:63], v[152:155], v[88:91]
  buffer_load_dwordx4 a[200:203], v2, s[20:23], s70 offen
  v_mfma_f32_16x16x32_bf16 v[112:115], a[60:63], v[156:159], v[112:115]
  s_add_u32 s70, s77, 125952
  v_mfma_f32_16x16x32_bf16 v[112:115], a[44:47], v[140:143], v[112:115]
  buffer_load_dwordx4 a[204:207], v2, s[20:23], s70 offen
  v_mfma_f32_16x16x32_bf16 v[116:119], a[48:51], v[140:143], v[116:119]
  s_add_u32 s70, s77, 126976
  v_mfma_f32_16x16x32_bf16 v[116:119], a[64:67], v[156:159], v[116:119]
  buffer_load_dwordx4 a[208:211], v2, s[20:23], s70 offen
  v_mfma_f32_16x16x32_bf16 v[92:95], a[64:67], v[152:155], v[92:95]
  s_add_u32 s70, s77, 128000
  v_mfma_f32_16x16x32_bf16 v[92:95], a[48:51], v[136:139], v[92:95]
  buffer_load_dwordx4 a[212:215], v2, s[20:23], s70 offen
  v_mfma_f32_16x16x32_bf16 v[68:71], a[48:51], v[132:135], v[68:71]
  v_mfma_f32_16x16x32_bf16 v[68:71], a[64:67], v[148:151], v[68:71]
  v_mfma_f32_16x16x32_bf16 v[44:47], a[64:67], v[144:147], v[44:47]
  v_mfma_f32_16x16x32_bf16 v[44:47], a[48:51], v[128:131], v[44:47]
  v_mfma_f32_16x16x32_bf16 v[48:51], a[68:71], v[128:131], v[48:51]
  v_mfma_f32_16x16x32_bf16 v[52:55], a[68:71], v[144:147], v[52:55]
  v_mfma_f32_16x16x32_bf16 v[76:79], a[68:71], v[148:151], v[76:79]
  v_mfma_f32_16x16x32_bf16 v[72:75], a[68:71], v[132:135], v[72:75]
  v_mfma_f32_16x16x32_bf16 v[96:99], a[68:71], v[136:139], v[96:99]
  v_mfma_f32_16x16x32_bf16 v[100:103], a[68:71], v[152:155], v[100:103]
  v_mfma_f32_16x16x32_bf16 v[124:127], a[68:71], v[156:159], v[124:127]
  v_mfma_f32_16x16x32_bf16 v[120:123], a[68:71], v[140:143], v[120:123]
  s_waitcnt vmcnt(20)
  s_lshr_b32 s70, s94, 6
  s_cmp_eq_u32 s70, s79
  s_cbranch_scc0 L_noy_111
  v_and_b32 v24, 3, v24
  v_cmp_ne_u32 vcc, 3, v24
  s_cbranch_vccnz L_spin_112
L_back_113:
  s_barrier
  v_mul_u32_u24 v21, 3641, v1
  v_lshrrev_b32 v21, 16, v21
  v_mul_u32_u24 v22, 18, v21
  v_sub_u32 v22, v1, v22
  s_mul_i32 s70, s34, 3
  v_add_u32 v21, s70, v21
  v_mul_u32_u24 v23, 27648, v21
  v_lshl_add_u32 v23, v22, 4, v23
  v_mul_u32_u24 v21, 288, v21
  v_lshl_add_u32 v21, v22, 4, v21
  v_add_u32 v27, 90112, v21
  s_mul_i32 s70, s32, 288
  s_add_u32 s70, s70, 57737216
  s_mov_b32 exec_hi, 0x3fffff
  buffer_load_dwordx4 a[0:3], v23, s[20:23], s70 offen sc1
  s_add_u32 s70, s70, 2304
  buffer_load_dwordx4 a[4:7], v23, s[20:23], s70 offen sc1
  s_add_u32 s70, s70, 2304
  buffer_load_dwordx4 a[8:11], v23, s[20:23], s70 offen sc1
  s_add_u32 s70, s70, 2304
  buffer_load_dwordx4 a[12:15], v23, s[20:23], s70 offen sc1
  s_add_u32 s70, s70, 2304
  buffer_load_dwordx4 a[16:19], v23, s[20:23], s70 offen sc1
  s_add_u32 s70, s70, 2304
  buffer_load_dwordx4 a[20:23], v23, s[20:23], s70 offen sc1
  s_add_u32 s70, s70, 2304
  buffer_load_dwordx4 a[24:27], v23, s[20:23], s70 offen sc1
  s_add_u32 s70, s70, 2304
  buffer_load_dwordx4 a[28:31], v23, s[20:23], s70 offen sc1
  s_add_u32 s70, s70, 2304
  buffer_load_dwordx4 a[32:35], v23, s[20:23], s70 offen sc1
  s_add_u32 s70, s70, 2304
  buffer_load_dwordx4 a[36:39], v23, s[20:23], s70 offen sc1
  s_add_u32 s70, s70, 2304
  buffer_load_dwordx4 a[40:43], v23, s[20:23], s70 offen sc1
  s_add_u32 s70, s70, 2304
  buffer_load_dwordx4 a[44:47], v23, s[20:23], s70 offen sc1
  s_add_u32 s70, s70, 2304
  s_mov_b64 exec, -1
L_noy_111:
  v_mfma_f32_16x16x32_bf16 v[32:35], a[72:75], v[160:163], v[32:35]
  s_add_u32 s70, s76, 49152
  v_mfma_f32_16x16x32_bf16 v[32:35], a[88:91], v[176:179], v[32:35]
  buffer_load_dwordx4 v[128:131], v2, s[20:23], s70 offen
  v_mfma_f32_16x16x32_bf16 v[56:59], a[88:91], v[180:183], v[56:59]
  s_add_u32 s70, s74, 49152
  v_mfma_f32_16x16x32_bf16 v[56:59], a[72:75], v[164:167], v[56:59]
  buffer_load_dwordx4 v[132:135], v2, s[20:23], s70 offen
  v_mfma_f32_16x16x32_bf16 v[80:83], a[72:75], v[168:171], v[80:83]
  s_add_u32 s70, s75, 49152
  v_mfma_f32_16x16x32_bf16 v[80:83], a[88:91], v[184:187], v[80:83]
  buffer_load_dwordx4 v[136:139], v2, s[20:23], s70 offen
  v_mfma_f32_16x16x32_bf16 v[104:107], a[88:91], v[188:191], v[104:107]
  s_add_u32 s70, s78, 49152
  v_mfma_f32_16x16x32_bf16 v[104:107], a[72:75], v[172:175], v[104:107]
  buffer_load_dwordx4 v[140:143], v2, s[20:23], s70 offen
  v_mfma_f32_16x16x32_bf16 v[108:111], a[76:79], v[172:175], v[108:111]
  s_add_u32 s70, s76, 51200
  v_mfma_f32_16x16x32_bf16 v[108:111], a[92:95], v[188:191], v[108:111]
  buffer_load_dwordx4 v[144:147], v2, s[20:23], s70 offen
  v_mfma_f32_16x16x32_bf16 v[84:87], a[92:95], v[184:187], v[84:87]
  s_add_u32 s70, s74, 51200
  v_mfma_f32_16x16x32_bf16 v[84:87], a[76:79], v[168:171], v[84:87]
  buffer_load_dwordx4 v[148:151], v2, s[20:23], s70 offen
  v_mfma_f32_16x16x32_bf16 v[60:63], a[76:79], v[164:167], v[60:63]
  s_add_u32 s70, s75, 51200
  v_mfma_f32_16x16x32_bf16 v[60:63], a[92:95], v[180:183], v[60:63]
  buffer_load_dwordx4 v[152:155], v2, s[20:23], s70 offen
  v_mfma_f32_16x16x32_bf16 v[36:39], a[92:95], v[176:179], v[36:39]
  s_add_u32 s70, s78, 51200
  v_mfma_f32_16x16x32_bf16 v[36:39], a[76:79], v[160:163], v[36:39]
  buffer_load_dwordx4 v[156:159], v2, s[20:23], s70 offen
  v_mfma_f32_16x16x32_bf16 v[40:43], a[80:83], v[160:163], v[40:43]
  s_add_u32 s70, s77, 129024
  v_mfma_f32_16x16x32_bf16 v[40:43], a[96:99], v[176:179], v[40:43]
  buffer_load_dwordx4 a[216:219], v2, s[20:23], s70 offen
  v_mfma_f32_16x16x32_bf16 v[64:67], a[96:99], v[180:183], v[64:67]
  s_add_u32 s70, s77, 130048
  v_mfma_f32_16x16x32_bf16 v[64:67], a[80:83], v[164:167], v[64:67]
  buffer_load_dwordx4 a[220:223], v2, s[20:23], s70 offen
  v_mfma_f32_16x16x32_bf16 v[88:91], a[80:83], v[168:171], v[88:91]
  s_add_u32 s70, s77, 131072
  v_mfma_f32_16x16x32_bf16 v[88:91], a[96:99], v[184:187], v[88:91]
  buffer_load_dwordx4 a[224:227], v2, s[20:23], s70 offen
  v_mfma_f32_16x16x32_bf16 v[112:115], a[96:99], v[188:191], v[112:115]
  s_add_u32 s70, s77, 132096
  v_mfma_f32_16x16x32_bf16 v[112:115], a[80:83], v[172:175], v[112:115]
  buffer_load_dwordx4 a[228:231], v2, s[20:23], s70 offen
  v_mfma_f32_16x16x32_bf16 v[116:119], a[84:87], v[172:175], v[116:119]
  s_add_u32 s70, s77, 133120
  v_mfma_f32_16x16x32_bf16 v[116:119], a[100:103], v[188:191], v[116:119]
  buffer_load_dwordx4 a[232:235], v2, s[20:23], s70 offen
  v_mfma_f32_16x16x32_bf16 v[92:95], a[100:103], v[184:187], v[92:95]
  s_add_u32 s70, s77, 134144
  v_mfma_f32_16x16x32_bf16 v[92:95], a[84:87], v[168:171], v[92:95]
  buffer_load_dwordx4 a[236:239], v2, s[20:23], s70 offen
  v_mfma_f32_16x16x32_bf16 v[68:71], a[84:87], v[164:167], v[68:71]
  v_mfma_f32_16x16x32_bf16 v[68:71], a[100:103], v[180:183], v[68:71]
  v_mfma_f32_16x16x32_bf16 v[44:47], a[100:103], v[176:179], v[44:47]
  v_mfma_f32_16x16x32_bf16 v[44:47], a[84:87], v[160:163], v[44:47]
  v_mfma_f32_16x16x32_bf16 v[48:51], a[104:107], v[160:163], v[48:51]
  v_mfma_f32_16x16x32_bf16 v[52:55], a[104:107], v[176:179], v[52:55]
  v_mfma_f32_16x16x32_bf16 v[76:79], a[104:107], v[180:183], v[76:79]
  v_mfma_f32_16x16x32_bf16 v[72:75], a[104:107], v[164:167], v[72:75]
  v_mfma_f32_16x16x32_bf16 v[96:99], a[104:107], v[168:171], v[96:99]
  v_mfma_f32_16x16x32_bf16 v[100:103], a[104:107], v[184:187], v[100:103]
  v_mfma_f32_16x16x32_bf16 v[124:127], a[104:107], v[188:191], v[124:127]
  v_mfma_f32_16x16x32_bf16 v[120:123], a[104:107], v[172:175], v[120:123]
  s_waitcnt vmcnt(20)
  v_mfma_f32_16x16x32_bf16 v[32:35], a[108:111], v[192:195], v[32:35]
  s_add_u32 s70, s76, 53248
  v_mfma_f32_16x16x32_bf16 v[32:35], a[124:127], v[208:211], v[32:35]
  buffer_load_dwordx4 v[160:163], v2, s[20:23], s70 offen
  v_mfma_f32_16x16x32_bf16 v[56:59], a[124:127], v[212:215], v[56:59]
  s_add_u32 s70, s74, 53248
  v_mfma_f32_16x16x32_bf16 v[56:59], a[108:111], v[196:199], v[56:59]
  buffer_load_dwordx4 v[164:167], v2, s[20:23], s70 offen
  v_mfma_f32_16x16x32_bf16 v[80:83], a[108:111], v[200:203], v[80:83]
  s_add_u32 s70, s75, 53248
  v_mfma_f32_16x16x32_bf16 v[80:83], a[124:127], v[216:219], v[80:83]
  buffer_load_dwordx4 v[168:171], v2, s[20:23], s70 offen
  v_mfma_f32_16x16x32_bf16 v[104:107], a[124:127], v[220:223], v[104:107]
  s_add_u32 s70, s78, 53248
  v_mfma_f32_16x16x32_bf16 v[104:107], a[108:111], v[204:207], v[104:107]
  buffer_load_dwordx4 v[172:175], v2, s[20:23], s70 offen
  v_mfma_f32_16x16x32_bf16 v[108:111], a[112:115], v[204:207], v[108:111]
  s_add_u32 s70, s76, 55296
  v_mfma_f32_16x16x32_bf16 v[108:111], a[128:131], v[220:223], v[108:111]
  buffer_load_dwordx4 v[176:179], v2, s[20:23], s70 offen
  v_mfma_f32_16x16x32_bf16 v[84:87], a[128:131], v[216:219], v[84:87]
  s_add_u32 s70, s74, 55296
  v_mfma_f32_16x16x32_bf16 v[84:87], a[112:115], v[200:203], v[84:87]
  buffer_load_dwordx4 v[180:183], v2, s[20:23], s70 offen
  v_mfma_f32_16x16x32_bf16 v[60:63], a[112:115], v[196:199], v[60:63]
  s_add_u32 s70, s75, 55296
  v_mfma_f32_16x16x32_bf16 v[60:63], a[128:131], v[212:215], v[60:63]
  buffer_load_dwordx4 v[184:187], v2, s[20:23], s70 offen
  v_mfma_f32_16x16x32_bf16 v[36:39], a[128:131], v[208:211], v[36:39]
  s_add_u32 s70, s78, 55296
  v_mfma_f32_16x16x32_bf16 v[36:39], a[112:115], v[192:195], v[36:39]
  buffer_load_dwordx4 v[188:191], v2, s[20:23], s70 offen
  v_mfma_f32_16x16x32_bf16 v[40:43], a[116:119], v[192:195], v[40:43]
  s_add_u32 s70, s77, 135168
  v_mfma_f32_16x16x32_bf16 v[40:43], a[132:135], v[208:211], v[40:43]
  buffer_load_dwordx4 a[240:243], v2, s[20:23], s70 offen
  v_mfma_f32_16x16x32_bf16 v[64:67], a[132:135], v[212:215], v[64:67]
  s_add_u32 s70, s77, 136192
  v_mfma_f32_16x16x32_bf16 v[64:67], a[116:119], v[196:199], v[64:67]
  buffer_load_dwordx4 a[244:247], v2, s[20:23], s70 offen
  v_mfma_f32_16x16x32_bf16 v[88:91], a[116:119], v[200:203], v[88:91]
  s_add_u32 s70, s77, 137216
  v_mfma_f32_16x16x32_bf16 v[88:91], a[132:135], v[216:219], v[88:91]
  buffer_load_dwordx4 a[248:251], v2, s[20:23], s70 offen
  v_mfma_f32_16x16x32_bf16 v[112:115], a[132:135], v[220:223], v[112:115]
  s_add_u32 s70, s77, 138240
  v_mfma_f32_16x16x32_bf16 v[112:115], a[116:119], v[204:207], v[112:115]
  buffer_load_dwordx4 a[252:255], v2, s[20:23], s70 offen
  v_mfma_f32_16x16x32_bf16 v[116:119], a[120:123], v[204:207], v[116:119]
  s_add_u32 s70, s77, 139264
  v_mfma_f32_16x16x32_bf16 v[116:119], a[136:139], v[220:223], v[116:119]
  buffer_load_dwordx4 v[224:227], v2, s[20:23], s70 offen
  v_mfma_f32_16x16x32_bf16 v[92:95], a[136:139], v[216:219], v[92:95]
  s_add_u32 s70, s77, 140288
  v_mfma_f32_16x16x32_bf16 v[92:95], a[120:123], v[200:203], v[92:95]
  buffer_load_dwordx4 v[228:231], v2, s[20:23], s70 offen
  v_mfma_f32_16x16x32_bf16 v[68:71], a[120:123], v[196:199], v[68:71]
  v_mfma_f32_16x16x32_bf16 v[68:71], a[136:139], v[212:215], v[68:71]
  v_mfma_f32_16x16x32_bf16 v[44:47], a[136:139], v[208:211], v[44:47]
  v_mfma_f32_16x16x32_bf16 v[44:47], a[120:123], v[192:195], v[44:47]
  v_mfma_f32_16x16x32_bf16 v[48:51], a[140:143], v[192:195], v[48:51]
  v_mfma_f32_16x16x32_bf16 v[52:55], a[140:143], v[208:211], v[52:55]
  v_mfma_f32_16x16x32_bf16 v[76:79], a[140:143], v[212:215], v[76:79]
  v_mfma_f32_16x16x32_bf16 v[72:75], a[140:143], v[196:199], v[72:75]
  v_mfma_f32_16x16x32_bf16 v[96:99], a[140:143], v[200:203], v[96:99]
  v_mfma_f32_16x16x32_bf16 v[100:103], a[140:143], v[216:219], v[100:103]
  v_mfma_f32_16x16x32_bf16 v[124:127], a[140:143], v[220:223], v[124:127]
  v_mfma_f32_16x16x32_bf16 v[120:123], a[140:143], v[204:207], v[120:123]
  s_waitcnt vmcnt(20)
  v_mfma_f32_16x16x32_bf16 v[32:35], a[144:147], v[128:131], v[32:35]
  s_add_u32 s70, s76, 57344
  v_mfma_f32_16x16x32_bf16 v[32:35], a[160:163], v[144:147], v[32:35]
  buffer_load_dwordx4 v[192:195], v2, s[20:23], s70 offen
  v_mfma_f32_16x16x32_bf16 v[56:59], a[160:163], v[148:151], v[56:59]
  s_add_u32 s70, s74, 57344
  v_mfma_f32_16x16x32_bf16 v[56:59], a[144:147], v[132:135], v[56:59]
  buffer_load_dwordx4 v[196:199], v2, s[20:23], s70 offen
  v_mfma_f32_16x16x32_bf16 v[80:83], a[144:147], v[136:139], v[80:83]
  s_add_u32 s70, s75, 57344
  v_mfma_f32_16x16x32_bf16 v[80:83], a[160:163], v[152:155], v[80:83]
  buffer_load_dwordx4 v[200:203], v2, s[20:23], s70 offen
  v_mfma_f32_16x16x32_bf16 v[104:107], a[160:163], v[156:159], v[104:107]
  s_add_u32 s70, s78, 57344
  v_mfma_f32_16x16x32_bf16 v[104:107], a[144:147], v[140:143], v[104:107]
  buffer_load_dwordx4 v[204:207], v2, s[20:23], s70 offen
  v_mfma_f32_16x16x32_bf16 v[108:111], a[148:151], v[140:143], v[108:111]
  s_add_u32 s70, s76, 59392
  v_mfma_f32_16x16x32_bf16 v[108:111], a[164:167], v[156:159], v[108:111]
  buffer_load_dwordx4 v[208:211], v2, s[20:23], s70 offen
  v_mfma_f32_16x16x32_bf16 v[84:87], a[164:167], v[152:155], v[84:87]
  s_add_u32 s70, s74, 59392
  v_mfma_f32_16x16x32_bf16 v[84:87], a[148:151], v[136:139], v[84:87]
  buffer_load_dwordx4 v[212:215], v2, s[20:23], s70 offen
  v_mfma_f32_16x16x32_bf16 v[60:63], a[148:151], v[132:135], v[60:63]
  s_add_u32 s70, s75, 59392
  v_mfma_f32_16x16x32_bf16 v[60:63], a[164:167], v[148:151], v[60:63]
  buffer_load_dwordx4 v[216:219], v2, s[20:23], s70 offen
  v_mfma_f32_16x16x32_bf16 v[36:39], a[164:167], v[144:147], v[36:39]
  s_add_u32 s70, s78, 59392
  v_mfma_f32_16x16x32_bf16 v[36:39], a[148:151], v[128:131], v[36:39]
  buffer_load_dwordx4 v[220:223], v2, s[20:23], s70 offen
  v_mfma_f32_16x16x32_bf16 v[40:43], a[152:155], v[128:131], v[40:43]
  s_add_u32 s70, s77, 141312
  v_mfma_f32_16x16x32_bf16 v[40:43], a[168:171], v[144:147], v[40:43]
  buffer_load_dwordx4 v[232:235], v2, s[20:23], s70 offen
  v_mfma_f32_16x16x32_bf16 v[64:67], a[168:171], v[148:151], v[64:67]
  s_add_u32 s70, s77, 142336
  v_mfma_f32_16x16x32_bf16 v[64:67], a[152:155], v[132:135], v[64:67]
  buffer_load_dwordx4 v[236:239], v2, s[20:23], s70 offen
  v_mfma_f32_16x16x32_bf16 v[88:91], a[152:155], v[136:139], v[88:91]
  s_add_u32 s70, s77, 143360
  v_mfma_f32_16x16x32_bf16 v[88:91], a[168:171], v[152:155], v[88:91]
  buffer_load_dwordx4 v[240:243], v2, s[20:23], s70 offen
  v_mfma_f32_16x16x32_bf16 v[112:115], a[168:171], v[156:159], v[112:115]
  s_add_u32 s70, s77, 144384
  v_mfma_f32_16x16x32_bf16 v[112:115], a[152:155], v[140:143], v[112:115]
  buffer_load_dwordx4 v[244:247], v2, s[20:23], s70 offen
  v_mfma_f32_16x16x32_bf16 v[116:119], a[156:159], v[140:143], v[116:119]
  s_add_u32 s70, s77, 145408
  v_mfma_f32_16x16x32_bf16 v[116:119], a[172:175], v[156:159], v[116:119]
  buffer_load_dwordx4 v[248:251], v2, s[20:23], s70 offen
  v_mfma_f32_16x16x32_bf16 v[92:95], a[172:175], v[152:155], v[92:95]
  s_add_u32 s70, s77, 146432
  v_mfma_f32_16x16x32_bf16 v[92:95], a[156:159], v[136:139], v[92:95]
  buffer_load_dwordx4 v[252:255], v2, s[20:23], s70 offen
  v_mfma_f32_16x16x32_bf16 v[68:71], a[156:159], v[132:135], v[68:71]
  v_mfma_f32_16x16x32_bf16 v[68:71], a[172:175], v[148:151], v[68:71]
  v_mfma_f32_16x16x32_bf16 v[44:47], a[172:175], v[144:147], v[44:47]
  v_mfma_f32_16x16x32_bf16 v[44:47], a[156:159], v[128:131], v[44:47]
  v_mfma_f32_16x16x32_bf16 v[48:51], a[176:179], v[128:131], v[48:51]
  v_mfma_f32_16x16x32_bf16 v[52:55], a[176:179], v[144:147], v[52:55]
  v_mfma_f32_16x16x32_bf16 v[76:79], a[176:179], v[148:151], v[76:79]
  v_mfma_f32_16x16x32_bf16 v[72:75], a[176:179], v[132:135], v[72:75]
  v_mfma_f32_16x16x32_bf16 v[96:99], a[176:179], v[136:139], v[96:99]
  v_mfma_f32_16x16x32_bf16 v[100:103], a[176:179], v[152:155], v[100:103]
  v_mfma_f32_16x16x32_bf16 v[124:127], a[176:179], v[156:159], v[124:127]
  v_mfma_f32_16x16x32_bf16 v[120:123], a[176:179], v[140:143], v[120:123]
  s_waitcnt vmcnt(20)
  v_mfma_f32_16x16x32_bf16 v[32:35], a[180:183], v[160:163], v[32:35]
  s_add_u32 s70, s76, 61440
  v_mfma_f32_16x16x32_bf16 v[32:35], a[196:199], v[176:179], v[32:35]
  buffer_load_dwordx4 v[128:131], v2, s[20:23], s70 offen
  v_mfma_f32_16x16x32_bf16 v[56:59], a[196:199], v[180:183], v[56:59]
  s_add_u32 s70, s74, 61440
  v_mfma_f32_16x16x32_bf16 v[56:59], a[180:183], v[164:167], v[56:59]
  buffer_load_dwordx4 v[132:135], v2, s[20:23], s70 offen
  v_mfma_f32_16x16x32_bf16 v[80:83], a[180:183], v[168:171], v[80:83]
  s_add_u32 s70, s75, 61440
  v_mfma_f32_16x16x32_bf16 v[80:83], a[196:199], v[184:187], v[80:83]
  buffer_load_dwordx4 v[136:139], v2, s[20:23], s70 offen
  v_mfma_f32_16x16x32_bf16 v[104:107], a[196:199], v[188:191], v[104:107]
  s_add_u32 s70, s78, 61440
  v_mfma_f32_16x16x32_bf16 v[104:107], a[180:183], v[172:175], v[104:107]
  buffer_load_dwordx4 v[140:143], v2, s[20:23], s70 offen
  v_mfma_f32_16x16x32_bf16 v[108:111], a[184:187], v[172:175], v[108:111]
  s_add_u32 s70, s76, 63488
  v_mfma_f32_16x16x32_bf16 v[108:111], a[200:203], v[188:191], v[108:111]
  buffer_load_dwordx4 v[144:147], v2, s[20:23], s70 offen
  v_mfma_f32_16x16x32_bf16 v[84:87], a[200:203], v[184:187], v[84:87]
  s_add_u32 s70, s74, 63488
  v_mfma_f32_16x16x32_bf16 v[84:87], a[184:187], v[168:171], v[84:87]
  buffer_load_dwordx4 v[148:151], v2, s[20:23], s70 offen
  v_mfma_f32_16x16x32_bf16 v[60:63], a[184:187], v[164:167], v[60:63]
  s_add_u32 s70, s75, 63488
  v_mfma_f32_16x16x32_bf16 v[60:63], a[200:203], v[180:183], v[60:63]
  buffer_load_dwordx4 v[152:155], v2, s[20:23], s70 offen
  v_mfma_f32_16x16x32_bf16 v[36:39], a[200:203], v[176:179], v[36:39]
  s_add_u32 s70, s78, 63488
  v_mfma_f32_16x16x32_bf16 v[36:39], a[184:187], v[160:163], v[36:39]
  buffer_load_dwordx4 v[156:159], v2, s[20:23], s70 offen
  v_mfma_f32_16x16x32_bf16 v[40:43], a[188:191], v[160:163], v[40:43]
  s_mov_b32 s70, 57671680
  v_mfma_f32_16x16x32_bf16 v[40:43], a[204:207], v[176:179], v[40:43]
  buffer_load_dword v7, v7, s[20:23], s70 offen sc1
  v_mfma_f32_16x16x32_bf16 v[64:67], a[204:207], v[180:183], v[64:67]
  s_nop 0
  v_mfma_f32_16x16x32_bf16 v[64:67], a[188:191], v[164:167], v[64:67]
  buffer_load_dwordx2 v[8:9], v6, s[12:15], 0 offen offset:0
  v_mfma_f32_16x16x32_bf16 v[88:91], a[188:191], v[168:171], v[88:91]
  s_nop 0
  v_mfma_f32_16x16x32_bf16 v[88:91], a[204:207], v[184:187], v[88:91]
  buffer_load_dwordx2 v[10:11], v6, s[12:15], 0 offen offset:32
  v_mfma_f32_16x16x32_bf16 v[112:115], a[204:207], v[188:191], v[112:115]
  s_nop 0
  v_mfma_f32_16x16x32_bf16 v[112:115], a[188:191], v[172:175], v[112:115]
  buffer_load_dwordx2 v[12:13], v6, s[12:15], 0 offen offset:64
  v_mfma_f32_16x16x32_bf16 v[116:119], a[192:195], v[172:175], v[116:119]
  s_nop 0
  v_mfma_f32_16x16x32_bf16 v[116:119], a[208:211], v[188:191], v[116:119]
  buffer_load_dwordx2 v[14:15], v6, s[12:15], 0 offen offset:96
  v_mfma_f32_16x16x32_bf16 v[92:95], a[208:211], v[184:187], v[92:95]
  s_nop 0
  v_mfma_f32_16x16x32_bf16 v[92:95], a[192:195], v[168:171], v[92:95]
  buffer_load_dwordx2 v[16:17], v6, s[12:15], 0 offen offset:128
  v_mfma_f32_16x16x32_bf16 v[68:71], a[192:195], v[164:167], v[68:71]
  v_mfma_f32_16x16x32_bf16 v[68:71], a[208:211], v[180:183], v[68:71]
  v_mfma_f32_16x16x32_bf16 v[44:47], a[208:211], v[176:179], v[44:47]
  v_mfma_f32_16x16x32_bf16 v[44:47], a[192:195], v[160:163], v[44:47]
  v_mfma_f32_16x16x32_bf16 v[48:51], a[212:215], v[160:163], v[48:51]
  v_mfma_f32_16x16x32_bf16 v[52:55], a[212:215], v[176:179], v[52:55]
  v_mfma_f32_16x16x32_bf16 v[76:79], a[212:215], v[180:183], v[76:79]
  v_mfma_f32_16x16x32_bf16 v[72:75], a[212:215], v[164:167], v[72:75]
  v_mfma_f32_16x16x32_bf16 v[96:99], a[212:215], v[168:171], v[96:99]
  v_mfma_f32_16x16x32_bf16 v[100:103], a[212:215], v[184:187], v[100:103]
  v_mfma_f32_16x16x32_bf16 v[124:127], a[212:215], v[188:191], v[124:127]
  v_mfma_f32_16x16x32_bf16 v[120:123], a[212:215], v[172:175], v[120:123]
  s_waitcnt vmcnt(20)
  v_mfma_f32_16x16x32_bf16 v[32:35], a[216:219], v[192:195], v[32:35]
  v_mfma_f32_16x16x32_bf16 v[32:35], a[232:235], v[208:211], v[32:35]
  v_mfma_f32_16x16x32_bf16 v[56:59], a[232:235], v[212:215], v[56:59]
  v_mfma_f32_16x16x32_bf16 v[56:59], a[216:219], v[196:199], v[56:59]
  v_mfma_f32_16x16x32_bf16 v[80:83], a[216:219], v[200:203], v[80:83]
  v_mfma_f32_16x16x32_bf16 v[80:83], a[232:235], v[216:219], v[80:83]
  v_mfma_f32_16x16x32_bf16 v[104:107], a[232:235], v[220:223], v[104:107]
  v_mfma_f32_16x16x32_bf16 v[104:107], a[216:219], v[204:207], v[104:107]
  v_mfma_f32_16x16x32_bf16 v[108:111], a[220:223], v[204:207], v[108:111]
  v_mfma_f32_16x16x32_bf16 v[108:111], a[236:239], v[220:223], v[108:111]
  v_mfma_f32_16x16x32_bf16 v[84:87], a[236:239], v[216:219], v[84:87]
  v_mfma_f32_16x16x32_bf16 v[84:87], a[220:223], v[200:203], v[84:87]
  v_mfma_f32_16x16x32_bf16 v[60:63], a[220:223], v[196:199], v[60:63]
  v_mfma_f32_16x16x32_bf16 v[60:63], a[236:239], v[212:215], v[60:63]
  v_mfma_f32_16x16x32_bf16 v[36:39], a[236:239], v[208:211], v[36:39]
  v_mfma_f32_16x16x32_bf16 v[36:39], a[220:223], v[192:195], v[36:39]
  v_mfma_f32_16x16x32_bf16 v[40:43], a[224:227], v[192:195], v[40:43]
  v_mfma_f32_16x16x32_bf16 v[40:43], a[240:243], v[208:211], v[40:43]
  v_mfma_f32_16x16x32_bf16 v[64:67], a[240:243], v[212:215], v[64:67]
  v_mfma_f32_16x16x32_bf16 v[64:67], a[224:227], v[196:199], v[64:67]
  v_mfma_f32_16x16x32_bf16 v[88:91], a[224:227], v[200:203], v[88:91]
  v_mfma_f32_16x16x32_bf16 v[88:91], a[240:243], v[216:219], v[88:91]
  v_mfma_f32_16x16x32_bf16 v[112:115], a[240:243], v[220:223], v[112:115]
  v_mfma_f32_16x16x32_bf16 v[112:115], a[224:227], v[204:207], v[112:115]
  v_mfma_f32_16x16x32_bf16 v[116:119], a[228:231], v[204:207], v[116:119]
  v_mfma_f32_16x16x32_bf16 v[116:119], a[244:247], v[220:223], v[116:119]
  v_mfma_f32_16x16x32_bf16 v[92:95], a[244:247], v[216:219], v[92:95]
  v_mfma_f32_16x16x32_bf16 v[92:95], a[228:231], v[200:203], v[92:95]
  v_mfma_f32_16x16x32_bf16 v[68:71], a[228:231], v[196:199], v[68:71]
  v_mfma_f32_16x16x32_bf16 v[68:71], a[244:247], v[212:215], v[68:71]
  v_mfma_f32_16x16x32_bf16 v[44:47], a[244:247], v[208:211], v[44:47]
  v_mfma_f32_16x16x32_bf16 v[44:47], a[228:231], v[192:195], v[44:47]
  v_mfma_f32_16x16x32_bf16 v[48:51], a[248:251], v[192:195], v[48:51]
  v_mfma_f32_16x16x32_bf16 v[52:55], a[248:251], v[208:211], v[52:55]
  v_mfma_f32_16x16x32_bf16 v[76:79], a[248:251], v[212:215], v[76:79]
  v_mfma_f32_16x16x32_bf16 v[72:75], a[248:251], v[196:199], v[72:75]
  v_mfma_f32_16x16x32_bf16 v[96:99], a[248:251], v[200:203], v[96:99]
  v_mfma_f32_16x16x32_bf16 v[100:103], a[248:251], v[216:219], v[100:103]
  v_mfma_f32_16x16x32_bf16 v[124:127], a[248:251], v[220:223], v[124:127]
  v_mfma_f32_16x16x32_bf16 v[120:123], a[248:251], v[204:207], v[120:123]
  s_waitcnt vmcnt(6)
  v_mfma_f32_16x16x32_bf16 v[32:35], a[252:255], v[128:131], v[32:35]
  v_mfma_f32_16x16x32_bf16 v[32:35], v[236:239], v[144:147], v[32:35]
  v_mfma_f32_16x16x32_bf16 v[56:59], v[236:239], v[148:151], v[56:59]
  v_mfma_f32_16x16x32_bf16 v[56:59], a[252:255], v[132:135], v[56:59]
  v_mfma_f32_16x16x32_bf16 v[80:83], a[252:255], v[136:139], v[80:83]
  v_mfma_f32_16x16x32_bf16 v[80:83], v[236:239], v[152:155], v[80:83]
  v_mfma_f32_16x16x32_bf16 v[104:107], v[236:239], v[156:159], v[104:107]
  v_mfma_f32_16x16x32_bf16 v[104:107], a[252:255], v[140:143], v[104:107]
  v_mfma_f32_16x16x32_bf16 v[108:111], v[224:227], v[140:143], v[108:111]
  v_mfma_f32_16x16x32_bf16 v[108:111], v[240:243], v[156:159], v[108:111]
  v_mfma_f32_16x16x32_bf16 v[84:87], v[240:243], v[152:155], v[84:87]
  v_mfma_f32_16x16x32_bf16 v[84:87], v[224:227], v[136:139], v[84:87]
  v_mfma_f32_16x16x32_bf16 v[60:63], v[224:227], v[132:135], v[60:63]
  v_mfma_f32_16x16x32_bf16 v[60:63], v[240:243], v[148:151], v[60:63]
  v_mfma_f32_16x16x32_bf16 v[36:39], v[240:243], v[144:147], v[36:39]
  v_mfma_f32_16x16x32_bf16 v[36:39], v[224:227], v[128:131], v[36:39]
  v_mfma_f32_16x16x32_bf16 v[40:43], v[228:231], v[128:131], v[40:43]
  v_mfma_f32_16x16x32_bf16 v[40:43], v[244:247], v[144:147], v[40:43]
  v_mfma_f32_16x16x32_bf16 v[64:67], v[244:247], v[148:151], v[64:67]
  v_mfma_f32_16x16x32_bf16 v[64:67], v[228:231], v[132:135], v[64:67]
  v_mfma_f32_16x16x32_bf16 v[88:91], v[228:231], v[136:139], v[88:91]
  v_mfma_f32_16x16x32_bf16 v[88:91], v[244:247], v[152:155], v[88:91]
  v_mfma_f32_16x16x32_bf16 v[112:115], v[244:247], v[156:159], v[112:115]
  v_mfma_f32_16x16x32_bf16 v[112:115], v[228:231], v[140:143], v[112:115]
  v_mfma_f32_16x16x32_bf16 v[116:119], v[232:235], v[140:143], v[116:119]
  v_mfma_f32_16x16x32_bf16 v[116:119], v[248:251], v[156:159], v[116:119]
  v_mfma_f32_16x16x32_bf16 v[92:95], v[248:251], v[152:155], v[92:95]
  v_mfma_f32_16x16x32_bf16 v[92:95], v[232:235], v[136:139], v[92:95]
  v_mfma_f32_16x16x32_bf16 v[68:71], v[232:235], v[132:135], v[68:71]
  v_mfma_f32_16x16x32_bf16 v[68:71], v[248:251], v[148:151], v[68:71]
  v_mfma_f32_16x16x32_bf16 v[44:47], v[248:251], v[144:147], v[44:47]
  v_mfma_f32_16x16x32_bf16 v[44:47], v[232:235], v[128:131], v[44:47]
  v_mfma_f32_16x16x32_bf16 v[48:51], v[252:255], v[128:131], v[48:51]
  v_mfma_f32_16x16x32_bf16 v[52:55], v[252:255], v[144:147], v[52:55]
  v_mfma_f32_16x16x32_bf16 v[76:79], v[252:255], v[148:151], v[76:79]
  v_mfma_f32_16x16x32_bf16 v[72:75], v[252:255], v[132:135], v[72:75]
  v_mfma_f32_16x16x32_bf16 v[96:99], v[252:255], v[136:139], v[96:99]
  v_mfma_f32_16x16x32_bf16 v[100:103], v[252:255], v[152:155], v[100:103]
  v_mfma_f32_16x16x32_bf16 v[124:127], v[252:255], v[156:159], v[124:127]
  v_mfma_f32_16x16x32_bf16 v[120:123], v[252:255], v[140:143], v[120:123]
  s_nop 3
  v_permlane32_swap_b32 v76, v148
  v_permlane32_swap_b32 v77, v149
  v_permlane32_swap_b32 v78, v150
  v_permlane32_swap_b32 v79, v151
  ds_write_b128 v3, v[56:59] offset:0
  ds_write_b128 v3, v[60:63] offset:1024
  ds_write_b128 v3, v[64:67] offset:2048
  ds_write_b128 v3, v[68:71] offset:3072
  v_add_f32 v72, v72, v148
  v_add_f32 v73, v73, v149
  v_add_f32 v74, v74, v150
  v_add_f32 v75, v75, v151
  ds_write_b128 v3, v[72:75] offset:4096
  v_permlane32_swap_b32 v100, v148
  v_permlane32_swap_b32 v101, v149
  v_permlane32_swap_b32 v102, v150
  v_permlane32_swap_b32 v103, v151
  ds_write_b128 v4, v[80:83] offset:0
  ds_write_b128 v4, v[84:87] offset:1024
  ds_write_b128 v4, v[88:91] offset:2048
  ds_write_b128 v4, v[92:95] offset:3072
  v_add_f32 v96, v96, v148
  v_add_f32 v97, v97, v149
  v_add_f32 v98, v98, v150
  v_add_f32 v99, v99, v151
  ds_write_b128 v4, v[96:99] offset:4096
  v_permlane32_swap_b32 v124, v148
  v_permlane32_swap_b32 v125, v149
  v_permlane32_swap_b32 v126, v150
  v_permlane32_swap_b32 v127, v151
  ds_write_b128 v5, v[104:107] offset:0
  ds_write_b128 v5, v[108:111] offset:1024
  ds_write_b128 v5, v[112:115] offset:2048
  ds_write_b128 v5, v[116:119] offset:3072
  v_add_f32 v120, v120, v148
  v_add_f32 v121, v121, v149
  v_add_f32 v122, v122, v150
  v_add_f32 v123, v123, v151
  ds_write_b128 v5, v[120:123] offset:4096
  v_permlane32_swap_b32 v52, v148
  v_permlane32_swap_b32 v53, v149
  v_permlane32_swap_b32 v54, v150
  v_permlane32_swap_b32 v55, v151
  v_add_f32 v48, v48, v148
  v_add_f32 v49, v49, v149
  v_add_f32 v50, v50, v150
  v_add_f32 v51, v51, v151
  s_waitcnt vmcnt(0)
  v_sub_f32 v19, 1.0, v7
  v_cvt_pk_bf16_f32 v19, v19, v19
  v_and_b32 v19, 0xffff0000, v19
  v_lshlrev_b32 v128, 16, v8
  v_and_b32 v129, 0xffff0000, v8
  v_lshlrev_b32 v130, 16, v9
  v_and_b32 v131, 0xffff0000, v9
  v_lshlrev_b32 v132, 16, v10
  v_and_b32 v133, 0xffff0000, v10
  v_lshlrev_b32 v134, 16, v11
  v_and_b32 v135, 0xffff0000, v11
  v_lshlrev_b32 v136, 16, v12
  v_and_b32 v137, 0xffff0000, v12
  v_lshlrev_b32 v138, 16, v13
  v_and_b32 v139, 0xffff0000, v13
  v_lshlrev_b32 v140, 16, v14
  v_and_b32 v141, 0xffff0000, v14
  v_lshlrev_b32 v142, 16, v15
  v_and_b32 v143, 0xffff0000, v15
  v_lshlrev_b32 v144, 16, v16
  v_and_b32 v145, 0xffff0000, v16
  v_lshlrev_b32 v146, 16, v17
  v_and_b32 v147, 0xffff0000, v17
  s_lshr_b32 s70, s94, 6
  s_cmp_eq_u32 s70, s79
  s_cbranch_scc0 L_noy_114
  s_waitcnt lgkmcnt(0)
  s_mov_b32 exec_hi, 0x3fffff
  v_accvgpr_read_b32 v56, a0
  v_accvgpr_read_b32 v57, a1
  v_accvgpr_read_b32 v58, a2
  v_accvgpr_read_b32 v59, a3
  v_accvgpr_read_b32 v60, a4
  v_accvgpr_read_b32 v61, a5
  v_accvgpr_read_b32 v62, a6
  v_accvgpr_read_b32 v63, a7
  v_accvgpr_read_b32 v64, a8
  v_accvgpr_read_b32 v65, a9
  v_accvgpr_read_b32 v66, a10
  v_accvgpr_read_b32 v67, a11
  v_accvgpr_read_b32 v68, a12
  v_accvgpr_read_b32 v69, a13
  v_accvgpr_read_b32 v70, a14
  v_accvgpr_read_b32 v71, a15
  v_accvgpr_read_b32 v72, a16
  v_accvgpr_read_b32 v73, a17
  v_accvgpr_read_b32 v74, a18
  v_accvgpr_read_b32 v75, a19
  v_accvgpr_read_b32 v76, a20
  v_accvgpr_read_b32 v77, a21
  v_accvgpr_read_b32 v78, a22
  v_accvgpr_read_b32 v79, a23
  v_accvgpr_read_b32 v80, a24
  v_accvgpr_read_b32 v81, a25
  v_accvgpr_read_b32 v82, a26
  v_accvgpr_read_b32 v83, a27
  v_accvgpr_read_b32 v84, a28
  v_accvgpr_read_b32 v85, a29
  v_accvgpr_read_b32 v86, a30
  v_accvgpr_read_b32 v87, a31
  v_accvgpr_read_b32 v88, a32
  v_accvgpr_read_b32 v89, a33
  v_accvgpr_read_b32 v90, a34
  v_accvgpr_read_b32 v91, a35
  v_accvgpr_read_b32 v92, a36
  v_accvgpr_read_b32 v93, a37
  v_accvgpr_read_b32 v94, a38
  v_accvgpr_read_b32 v95, a39
  v_accvgpr_read_b32 v96, a40
  v_accvgpr_read_b32 v97, a41
  v_accvgpr_read_b32 v98, a42
  v_accvgpr_read_b32 v99, a43
  v_accvgpr_read_b32 v100, a44
  v_accvgpr_read_b32 v101, a45
  v_accvgpr_read_b32 v102, a46
  v_accvgpr_read_b32 v103, a47
  v_pk_add_f32 v[56:57], v[56:57], v[60:61]
  v_pk_add_f32 v[58:59], v[58:59], v[62:63]
  v_pk_add_f32 v[56:57], v[56:57], v[64:65]
  v_pk_add_f32 v[58:59], v[58:59], v[66:67]
  v_pk_add_f32 v[56:57], v[56:57], v[68:69]
  v_pk_add_f32 v[58:59], v[58:59], v[70:71]
  v_pk_add_f32 v[56:57], v[56:57], v[72:73]
  v_pk_add_f32 v[58:59], v[58:59], v[74:75]
  v_pk_add_f32 v[56:57], v[56:57], v[76:77]
  v_pk_add_f32 v[58:59], v[58:59], v[78:79]
  v_pk_add_f32 v[56:57], v[56:57], v[80:81]
  v_pk_add_f32 v[58:59], v[58:59], v[82:83]
  v_pk_add_f32 v[56:57], v[56:57], v[84:85]
  v_pk_add_f32 v[58:59], v[58:59], v[86:87]
  v_pk_add_f32 v[56:57], v[56:57], v[88:89]
  v_pk_add_f32 v[58:59], v[58:59], v[90:91]
  v_pk_add_f32 v[56:57], v[56:57], v[92:93]
  v_pk_add_f32 v[58:59], v[58:59], v[94:95]
  v_pk_add_f32 v[56:57], v[56:57], v[96:97]
  v_pk_add_f32 v[58:59], v[58:59], v[98:99]
  v_pk_add_f32 v[56:57], v[56:57], v[100:101]
  v_pk_add_f32 v[58:59], v[58:59], v[102:103]
  ds_write_b128 v27, v[56:59]
  s_mov_b64 exec, -1
L_noy_114:
  s_waitcnt lgkmcnt(0)
  s_barrier
  ds_read_b128 v[160:163], v18 offset:0
  ds_read_b128 v[164:167], v18 offset:1024
  ds_read_b128 v[168:171], v18 offset:2048
  ds_read_b128 v[172:175], v18 offset:3072
  ds_read_b128 v[176:179], v18 offset:4096
  ds_read_b128 v[180:183], v18 offset:5120
  ds_read_b128 v[184:187], v18 offset:6144
  ds_read_b128 v[188:191], v18 offset:7168
  ds_read_b128 v[192:195], v18 offset:8192
  ds_read_b128 v[196:199], v18 offset:9216
  ds_read_b128 v[200:203], v18 offset:10240
  ds_read_b128 v[204:207], v18 offset:11264
  ds_read_b128 v[208:211], v18 offset:12288
  ds_read_b128 v[212:215], v18 offset:13312
  ds_read_b128 v[216:219], v18 offset:14336
  s_lshr_b32 s70, s94, 4
  s_lshl_b32 s71, s79, 2
  s_add_u32 s71, s71, s34
  s_cmp_eq_u32 s70, s71
  s_cbranch_scc0 L_noy_115
  v_min_u32 v24, 17, v1
  v_lshlrev_b32 v24, 4, v24
  v_add_u32 v24, 90112, v24
  s_waitcnt lgkmcnt(0)
  ds_read_b128 v[56:59], v24 offset:0
  ds_read_b128 v[60:63], v24 offset:288
  ds_read_b128 v[64:67], v24 offset:576
  ds_read_b128 v[68:71], v24 offset:864
  ds_read_b128 v[72:75], v24 offset:1152
  ds_read_b128 v[76:79], v24 offset:1440
  ds_read_b128 v[80:83], v24 offset:1728
  ds_read_b128 v[84:87], v24 offset:2016
  ds_read_b128 v[88:91], v24 offset:2304
  ds_read_b128 v[92:95], v24 offset:2592
  ds_read_b128 v[96:99], v24 offset:2880
  ds_read_b128 v[100:103], v24 offset:3168
  s_waitcnt lgkmcnt(0)
  v_pk_add_f32 v[56:57], v[56:57], v[60:61]
  v_pk_add_f32 v[58:59], v[58:59], v[62:63]
  v_pk_add_f32 v[56:57], v[56:57], v[64:65]
  v_pk_add_f32 v[58:59], v[58:59], v[66:67]
  v_pk_add_f32 v[56:57], v[56:57], v[68:69]
  v_pk_add_f32 v[58:59], v[58:59], v[70:71]
  v_pk_add_f32 v[56:57], v[56:57], v[72:73]
  v_pk_add_f32 v[58:59], v[58:59], v[74:75]
  v_pk_add_f32 v[56:57], v[56:57], v[76:77]
  v_pk_add_f32 v[58:59], v[58:59], v[78:79]
  v_pk_add_f32 v[56:57], v[56:57], v[80:81]
  v_pk_add_f32 v[58:59], v[58:59], v[82:83]
  v_pk_add_f32 v[56:57], v[56:57], v[84:85]
  v_pk_add_f32 v[58:59], v[58:59], v[86:87]
  v_pk_add_f32 v[56:57], v[56:57], v[88:89]
  v_pk_add_f32 v[58:59], v[58:59], v[90:91]
  v_pk_add_f32 v[56:57], v[56:57], v[92:93]
  v_pk_add_f32 v[58:59], v[58:59], v[94:95]
  v_pk_add_f32 v[56:57], v[56:57], v[96:97]
  v_pk_add_f32 v[58:59], v[58:59], v[98:99]
  v_pk_add_f32 v[56:57], v[56:57], v[100:101]
  v_pk_add_f32 v[58:59], v[58:59], v[102:103]
  v_cvt_pk_bf16_f32 v56, v56, v56
  v_and_b32 v56, 0xffff0000, v56
  v_mul_f32 v56, s95, v56
  v_cvt_pk_bf16_f32 v56, v56, v56
  v_and_b32 v56, 0xffff0000, v56
  v_cvt_pk_bf16_f32 v57, v57, v57
  v_and_b32 v57, 0xffff0000, v57
  v_mul_f32 v57, s95, v57
  v_cvt_pk_bf16_f32 v57, v57, v57
  v_and_b32 v57, 0xffff0000, v57
  v_cvt_pk_bf16_f32 v58, v58, v58
  v_and_b32 v58, 0xffff0000, v58
  v_mul_f32 v58, s95, v58
  v_cvt_pk_bf16_f32 v58, v58, v58
  v_and_b32 v58, 0xffff0000, v58
  v_cvt_pk_bf16_f32 v59, v59, v59
  v_and_b32 v59, 0xffff0000, v59
  v_mul_f32 v59, s95, v59
  v_cvt_pk_bf16_f32 v59, v59, v59
  v_and_b32 v59, 0xffff0000, v59
  ds_write_b128 v24, v[56:59] offset:4096
  v_lshrrev_b32 v25, 4, v1
  v_lshlrev_b32 v25, 4, v25
  v_add_u32 v25, 94208, v25
  v_and_b32 v26, 15, v1
  s_and_b32 s70, s94, 15
  v_cmp_eq_u32 vcc, s70, v26
  s_waitcnt lgkmcnt(0)
  ds_read_b128 v[56:59], v25 offset:0
  ds_read_b128 v[60:63], v25 offset:64
  ds_read_b128 v[64:67], v25 offset:128
  ds_read_b128 v[68:71], v25 offset:192
  ds_read_b128 v[72:75], v25 offset:256
  s_waitcnt lgkmcnt(0)
  s_mov_b64 exec, vcc
  v_add_f32 v128, v128, v56
  v_cvt_pk_bf16_f32 v128, v128, v128
  v_and_b32 v128, 0xffff0000, v128
  v_add_f32 v129, v129, v57
  v_cvt_pk_bf16_f32 v129, v129, v129
  v_and_b32 v129, 0xffff0000, v129
  v_add_f32 v130, v130, v58
  v_cvt_pk_bf16_f32 v130, v130, v130
  v_and_b32 v130, 0xffff0000, v130
  v_add_f32 v131, v131, v59
  v_cvt_pk_bf16_f32 v131, v131, v131
  v_and_b32 v131, 0xffff0000, v131
  v_add_f32 v132, v132, v60
  v_cvt_pk_bf16_f32 v132, v132, v132
  v_and_b32 v132, 0xffff0000, v132
  v_add_f32 v133, v133, v61
  v_cvt_pk_bf16_f32 v133, v133, v133
  v_and_b32 v133, 0xffff0000, v133
  v_add_f32 v134, v134, v62
  v_cvt_pk_bf16_f32 v134, v134, v134
  v_and_b32 v134, 0xffff0000, v134
  v_add_f32 v135, v135, v63
  v_cvt_pk_bf16_f32 v135, v135, v135
  v_and_b32 v135, 0xffff0000, v135
  v_add_f32 v136, v136, v64
  v_cvt_pk_bf16_f32 v136, v136, v136
  v_and_b32 v136, 0xffff0000, v136
  v_add_f32 v137, v137, v65
  v_cvt_pk_bf16_f32 v137, v137, v137
  v_and_b32 v137, 0xffff0000, v137
  v_add_f32 v138, v138, v66
  v_cvt_pk_bf16_f32 v138, v138, v138
  v_and_b32 v138, 0xffff0000, v138
  v_add_f32 v139, v139, v67
  v_cvt_pk_bf16_f32 v139, v139, v139
  v_and_b32 v139, 0xffff0000, v139
  v_add_f32 v140, v140, v68
  v_cvt_pk_bf16_f32 v140, v140, v140
  v_and_b32 v140, 0xffff0000, v140
  v_add_f32 v141, v141, v69
  v_cvt_pk_bf16_f32 v141, v141, v141
  v_and_b32 v141, 0xffff0000, v141
  v_add_f32 v142, v142, v70
  v_cvt_pk_bf16_f32 v142, v142, v142
  v_and_b32 v142, 0xffff0000, v142
  v_add_f32 v143, v143, v71
  v_cvt_pk_bf16_f32 v143, v143, v143
  v_and_b32 v143, 0xffff0000, v143
  v_add_f32 v144, v144, v72
  v_cvt_pk_bf16_f32 v144, v144, v144
  v_and_b32 v144, 0xffff0000, v144
  v_add_f32 v145, v145, v73
  v_cvt_pk_bf16_f32 v145, v145, v145
  v_and_b32 v145, 0xffff0000, v145
  v_add_f32 v146, v146, v74
  v_cvt_pk_bf16_f32 v146, v146, v146
  v_and_b32 v146, 0xffff0000, v146
  v_add_f32 v147, v147, v75
  v_cvt_pk_bf16_f32 v147, v147, v147
  v_and_b32 v147, 0xffff0000, v147
  s_mov_b64 exec, -1
L_noy_115:
  v_mul_f32 v128, v19, v128
  v_mul_f32 v129, v19, v129
  v_mul_f32 v130, v19, v130
  v_mul_f32 v131, v19, v131
  v_mul_f32 v132, v19, v132
  v_mul_f32 v133, v19, v133
  v_mul_f32 v134, v19, v134
  v_mul_f32 v135, v19, v135
  v_mul_f32 v136, v19, v136
  v_mul_f32 v137, v19, v137
  v_mul_f32 v138, v19, v138
  v_mul_f32 v139, v19, v139
  v_mul_f32 v140, v19, v140
  v_mul_f32 v141, v19, v141
  v_mul_f32 v142, v19, v142
  v_mul_f32 v143, v19, v143
  v_mul_f32 v144, v19, v144
  v_mul_f32 v145, v19, v145
  v_mul_f32 v146, v19, v146
  v_mul_f32 v147, v19, v147
  s_waitcnt lgkmcnt(4)
  v_pk_add_f32 v[32:33], v[32:33], v[160:161]
  v_pk_add_f32 v[34:35], v[34:35], v[162:163]
  v_pk_add_f32 v[32:33], v[32:33], v[180:181]
  v_pk_add_f32 v[34:35], v[34:35], v[182:183]
  v_pk_add_f32 v[32:33], v[32:33], v[200:201]
  v_pk_add_f32 v[34:35], v[34:35], v[202:203]
  v_fmac_f32 v128, v7, v32
  v_fmac_f32 v129, v7, v33
  v_fmac_f32 v130, v7, v34
  v_fmac_f32 v131, v7, v35
  v_cvt_pk_bf16_f32 v128, v128, v129
  v_cvt_pk_bf16_f32 v129, v130, v131
  buffer_store_dwordx2 v[128:129], v6, s[24:27], 0 offen offset:0
  s_waitcnt lgkmcnt(3)
  v_pk_add_f32 v[36:37], v[36:37], v[164:165]
  v_pk_add_f32 v[38:39], v[38:39], v[166:167]
  v_pk_add_f32 v[36:37], v[36:37], v[184:185]
  v_pk_add_f32 v[38:39], v[38:39], v[186:187]
  v_pk_add_f32 v[36:37], v[36:37], v[204:205]
  v_pk_add_f32 v[38:39], v[38:39], v[206:207]
  v_fmac_f32 v132, v7, v36
  v_fmac_f32 v133, v7, v37
  v_fmac_f32 v134, v7, v38
  v_fmac_f32 v135, v7, v39
  v_cvt_pk_bf16_f32 v132, v132, v133
  v_cvt_pk_bf16_f32 v133, v134, v135
  buffer_store_dwordx2 v[132:133], v6, s[24:27], 0 offen offset:32
  s_waitcnt lgkmcnt(2)
  v_pk_add_f32 v[40:41], v[40:41], v[168:169]
  v_pk_add_f32 v[42:43], v[42:43], v[170:171]
  v_pk_add_f32 v[40:41], v[40:41], v[188:189]
  v_pk_add_f32 v[42:43], v[42:43], v[190:191]
  v_pk_add_f32 v[40:41], v[40:41], v[208:209]
  v_pk_add_f32 v[42:43], v[42:43], v[210:211]
  v_fmac_f32 v136, v7, v40
  v_fmac_f32 v137, v7, v41
  v_fmac_f32 v138, v7, v42
  v_fmac_f32 v139, v7, v43
  v_cvt_pk_bf16_f32 v136, v136, v137
  v_cvt_pk_bf16_f32 v137, v138, v139
  buffer_store_dwordx2 v[136:137], v6, s[24:27], 0 offen offset:64
  s_waitcnt lgkmcnt(1)
  v_pk_add_f32 v[44:45], v[44:45], v[172:173]
  v_pk_add_f32 v[46:47], v[46:47], v[174:175]
  v_pk_add_f32 v[44:45], v[44:45], v[192:193]
  v_pk_add_f32 v[46:47], v[46:47], v[194:195]
  v_pk_add_f32 v[44:45], v[44:45], v[212:213]
  v_pk_add_f32 v[46:47], v[46:47], v[214:215]
  v_fmac_f32 v140, v7, v44
  v_fmac_f32 v141, v7, v45
  v_fmac_f32 v142, v7, v46
  v_fmac_f32 v143, v7, v47
  v_cvt_pk_bf16_f32 v140, v140, v141
  v_cvt_pk_bf16_f32 v141, v142, v143
  buffer_store_dwordx2 v[140:141], v6, s[24:27], 0 offen offset:96
  s_waitcnt lgkmcnt(0)
  v_pk_add_f32 v[48:49], v[48:49], v[176:177]
  v_pk_add_f32 v[50:51], v[50:51], v[178:179]
  v_pk_add_f32 v[48:49], v[48:49], v[196:197]
  v_pk_add_f32 v[50:51], v[50:51], v[198:199]
  v_pk_add_f32 v[48:49], v[48:49], v[216:217]
  v_pk_add_f32 v[50:51], v[50:51], v[218:219]
  v_fmac_f32 v144, v7, v48
  v_fmac_f32 v145, v7, v49
  v_fmac_f32 v146, v7, v50
  v_fmac_f32 v147, v7, v51
  v_cvt_pk_bf16_f32 v144, v144, v145
  v_cvt_pk_bf16_f32 v145, v146, v147
  s_mov_b32 exec_hi, 0
  buffer_store_dwordx2 v[144:145], v6, s[24:27], 0 offen offset:128
  s_mov_b64 exec, -1
  s_waitcnt vmcnt(0)
L_end:
  s_endpgm
L_dlast31:
  v_add_f32 v32, v108, v80
  v_add_f32 v33, v109, v81
  v_add_f32 v34, v110, v82
  v_add_f32 v35, v111, v83
  v_mov_b32 v36, 0xff800000
  v_mov_b32 v37, 0xff800000
  v_mov_b32 v38, 0xff800000
  v_mov_b32 v39, 0xff800000
  v_mov_b32 v40, v84
  v_mov_b32 v41, v85
  v_mov_b32 v42, v86
  v_mov_b32 v43, v87
  v_add_f32 v44, v108, v84
  v_add_f32 v45, v109, v85
  v_add_f32 v46, v110, v86
  v_add_f32 v47, v111, v87
  s_nop 1
  v_mfma_f32_16x16x32_bf16 v[32:35], a[64:67], a[0:3], v[32:35]
  v_exp_f32 v117, v61
  v_mfma_f32_16x16x32_bf16 v[32:35], a[68:71], a[4:7], v[32:35]
  v_cvt_pk_bf16_f32 v74, v112, v113
  v_mfma_f32_16x16x32_bf16 v[32:35], a[72:75], a[8:11], v[32:35]
  v_exp_f32 v118, v62
  v_mfma_f32_16x16x32_bf16 v[32:35], a[76:79], a[12:15], v[32:35]
  buffer_load_dword v125, v124, s[20:23], 0 offen sc1
  v_mfma_f32_16x16x32_bf16 v[40:43], a[76:79], a[28:31], v[40:43]
  v_exp_f32 v119, v63
  v_mfma_f32_16x16x32_bf16 v[40:43], a[72:75], a[24:27], v[40:43]
  v_cvt_pk_bf16_f32 v75, v114, v115
  v_mfma_f32_16x16x32_bf16 v[40:43], a[68:71], a[20:23], v[40:43]
  v_cvt_pk_bf16_f32 v78, v116, v117
  v_mfma_f32_16x16x32_bf16 v[40:43], a[64:67], a[16:19], v[40:43]
  s_waitcnt lgkmcnt(0)
  v_cvt_pk_bf16_f32 v79, v118, v119
  v_mfma_f32_16x16x32_bf16 v[36:39], a[80:83], a[0:3], v[36:39]
  s_nop 1
  v_mfma_f32_16x16x32_bf16 v[36:39], a[84:87], a[4:7], v[36:39]
  s_nop 0
  v_mfma_f32_16x16x32_bf16 v[104:107], a[128:131], v[72:75], v[100:103]
  v_exp_f32 v112, v32
  v_mfma_f32_16x16x32_bf16 v[104:107], a[132:135], v[76:79], v[104:107]
  v_exp_f32 v113, v33
  v_mfma_f32_16x16x32_bf16 v[36:39], a[88:91], a[8:11], v[36:39]
  s_nop 0
  s_mov_b32 s72, 58216448
  buffer_load_dwordx4 v[24:27], v126, s[20:23], s72 offen sc1
  v_mfma_f32_16x16x32_bf16 v[36:39], a[92:95], a[12:15], v[36:39]
  s_nop 0
  v_exp_f32 v114, v34
  v_mfma_f32_16x16x32_bf16 v[44:47], a[92:95], a[28:31], v[44:47]
  s_nop 0
  v_exp_f32 v115, v35
  v_mfma_f32_16x16x32_bf16 v[44:47], a[88:91], a[24:27], v[44:47]
  v_cmp_nge_f32 vcc, s87, v106
  v_mfma_f32_16x16x32_bf16 v[44:47], a[84:87], a[20:23], v[44:47]
  v_exp_f32 v116, v40
  v_mfma_f32_16x16x32_bf16 v[44:47], a[80:83], a[16:19], v[44:47]
  s_cbranch_vccnz L_rs_92
L_rr_93:
  v_exp_f32 v117, v41
  v_mfma_f32_16x16x32_bf16 v[192:195], a[96:99], v[72:75], v[192:195]
  v_cvt_pk_bf16_f32 v64, v112, v113
  v_mfma_f32_16x16x32_bf16 v[196:199], a[96:99], v[76:79], v[196:199]
  s_add_u32 s86, s86, 16384
  v_exp_f32 v118, v42
  v_mfma_f32_16x16x32_bf16 v[200:203], a[100:103], v[72:75], v[200:203]
  s_cmp_ge_u32 s86, 147456
  v_mfma_f32_16x16x32_bf16 v[204:207], a[100:103], v[76:79], v[204:207]
  s_cselect_b32 s86, 0, s86
  v_exp_f32 v119, v43
  v_mfma_f32_16x16x32_bf16 v[208:211], a[104:107], v[72:75], v[208:211]
  v_mov_b32 v100, v104
  v_mfma_f32_16x16x32_bf16 v[212:215], a[104:107], v[76:79], v[212:215]
  v_exp_f32 v112, v36
  v_mfma_f32_16x16x32_bf16 v[216:219], a[108:111], v[72:75], v[216:219]
  v_cvt_pk_bf16_f32 v65, v114, v115
  v_mfma_f32_16x16x32_bf16 v[220:223], a[108:111], v[76:79], v[220:223]
  v_exp_f32 v113, v37
  v_mfma_f32_16x16x32_bf16 v[224:227], a[112:115], v[72:75], v[224:227]
  v_cvt_pk_bf16_f32 v68, v116, v117
  v_mfma_f32_16x16x32_bf16 v[228:231], a[112:115], v[76:79], v[228:231]
  v_exp_f32 v114, v38
  v_mfma_f32_16x16x32_bf16 v[232:235], a[116:119], v[72:75], v[232:235]
  v_mfma_f32_16x16x32_bf16 v[236:239], a[116:119], v[76:79], v[236:239]
  v_exp_f32 v115, v39
  v_mfma_f32_16x16x32_bf16 v[240:243], a[120:123], v[72:75], v[240:243]
  v_cvt_pk_bf16_f32 v69, v118, v119
  v_mfma_f32_16x16x32_bf16 v[244:247], a[120:123], v[76:79], v[244:247]
  v_exp_f32 v116, v44
  v_mfma_f32_16x16x32_bf16 v[248:251], a[124:127], v[72:75], v[248:251]
  v_mov_b32 v101, v105
  v_mfma_f32_16x16x32_bf16 v[252:255], a[124:127], v[76:79], v[252:255]
  s_waitcnt vmcnt(0)
  v_add_u32 v3, s86, v2
  s_branch L_final
L_rs_20:
  s_call_b64 s[90:91], L_rescale_000
  s_branch L_rr_21
L_rs_22:
  s_call_b64 s[90:91], L_rescale_110
  s_branch L_rr_23
L_rs_24:
  s_call_b64 s[90:91], L_rescale_000
  s_branch L_rr_25
L_rs_26:
  s_call_b64 s[90:91], L_rescale_110
  s_branch L_rr_27
L_rs_28:
  s_call_b64 s[90:91], L_rescale_000
  s_branch L_rr_29
L_rs_30:
  s_call_b64 s[90:91], L_rescale_110
  s_branch L_rr_31
L_rs_32:
  s_call_b64 s[90:91], L_rescale_000
  s_branch L_rr_33
L_rs_34:
  s_call_b64 s[90:91], L_rescale_110
  s_branch L_rr_35
L_rs_36:
  s_call_b64 s[90:91], L_rescale_000
  s_branch L_rr_37
L_rs_38:
  s_call_b64 s[90:91], L_rescale_110
  s_branch L_rr_39
L_rs_40:
  s_call_b64 s[90:91], L_rescale_000
  s_branch L_rr_41
L_rs_42:
  s_call_b64 s[90:91], L_rescale_110
  s_branch L_rr_43
L_rs_44:
  s_call_b64 s[90:91], L_rescale_000
  s_branch L_rr_45
L_rs_46:
  s_call_b64 s[90:91], L_rescale_110
  s_branch L_rr_47
L_rs_48:
  s_call_b64 s[90:91], L_rescale_000
  s_branch L_rr_49
L_rs_50:
  s_call_b64 s[90:91], L_rescale_110
  s_branch L_rr_51
L_rs_52:
  s_call_b64 s[90:91], L_rescale_000
  s_branch L_rr_53
L_rs_54:
  s_call_b64 s[90:91], L_rescale_110
  s_branch L_rr_55
L_rs_56:
  s_call_b64 s[90:91], L_rescale_000
  s_branch L_rr_57
L_rs_58:
  s_call_b64 s[90:91], L_rescale_110
  s_branch L_rr_59
L_rs_60:
  s_call_b64 s[90:91], L_rescale_000
  s_branch L_rr_61
L_rs_62:
  s_call_b64 s[90:91], L_rescale_110
  s_branch L_rr_63
L_rs_64:
  s_call_b64 s[90:91], L_rescale_000
  s_branch L_rr_65
L_rs_68:
  s_call_b64 s[90:91], L_rescale_110
  s_branch L_rr_69
L_rs_70:
  s_call_b64 s[90:91], L_rescale_000
  s_branch L_rr_71
L_rs_74:
  s_call_b64 s[90:91], L_rescale_110
  s_branch L_rr_75
L_rs_76:
  s_call_b64 s[90:91], L_rescale_000
  s_branch L_rr_77
L_rs_80:
  s_call_b64 s[90:91], L_rescale_110
  s_branch L_rr_81
L_rs_82:
  s_call_b64 s[90:91], L_rescale_001
  s_branch L_rr_83
L_rs_86:
  s_call_b64 s[90:91], L_rescale_011
  s_branch L_rr_87
L_rs_88:
  s_call_b64 s[90:91], L_rescale_001
  s_branch L_rr_89
L_rs_90:
  s_call_b64 s[90:91], L_rescale_011
  s_branch L_rr_91
L_rs_92:
  s_call_b64 s[90:91], L_rescale_110
  s_branch L_rr_93
L_rs_94:
  s_call_b64 s[90:91], L_rescale_000
  s_branch L_rr_95
L_pub_66:
  s_add_u32 s71, s89, 20480
  v_mov_b32 v30, 1
  s_mov_b64 exec, 1
  buffer_store_dword v30, off, s[20:23], s71 sc1
  s_mov_b64 exec, -1
  s_branch L_pubr_67
L_pub_72:
  s_add_u32 s71, s89, 20480
  v_mov_b32 v30, 1
  s_mov_b64 exec, 1
  buffer_store_dword v30, off, s[20:23], s71 sc1
  s_mov_b64 exec, -1
  s_branch L_pubr_73
L_pub_78:
  s_add_u32 s71, s89, 20480
  v_mov_b32 v30, 1
  s_mov_b64 exec, 1
  buffer_store_dword v30, off, s[20:23], s71 sc1
  s_mov_b64 exec, -1
  s_branch L_pubr_79
L_pub_84:
  v_rcp_f32 v5, v100
  v_rcp_f32 v7, v101
  s_lshl_b32 s70, s37, 18
  s_lshl_b32 s71, s35, 13
  s_add_u32 s70, s70, s71
  s_add_u32 s70, s70, 34603008
  v_mov_b32 v6, v5
  v_mov_b32 v8, v7
  v_mov_b32 v9, v8
  v_mov_b32 v7, v6
  v_pk_mul_f32 v[192:193], v[192:193], v[6:7]
  v_pk_mul_f32 v[194:195], v[194:195], v[6:7]
  v_pk_mul_f32 v[200:201], v[200:201], v[6:7]
  v_pk_mul_f32 v[202:203], v[202:203], v[6:7]
  v_cvt_pk_bf16_f32 v192, v192, v193
  v_cvt_pk_bf16_f32 v193, v194, v195
  v_cvt_pk_bf16_f32 v194, v200, v201
  v_cvt_pk_bf16_f32 v195, v202, v203
  buffer_store_dwordx4 v[192:195], v2, s[20:23], s70 offen offset:0 sc1
  v_pk_mul_f32 v[196:197], v[196:197], v[8:9]
  v_pk_mul_f32 v[198:199], v[198:199], v[8:9]
  v_pk_mul_f32 v[204:205], v[204:205], v[8:9]
  v_pk_mul_f32 v[206:207], v[206:207], v[8:9]
  v_cvt_pk_bf16_f32 v196, v196, v197
  v_cvt_pk_bf16_f32 v197, v198, v199
  v_cvt_pk_bf16_f32 v198, v204, v205
  v_cvt_pk_bf16_f32 v199, v206, v207
  buffer_store_dwordx4 v[196:199], v2, s[20:23], s70 offen offset:1024 sc1
  v_pk_mul_f32 v[208:209], v[208:209], v[6:7]
  v_pk_mul_f32 v[210:211], v[210:211], v[6:7]
  v_pk_mul_f32 v[216:217], v[216:217], v[6:7]
  v_pk_mul_f32 v[218:219], v[218:219], v[6:7]
  v_cvt_pk_bf16_f32 v208, v208, v209
  v_cvt_pk_bf16_f32 v209, v210, v211
  v_cvt_pk_bf16_f32 v210, v216, v217
  v_cvt_pk_bf16_f32 v211, v218, v219
  buffer_store_dwordx4 v[208:211], v2, s[20:23], s70 offen offset:2048 sc1
  v_pk_mul_f32 v[212:213], v[212:213], v[8:9]
  v_pk_mul_f32 v[214:215], v[214:215], v[8:9]
  v_pk_mul_f32 v[220:221], v[220:221], v[8:9]
  v_pk_mul_f32 v[222:223], v[222:223], v[8:9]
  v_cvt_pk_bf16_f32 v212, v212, v213
  v_cvt_pk_bf16_f32 v213, v214, v215
  v_cvt_pk_bf16_f32 v214, v220, v221
  v_cvt_pk_bf16_f32 v215, v222, v223
  buffer_store_dwordx4 v[212:215], v2, s[20:23], s70 offen offset:3072 sc1
  s_add_u32 s70, s70, 4096
  v_pk_mul_f32 v[224:225], v[224:225], v[6:7]
  v_pk_mul_f32 v[226:227], v[226:227], v[6:7]
  v_pk_mul_f32 v[232:233], v[232:233], v[6:7]
  v_pk_mul_f32 v[234:235], v[234:235], v[6:7]
  v_cvt_pk_bf16_f32 v224, v224, v225
  v_cvt_pk_bf16_f32 v225, v226, v227
  v_cvt_pk_bf16_f32 v226, v232, v233
  v_cvt_pk_bf16_f32 v227, v234, v235
  buffer_store_dwordx4 v[224:227], v2, s[20:23], s70 offen offset:0 sc1
  v_pk_mul_f32 v[228:229], v[228:229], v[8:9]
  v_pk_mul_f32 v[230:231], v[230:231], v[8:9]
  v_pk_mul_f32 v[236:237], v[236:237], v[8:9]
  v_pk_mul_f32 v[238:239], v[238:239], v[8:9]
  v_cvt_pk_bf16_f32 v228, v228, v229
  v_cvt_pk_bf16_f32 v229, v230, v231
  v_cvt_pk_bf16_f32 v230, v236, v237
  v_cvt_pk_bf16_f32 v231, v238, v239
  buffer_store_dwordx4 v[228:231], v2, s[20:23], s70 offen offset:1024 sc1
  v_pk_mul_f32 v[240:241], v[240:241], v[6:7]
  v_pk_mul_f32 v[242:243], v[242:243], v[6:7]
  v_pk_mul_f32 v[248:249], v[248:249], v[6:7]
  v_pk_mul_f32 v[250:251], v[250:251], v[6:7]
  v_cvt_pk_bf16_f32 v240, v240, v241
  v_cvt_pk_bf16_f32 v241, v242, v243
  v_cvt_pk_bf16_f32 v242, v248, v249
  v_cvt_pk_bf16_f32 v243, v250, v251
  buffer_store_dwordx4 v[240:243], v2, s[20:23], s70 offen offset:2048 sc1
  v_pk_mul_f32 v[244:245], v[244:245], v[8:9]
  v_pk_mul_f32 v[246:247], v[246:247], v[8:9]
  v_pk_mul_f32 v[252:253], v[252:253], v[8:9]
  v_pk_mul_f32 v[254:255], v[254:255], v[8:9]
  v_cvt_pk_bf16_f32 v244, v244, v245
  v_cvt_pk_bf16_f32 v245, v246, v247
  v_cvt_pk_bf16_f32 v246, v252, v253
  v_cvt_pk_bf16_f32 v247, v254, v255
  buffer_store_dwordx4 v[244:247], v2, s[20:23], s70 offen offset:3072 sc1
  s_branch L_pubr_85
L_rescale_000:
  s_nop 7
  v_max3_f32 v5, v32, v33, v34
  v_max3_f32 v5, v5, v35, v36
  v_max3_f32 v5, v5, v37, v38
  v_max_f32 v5, v5, v39
  v_max3_f32 v6, v40, v41, v42
  v_max3_f32 v6, v6, v43, v44
  v_max3_f32 v6, v6, v45, v46
  v_max_f32 v6, v6, v47
  v_mov_b32 v7, v5
  v_mov_b32 v8, v6
  s_nop 1
  v_permlane16_swap_b32 v5, v7
  v_permlane16_swap_b32 v6, v8
  v_max_f32 v5, v5, v7
  v_max_f32 v6, v6, v8
  v_mov_b32 v7, v5
  v_mov_b32 v8, v6
  s_nop 1
  v_permlane32_swap_b32 v5, v7
  v_permlane32_swap_b32 v6, v8
  v_max_f32 v5, v5, v7
  v_max_f32 v6, v6, v8
  v_max_f32 v5, 0, v5
  v_max_f32 v6, 0, v6
  v_exp_f32 v10, -v5
  v_exp_f32 v12, -v6
  v_sub_f32 v80, v80, v5
  v_sub_f32 v81, v81, v5
  v_sub_f32 v82, v82, v5
  v_sub_f32 v83, v83, v5
  v_sub_f32 v32, v32, v5
  v_sub_f32 v33, v33, v5
  v_sub_f32 v34, v34, v5
  v_sub_f32 v35, v35, v5
  v_sub_f32 v36, v36, v5
  v_sub_f32 v37, v37, v5
  v_sub_f32 v38, v38, v5
  v_sub_f32 v39, v39, v5
  v_sub_f32 v84, v84, v6
  v_sub_f32 v85, v85, v6
  v_sub_f32 v86, v86, v6
  v_sub_f32 v87, v87, v6
  v_sub_f32 v40, v40, v6
  v_sub_f32 v41, v41, v6
  v_sub_f32 v42, v42, v6
  v_sub_f32 v43, v43, v6
  v_sub_f32 v44, v44, v6
  v_sub_f32 v45, v45, v6
  v_sub_f32 v46, v46, v6
  v_sub_f32 v47, v47, v6
  v_mov_b32 v11, v10
  v_mul_f32 v96, v96, v10
  v_mov_b32 v13, v12
  v_mul_f32 v97, v97, v12
  v_pk_mul_f32 v[128:129], v[128:129], v[10:11]
  v_pk_mul_f32 v[130:131], v[130:131], v[10:11]
  v_pk_mul_f32 v[132:133], v[132:133], v[12:13]
  v_pk_mul_f32 v[134:135], v[134:135], v[12:13]
  v_pk_mul_f32 v[136:137], v[136:137], v[10:11]
  v_pk_mul_f32 v[138:139], v[138:139], v[10:11]
  v_pk_mul_f32 v[140:141], v[140:141], v[12:13]
  v_pk_mul_f32 v[142:143], v[142:143], v[12:13]
  v_pk_mul_f32 v[144:145], v[144:145], v[10:11]
  v_pk_mul_f32 v[146:147], v[146:147], v[10:11]
  v_pk_mul_f32 v[148:149], v[148:149], v[12:13]
  v_pk_mul_f32 v[150:151], v[150:151], v[12:13]
  v_pk_mul_f32 v[152:153], v[152:153], v[10:11]
  v_pk_mul_f32 v[154:155], v[154:155], v[10:11]
  v_pk_mul_f32 v[156:157], v[156:157], v[12:13]
  v_pk_mul_f32 v[158:159], v[158:159], v[12:13]
  v_pk_mul_f32 v[160:161], v[160:161], v[10:11]
  v_pk_mul_f32 v[162:163], v[162:163], v[10:11]
  v_pk_mul_f32 v[164:165], v[164:165], v[12:13]
  v_pk_mul_f32 v[166:167], v[166:167], v[12:13]
  v_pk_mul_f32 v[168:169], v[168:169], v[10:11]
  v_pk_mul_f32 v[170:171], v[170:171], v[10:11]
  v_pk_mul_f32 v[172:173], v[172:173], v[12:13]
  v_pk_mul_f32 v[174:175], v[174:175], v[12:13]
  v_pk_mul_f32 v[176:177], v[176:177], v[10:11]
  v_pk_mul_f32 v[178:179], v[178:179], v[10:11]
  v_pk_mul_f32 v[180:181], v[180:181], v[12:13]
  v_pk_mul_f32 v[182:183], v[182:183], v[12:13]
  v_pk_mul_f32 v[184:185], v[184:185], v[10:11]
  v_pk_mul_f32 v[186:187], v[186:187], v[10:11]
  v_pk_mul_f32 v[188:189], v[188:189], v[12:13]
  v_pk_mul_f32 v[190:191], v[190:191], v[12:13]
  v_exp_f32 v14, v32
  v_exp_f32 v15, v33
  v_exp_f32 v16, v34
  v_exp_f32 v17, v35
  v_exp_f32 v18, v36
  v_exp_f32 v19, v37
  v_exp_f32 v20, v38
  v_exp_f32 v21, v39
  s_nop 0
  v_cvt_pk_bf16_f32 v64, v14, v15
  v_cvt_pk_bf16_f32 v65, v16, v17
  v_cvt_pk_bf16_f32 v66, v18, v19
  v_cvt_pk_bf16_f32 v67, v20, v21
  v_exp_f32 v14, v40
  v_exp_f32 v15, v41
  v_exp_f32 v16, v42
  v_exp_f32 v17, v43
  v_exp_f32 v18, v44
  v_exp_f32 v19, v45
  v_exp_f32 v20, v46
  v_exp_f32 v21, v47
  s_nop 0
  v_cvt_pk_bf16_f32 v68, v14, v15
  v_cvt_pk_bf16_f32 v69, v16, v17
  v_cvt_pk_bf16_f32 v70, v18, v19
  v_cvt_pk_bf16_f32 v71, v20, v21
  s_nop 1
  v_mfma_f32_16x16x32_bf16 v[104:107], a[128:131], v[64:67], v[96:99]
  v_mfma_f32_16x16x32_bf16 v[104:107], a[132:135], v[68:71], v[104:107]
  s_nop 7
  s_setpc_b64 s[90:91]
L_rescale_110:
  s_nop 7
  v_max3_f32 v5, v48, v49, v50
  v_max3_f32 v5, v5, v51, v52
  v_max3_f32 v5, v5, v53, v54
  v_max_f32 v5, v5, v55
  v_max3_f32 v6, v56, v57, v58
  v_max3_f32 v6, v6, v59, v60
  v_max3_f32 v6, v6, v61, v62
  v_max_f32 v6, v6, v63
  v_mov_b32 v7, v5
  v_mov_b32 v8, v6
  s_nop 1
  v_permlane16_swap_b32 v5, v7
  v_permlane16_swap_b32 v6, v8
  v_max_f32 v5, v5, v7
  v_max_f32 v6, v6, v8
  v_mov_b32 v7, v5
  v_mov_b32 v8, v6
  s_nop 1
  v_permlane32_swap_b32 v5, v7
  v_permlane32_swap_b32 v6, v8
  v_max_f32 v5, v5, v7
  v_max_f32 v6, v6, v8
  v_max_f32 v5, 0, v5
  v_max_f32 v6, 0, v6
  v_exp_f32 v10, -v5
  v_exp_f32 v12, -v6
  v_sub_f32 v88, v88, v5
  v_sub_f32 v89, v89, v5
  v_sub_f32 v90, v90, v5
  v_sub_f32 v91, v91, v5
  v_sub_f32 v48, v48, v5
  v_sub_f32 v49, v49, v5
  v_sub_f32 v50, v50, v5
  v_sub_f32 v51, v51, v5
  v_sub_f32 v52, v52, v5
  v_sub_f32 v53, v53, v5
  v_sub_f32 v54, v54, v5
  v_sub_f32 v55, v55, v5
  v_sub_f32 v92, v92, v6
  v_sub_f32 v93, v93, v6
  v_sub_f32 v94, v94, v6
  v_sub_f32 v95, v95, v6
  v_sub_f32 v56, v56, v6
  v_sub_f32 v57, v57, v6
  v_sub_f32 v58, v58, v6
  v_sub_f32 v59, v59, v6
  v_sub_f32 v60, v60, v6
  v_sub_f32 v61, v61, v6
  v_sub_f32 v62, v62, v6
  v_sub_f32 v63, v63, v6
  v_mov_b32 v11, v10
  v_mul_f32 v100, v100, v10
  v_mov_b32 v13, v12
  v_mul_f32 v101, v101, v12
  v_pk_mul_f32 v[192:193], v[192:193], v[10:11]
  v_pk_mul_f32 v[194:195], v[194:195], v[10:11]
  v_pk_mul_f32 v[196:197], v[196:197], v[12:13]
  v_pk_mul_f32 v[198:199], v[198:199], v[12:13]
  v_pk_mul_f32 v[200:201], v[200:201], v[10:11]
  v_pk_mul_f32 v[202:203], v[202:203], v[10:11]
  v_pk_mul_f32 v[204:205], v[204:205], v[12:13]
  v_pk_mul_f32 v[206:207], v[206:207], v[12:13]
  v_pk_mul_f32 v[208:209], v[208:209], v[10:11]
  v_pk_mul_f32 v[210:211], v[210:211], v[10:11]
  v_pk_mul_f32 v[212:213], v[212:213], v[12:13]
  v_pk_mul_f32 v[214:215], v[214:215], v[12:13]
  v_pk_mul_f32 v[216:217], v[216:217], v[10:11]
  v_pk_mul_f32 v[218:219], v[218:219], v[10:11]
  v_pk_mul_f32 v[220:221], v[220:221], v[12:13]
  v_pk_mul_f32 v[222:223], v[222:223], v[12:13]
  v_pk_mul_f32 v[224:225], v[224:225], v[10:11]
  v_pk_mul_f32 v[226:227], v[226:227], v[10:11]
  v_pk_mul_f32 v[228:229], v[228:229], v[12:13]
  v_pk_mul_f32 v[230:231], v[230:231], v[12:13]
  v_pk_mul_f32 v[232:233], v[232:233], v[10:11]
  v_pk_mul_f32 v[234:235], v[234:235], v[10:11]
  v_pk_mul_f32 v[236:237], v[236:237], v[12:13]
  v_pk_mul_f32 v[238:239], v[238:239], v[12:13]
  v_pk_mul_f32 v[240:241], v[240:241], v[10:11]
  v_pk_mul_f32 v[242:243], v[242:243], v[10:11]
  v_pk_mul_f32 v[244:245], v[244:245], v[12:13]
  v_pk_mul_f32 v[246:247], v[246:247], v[12:13]
  v_pk_mul_f32 v[248:249], v[248:249], v[10:11]
  v_pk_mul_f32 v[250:251], v[250:251], v[10:11]
  v_pk_mul_f32 v[252:253], v[252:253], v[12:13]
  v_pk_mul_f32 v[254:255], v[254:255], v[12:13]
  v_exp_f32 v14, v48
  v_exp_f32 v15, v49
  v_exp_f32 v16, v50
  v_exp_f32 v17, v51
  v_exp_f32 v18, v52
  v_exp_f32 v19, v53
  v_exp_f32 v20, v54
  v_exp_f32 v21, v55
  s_nop 0
  v_cvt_pk_bf16_f32 v72, v14, v15
  v_cvt_pk_bf16_f32 v73, v16, v17
  v_cvt_pk_bf16_f32 v74, v18, v19
  v_cvt_pk_bf16_f32 v75, v20, v21
  v_exp_f32 v14, v56
  v_exp_f32 v15, v57
  v_exp_f32 v16, v58
  v_exp_f32 v17, v59
  v_exp_f32 v18, v60
  v_exp_f32 v19, v61
  v_exp_f32 v20, v62
  v_exp_f32 v21, v63
  s_nop 0
  v_cvt_pk_bf16_f32 v76, v14, v15
  v_cvt_pk_bf16_f32 v77, v16, v17
  v_cvt_pk_bf16_f32 v78, v18, v19
  v_cvt_pk_bf16_f32 v79, v20, v21
  s_nop 1
  v_mfma_f32_16x16x32_bf16 v[104:107], a[128:131], v[72:75], v[100:103]
  v_mfma_f32_16x16x32_bf16 v[104:107], a[132:135], v[76:79], v[104:107]
  s_nop 7
  s_setpc_b64 s[90:91]
L_rescale_001:
  s_nop 7
  v_max3_f32 v5, v32, v33, v34
  v_max3_f32 v5, v5, v35, v36
  v_max3_f32 v5, v5, v37, v38
  v_max_f32 v5, v5, v39
  v_max3_f32 v6, v40, v41, v42
  v_max3_f32 v6, v6, v43, v44
  v_max3_f32 v6, v6, v45, v46
  v_max_f32 v6, v6, v47
  v_mov_b32 v7, v5
  v_mov_b32 v8, v6
  s_nop 1
  v_permlane16_swap_b32 v5, v7
  v_permlane16_swap_b32 v6, v8
  v_max_f32 v5, v5, v7
  v_max_f32 v6, v6, v8
  v_mov_b32 v7, v5
  v_mov_b32 v8, v6
  s_nop 1
  v_permlane32_swap_b32 v5, v7
  v_permlane32_swap_b32 v6, v8
  v_max_f32 v5, v5, v7
  v_max_f32 v6, v6, v8
  v_max_f32 v5, 0, v5
  v_max_f32 v6, 0, v6
  v_exp_f32 v10, -v5
  v_exp_f32 v12, -v6
  v_sub_f32 v80, v80, v5
  v_sub_f32 v81, v81, v5
  v_sub_f32 v82, v82, v5
  v_sub_f32 v83, v83, v5
  v_sub_f32 v32, v32, v5
  v_sub_f32 v33, v33, v5
  v_sub_f32 v34, v34, v5
  v_sub_f32 v35, v35, v5
  v_sub_f32 v36, v36, v5
  v_sub_f32 v37, v37, v5
  v_sub_f32 v38, v38, v5
  v_sub_f32 v39, v39, v5
  v_sub_f32 v48, v48, v5
  v_sub_f32 v49, v49, v5
  v_sub_f32 v50, v50, v5
  v_sub_f32 v51, v51, v5
  v_sub_f32 v52, v52, v5
  v_sub_f32 v53, v53, v5
  v_sub_f32 v54, v54, v5
  v_sub_f32 v55, v55, v5
  v_sub_f32 v84, v84, v6
  v_sub_f32 v85, v85, v6
  v_sub_f32 v86, v86, v6
  v_sub_f32 v87, v87, v6
  v_sub_f32 v40, v40, v6
  v_sub_f32 v41, v41, v6
  v_sub_f32 v42, v42, v6
  v_sub_f32 v43, v43, v6
  v_sub_f32 v44, v44, v6
  v_sub_f32 v45, v45, v6
  v_sub_f32 v46, v46, v6
  v_sub_f32 v47, v47, v6
  v_sub_f32 v56, v56, v6
  v_sub_f32 v57, v57, v6
  v_sub_f32 v58, v58, v6
  v_sub_f32 v59, v59, v6
  v_sub_f32 v60, v60, v6
  v_sub_f32 v61, v61, v6
  v_sub_f32 v62, v62, v6
  v_sub_f32 v63, v63, v6
  v_mov_b32 v11, v10
  v_mul_f32 v96, v96, v10
  v_mov_b32 v13, v12
  v_mul_f32 v97, v97, v12
  v_pk_mul_f32 v[128:129], v[128:129], v[10:11]
  v_pk_mul_f32 v[130:131], v[130:131], v[10:11]
  v_pk_mul_f32 v[132:133], v[132:133], v[12:13]
  v_pk_mul_f32 v[134:135], v[134:135], v[12:13]
  v_pk_mul_f32 v[136:137], v[136:137], v[10:11]
  v_pk_mul_f32 v[138:139], v[138:139], v[10:11]
  v_pk_mul_f32 v[140:141], v[140:141], v[12:13]
  v_pk_mul_f32 v[142:143], v[142:143], v[12:13]
  v_pk_mul_f32 v[144:145], v[144:145], v[10:11]
  v_pk_mul_f32 v[146:147], v[146:147], v[10:11]
  v_pk_mul_f32 v[148:149], v[148:149], v[12:13]
  v_pk_mul_f32 v[150:151], v[150:151], v[12:13]
  v_pk_mul_f32 v[152:153], v[152:153], v[10:11]
  v_pk_mul_f32 v[154:155], v[154:155], v[10:11]
  v_pk_mul_f32 v[156:157], v[156:157], v[12:13]
  v_pk_mul_f32 v[158:159], v[158:159], v[12:13]
  v_pk_mul_f32 v[160:161], v[160:161], v[10:11]
  v_pk_mul_f32 v[162:163], v[162:163], v[10:11]
  v_pk_mul_f32 v[164:165], v[164:165], v[12:13]
  v_pk_mul_f32 v[166:167], v[166:167], v[12:13]
  v_pk_mul_f32 v[168:169], v[168:169], v[10:11]
  v_pk_mul_f32 v[170:171], v[170:171], v[10:11]
  v_pk_mul_f32 v[172:173], v[172:173], v[12:13]
  v_pk_mul_f32 v[174:175], v[174:175], v[12:13]
  v_pk_mul_f32 v[176:177], v[176:177], v[10:11]
  v_pk_mul_f32 v[178:179], v[178:179], v[10:11]
  v_pk_mul_f32 v[180:181], v[180:181], v[12:13]
  v_pk_mul_f32 v[182:183], v[182:183], v[12:13]
  v_pk_mul_f32 v[184:185], v[184:185], v[10:11]
  v_pk_mul_f32 v[186:187], v[186:187], v[10:11]
  v_pk_mul_f32 v[188:189], v[188:189], v[12:13]
  v_pk_mul_f32 v[190:191], v[190:191], v[12:13]
  v_exp_f32 v14, v32
  v_exp_f32 v15, v33
  v_exp_f32 v16, v34
  v_exp_f32 v17, v35
  v_exp_f32 v18, v36
  v_exp_f32 v19, v37
  v_exp_f32 v20, v38
  v_exp_f32 v21, v39
  s_nop 0
  v_cvt_pk_bf16_f32 v64, v14, v15
  v_cvt_pk_bf16_f32 v65, v16, v17
  v_cvt_pk_bf16_f32 v66, v18, v19
  v_cvt_pk_bf16_f32 v67, v20, v21
  v_exp_f32 v14, v40
  v_exp_f32 v15, v41
  v_exp_f32 v16, v42
  v_exp_f32 v17, v43
  v_exp_f32 v18, v44
  v_exp_f32 v19, v45
  v_exp_f32 v20, v46
  v_exp_f32 v21, v47
  s_nop 0
  v_cvt_pk_bf16_f32 v68, v14, v15
  v_cvt_pk_bf16_f32 v69, v16, v17
  v_cvt_pk_bf16_f32 v70, v18, v19
  v_cvt_pk_bf16_f32 v71, v20, v21
  s_nop 1
  v_mfma_f32_16x16x32_bf16 v[104:107], a[128:131], v[64:67], v[96:99]
  v_mfma_f32_16x16x32_bf16 v[104:107], a[132:135], v[68:71], v[104:107]
  v_exp_f32 v112, v48
  v_exp_f32 v113, v49
  v_exp_f32 v114, v50
  v_exp_f32 v115, v51
  v_exp_f32 v116, v56
  s_nop 7
  s_setpc_b64 s[90:91]
L_rescale_011:
  s_nop 7
  v_max3_f32 v5, v48, v49, v50
  v_max3_f32 v5, v5, v51, v52
  v_max3_f32 v5, v5, v53, v54
  v_max_f32 v5, v5, v55
  v_max3_f32 v6, v56, v57, v58
  v_max3_f32 v6, v6, v59, v60
  v_max3_f32 v6, v6, v61, v62
  v_max_f32 v6, v6, v63
  v_mov_b32 v7, v5
  v_mov_b32 v8, v6
  s_nop 1
  v_permlane16_swap_b32 v5, v7
  v_permlane16_swap_b32 v6, v8
  v_max_f32 v5, v5, v7
  v_max_f32 v6, v6, v8
  v_mov_b32 v7, v5
  v_mov_b32 v8, v6
  s_nop 1
  v_permlane32_swap_b32 v5, v7
  v_permlane32_swap_b32 v6, v8
  v_max_f32 v5, v5, v7
  v_max_f32 v6, v6, v8
  v_max_f32 v5, 0, v5
  v_max_f32 v6, 0, v6
  v_exp_f32 v10, -v5
  v_exp_f32 v12, -v6
  v_sub_f32 v80, v80, v5
  v_sub_f32 v81, v81, v5
  v_sub_f32 v82, v82, v5
  v_sub_f32 v83, v83, v5
  v_sub_f32 v48, v48, v5
  v_sub_f32 v49, v49, v5
  v_sub_f32 v50, v50, v5
  v_sub_f32 v51, v51, v5
  v_sub_f32 v52, v52, v5
  v_sub_f32 v53, v53, v5
  v_sub_f32 v54, v54, v5
  v_sub_f32 v55, v55, v5
  v_sub_f32 v32, v32, v5
  v_sub_f32 v33, v33, v5
  v_sub_f32 v34, v34, v5
  v_sub_f32 v35, v35, v5
  v_sub_f32 v36, v36, v5
  v_sub_f32 v37, v37, v5
  v_sub_f32 v38, v38, v5
  v_sub_f32 v39, v39, v5
  v_sub_f32 v84, v84, v6
  v_sub_f32 v85, v85, v6
  v_sub_f32 v86, v86, v6
  v_sub_f32 v87, v87, v6
  v_sub_f32 v56, v56, v6
  v_sub_f32 v57, v57, v6
  v_sub_f32 v58, v58, v6
  v_sub_f32 v59, v59, v6
  v_sub_f32 v60, v60, v6
  v_sub_f32 v61, v61, v6
  v_sub_f32 v62, v62, v6
  v_sub_f32 v63, v63, v6
  v_sub_f32 v40, v40, v6
  v_sub_f32 v41, v41, v6
  v_sub_f32 v42, v42, v6
  v_sub_f32 v43, v43, v6
  v_sub_f32 v44, v44, v6
  v_sub_f32 v45, v45, v6
  v_sub_f32 v46, v46, v6
  v_sub_f32 v47, v47, v6
  v_mov_b32 v11, v10
  v_mul_f32 v96, v96, v10
  v_mov_b32 v13, v12
  v_mul_f32 v97, v97, v12
  v_pk_mul_f32 v[128:129], v[128:129], v[10:11]
  v_pk_mul_f32 v[130:131], v[130:131], v[10:11]
  v_pk_mul_f32 v[132:133], v[132:133], v[12:13]
  v_pk_mul_f32 v[134:135], v[134:135], v[12:13]
  v_pk_mul_f32 v[136:137], v[136:137], v[10:11]
  v_pk_mul_f32 v[138:139], v[138:139], v[10:11]
  v_pk_mul_f32 v[140:141], v[140:141], v[12:13]
  v_pk_mul_f32 v[142:143], v[142:143], v[12:13]
  v_pk_mul_f32 v[144:145], v[144:145], v[10:11]
  v_pk_mul_f32 v[146:147], v[146:147], v[10:11]
  v_pk_mul_f32 v[148:149], v[148:149], v[12:13]
  v_pk_mul_f32 v[150:151], v[150:151], v[12:13]
  v_pk_mul_f32 v[152:153], v[152:153], v[10:11]
  v_pk_mul_f32 v[154:155], v[154:155], v[10:11]
  v_pk_mul_f32 v[156:157], v[156:157], v[12:13]
  v_pk_mul_f32 v[158:159], v[158:159], v[12:13]
  v_pk_mul_f32 v[160:161], v[160:161], v[10:11]
  v_pk_mul_f32 v[162:163], v[162:163], v[10:11]
  v_pk_mul_f32 v[164:165], v[164:165], v[12:13]
  v_pk_mul_f32 v[166:167], v[166:167], v[12:13]
  v_pk_mul_f32 v[168:169], v[168:169], v[10:11]
  v_pk_mul_f32 v[170:171], v[170:171], v[10:11]
  v_pk_mul_f32 v[172:173], v[172:173], v[12:13]
  v_pk_mul_f32 v[174:175], v[174:175], v[12:13]
  v_pk_mul_f32 v[176:177], v[176:177], v[10:11]
  v_pk_mul_f32 v[178:179], v[178:179], v[10:11]
  v_pk_mul_f32 v[180:181], v[180:181], v[12:13]
  v_pk_mul_f32 v[182:183], v[182:183], v[12:13]
  v_pk_mul_f32 v[184:185], v[184:185], v[10:11]
  v_pk_mul_f32 v[186:187], v[186:187], v[10:11]
  v_pk_mul_f32 v[188:189], v[188:189], v[12:13]
  v_pk_mul_f32 v[190:191], v[190:191], v[12:13]
  v_exp_f32 v14, v48
  v_exp_f32 v15, v49
  v_exp_f32 v16, v50
  v_exp_f32 v17, v51
  v_exp_f32 v18, v52
  v_exp_f32 v19, v53
  v_exp_f32 v20, v54
  v_exp_f32 v21, v55
  s_nop 0
  v_cvt_pk_bf16_f32 v72, v14, v15
  v_cvt_pk_bf16_f32 v73, v16, v17
  v_cvt_pk_bf16_f32 v74, v18, v19
  v_cvt_pk_bf16_f32 v75, v20, v21
  v_exp_f32 v14, v56
  v_exp_f32 v15, v57
  v_exp_f32 v16, v58
  v_exp_f32 v17, v59
  v_exp_f32 v18, v60
  v_exp_f32 v19, v61
  v_exp_f32 v20, v62
  v_exp_f32 v21, v63
  s_nop 0
  v_cvt_pk_bf16_f32 v76, v14, v15
  v_cvt_pk_bf16_f32 v77, v16, v17
  v_cvt_pk_bf16_f32 v78, v18, v19
  v_cvt_pk_bf16_f32 v79, v20, v21
  s_nop 1
  v_mfma_f32_16x16x32_bf16 v[104:107], a[128:131], v[72:75], v[96:99]
  v_mfma_f32_16x16x32_bf16 v[104:107], a[132:135], v[76:79], v[104:107]
  v_exp_f32 v112, v32
  v_exp_f32 v113, v33
  v_exp_f32 v114, v34
  v_exp_f32 v115, v35
  v_exp_f32 v116, v40
  s_nop 7
  s_setpc_b64 s[90:91]
L_wb_8:
  buffer_wbl2 sc1
  s_waitcnt vmcnt(0)
  s_branch L_back_9
L_wb_15:
  buffer_wbl2 sc1
  s_waitcnt vmcnt(0)
  s_branch L_back_16
L_spin_3:
  s_mov_b32 s96, 0
L_again_116:
  s_sleep 4
  v_min_u32 v29, 27, v1
  v_lshlrev_b32 v29, 2, v29
  global_load_dword v29, v29, s[66:67] sc1
  s_waitcnt vmcnt(0)
  v_cmp_ne_u32 vcc, 1, v29
  s_add_u32 s96, s96, 1
  s_cbranch_vccz L_back_4
  s_cmp_lt_u32 s96, 1048576
  s_cbranch_scc1 L_again_116
  s_branch L_back_4
L_spin_6:
  s_mov_b32 s96, 0
L_again_117:
  s_sleep 4
  v_min_u32 v29, 27, v1
  v_lshlrev_b32 v29, 2, v29
  global_load_dword v29, v29, s[66:67] sc1
  s_waitcnt vmcnt(0)
  v_cmp_ne_u32 vcc, 1, v29
  s_add_u32 s96, s96, 1
  s_cbranch_vccz L_back_7
  s_cmp_lt_u32 s96, 1048576
  s_cbranch_scc1 L_again_117
  s_branch L_back_7
L_spin_10:
  s_mov_b32 s96, 0
L_again_118:
  s_sleep 4
  s_mov_b32 s72, 58195968
  buffer_load_dwordx4 v[116:119], v113, s[20:23], s72 offen sc1
  s_waitcnt vmcnt(0)
  v_and_b32 v116, v116, v117
  v_and_b32 v118, v118, v119
  v_and_b32 v116, v116, v118
  v_and_b32 v116, 1, v116
  v_cmp_ne_u32 vcc, 1, v116
  s_add_u32 s96, s96, 1
  s_cbranch_vccz L_back_11
  s_cmp_lt_u32 s96, 1048576
  s_cbranch_scc1 L_again_118
  s_branch L_back_11
L_spin_12:
  s_mov_b32 s96, 0
L_again_119:
  s_sleep 4
  s_mov_b32 s72, 58208256
  buffer_load_dwordx4 v[80:83], v2, s[20:23], s72 offen offset:0 sc1
  buffer_load_dwordx4 v[84:87], v2, s[20:23], s72 offen offset:1024 sc1
  buffer_load_dwordx4 v[88:91], v2, s[20:23], s72 offen offset:2048 sc1
  buffer_load_dwordx4 v[92:95], v2, s[20:23], s72 offen offset:3072 sc1
  s_waitcnt vmcnt(0)
  v_min_u32 v112, v80, v81
  v_min3_u32 v112, v112, v82, v83
  v_min3_u32 v112, v112, v84, v85
  v_min3_u32 v112, v112, v86, v87
  v_min3_u32 v112, v112, v88, v89
  v_min3_u32 v112, v112, v90, v91
  v_min3_u32 v112, v112, v92, v93
  v_min3_u32 v112, v112, v94, v95
  v_cmp_eq_u32 vcc, 0, v112
  s_add_u32 s96, s96, 1
  s_cbranch_vccz L_back_13
  s_cmp_lt_u32 s96, 1048576
  s_cbranch_scc1 L_again_119
  s_branch L_back_13
L_spin_17:
  s_mov_b32 s96, 0
L_again_120:
  s_sleep 4
  v_and_b32 v127, 31, v1
  v_lshlrev_b32 v127, 2, v127
  s_and_b32 s71, s100, 0xffffff80
  s_add_u32 s71, s71, 8192
  buffer_load_dword v127, v127, s[20:23], s71 offen sc1
  s_waitcnt vmcnt(0)
  v_cmp_ne_u32 vcc, 1, v127
  s_add_u32 s96, s96, 1
  s_cbranch_vccz L_back_18
  s_cmp_lt_u32 s96, 1048576
  s_cbranch_scc1 L_again_120
  s_branch L_back_18
L_spin_97:
  s_mov_b32 s96, 0
L_again_121:
  s_sleep 4
  buffer_load_dword v125, v124, s[20:23], 0 offen sc1
  s_waitcnt vmcnt(0)
  v_cmp_ne_u32 vcc, 1, v125
  s_add_u32 s96, s96, 1
  s_cbranch_vccz L_back_98
  s_cmp_lt_u32 s96, 1048576
  s_cbranch_scc1 L_again_121
  s_branch L_back_98
L_spin_100:
  s_mov_b32 s96, 0
L_again_122:
  s_sleep 4
  s_mov_b32 s72, 58216448
  buffer_load_dwordx4 v[24:27], v126, s[20:23], s72 offen sc1
  s_waitcnt vmcnt(0)
  v_and_b32 v24, v24, v25
  v_and_b32 v26, v26, v27
  v_and_b32 v24, v24, v26
  v_and_b32 v24, 1, v24
  v_cmp_ne_u32 vcc, 1, v24
  s_add_u32 s96, s96, 1
  s_cbranch_vccz L_back_101
  s_cmp_lt_u32 s96, 1048576
  s_cbranch_scc1 L_again_122
  s_branch L_back_101
L_spin_108:
  s_mov_b32 s96, 0
L_again_123:
  s_sleep 4
  s_mov_b32 s72, 58228736
  buffer_load_dword v24, v29, s[20:23], s72 offen sc1
  s_waitcnt vmcnt(0)
  v_and_b32 v24, 1, v24
  v_cmp_ne_u32 vcc, 1, v24
  s_add_u32 s96, s96, 1
  s_cbranch_vccz L_back_109
  s_cmp_lt_u32 s96, 1048576
  s_cbranch_scc1 L_again_123
  s_branch L_back_109
L_spin_112:
  s_mov_b32 s96, 0
L_again_124:
  s_sleep 4
  s_mov_b32 s72, 58228736
  buffer_load_dword v24, v29, s[20:23], s72 offen sc1
  s_waitcnt vmcnt(0)
  v_and_b32 v24, 3, v24
  v_cmp_ne_u32 vcc, 3, v24
  s_add_u32 s96, s96, 1
  s_cbranch_vccz L_back_113
  s_cmp_lt_u32 s96, 1048576
  s_cbranch_scc1 L_again_124
  s_branch L_back_113
L_code_end:
.section .rodata,"a"
.p2align 6
.amdhsa_kernel gated_mix__compressed_kv_cla__moe_arch_mod__prompt_kernel
  .amdhsa_next_free_vgpr 512
  .amdhsa_next_free_sgpr 102
  .amdhsa_accum_offset 256
  .amdhsa_group_segment_fixed_size 0
  .amdhsa_kernarg_size 120
  .amdhsa_user_sgpr_count 2
  .amdhsa_user_sgpr_kernarg_segment_ptr 1
  .amdhsa_system_sgpr_workgroup_id_x 1
.end_amdhsa_kernel
```
